```python
import torch

def _softmax(x, axis=-1):
    return torch.softmax(x, dim=axis)

def _gelu(x):
    return torch.nn.functional.gelu(x, approximate='tanh')

def _silu(x):
    return torch.nn.functional.silu(x)

def _sigmoid(x):
    return torch.sigmoid(x)

def _layernorm(x, axis=-1, eps=1e-05):
    m = x.mean(dim=axis, keepdim=True)
    v = x.var(dim=axis, keepdim=True, unbiased=False)
    return (x - m) / torch.sqrt(v + eps)

def _scatter_add(tgt, idx, src, axis=0):
    return tgt.clone().index_add_(axis, idx, src)

def _segment_sum(src, seg, n):
    out = torch.zeros((n,) + src.shape[1:], dtype=src.dtype)
    return out.index_add_(0, seg, src)

def _pad(x, pw):
    flat = tuple((v for pair in reversed(pw) for v in pair))
    return torch.nn.functional.pad(x, flat)
kernel_name = 'concat_heads__mha_block__memory_aug_recurrent_mem_tr__prompt'

def setup_inputs():

    _w = lambda a: (lambda t: t.to(torch.bfloat16) if t.is_floating_point() else t)(torch.as_tensor(a))

    def _A_setup():
        B, S, D, H = (1, 2048, 576, 32)
        return {'x': _w((lambda *s: torch.randn(*s, dtype=torch.bfloat16) * 0.2)(B, S, D)), 'wqkv': _w((lambda *s: torch.randn(*s, dtype=torch.bfloat16) * 0.2)(D, 3 * D)), 'wo': _w((lambda *s: torch.randn(*s, dtype=torch.bfloat16) * 0.05)(D, D))}
    _A_in = _A_setup()

    def _B_setup():
        B, S, Dm = (1, 2048, 576)
        H, Dh = (32, 128)
        M, seg = (8, 32)
        seg = min(seg, S)
        S = S // seg * seg
        return {'x': _w((lambda *s: torch.randn(*s, dtype=torch.bfloat16) * 0.05)(B, S, Dm)), 'mem0': _w((lambda *s: torch.randn(*s, dtype=torch.bfloat16) * 0.8)(B, M, Dm)), 'Wq': _w((lambda *s: torch.randn(*s, dtype=torch.bfloat16) * 1.6)(Dm, H, Dh) * Dm ** (-0.5)), 'Wk': _w((lambda *s: torch.randn(*s, dtype=torch.bfloat16) * 1.6)(Dm, H, Dh) * Dm ** (-0.5)), 'Wv': _w((lambda *s: torch.randn(*s, dtype=torch.bfloat16) * 0.8)(Dm, H, Dh) * Dm ** (-0.5)), 'Wo': _w((lambda *s: torch.randn(*s, dtype=torch.bfloat16) * 0.8)(H, Dh, Dm) * (H * Dh) ** (-0.5)), 'seg_len': seg}
    _B_in = _B_setup()
    return {'A_x': _A_in['x'], 'A_wqkv': _A_in['wqkv'], 'A_wo': _A_in['wo'], 'B_x': _B_in['x'], 'B_mem0': _B_in['mem0'], 'B_Wq': _B_in['Wq'], 'B_Wk': _B_in['Wk'], 'B_Wv': _B_in['Wv'], 'B_Wo': _B_in['Wo'], 'B_seg_len': _B_in['seg_len']}

def reference(A_x, A_wqkv, A_wo, B_x, B_mem0, B_Wq, B_Wk, B_Wv, B_Wo, B_seg_len):

    def _A_ref(x, wqkv, wo):
        B, S, D = x.shape
        H = 32
        Dh = D // H
        qkv = (lambda x, *d: x.permute(*d))((x @ wqkv).reshape(B, S, 3, H, Dh), 2, 0, 3, 1, 4)
        q, k, v = (qkv[0], qkv[1], qkv[2])
        scores = torch.einsum('bhqd,bhkd->bhqk', q, k) * Dh ** (-0.5)
        p = _softmax(scores, axis=-1)
        o = torch.einsum('bhqk,bhkd->bhqd', p, v)
        return (lambda x, *d: x.permute(*d))(o, 0, 2, 1, 3).reshape(B, S, D) @ wo

    def _B_ref(x, mem0, Wq, Wk, Wv, Wo, seg_len):
        B, S, Dm = x.shape
        H, Dh = (Wq.shape[1], Wq.shape[2])
        M = mem0.shape[1]
        scale = Dh ** (-0.5)
        n_seg = S // seg_len
        L = M + seg_len
        idx = torch.arange(L)
        mask = (idx[:, None] < M) | (idx[:, None] >= idx[None, :])
        mem = mem0
        outs = []
        for s in range(n_seg):
            xs = x[:, s * seg_len:(s + 1) * seg_len, :].clone()
            h = torch.concatenate([mem, xs], axis=1)
            q = torch.einsum('btd,dhe->bhte', h, Wq)
            k = torch.einsum('btd,dhe->bhte', h, Wk)
            v = torch.einsum('btd,dhe->bhte', h, Wv)
            scores = torch.einsum('bhqe,bhke->bhqk', q, k) * scale
            scores = torch.where(mask[None, None], scores, -1000000000.0)
            p = _softmax(scores, axis=-1)
            o = torch.einsum('bhqk,bhke->bhqe', p, v)
            o = torch.einsum('bhte,hed->btd', o, Wo)
            mem = o[:, :M, :].clone()
            outs.append(o[:, M:, :])
        return torch.concatenate(outs, axis=1)
    a = _A_ref(A_x, A_wqkv, A_wo)
    b = _B_ref(B_x, B_mem0, B_Wq, B_Wk, B_Wv, B_Wo, B_seg_len)
    return torch.concatenate([a, b], axis=-1)
```

```asm
; @launch grid=(256,1,1) block=(256,1,1) lds=163840
.amdgcn_target "amdgcn-amd-amdhsa--gfx950"
.text
.globl concat_heads__mha_block__memory_aug_recurrent_mem_tr__prompt_kernel
.p2align 8
.type concat_heads__mha_block__memory_aug_recurrent_mem_tr__prompt_kernel,@function
concat_heads__mha_block__memory_aug_recurrent_mem_tr__prompt_kernel:
    s_cmp_ge_u32 s2, 256
    s_cbranch_scc1 L_exit
    s_load_dwordx16 s[32:47], s[0:1], 0
    s_load_dwordx8 s[48:55], s[0:1], 64
    s_load_dwordx2 s[56:57], s[0:1], 96
    s_getreg_b32 s3, hwreg(HW_REG_XCC_ID, 0, 4)
    s_and_b32 s3, s3, 7
    v_lshrrev_b32 v1, 6, v0
    s_and_b32 s5, s2, 7
    s_lshr_b32 s6, s2, 3
    v_readfirstlane_b32 s4, v1
    s_mov_b32 s58, 16384
    s_mov_b32 s7, 0
    s_waitcnt lgkmcnt(0)
    s_mov_b32 s8, s56
    s_mov_b32 s9, s57
    s_mov_b32 s10, 268435456
    s_mov_b32 s11, 0x00020000
    s_mov_b32 s12, s54
    s_mov_b32 s13, s55
    s_mov_b32 s14, 256
    s_mov_b32 s15, 0x00020000
    v_mov_b32 v4, 0
    v_mov_b32 v5, 0
    v_mov_b32 v6, 0
    v_mov_b32 v7, 0
    v_mov_b32 v8, -1
    v_mov_b32 v9, -1
    v_mov_b32 v10, -1
    v_mov_b32 v11, -1
    v_lshlrev_b32 v2, 4, v0
    s_lshl_b32 s60, s2, 7
    s_add_u32 s60, s60, 0
    s_mul_i32 s61, s2, 2432
    s_add_u32 s61, s61, 65536
    v_cmp_gt_u32 vcc, 8, v0
    s_and_saveexec_b64 s[62:63], vcc
    buffer_store_dwordx4 v[4:7], v2, s[8:11], s60 offen sc1
    s_mov_b64 exec, s[62:63]
    v_cmp_gt_u32 vcc, 152, v0
    s_and_saveexec_b64 s[62:63], vcc
    buffer_store_dwordx4 v[8:11], v2, s[8:11], s61 offen sc1
    s_mov_b64 exec, s[62:63]
    s_cmp_eq_u32 s5, 0
    s_cbranch_scc1 L_chain
    s_cmp_lt_u32 s5, 4
    s_cbranch_scc1 L_xrole
    s_waitcnt vmcnt(0)
    s_barrier
    s_cmp_lg_u32 s4, 0
    s_cbranch_scc1 L_noann_1
    s_lshl_b32 s60, s3, 3
    s_lshl_b64 s[62:63], 1, s60
    v_mov_b32 v4, s62
    v_mov_b32 v5, s63
    s_lshl_b32 s60, s5, 5
    s_mov_b64 exec, 1
    buffer_atomic_add_x2 v[4:5], off, s[12:15], s60 sc1
    s_mov_b64 exec, -1
L_noann_1:
    s_cmp_eq_u32 s5, 0
    s_cbranch_scc1 L_chain
    s_cmp_lt_u32 s5, 4
    s_cbranch_scc1 L_xrole
    s_branch L_arole
L_chain:
    v_and_b32 v1, 63, v0
    v_and_b32 v2, 15, v0
    v_lshrrev_b32 v3, 4, v1
    v_and_b32 v40, 1, v3
    v_lshlrev_b32 v40, 1, v40
    v_xor_b32 v40, v40, v2
    v_lshlrev_b32 v41, 13, v3
    v_xor_b32 v32, 0, v40
    v_lshl_add_u32 v32, v32, 4, v41
    v_xor_b32 v33, 4, v40
    v_lshl_add_u32 v33, v33, 4, v41
    v_xor_b32 v34, 8, v40
    v_lshl_add_u32 v34, v34, 4, v41
    v_xor_b32 v35, 12, v40
    v_lshl_add_u32 v35, v35, 4, v41
    v_lshrrev_b32 v40, 3, v1
    v_and_b32 v41, 7, v1
    v_lshrrev_b32 v42, 2, v40
    v_lshlrev_b32 v42, 1, v42
    v_xor_b32 v41, v41, v42
    s_movk_i32 s60, 1152
    v_mul_lo_u32 v40, v40, s60
    v_xor_b32 v36, 0, v41
    v_lshl_add_u32 v36, v36, 4, v40
    v_xor_b32 v37, 4, v41
    v_lshl_add_u32 v37, v37, 4, v40
    v_xor_b32 v38, 0, v41
    v_lshl_add_u32 v38, v38, 4, v40
    v_xor_b32 v39, 4, v41
    v_lshl_add_u32 v39, v39, 4, v40
    v_lshrrev_b32 v40, 2, v2
    v_and_b32 v41, 1, v40
    v_lshrrev_b32 v42, 1, v40
    v_and_b32 v43, 1, v3
    v_lshrrev_b32 v44, 1, v3
    v_lshlrev_b32 v45, 4, v44
    v_lshl_add_u32 v45, v43, 2, v45
    v_add_u32 v45, v45, v41
    v_lshl_add_u32 v45, v42, 3, v45
    v_lshl_add_u32 v46, v42, 1, v43
    v_bfe_u32 v47, v2, 1, 1
    v_and_b32 v48, 1, v2
    v_lshlrev_b32 v48, 3, v48
    v_lshlrev_b32 v49, 2, v46
    v_lshl_add_u32 v49, v41, 1, v49
    s_lshl_b32 s60, s4, 2
    v_add_u32 v50, s60, v47
    v_lshl_add_u32 v51, v45, 8, v48
    v_add_u32 v52, 0, v50
    v_xor_b32 v52, v52, v49
    v_lshl_add_u32 v20, v52, 4, v51
    v_add_u32 v52, 2, v50
    v_xor_b32 v52, v52, v49
    v_lshl_add_u32 v21, v52, 4, v51
    v_lshlrev_b32 v49, 1, v46
    s_lshl_b32 s60, s4, 1
    v_add_u32 v50, s60, v47
    v_xor_b32 v50, v50, v49
    v_lshl_add_u32 v51, v45, 7, v48
    v_lshl_add_u32 v22, v50, 4, v51
    v_and_b32 v40, 1, v3
    v_lshlrev_b32 v40, 1, v40
    v_xor_b32 v40, v40, v2
    s_movk_i32 s60, 1152
    v_mul_lo_u32 v41, v3, s60
    v_xor_b32 v68, 0, v40
    v_lshl_add_u32 v68, v68, 4, v41
    v_xor_b32 v69, 4, v40
    v_lshl_add_u32 v69, v69, 4, v41
    v_xor_b32 v70, 8, v40
    v_lshl_add_u32 v70, v70, 4, v41
    v_xor_b32 v71, 12, v40
    v_lshl_add_u32 v71, v71, 4, v41
    v_lshrrev_b32 v40, 2, v2
    v_and_b32 v41, 1, v40
    v_lshrrev_b32 v42, 1, v40
    v_and_b32 v43, 1, v3
    v_lshrrev_b32 v44, 1, v3
    v_lshlrev_b32 v45, 3, v44
    v_lshl_add_u32 v45, v43, 2, v45
    v_add_u32 v45, v45, v41
    v_bfe_u32 v46, v2, 1, 1
    v_lshl_add_u32 v46, v42, 3, v46
    s_lshl_b32 s60, s4, 1
    v_add_u32 v46, s60, v46
    v_lshlrev_b32 v47, 2, v3
    v_lshl_add_u32 v47, v41, 1, v47
    v_xor_b32 v46, v46, v47
    v_and_b32 v48, 1, v2
    v_lshlrev_b32 v48, 3, v48
    v_lshl_add_u32 v48, v45, 8, v48
    v_lshl_add_u32 v28, v46, 4, v48
    s_lshl_b32 s65, s4, 12
    s_lshl_b32 s66, s6, 8
    s_lshl_b32 s67, s4, 17
    s_add_u32 s66, s66, s67
    s_mul_i32 s67, s6, 147456
    s_mul_i32 s68, s4, 36864
    s_add_u32 s68, s68, s67
    s_mul_i32 s69, s4, 18432
    s_add_u32 s67, s67, s69
    s_mov_b32 s16, s42
    s_mov_b32 s17, s43
    s_mov_b32 s18, 4718592
    s_mov_b32 s19, 0x00020000
    s_mov_b32 s20, s44
    s_mov_b32 s21, s45
    s_mov_b32 s22, 4718592
    s_mov_b32 s23, 0x00020000
    s_mov_b32 s24, s48
    s_mov_b32 s25, s49
    s_mov_b32 s26, 4718592
    s_mov_b32 s27, 0x00020000
    s_mov_b32 s28, s46
    s_mov_b32 s29, s47
    s_mov_b32 s30, 4718592
    s_mov_b32 s31, 0x00020000
    v_lshlrev_b32 v4, 4, v1
    s_lshl_b32 s60, s4, 12
    v_add_u32 v26, s60, v4
    s_add_u32 m0, s65, 0
    s_add_u32 s64, s66, 0
    buffer_load_dwordx4 v32, s[16:19], s64 offen lds
    s_add_u32 m0, s65, 1024
    s_add_u32 s64, s66, 32768
    buffer_load_dwordx4 v33, s[16:19], s64 offen lds
    s_add_u32 m0, s65, 2048
    s_add_u32 s64, s66, 65536
    buffer_load_dwordx4 v34, s[16:19], s64 offen lds
    s_add_u32 m0, s65, 3072
    s_add_u32 s64, s66, 98304
    buffer_load_dwordx4 v35, s[16:19], s64 offen lds
    s_add_u32 m0, s65, 16384
    s_add_u32 s64, s66, 524288
    buffer_load_dwordx4 v32, s[16:19], s64 offen lds
    s_add_u32 m0, s65, 17408
    s_add_u32 s64, s66, 557056
    buffer_load_dwordx4 v33, s[16:19], s64 offen lds
    s_add_u32 m0, s65, 18432
    s_add_u32 s64, s66, 589824
    buffer_load_dwordx4 v34, s[16:19], s64 offen lds
    s_add_u32 m0, s65, 19456
    s_add_u32 s64, s66, 622592
    buffer_load_dwordx4 v35, s[16:19], s64 offen lds
    s_add_u32 m0, s65, 32768
    s_add_u32 s64, s66, 1048576
    buffer_load_dwordx4 v32, s[16:19], s64 offen lds
    s_add_u32 m0, s65, 33792
    s_add_u32 s64, s66, 1081344
    buffer_load_dwordx4 v33, s[16:19], s64 offen lds
    s_add_u32 m0, s65, 34816
    s_add_u32 s64, s66, 1114112
    buffer_load_dwordx4 v34, s[16:19], s64 offen lds
    s_add_u32 m0, s65, 35840
    s_add_u32 s64, s66, 1146880
    buffer_load_dwordx4 v35, s[16:19], s64 offen lds
    s_add_u32 m0, s65, 49152
    s_add_u32 s64, s66, 1572864
    buffer_load_dwordx4 v32, s[16:19], s64 offen lds
    s_add_u32 m0, s65, 50176
    s_add_u32 s64, s66, 1605632
    buffer_load_dwordx4 v33, s[16:19], s64 offen lds
    s_add_u32 m0, s65, 51200
    s_add_u32 s64, s66, 1638400
    buffer_load_dwordx4 v34, s[16:19], s64 offen lds
    s_add_u32 m0, s65, 52224
    s_add_u32 s64, s66, 1671168
    buffer_load_dwordx4 v35, s[16:19], s64 offen lds
    s_add_u32 m0, s65, 65536
    s_add_u32 s64, s66, 2097152
    buffer_load_dwordx4 v32, s[16:19], s64 offen lds
    s_add_u32 m0, s65, 66560
    s_add_u32 s64, s66, 2129920
    buffer_load_dwordx4 v33, s[16:19], s64 offen lds
    s_add_u32 m0, s65, 67584
    s_add_u32 s64, s66, 2162688
    buffer_load_dwordx4 v34, s[16:19], s64 offen lds
    s_add_u32 m0, s65, 68608
    s_add_u32 s64, s66, 2195456
    buffer_load_dwordx4 v35, s[16:19], s64 offen lds
    s_add_u32 m0, s65, 81920
    s_add_u32 s64, s66, 2621440
    buffer_load_dwordx4 v32, s[16:19], s64 offen lds
    s_add_u32 m0, s65, 82944
    s_add_u32 s64, s66, 2654208
    buffer_load_dwordx4 v33, s[16:19], s64 offen lds
    s_add_u32 m0, s65, 83968
    s_add_u32 s64, s66, 2686976
    buffer_load_dwordx4 v34, s[16:19], s64 offen lds
    s_add_u32 m0, s65, 84992
    s_add_u32 s64, s66, 2719744
    buffer_load_dwordx4 v35, s[16:19], s64 offen lds
    s_add_u32 m0, s65, 98304
    s_add_u32 s64, s66, 3145728
    buffer_load_dwordx4 v32, s[16:19], s64 offen lds
    s_add_u32 m0, s65, 99328
    s_add_u32 s64, s66, 3178496
    buffer_load_dwordx4 v33, s[16:19], s64 offen lds
    s_add_u32 m0, s65, 100352
    s_add_u32 s64, s66, 3211264
    buffer_load_dwordx4 v34, s[16:19], s64 offen lds
    s_add_u32 m0, s65, 101376
    s_add_u32 s64, s66, 3244032
    buffer_load_dwordx4 v35, s[16:19], s64 offen lds
    s_add_u32 m0, s65, 114688
    s_add_u32 s64, s66, 3670016
    buffer_load_dwordx4 v32, s[16:19], s64 offen lds
    s_add_u32 m0, s65, 115712
    s_add_u32 s64, s66, 3702784
    buffer_load_dwordx4 v33, s[16:19], s64 offen lds
    s_add_u32 m0, s65, 116736
    s_add_u32 s64, s66, 3735552
    buffer_load_dwordx4 v34, s[16:19], s64 offen lds
    s_add_u32 m0, s65, 117760
    s_add_u32 s64, s66, 3768320
    buffer_load_dwordx4 v35, s[16:19], s64 offen lds
    v_and_b32 v40, 7, v2
    v_lshrrev_b32 v41, 3, v2
    v_and_b32 v42, 1, v3
    v_lshrrev_b32 v43, 1, v3
    v_mov_b32 v5, 0x4444
    v_mov_b32 v44, 0xeeee
    v_cmp_eq_u32 vcc, 1, v41
    s_nop 1
    v_cndmask_b32 v5, v5, v44, vcc
    v_lshlrev_b32 v44, 2, v42
    v_sub_u32 v44, v40, v44
    v_mov_b32 v45, 0x3f80
    v_mov_b32 v46, 0x3f800000
    v_mov_b32 v6, 0
    v_cmp_eq_u32 vcc, 0, v44
    s_nop 1
    v_cndmask_b32 v6, v6, v45, vcc
    v_cmp_eq_u32 vcc, 1, v44
    s_nop 1
    v_cndmask_b32 v6, v6, v46, vcc
    v_mov_b32 v7, 0
    v_cmp_eq_u32 vcc, 2, v44
    s_nop 1
    v_cndmask_b32 v7, v7, v45, vcc
    v_cmp_eq_u32 vcc, 3, v44
    s_nop 1
    v_cndmask_b32 v7, v7, v46, vcc
    v_and_b32 v47, 1, v2
    v_cmp_eq_u32 vcc, 1, v47
    s_nop 1
    v_cndmask_b32 v48, v45, v46, vcc
    v_lshrrev_b32 v49, 2, v40
    v_lshl_add_u32 v49, v3, 1, v49
    v_lshlrev_b32 v49, 7, v49
    v_and_b32 v50, 3, v2
    v_lshl_add_u32 v49, v50, 5, v49
    v_lshl_add_u32 v8, v41, 4, v49
    v_lshlrev_b32 v49, 15, v43
    v_lshl_add_u32 v49, v42, 10, v49
    v_lshl_add_u32 v9, v2, 3, v49
    v_lshl_add_u32 v49, v41, 1, v3
    v_lshlrev_b32 v49, 5, v49
    v_lshl_add_u32 v49, v40, 2, v49
    v_mov_b32 v50, 0x80000000
    v_cmp_gt_u32 vcc, 2, v3
    s_nop 1
    v_cndmask_b32 v10, v50, v49, vcc
    s_lshl_b32 s60, s4, 10
    s_add_u32 s60, s60, 156672
    v_add_u32 v11, s60, v4
    s_lshl_b32 s60, s4, 2
    s_add_u32 s60, s60, 160768
    v_add_u32 v12, s60, v4
    s_lshr_b32 s60, s4, 1
    s_lshl_b32 s60, s60, 10
    s_and_b32 s61, s4, 1
    s_lshl_b32 s61, s61, 9
    s_add_u32 s60, s60, s61
    s_add_u32 s60, s60, 161792
    v_lshl_add_u32 v49, v43, 3, v40
    v_lshlrev_b32 v49, 4, v49
    v_lshl_add_u32 v49, v42, 3, v49
    v_lshl_add_u32 v49, v41, 8, v49
    v_add_u32 v14, s60, v49
    v_lshlrev_b32 v49, 7, v3
    v_lshl_add_u32 v49, v40, 4, v49
    v_add_u32 v13, 161792, v49
    v_add_u32 v15, 147456, v4
    s_movk_i32 s60, 1152
    v_mul_lo_u32 v49, v40, s60
    v_lshl_add_u32 v49, v3, 5, v49
    v_lshl_add_u32 v51, v41, 4, v49
    v_and_b32 v3, 31, v1
    v_lshlrev_b32 v3, 7, v3
    v_mov_b32 v0, v48
    s_mov_b32 s76, s40
    s_mov_b32 s77, s41
    s_mov_b32 s78, 9216
    s_mov_b32 s79, 0x00020000
    s_min_u32 s60, s4, 2
    s_mul_i32 s60, s60, 384
    buffer_load_dwordx4 v[64:67], v51, s[76:79], s60 offen offset:0
    buffer_load_dwordx4 v[72:75], v51, s[76:79], s60 offen offset:128
    buffer_load_dwordx4 v[76:79], v51, s[76:79], s60 offen offset:256
    s_lshl_b32 s82, s6, 8
    s_add_u32 s82, s82, 0
    v_lshrrev_b32 v43, 4, v4
    v_and_b32 v42, 7, v43
    v_lshlrev_b32 v42, 5, v42
    v_and_b32 v46, 3, v43
    v_min_u32 v46, 2, v46
    v_lshlrev_b32 v46, 2, v46
    v_mov_b32 v47, 0
    s_mov_b32 s43, 0
    s_waitcnt vmcnt(28) lgkmcnt(0)
    s_barrier
    s_add_u32 m0, s65, 131072
    s_add_u32 s64, s66, 4194304
    buffer_load_dwordx4 v32, s[16:19], s64 offen lds
    s_add_u32 m0, s65, 132096
    s_add_u32 s64, s66, 4227072
    buffer_load_dwordx4 v33, s[16:19], s64 offen lds
    s_add_u32 m0, s65, 133120
    s_add_u32 s64, s66, 4259840
    buffer_load_dwordx4 v34, s[16:19], s64 offen lds
    s_add_u32 m0, s65, 134144
    s_add_u32 s64, s66, 4292608
    buffer_load_dwordx4 v35, s[16:19], s64 offen lds
    v_add_u32 v24, 0, v20
    v_add_u32 v25, 0, v21
    ds_read_b64_tr_b16 a[0:1], v24 offset:0
    ds_read_b64_tr_b16 a[2:3], v24 offset:512
    ds_read_b64_tr_b16 a[4:5], v24 offset:8192
    ds_read_b64_tr_b16 a[6:7], v24 offset:8704
    ds_read_b64_tr_b16 a[72:73], v25 offset:0
    ds_read_b64_tr_b16 a[74:75], v25 offset:512
    ds_read_b64_tr_b16 a[76:77], v25 offset:8192
    ds_read_b64_tr_b16 a[78:79], v25 offset:8704
    s_cmp_lg_u32 s4, 0
    s_cbranch_scc1 L_noann_2
    s_lshl_b32 s60, s3, 3
    s_lshl_b64 s[62:63], 1, s60
    v_mov_b32 v52, s62
    v_mov_b32 v53, s63
    s_lshl_b32 s60, s5, 5
    s_mov_b64 exec, 1
    buffer_atomic_add_x2 v[52:53], off, s[12:15], s60 sc1
    s_mov_b64 exec, -1
L_noann_2:
    s_waitcnt vmcnt(28) lgkmcnt(0)
    s_barrier
    s_add_u32 m0, s65, 0
    s_add_u32 s64, s66, 0
    buffer_load_dwordx4 v32, s[20:23], s64 offen lds
    s_add_u32 m0, s65, 1024
    s_add_u32 s64, s66, 32768
    buffer_load_dwordx4 v33, s[20:23], s64 offen lds
    s_add_u32 m0, s65, 2048
    s_add_u32 s64, s66, 65536
    buffer_load_dwordx4 v34, s[20:23], s64 offen lds
    s_add_u32 m0, s65, 3072
    s_add_u32 s64, s66, 98304
    buffer_load_dwordx4 v35, s[20:23], s64 offen lds
    v_add_u32 v24, 16384, v20
    v_add_u32 v25, 16384, v21
    ds_read_b64_tr_b16 a[8:9], v24 offset:0
    ds_read_b64_tr_b16 a[10:11], v24 offset:512
    ds_read_b64_tr_b16 a[12:13], v24 offset:8192
    ds_read_b64_tr_b16 a[14:15], v24 offset:8704
    ds_read_b64_tr_b16 a[80:81], v25 offset:0
    ds_read_b64_tr_b16 a[82:83], v25 offset:512
    ds_read_b64_tr_b16 a[84:85], v25 offset:8192
    ds_read_b64_tr_b16 a[86:87], v25 offset:8704
    s_waitcnt vmcnt(28) lgkmcnt(0)
    s_barrier
    s_add_u32 m0, s65, 16384
    s_add_u32 s64, s66, 524288
    buffer_load_dwordx4 v32, s[20:23], s64 offen lds
    s_add_u32 m0, s65, 17408
    s_add_u32 s64, s66, 557056
    buffer_load_dwordx4 v33, s[20:23], s64 offen lds
    s_add_u32 m0, s65, 18432
    s_add_u32 s64, s66, 589824
    buffer_load_dwordx4 v34, s[20:23], s64 offen lds
    s_add_u32 m0, s65, 19456
    s_add_u32 s64, s66, 622592
    buffer_load_dwordx4 v35, s[20:23], s64 offen lds
    v_add_u32 v24, 32768, v20
    v_add_u32 v25, 32768, v21
    ds_read_b64_tr_b16 a[16:17], v24 offset:0
    ds_read_b64_tr_b16 a[18:19], v24 offset:512
    ds_read_b64_tr_b16 a[20:21], v24 offset:8192
    ds_read_b64_tr_b16 a[22:23], v24 offset:8704
    ds_read_b64_tr_b16 a[88:89], v25 offset:0
    ds_read_b64_tr_b16 a[90:91], v25 offset:512
    ds_read_b64_tr_b16 a[92:93], v25 offset:8192
    ds_read_b64_tr_b16 a[94:95], v25 offset:8704
    s_waitcnt vmcnt(28) lgkmcnt(0)
    s_barrier
    s_add_u32 m0, s65, 32768
    s_add_u32 s64, s66, 1048576
    buffer_load_dwordx4 v32, s[20:23], s64 offen lds
    s_add_u32 m0, s65, 33792
    s_add_u32 s64, s66, 1081344
    buffer_load_dwordx4 v33, s[20:23], s64 offen lds
    s_add_u32 m0, s65, 34816
    s_add_u32 s64, s66, 1114112
    buffer_load_dwordx4 v34, s[20:23], s64 offen lds
    s_add_u32 m0, s65, 35840
    s_add_u32 s64, s66, 1146880
    buffer_load_dwordx4 v35, s[20:23], s64 offen lds
    v_add_u32 v24, 49152, v20
    v_add_u32 v25, 49152, v21
    ds_read_b64_tr_b16 a[24:25], v24 offset:0
    ds_read_b64_tr_b16 a[26:27], v24 offset:512
    ds_read_b64_tr_b16 a[28:29], v24 offset:8192
    ds_read_b64_tr_b16 a[30:31], v24 offset:8704
    ds_read_b64_tr_b16 a[96:97], v25 offset:0
    ds_read_b64_tr_b16 a[98:99], v25 offset:512
    ds_read_b64_tr_b16 a[100:101], v25 offset:8192
    ds_read_b64_tr_b16 a[102:103], v25 offset:8704
    s_waitcnt vmcnt(28) lgkmcnt(0)
    s_barrier
    s_add_u32 m0, s65, 49152
    s_add_u32 s64, s66, 1572864
    buffer_load_dwordx4 v32, s[20:23], s64 offen lds
    s_add_u32 m0, s65, 50176
    s_add_u32 s64, s66, 1605632
    buffer_load_dwordx4 v33, s[20:23], s64 offen lds
    s_add_u32 m0, s65, 51200
    s_add_u32 s64, s66, 1638400
    buffer_load_dwordx4 v34, s[20:23], s64 offen lds
    s_add_u32 m0, s65, 52224
    s_add_u32 s64, s66, 1671168
    buffer_load_dwordx4 v35, s[20:23], s64 offen lds
    v_add_u32 v24, 65536, v20
    v_add_u32 v25, 65536, v21
    ds_read_b64_tr_b16 a[32:33], v24 offset:0
    ds_read_b64_tr_b16 a[34:35], v24 offset:512
    ds_read_b64_tr_b16 a[36:37], v24 offset:8192
    ds_read_b64_tr_b16 a[38:39], v24 offset:8704
    ds_read_b64_tr_b16 a[104:105], v25 offset:0
    ds_read_b64_tr_b16 a[106:107], v25 offset:512
    ds_read_b64_tr_b16 a[108:109], v25 offset:8192
    ds_read_b64_tr_b16 a[110:111], v25 offset:8704
    s_waitcnt vmcnt(28) lgkmcnt(0)
    s_barrier
    s_add_u32 m0, s65, 65536
    s_add_u32 s64, s66, 2097152
    buffer_load_dwordx4 v32, s[20:23], s64 offen lds
    s_add_u32 m0, s65, 66560
    s_add_u32 s64, s66, 2129920
    buffer_load_dwordx4 v33, s[20:23], s64 offen lds
    s_add_u32 m0, s65, 67584
    s_add_u32 s64, s66, 2162688
    buffer_load_dwordx4 v34, s[20:23], s64 offen lds
    s_add_u32 m0, s65, 68608
    s_add_u32 s64, s66, 2195456
    buffer_load_dwordx4 v35, s[20:23], s64 offen lds
    v_add_u32 v24, 81920, v20
    v_add_u32 v25, 81920, v21
    ds_read_b64_tr_b16 a[40:41], v24 offset:0
    ds_read_b64_tr_b16 a[42:43], v24 offset:512
    ds_read_b64_tr_b16 a[44:45], v24 offset:8192
    ds_read_b64_tr_b16 a[46:47], v24 offset:8704
    ds_read_b64_tr_b16 a[112:113], v25 offset:0
    ds_read_b64_tr_b16 a[114:115], v25 offset:512
    ds_read_b64_tr_b16 a[116:117], v25 offset:8192
    ds_read_b64_tr_b16 a[118:119], v25 offset:8704
    s_waitcnt vmcnt(28) lgkmcnt(0)
    s_barrier
    s_add_u32 m0, s65, 81920
    s_add_u32 s64, s66, 2621440
    buffer_load_dwordx4 v32, s[20:23], s64 offen lds
    s_add_u32 m0, s65, 82944
    s_add_u32 s64, s66, 2654208
    buffer_load_dwordx4 v33, s[20:23], s64 offen lds
    s_add_u32 m0, s65, 83968
    s_add_u32 s64, s66, 2686976
    buffer_load_dwordx4 v34, s[20:23], s64 offen lds
    s_add_u32 m0, s65, 84992
    s_add_u32 s64, s66, 2719744
    buffer_load_dwordx4 v35, s[20:23], s64 offen lds
    v_add_u32 v24, 98304, v20
    v_add_u32 v25, 98304, v21
    ds_read_b64_tr_b16 a[48:49], v24 offset:0
    ds_read_b64_tr_b16 a[50:51], v24 offset:512
    ds_read_b64_tr_b16 a[52:53], v24 offset:8192
    ds_read_b64_tr_b16 a[54:55], v24 offset:8704
    ds_read_b64_tr_b16 a[120:121], v25 offset:0
    ds_read_b64_tr_b16 a[122:123], v25 offset:512
    ds_read_b64_tr_b16 a[124:125], v25 offset:8192
    ds_read_b64_tr_b16 a[126:127], v25 offset:8704
    s_waitcnt vmcnt(28) lgkmcnt(0)
    s_barrier
    s_add_u32 m0, s65, 98304
    s_add_u32 s64, s66, 3145728
    buffer_load_dwordx4 v32, s[20:23], s64 offen lds
    s_add_u32 m0, s65, 99328
    s_add_u32 s64, s66, 3178496
    buffer_load_dwordx4 v33, s[20:23], s64 offen lds
    s_add_u32 m0, s65, 100352
    s_add_u32 s64, s66, 3211264
    buffer_load_dwordx4 v34, s[20:23], s64 offen lds
    s_add_u32 m0, s65, 101376
    s_add_u32 s64, s66, 3244032
    buffer_load_dwordx4 v35, s[20:23], s64 offen lds
    v_add_u32 v24, 114688, v20
    v_add_u32 v25, 114688, v21
    ds_read_b64_tr_b16 a[56:57], v24 offset:0
    ds_read_b64_tr_b16 a[58:59], v24 offset:512
    ds_read_b64_tr_b16 a[60:61], v24 offset:8192
    ds_read_b64_tr_b16 a[62:63], v24 offset:8704
    ds_read_b64_tr_b16 a[128:129], v25 offset:0
    ds_read_b64_tr_b16 a[130:131], v25 offset:512
    ds_read_b64_tr_b16 a[132:133], v25 offset:8192
    ds_read_b64_tr_b16 a[134:135], v25 offset:8704
    s_waitcnt vmcnt(28) lgkmcnt(0)
    s_barrier
    s_add_u32 m0, s65, 114688
    s_add_u32 s64, s66, 3670016
    buffer_load_dwordx4 v32, s[20:23], s64 offen lds
    s_add_u32 m0, s65, 115712
    s_add_u32 s64, s66, 3702784
    buffer_load_dwordx4 v33, s[20:23], s64 offen lds
    s_add_u32 m0, s65, 116736
    s_add_u32 s64, s66, 3735552
    buffer_load_dwordx4 v34, s[20:23], s64 offen lds
    s_add_u32 m0, s65, 117760
    s_add_u32 s64, s66, 3768320
    buffer_load_dwordx4 v35, s[20:23], s64 offen lds
    v_add_u32 v24, 131072, v20
    v_add_u32 v25, 131072, v21
    ds_read_b64_tr_b16 a[64:65], v24 offset:0
    ds_read_b64_tr_b16 a[66:67], v24 offset:512
    ds_read_b64_tr_b16 a[68:69], v24 offset:8192
    ds_read_b64_tr_b16 a[70:71], v24 offset:8704
    ds_read_b64_tr_b16 a[136:137], v25 offset:0
    ds_read_b64_tr_b16 a[138:139], v25 offset:512
    ds_read_b64_tr_b16 a[140:141], v25 offset:8192
    ds_read_b64_tr_b16 a[142:143], v25 offset:8704
    buffer_load_dwordx2 v[44:45], v42, s[12:15], 0 offen sc1
    s_waitcnt vmcnt(28) lgkmcnt(0)
    s_barrier
    s_add_u32 m0, s65, 131072
    s_add_u32 s64, s66, 4194304
    buffer_load_dwordx4 v32, s[20:23], s64 offen lds
    s_add_u32 m0, s65, 132096
    s_add_u32 s64, s66, 4227072
    buffer_load_dwordx4 v33, s[20:23], s64 offen lds
    s_add_u32 m0, s65, 133120
    s_add_u32 s64, s66, 4259840
    buffer_load_dwordx4 v34, s[20:23], s64 offen lds
    s_add_u32 m0, s65, 134144
    s_add_u32 s64, s66, 4292608
    buffer_load_dwordx4 v35, s[20:23], s64 offen lds
    v_add_u32 v24, 0, v20
    v_add_u32 v25, 0, v21
    ds_read_b64_tr_b16 a[144:145], v24 offset:0
    ds_read_b64_tr_b16 a[146:147], v24 offset:512
    ds_read_b64_tr_b16 a[148:149], v24 offset:8192
    ds_read_b64_tr_b16 a[150:151], v24 offset:8704
    ds_read_b64_tr_b16 a[216:217], v25 offset:0
    ds_read_b64_tr_b16 a[218:219], v25 offset:512
    ds_read_b64_tr_b16 a[220:221], v25 offset:8192
    ds_read_b64_tr_b16 a[222:223], v25 offset:8704
    s_waitcnt vmcnt(28) lgkmcnt(0)
    s_barrier
    s_add_u32 m0, s65, 0
    s_add_u32 s64, s67, 0
    buffer_load_dwordx4 v68, s[24:27], s64 offen lds
    s_add_u32 m0, s65, 1024
    s_add_u32 s64, s67, 4608
    buffer_load_dwordx4 v69, s[24:27], s64 offen lds
    s_add_u32 m0, s65, 2048
    s_add_u32 s64, s67, 9216
    buffer_load_dwordx4 v70, s[24:27], s64 offen lds
    s_add_u32 m0, s65, 3072
    s_add_u32 s64, s67, 13824
    buffer_load_dwordx4 v71, s[24:27], s64 offen lds
    v_add_u32 v24, 16384, v20
    v_add_u32 v25, 16384, v21
    ds_read_b64_tr_b16 a[152:153], v24 offset:0
    ds_read_b64_tr_b16 a[154:155], v24 offset:512
    ds_read_b64_tr_b16 a[156:157], v24 offset:8192
    ds_read_b64_tr_b16 a[158:159], v24 offset:8704
    ds_read_b64_tr_b16 a[224:225], v25 offset:0
    ds_read_b64_tr_b16 a[226:227], v25 offset:512
    ds_read_b64_tr_b16 a[228:229], v25 offset:8192
    ds_read_b64_tr_b16 a[230:231], v25 offset:8704
    s_min_u32 s60, s4, 2
    s_mul_i32 s60, s60, 3072
    v_add_u32 v41, s60, v15
    ds_write_b128 v41, v[64:67] offset:0
    ds_write_b128 v41, v[72:75] offset:1024
    ds_write_b128 v41, v[76:79] offset:2048
    s_waitcnt vmcnt(28) lgkmcnt(0)
    s_barrier
    s_add_u32 m0, s65, 16384
    s_add_u32 s64, s67, 73728
    buffer_load_dwordx4 v68, s[24:27], s64 offen lds
    s_add_u32 m0, s65, 17408
    s_add_u32 s64, s67, 78336
    buffer_load_dwordx4 v69, s[24:27], s64 offen lds
    s_add_u32 m0, s65, 18432
    s_add_u32 s64, s67, 82944
    buffer_load_dwordx4 v70, s[24:27], s64 offen lds
    s_add_u32 m0, s65, 19456
    s_add_u32 s64, s67, 87552
    buffer_load_dwordx4 v71, s[24:27], s64 offen lds
    v_add_u32 v24, 32768, v20
    v_add_u32 v25, 32768, v21
    ds_read_b64_tr_b16 a[160:161], v24 offset:0
    ds_read_b64_tr_b16 a[162:163], v24 offset:512
    ds_read_b64_tr_b16 a[164:165], v24 offset:8192
    ds_read_b64_tr_b16 a[166:167], v24 offset:8704
    ds_read_b64_tr_b16 a[232:233], v25 offset:0
    ds_read_b64_tr_b16 a[234:235], v25 offset:512
    ds_read_b64_tr_b16 a[236:237], v25 offset:8192
    ds_read_b64_tr_b16 a[238:239], v25 offset:8704
    s_waitcnt vmcnt(28) lgkmcnt(0)
    s_barrier
    s_add_u32 m0, s65, 32768
    s_add_u32 s64, s67, 256
    buffer_load_dwordx4 v68, s[24:27], s64 offen lds
    s_add_u32 m0, s65, 33792
    s_add_u32 s64, s67, 4864
    buffer_load_dwordx4 v69, s[24:27], s64 offen lds
    s_add_u32 m0, s65, 34816
    s_add_u32 s64, s67, 9472
    buffer_load_dwordx4 v70, s[24:27], s64 offen lds
    s_add_u32 m0, s65, 35840
    s_add_u32 s64, s67, 14080
    buffer_load_dwordx4 v71, s[24:27], s64 offen lds
    v_add_u32 v24, 49152, v20
    v_add_u32 v25, 49152, v21
    ds_read_b64_tr_b16 a[168:169], v24 offset:0
    ds_read_b64_tr_b16 a[170:171], v24 offset:512
    ds_read_b64_tr_b16 a[172:173], v24 offset:8192
    ds_read_b64_tr_b16 a[174:175], v24 offset:8704
    ds_read_b64_tr_b16 a[240:241], v25 offset:0
    ds_read_b64_tr_b16 a[242:243], v25 offset:512
    ds_read_b64_tr_b16 a[244:245], v25 offset:8192
    ds_read_b64_tr_b16 a[246:247], v25 offset:8704
    s_waitcnt vmcnt(28) lgkmcnt(0)
    s_barrier
    s_add_u32 m0, s65, 49152
    s_add_u32 s64, s67, 73984
    buffer_load_dwordx4 v68, s[24:27], s64 offen lds
    s_add_u32 m0, s65, 50176
    s_add_u32 s64, s67, 78592
    buffer_load_dwordx4 v69, s[24:27], s64 offen lds
    s_add_u32 m0, s65, 51200
    s_add_u32 s64, s67, 83200
    buffer_load_dwordx4 v70, s[24:27], s64 offen lds
    s_add_u32 m0, s65, 52224
    s_add_u32 s64, s67, 87808
    buffer_load_dwordx4 v71, s[24:27], s64 offen lds
    v_add_u32 v24, 65536, v20
    v_add_u32 v25, 65536, v21
    ds_read_b64_tr_b16 a[176:177], v24 offset:0
    ds_read_b64_tr_b16 a[178:179], v24 offset:512
    ds_read_b64_tr_b16 a[180:181], v24 offset:8192
    ds_read_b64_tr_b16 a[182:183], v24 offset:8704
    ds_read_b64_tr_b16 a[248:249], v25 offset:0
    ds_read_b64_tr_b16 a[250:251], v25 offset:512
    ds_read_b64_tr_b16 a[252:253], v25 offset:8192
    ds_read_b64_tr_b16 a[254:255], v25 offset:8704
    s_waitcnt vmcnt(28) lgkmcnt(0)
    s_barrier
    s_add_u32 m0, s65, 65536
    s_add_u32 s64, s67, 512
    buffer_load_dwordx4 v68, s[24:27], s64 offen lds
    s_add_u32 m0, s65, 66560
    s_add_u32 s64, s67, 5120
    buffer_load_dwordx4 v69, s[24:27], s64 offen lds
    s_add_u32 m0, s65, 67584
    s_add_u32 s64, s67, 9728
    buffer_load_dwordx4 v70, s[24:27], s64 offen lds
    s_add_u32 m0, s65, 68608
    s_add_u32 s64, s67, 14336
    buffer_load_dwordx4 v71, s[24:27], s64 offen lds
    v_add_u32 v24, 81920, v20
    v_add_u32 v25, 81920, v21
    ds_read_b64_tr_b16 a[184:185], v24 offset:0
    ds_read_b64_tr_b16 a[186:187], v24 offset:512
    ds_read_b64_tr_b16 a[188:189], v24 offset:8192
    ds_read_b64_tr_b16 a[190:191], v24 offset:8704
    ds_read_b64_tr_b16 v[80:81], v25 offset:0
    ds_read_b64_tr_b16 v[82:83], v25 offset:512
    ds_read_b64_tr_b16 v[84:85], v25 offset:8192
    ds_read_b64_tr_b16 v[86:87], v25 offset:8704
    s_waitcnt vmcnt(28) lgkmcnt(0)
    s_barrier
    s_add_u32 m0, s65, 81920
    s_add_u32 s64, s67, 74240
    buffer_load_dwordx4 v68, s[24:27], s64 offen lds
    s_add_u32 m0, s65, 82944
    s_add_u32 s64, s67, 78848
    buffer_load_dwordx4 v69, s[24:27], s64 offen lds
    s_add_u32 m0, s65, 83968
    s_add_u32 s64, s67, 83456
    buffer_load_dwordx4 v70, s[24:27], s64 offen lds
    s_add_u32 m0, s65, 84992
    s_add_u32 s64, s67, 88064
    buffer_load_dwordx4 v71, s[24:27], s64 offen lds
    v_add_u32 v24, 98304, v20
    v_add_u32 v25, 98304, v21
    ds_read_b64_tr_b16 a[192:193], v24 offset:0
    ds_read_b64_tr_b16 a[194:195], v24 offset:512
    ds_read_b64_tr_b16 a[196:197], v24 offset:8192
    ds_read_b64_tr_b16 a[198:199], v24 offset:8704
    ds_read_b64_tr_b16 v[88:89], v25 offset:0
    ds_read_b64_tr_b16 v[90:91], v25 offset:512
    ds_read_b64_tr_b16 v[92:93], v25 offset:8192
    ds_read_b64_tr_b16 v[94:95], v25 offset:8704
    s_waitcnt vmcnt(28) lgkmcnt(0)
    s_barrier
    s_add_u32 m0, s65, 98304
    s_add_u32 s64, s67, 768
    buffer_load_dwordx4 v68, s[24:27], s64 offen lds
    s_add_u32 m0, s65, 99328
    s_add_u32 s64, s67, 5376
    buffer_load_dwordx4 v69, s[24:27], s64 offen lds
    s_add_u32 m0, s65, 100352
    s_add_u32 s64, s67, 9984
    buffer_load_dwordx4 v70, s[24:27], s64 offen lds
    s_add_u32 m0, s65, 101376
    s_add_u32 s64, s67, 14592
    buffer_load_dwordx4 v71, s[24:27], s64 offen lds
    v_add_u32 v24, 114688, v20
    v_add_u32 v25, 114688, v21
    ds_read_b64_tr_b16 a[200:201], v24 offset:0
    ds_read_b64_tr_b16 a[202:203], v24 offset:512
    ds_read_b64_tr_b16 a[204:205], v24 offset:8192
    ds_read_b64_tr_b16 a[206:207], v24 offset:8704
    ds_read_b64_tr_b16 v[96:97], v25 offset:0
    ds_read_b64_tr_b16 v[98:99], v25 offset:512
    ds_read_b64_tr_b16 v[100:101], v25 offset:8192
    ds_read_b64_tr_b16 v[102:103], v25 offset:8704
    s_waitcnt vmcnt(28) lgkmcnt(0)
    s_barrier
    s_add_u32 m0, s65, 114688
    s_add_u32 s64, s67, 74496
    buffer_load_dwordx4 v68, s[24:27], s64 offen lds
    s_add_u32 m0, s65, 115712
    s_add_u32 s64, s67, 79104
    buffer_load_dwordx4 v69, s[24:27], s64 offen lds
    s_add_u32 m0, s65, 116736
    s_add_u32 s64, s67, 83712
    buffer_load_dwordx4 v70, s[24:27], s64 offen lds
    s_add_u32 m0, s65, 117760
    s_add_u32 s64, s67, 88320
    buffer_load_dwordx4 v71, s[24:27], s64 offen lds
    v_add_u32 v24, 131072, v20
    v_add_u32 v25, 131072, v21
    ds_read_b64_tr_b16 a[208:209], v24 offset:0
    ds_read_b64_tr_b16 a[210:211], v24 offset:512
    ds_read_b64_tr_b16 a[212:213], v24 offset:8192
    ds_read_b64_tr_b16 a[214:215], v24 offset:8704
    ds_read_b64_tr_b16 v[104:105], v25 offset:0
    ds_read_b64_tr_b16 v[106:107], v25 offset:512
    ds_read_b64_tr_b16 v[108:109], v25 offset:8192
    ds_read_b64_tr_b16 v[110:111], v25 offset:8704
    s_waitcnt vmcnt(28) lgkmcnt(0)
    s_barrier
    s_add_u32 m0, s65, 131072
    s_add_u32 s64, s68, 1024
    buffer_load_dwordx4 v36, s[24:27], s64 offen lds
    s_add_u32 m0, s65, 132096
    s_add_u32 s64, s68, 10240
    buffer_load_dwordx4 v37, s[24:27], s64 offen lds
    s_add_u32 m0, s65, 133120
    s_add_u32 s64, s68, 19456
    buffer_load_dwordx4 v38, s[24:27], s64 offen lds
    s_add_u32 m0, s65, 134144
    s_add_u32 s64, s68, 28672
    buffer_load_dwordx4 v39, s[24:27], s64 offen lds
    v_add_u32 v24, 0, v28
    ds_read_b64_tr_b16 v[112:113], v24 offset:0
    ds_read_b64_tr_b16 v[114:115], v24 offset:512
    ds_read_b64_tr_b16 v[116:117], v24 offset:4096
    ds_read_b64_tr_b16 v[118:119], v24 offset:4608
    ds_read_b64_tr_b16 v[120:121], v24 offset:8192
    ds_read_b64_tr_b16 v[122:123], v24 offset:8704
    ds_read_b64_tr_b16 v[124:125], v24 offset:12288
    ds_read_b64_tr_b16 v[126:127], v24 offset:12800
    v_sad_u8 v40, v44, 0, 0
    v_sad_u8 v40, v45, 0, v40
    v_cmp_ne_u32 vcc, 32, v40
    s_cmp_eq_u64 vcc, 0
    s_cselect_b32 s43, 1, 0
    v_or_b32 v40, v44, v45
    v_and_b32 v40, 0x20202020, v40
    s_nop 0
    v_readlane_b32 s7, v40, s5
    s_waitcnt vmcnt(28) lgkmcnt(0)
    s_barrier
    s_add_u32 m0, s65, 0
    s_add_u32 s64, s66, 0
    buffer_load_dwordx4 v32, s[28:31], s64 offen lds
    s_add_u32 m0, s65, 1024
    s_add_u32 s64, s66, 32768
    buffer_load_dwordx4 v33, s[28:31], s64 offen lds
    s_add_u32 m0, s65, 2048
    s_add_u32 s64, s66, 65536
    buffer_load_dwordx4 v34, s[28:31], s64 offen lds
    s_add_u32 m0, s65, 3072
    s_add_u32 s64, s66, 98304
    buffer_load_dwordx4 v35, s[28:31], s64 offen lds
    v_add_u32 v24, 16384, v28
    ds_read_b64_tr_b16 v[128:129], v24 offset:0
    ds_read_b64_tr_b16 v[130:131], v24 offset:512
    ds_read_b64_tr_b16 v[132:133], v24 offset:4096
    ds_read_b64_tr_b16 v[134:135], v24 offset:4608
    ds_read_b64_tr_b16 v[136:137], v24 offset:8192
    ds_read_b64_tr_b16 v[138:139], v24 offset:8704
    ds_read_b64_tr_b16 v[140:141], v24 offset:12288
    ds_read_b64_tr_b16 v[142:143], v24 offset:12800
    s_waitcnt vmcnt(28) lgkmcnt(0)
    s_barrier
    s_add_u32 m0, s65, 16384
    s_add_u32 s64, s66, 524288
    buffer_load_dwordx4 v32, s[28:31], s64 offen lds
    s_add_u32 m0, s65, 17408
    s_add_u32 s64, s66, 557056
    buffer_load_dwordx4 v33, s[28:31], s64 offen lds
    s_add_u32 m0, s65, 18432
    s_add_u32 s64, s66, 589824
    buffer_load_dwordx4 v34, s[28:31], s64 offen lds
    s_add_u32 m0, s65, 19456
    s_add_u32 s64, s66, 622592
    buffer_load_dwordx4 v35, s[28:31], s64 offen lds
    v_add_u32 v24, 32768, v28
    ds_read_b64_tr_b16 v[144:145], v24 offset:0
    ds_read_b64_tr_b16 v[146:147], v24 offset:512
    ds_read_b64_tr_b16 v[148:149], v24 offset:4096
    ds_read_b64_tr_b16 v[150:151], v24 offset:4608
    ds_read_b64_tr_b16 v[152:153], v24 offset:8192
    ds_read_b64_tr_b16 v[154:155], v24 offset:8704
    ds_read_b64_tr_b16 v[156:157], v24 offset:12288
    ds_read_b64_tr_b16 v[158:159], v24 offset:12800
    s_waitcnt vmcnt(28) lgkmcnt(0)
    s_barrier
    s_add_u32 m0, s65, 32768
    s_add_u32 s64, s66, 1048576
    buffer_load_dwordx4 v32, s[28:31], s64 offen lds
    s_add_u32 m0, s65, 33792
    s_add_u32 s64, s66, 1081344
    buffer_load_dwordx4 v33, s[28:31], s64 offen lds
    s_add_u32 m0, s65, 34816
    s_add_u32 s64, s66, 1114112
    buffer_load_dwordx4 v34, s[28:31], s64 offen lds
    s_add_u32 m0, s65, 35840
    s_add_u32 s64, s66, 1146880
    buffer_load_dwordx4 v35, s[28:31], s64 offen lds
    v_add_u32 v24, 49152, v28
    ds_read_b64_tr_b16 v[160:161], v24 offset:0
    ds_read_b64_tr_b16 v[162:163], v24 offset:512
    ds_read_b64_tr_b16 v[164:165], v24 offset:4096
    ds_read_b64_tr_b16 v[166:167], v24 offset:4608
    ds_read_b64_tr_b16 v[168:169], v24 offset:8192
    ds_read_b64_tr_b16 v[170:171], v24 offset:8704
    ds_read_b64_tr_b16 v[172:173], v24 offset:12288
    ds_read_b64_tr_b16 v[174:175], v24 offset:12800
    s_waitcnt vmcnt(28) lgkmcnt(0)
    s_barrier
    s_add_u32 m0, s65, 49152
    s_add_u32 s64, s66, 1572864
    buffer_load_dwordx4 v32, s[28:31], s64 offen lds
    s_add_u32 m0, s65, 50176
    s_add_u32 s64, s66, 1605632
    buffer_load_dwordx4 v33, s[28:31], s64 offen lds
    s_add_u32 m0, s65, 51200
    s_add_u32 s64, s66, 1638400
    buffer_load_dwordx4 v34, s[28:31], s64 offen lds
    s_add_u32 m0, s65, 52224
    s_add_u32 s64, s66, 1671168
    buffer_load_dwordx4 v35, s[28:31], s64 offen lds
    v_add_u32 v24, 65536, v28
    ds_read_b64_tr_b16 v[176:177], v24 offset:0
    ds_read_b64_tr_b16 v[178:179], v24 offset:512
    ds_read_b64_tr_b16 v[180:181], v24 offset:4096
    ds_read_b64_tr_b16 v[182:183], v24 offset:4608
    ds_read_b64_tr_b16 v[184:185], v24 offset:8192
    ds_read_b64_tr_b16 v[186:187], v24 offset:8704
    ds_read_b64_tr_b16 v[188:189], v24 offset:12288
    ds_read_b64_tr_b16 v[190:191], v24 offset:12800
    s_waitcnt vmcnt(28) lgkmcnt(0)
    s_barrier
    s_add_u32 m0, s65, 65536
    s_add_u32 s64, s66, 2097152
    buffer_load_dwordx4 v32, s[28:31], s64 offen lds
    s_add_u32 m0, s65, 66560
    s_add_u32 s64, s66, 2129920
    buffer_load_dwordx4 v33, s[28:31], s64 offen lds
    s_add_u32 m0, s65, 67584
    s_add_u32 s64, s66, 2162688
    buffer_load_dwordx4 v34, s[28:31], s64 offen lds
    s_add_u32 m0, s65, 68608
    s_add_u32 s64, s66, 2195456
    buffer_load_dwordx4 v35, s[28:31], s64 offen lds
    v_add_u32 v24, 81920, v28
    ds_read_b64_tr_b16 v[192:193], v24 offset:0
    ds_read_b64_tr_b16 v[194:195], v24 offset:512
    ds_read_b64_tr_b16 v[196:197], v24 offset:4096
    ds_read_b64_tr_b16 v[198:199], v24 offset:4608
    ds_read_b64_tr_b16 v[200:201], v24 offset:8192
    ds_read_b64_tr_b16 v[202:203], v24 offset:8704
    ds_read_b64_tr_b16 v[204:205], v24 offset:12288
    ds_read_b64_tr_b16 v[206:207], v24 offset:12800
    s_waitcnt vmcnt(28) lgkmcnt(0)
    s_barrier
    s_add_u32 m0, s65, 81920
    s_add_u32 s64, s66, 2621440
    buffer_load_dwordx4 v32, s[28:31], s64 offen lds
    s_add_u32 m0, s65, 82944
    s_add_u32 s64, s66, 2654208
    buffer_load_dwordx4 v33, s[28:31], s64 offen lds
    s_add_u32 m0, s65, 83968
    s_add_u32 s64, s66, 2686976
    buffer_load_dwordx4 v34, s[28:31], s64 offen lds
    s_add_u32 m0, s65, 84992
    s_add_u32 s64, s66, 2719744
    buffer_load_dwordx4 v35, s[28:31], s64 offen lds
    v_add_u32 v24, 98304, v28
    ds_read_b64_tr_b16 v[208:209], v24 offset:0
    ds_read_b64_tr_b16 v[210:211], v24 offset:512
    ds_read_b64_tr_b16 v[212:213], v24 offset:4096
    ds_read_b64_tr_b16 v[214:215], v24 offset:4608
    ds_read_b64_tr_b16 v[216:217], v24 offset:8192
    ds_read_b64_tr_b16 v[218:219], v24 offset:8704
    ds_read_b64_tr_b16 v[220:221], v24 offset:12288
    ds_read_b64_tr_b16 v[222:223], v24 offset:12800
    s_waitcnt vmcnt(28) lgkmcnt(0)
    s_barrier
    s_add_u32 m0, s65, 98304
    s_add_u32 s64, s66, 3145728
    buffer_load_dwordx4 v32, s[28:31], s64 offen lds
    s_add_u32 m0, s65, 99328
    s_add_u32 s64, s66, 3178496
    buffer_load_dwordx4 v33, s[28:31], s64 offen lds
    s_add_u32 m0, s65, 100352
    s_add_u32 s64, s66, 3211264
    buffer_load_dwordx4 v34, s[28:31], s64 offen lds
    s_add_u32 m0, s65, 101376
    s_add_u32 s64, s66, 3244032
    buffer_load_dwordx4 v35, s[28:31], s64 offen lds
    v_add_u32 v24, 114688, v28
    ds_read_b64_tr_b16 v[224:225], v24 offset:0
    ds_read_b64_tr_b16 v[226:227], v24 offset:512
    ds_read_b64_tr_b16 v[228:229], v24 offset:4096
    ds_read_b64_tr_b16 v[230:231], v24 offset:4608
    ds_read_b64_tr_b16 v[232:233], v24 offset:8192
    ds_read_b64_tr_b16 v[234:235], v24 offset:8704
    ds_read_b64_tr_b16 v[236:237], v24 offset:12288
    ds_read_b64_tr_b16 v[238:239], v24 offset:12800
    s_waitcnt vmcnt(28) lgkmcnt(0)
    s_barrier
    s_add_u32 m0, s65, 114688
    s_add_u32 s64, s66, 3670016
    buffer_load_dwordx4 v32, s[28:31], s64 offen lds
    s_add_u32 m0, s65, 115712
    s_add_u32 s64, s66, 3702784
    buffer_load_dwordx4 v33, s[28:31], s64 offen lds
    s_add_u32 m0, s65, 116736
    s_add_u32 s64, s66, 3735552
    buffer_load_dwordx4 v34, s[28:31], s64 offen lds
    s_add_u32 m0, s65, 117760
    s_add_u32 s64, s66, 3768320
    buffer_load_dwordx4 v35, s[28:31], s64 offen lds
    v_add_u32 v24, 131072, v22
    ds_read_b64_tr_b16 v[240:241], v24 offset:0
    ds_read_b64_tr_b16 v[242:243], v24 offset:256
    ds_read_b64_tr_b16 v[244:245], v24 offset:4096
    ds_read_b64_tr_b16 v[246:247], v24 offset:4352
    ds_read_b64_tr_b16 v[248:249], v24 offset:8192
    ds_read_b64_tr_b16 v[250:251], v24 offset:8448
    ds_read_b64_tr_b16 v[252:253], v24 offset:12288
    ds_read_b64_tr_b16 v[254:255], v24 offset:12544
    s_waitcnt vmcnt(28) lgkmcnt(0)
    s_barrier
    s_add_u32 m0, s65, 131072
    s_add_u32 s64, s66, 4194304
    buffer_load_dwordx4 v32, s[28:31], s64 offen lds
    s_add_u32 m0, s65, 132096
    s_add_u32 s64, s66, 4227072
    buffer_load_dwordx4 v33, s[28:31], s64 offen lds
    s_add_u32 m0, s65, 133120
    s_add_u32 s64, s66, 4259840
    buffer_load_dwordx4 v34, s[28:31], s64 offen lds
    s_add_u32 m0, s65, 134144
    s_add_u32 s64, s66, 4292608
    buffer_load_dwordx4 v35, s[28:31], s64 offen lds
    v_add_u32 v24, 0, v20
    v_add_u32 v25, 0, v21
    ds_read_b64_tr_b16 v[48:49], v24 offset:0
    ds_read_b64_tr_b16 v[50:51], v24 offset:512
    ds_read_b64_tr_b16 v[52:53], v24 offset:8192
    ds_read_b64_tr_b16 v[54:55], v24 offset:8704
    ds_read_b64_tr_b16 v[56:57], v25 offset:0
    ds_read_b64_tr_b16 v[58:59], v25 offset:512
    ds_read_b64_tr_b16 v[60:61], v25 offset:8192
    ds_read_b64_tr_b16 v[62:63], v25 offset:8704
    s_waitcnt vmcnt(28) lgkmcnt(0)
    s_barrier
    v_add_u32 v27, 0, v26
    ds_write_b128 v27, v[48:51] offset:0
    ds_write_b128 v27, v[52:55] offset:1024
    ds_write_b128 v27, v[56:59] offset:2048
    ds_write_b128 v27, v[60:63] offset:3072
    v_add_u32 v24, 16384, v20
    v_add_u32 v25, 16384, v21
    ds_read_b64_tr_b16 v[48:49], v24 offset:0
    ds_read_b64_tr_b16 v[50:51], v24 offset:512
    ds_read_b64_tr_b16 v[52:53], v24 offset:8192
    ds_read_b64_tr_b16 v[54:55], v24 offset:8704
    ds_read_b64_tr_b16 v[56:57], v25 offset:0
    ds_read_b64_tr_b16 v[58:59], v25 offset:512
    ds_read_b64_tr_b16 v[60:61], v25 offset:8192
    ds_read_b64_tr_b16 v[62:63], v25 offset:8704
    s_waitcnt vmcnt(24) lgkmcnt(0)
    s_barrier
    v_add_u32 v27, 16384, v26
    ds_write_b128 v27, v[48:51] offset:0
    ds_write_b128 v27, v[52:55] offset:1024
    ds_write_b128 v27, v[56:59] offset:2048
    ds_write_b128 v27, v[60:63] offset:3072
    v_add_u32 v24, 32768, v20
    v_add_u32 v25, 32768, v21
    ds_read_b64_tr_b16 v[48:49], v24 offset:0
    ds_read_b64_tr_b16 v[50:51], v24 offset:512
    ds_read_b64_tr_b16 v[52:53], v24 offset:8192
    ds_read_b64_tr_b16 v[54:55], v24 offset:8704
    ds_read_b64_tr_b16 v[56:57], v25 offset:0
    ds_read_b64_tr_b16 v[58:59], v25 offset:512
    ds_read_b64_tr_b16 v[60:61], v25 offset:8192
    ds_read_b64_tr_b16 v[62:63], v25 offset:8704
    s_waitcnt vmcnt(20) lgkmcnt(0)
    s_barrier
    v_add_u32 v27, 32768, v26
    ds_write_b128 v27, v[48:51] offset:0
    ds_write_b128 v27, v[52:55] offset:1024
    ds_write_b128 v27, v[56:59] offset:2048
    ds_write_b128 v27, v[60:63] offset:3072
    v_add_u32 v24, 49152, v20
    v_add_u32 v25, 49152, v21
    ds_read_b64_tr_b16 v[48:49], v24 offset:0
    ds_read_b64_tr_b16 v[50:51], v24 offset:512
    ds_read_b64_tr_b16 v[52:53], v24 offset:8192
    ds_read_b64_tr_b16 v[54:55], v24 offset:8704
    ds_read_b64_tr_b16 v[56:57], v25 offset:0
    ds_read_b64_tr_b16 v[58:59], v25 offset:512
    ds_read_b64_tr_b16 v[60:61], v25 offset:8192
    ds_read_b64_tr_b16 v[62:63], v25 offset:8704
    s_waitcnt vmcnt(16) lgkmcnt(0)
    s_barrier
    v_add_u32 v27, 49152, v26
    ds_write_b128 v27, v[48:51] offset:0
    ds_write_b128 v27, v[52:55] offset:1024
    ds_write_b128 v27, v[56:59] offset:2048
    ds_write_b128 v27, v[60:63] offset:3072
    v_add_u32 v24, 65536, v20
    v_add_u32 v25, 65536, v21
    ds_read_b64_tr_b16 v[48:49], v24 offset:0
    ds_read_b64_tr_b16 v[50:51], v24 offset:512
    ds_read_b64_tr_b16 v[52:53], v24 offset:8192
    ds_read_b64_tr_b16 v[54:55], v24 offset:8704
    ds_read_b64_tr_b16 v[56:57], v25 offset:0
    ds_read_b64_tr_b16 v[58:59], v25 offset:512
    ds_read_b64_tr_b16 v[60:61], v25 offset:8192
    ds_read_b64_tr_b16 v[62:63], v25 offset:8704
    s_waitcnt vmcnt(12) lgkmcnt(0)
    s_barrier
    v_add_u32 v27, 65536, v26
    ds_write_b128 v27, v[48:51] offset:0
    ds_write_b128 v27, v[52:55] offset:1024
    ds_write_b128 v27, v[56:59] offset:2048
    ds_write_b128 v27, v[60:63] offset:3072
    v_add_u32 v24, 81920, v20
    v_add_u32 v25, 81920, v21
    ds_read_b64_tr_b16 v[48:49], v24 offset:0
    ds_read_b64_tr_b16 v[50:51], v24 offset:512
    ds_read_b64_tr_b16 v[52:53], v24 offset:8192
    ds_read_b64_tr_b16 v[54:55], v24 offset:8704
    ds_read_b64_tr_b16 v[56:57], v25 offset:0
    ds_read_b64_tr_b16 v[58:59], v25 offset:512
    ds_read_b64_tr_b16 v[60:61], v25 offset:8192
    ds_read_b64_tr_b16 v[62:63], v25 offset:8704
    s_cmp_eq_u32 s43, 0
    s_cbranch_scc1 L_nofl_3
    buffer_load_dword v47, v46, s[8:11], s82 offen sc1
L_nofl_3:
    s_waitcnt vmcnt(8) lgkmcnt(0)
    s_barrier
    v_add_u32 v27, 81920, v26
    ds_write_b128 v27, v[48:51] offset:0
    ds_write_b128 v27, v[52:55] offset:1024
    ds_write_b128 v27, v[56:59] offset:2048
    ds_write_b128 v27, v[60:63] offset:3072
    v_add_u32 v24, 98304, v20
    v_add_u32 v25, 98304, v21
    ds_read_b64_tr_b16 v[48:49], v24 offset:0
    ds_read_b64_tr_b16 v[50:51], v24 offset:512
    ds_read_b64_tr_b16 v[52:53], v24 offset:8192
    ds_read_b64_tr_b16 v[54:55], v24 offset:8704
    ds_read_b64_tr_b16 v[56:57], v25 offset:0
    ds_read_b64_tr_b16 v[58:59], v25 offset:512
    ds_read_b64_tr_b16 v[60:61], v25 offset:8192
    ds_read_b64_tr_b16 v[62:63], v25 offset:8704
    s_waitcnt vmcnt(4) lgkmcnt(0)
    s_barrier
    v_add_u32 v27, 98304, v26
    ds_write_b128 v27, v[48:51] offset:0
    ds_write_b128 v27, v[52:55] offset:1024
    ds_write_b128 v27, v[56:59] offset:2048
    ds_write_b128 v27, v[60:63] offset:3072
    v_add_u32 v24, 114688, v20
    v_add_u32 v25, 114688, v21
    ds_read_b64_tr_b16 v[48:49], v24 offset:0
    ds_read_b64_tr_b16 v[50:51], v24 offset:512
    ds_read_b64_tr_b16 v[52:53], v24 offset:8192
    ds_read_b64_tr_b16 v[54:55], v24 offset:8704
    ds_read_b64_tr_b16 v[56:57], v25 offset:0
    ds_read_b64_tr_b16 v[58:59], v25 offset:512
    ds_read_b64_tr_b16 v[60:61], v25 offset:8192
    ds_read_b64_tr_b16 v[62:63], v25 offset:8704
    s_waitcnt vmcnt(0) lgkmcnt(0)
    s_barrier
    v_add_u32 v27, 114688, v26
    ds_write_b128 v27, v[48:51] offset:0
    ds_write_b128 v27, v[52:55] offset:1024
    ds_write_b128 v27, v[56:59] offset:2048
    ds_write_b128 v27, v[60:63] offset:3072
    v_add_u32 v24, 131072, v20
    v_add_u32 v25, 131072, v21
    ds_read_b64_tr_b16 v[48:49], v24 offset:0
    ds_read_b64_tr_b16 v[50:51], v24 offset:512
    ds_read_b64_tr_b16 v[52:53], v24 offset:8192
    ds_read_b64_tr_b16 v[54:55], v24 offset:8704
    ds_read_b64_tr_b16 v[56:57], v25 offset:0
    ds_read_b64_tr_b16 v[58:59], v25 offset:512
    ds_read_b64_tr_b16 v[60:61], v25 offset:8192
    ds_read_b64_tr_b16 v[62:63], v25 offset:8704
    s_waitcnt lgkmcnt(0)
    s_barrier
    v_add_u32 v27, 131072, v26
    ds_write_b128 v27, v[48:51] offset:0
    ds_write_b128 v27, v[52:55] offset:1024
    ds_write_b128 v27, v[56:59] offset:2048
    ds_write_b128 v27, v[60:63] offset:3072
    s_mov_b32 s72, 0xff00ff
    s_mov_b32 s73, 0xff00ff
    s_mov_b32 s74, 0xff00ff00
    s_mov_b32 s75, 0xff00ff00
    s_mov_b32 s76, 0x0
    s_mov_b32 s77, 0xffffffff
    s_mov_b32 s78, 0x30003
    s_mov_b32 s79, 0x30003
    s_mov_b32 s64, 0x3e0293ee
    s_add_u32 s67, s6, 32
    s_cmp_eq_u32 s4, 2
    s_cselect_b32 s67, s6, s67
    s_add_u32 s70, s6, 64
    s_cmp_eq_u32 s4, 0
    s_cselect_b32 s67, s70, s67
    s_mov_b32 s65, 1
    s_cmp_ge_u32 s67, 72
    s_cselect_b32 s65, 0, s65
    s_cmp_eq_u32 s4, 3
    s_cselect_b32 s65, 0, s65
    s_cmp_lg_u32 s43, 0
    s_cbranch_scc1 L_initok_4
    v_lshrrev_b32 v72, 4, v4
    v_and_b32 v74, 7, v72
    v_lshlrev_b32 v74, 5, v74
    s_mov_b32 s59, 0
L_init_5:
    buffer_load_dwordx2 v[76:77], v74, s[12:15], 0 offen sc1
    s_waitcnt vmcnt(0)
    v_sad_u8 v75, v76, 0, 0
    v_sad_u8 v75, v77, 0, v75
    v_cmp_ne_u32 vcc, 32, v75
    s_cbranch_vccz L_init_ok_6
    s_add_u32 s59, s59, 1
    s_cmp_lt_u32 s59, s58
    s_cbranch_scc1 L_init_5
    s_mov_b32 s58, 0
L_init_ok_6:
    v_or_b32 v75, v76, v77
    v_and_b32 v75, 0x20202020, v75
    s_nop 0
    v_readlane_b32 s7, v75, s5
L_initok_4:
    s_lshl_b32 s68, s6, 20
    s_lshl_b32 s60, s4, 12
    s_add_u32 s68, s68, s60
    s_add_u32 s68, s68, 1048576
    s_lshl_b32 s69, s6, 19
    s_lshl_b32 s60, s4, 11
    s_add_u32 s69, s69, s60
    s_add_u32 s69, s69, 35651584
    v_cmp_ne_u32 vcc, 1, v47
    s_cbranch_vccz L_flok_7
    s_mov_b32 s59, 0
L_kv0_8:
    buffer_load_dword v47, v46, s[8:11], s82 offen sc1
    s_waitcnt vmcnt(0)
    v_cmp_ne_u32 vcc, 1, v47
    s_cbranch_vccz L_kv0_ok_9
    s_add_u32 s59, s59, 1
    s_cmp_lt_u32 s59, s58
    s_cbranch_scc1 L_kv0_8
    s_mov_b32 s58, 0
L_kv0_ok_9:
L_flok_7:
    buffer_load_dwordx4 v[16:19], v4, s[8:11], s68 offen offset:0 sc1
    buffer_load_dwordx4 v[20:23], v4, s[8:11], s68 offen offset:1024 sc1
    buffer_load_dwordx4 v[24:27], v4, s[8:11], s68 offen offset:2048 sc1
    buffer_load_dwordx4 v[28:31], v4, s[8:11], s68 offen offset:3072 sc1
    s_mov_b32 s60, 0
    s_mov_b32 s61, 65536
    s_mov_b32 s62, 74752
    s_mov_b32 s63, 98304
    s_mov_b32 s28, 0
    s_mov_b32 s36, 0
    s_lshr_b32 s40, s4, 1
    s_lshl_b32 s40, s40, 14
    s_and_b32 s41, s4, 1
    s_lshl_b32 s41, s41, 11
    s_add_u32 s40, s40, s41
    s_lshr_b32 s41, s6, 3
    s_lshl_b32 s41, s41, 12
    s_add_u32 s40, s40, s41
    s_and_b32 s41, s6, 7
    s_lshl_b32 s41, s41, 7
    s_add_u32 s40, s40, s41
    s_lshr_b32 s41, s67, 2
    s_lshl_b32 s41, s41, 14
    s_and_b32 s42, s67, 3
    s_lshl_b32 s42, s42, 10
    s_add_u32 s41, s41, s42
    s_mov_b32 s42, 0
    s_lshl_b32 s70, s4, 12
    v_add_u32 v1, s70, v4
    s_waitcnt lgkmcnt(0)
    s_branch L_t0skip_10
    s_cmp_lg_u32 s4, 3
    s_cbranch_scc1 L_t0skip_10
    s_add_u32 s70, s82, 12
    buffer_load_dword v2, off, s[8:11], s70 sc1
L_t0skip_10:
    s_add_u32 s71, s68, 16384
    buffer_load_dword v2, v3, s[8:11], s71 offen
    v_mov_b64 v[32:33], 0
    v_mov_b64 v[34:35], 0
    v_mov_b64 v[36:37], 0
    v_mov_b64 v[38:39], 0
    v_mov_b64 v[40:41], 0
    v_mov_b64 v[42:43], 0
    v_mov_b64 v[44:45], 0
    v_mov_b64 v[46:47], 0
    v_mov_b64 v[48:49], 0
    v_mov_b64 v[50:51], 0
    v_mov_b64 v[52:53], 0
    v_mov_b64 v[54:55], 0
    ds_read_b128 v[64:67], v1 offset:0
    ds_read_b128 v[68:71], v1 offset:1024
    ds_read_b128 v[72:75], v1 offset:2048
    ds_read_b128 v[76:79], v1 offset:3072
    s_barrier
    s_cmp_eq_u32 s7, 0
    s_cbranch_scc1 L_chain_slow_12
    s_branch L_cl_13
.p2align 8
L_cl_13:
    ds_read_b128 v[56:59], v15
    ds_read_b128 v[60:63], v15 offset:1024
    s_add_u32 s70, s68, 32768
    buffer_load_dword v2, v3, s[8:11], s70 offen
    s_add_u32 s71, s60, 3
    s_min_u32 s71, s71, 63
    s_lshl_b32 s71, s71, 2
    s_add_u32 s71, s71, s82
    buffer_load_dword v2, off, s[8:11], s71 sc1
    s_waitcnt lgkmcnt(1)
    v_smfmac_f32_16x16x64_bf16 v[32:35], v[56:59], a[0:7], v5
    v_smfmac_f32_16x16x64_bf16 v[48:51], v[56:59], v[64:71], v5
    ds_read_b128 v[64:67], v1 offset:16384
    ds_read_b128 v[68:71], v1 offset:17408
    v_smfmac_f32_16x16x64_bf16 v[36:39], v[56:59], a[72:79], v5
    v_smfmac_f32_16x16x64_bf16 v[40:43], v[56:59], a[144:151], v5
    v_smfmac_f32_16x16x64_bf16 v[52:55], v[56:59], v[72:79], v5
    ds_read_b128 v[72:75], v1 offset:18432
    ds_read_b128 v[76:79], v1 offset:19456
    v_smfmac_f32_16x16x64_bf16 v[44:47], v[56:59], a[216:223], v5
    ds_read_b128 v[56:59], v15 offset:2048
    s_waitcnt lgkmcnt(5)
    v_smfmac_f32_16x16x64_bf16 v[32:35], v[60:63], a[8:15], v5
    s_waitcnt lgkmcnt(3)
    v_smfmac_f32_16x16x64_bf16 v[48:51], v[60:63], v[64:71], v5
    ds_read_b128 v[64:67], v1 offset:32768
    ds_read_b128 v[68:71], v1 offset:33792
    v_smfmac_f32_16x16x64_bf16 v[36:39], v[60:63], a[80:87], v5
    v_smfmac_f32_16x16x64_bf16 v[40:43], v[60:63], a[152:159], v5
    s_waitcnt lgkmcnt(3)
    v_smfmac_f32_16x16x64_bf16 v[52:55], v[60:63], v[72:79], v5
    ds_read_b128 v[72:75], v1 offset:34816
    ds_read_b128 v[76:79], v1 offset:35840
    v_smfmac_f32_16x16x64_bf16 v[44:47], v[60:63], a[224:231], v5
    ds_read_b128 v[60:63], v15 offset:3072
    s_waitcnt lgkmcnt(5)
    v_smfmac_f32_16x16x64_bf16 v[32:35], v[56:59], a[16:23], v5
    s_waitcnt lgkmcnt(3)
    v_smfmac_f32_16x16x64_bf16 v[48:51], v[56:59], v[64:71], v5
    ds_read_b128 v[64:67], v1 offset:49152
    ds_read_b128 v[68:71], v1 offset:50176
    v_smfmac_f32_16x16x64_bf16 v[36:39], v[56:59], a[88:95], v5
    v_smfmac_f32_16x16x64_bf16 v[40:43], v[56:59], a[160:167], v5
    s_waitcnt lgkmcnt(3)
    v_smfmac_f32_16x16x64_bf16 v[52:55], v[56:59], v[72:79], v5
    ds_read_b128 v[72:75], v1 offset:51200
    ds_read_b128 v[76:79], v1 offset:52224
    v_smfmac_f32_16x16x64_bf16 v[44:47], v[56:59], a[232:239], v5
    ds_read_b128 v[56:59], v15 offset:4096
    s_waitcnt lgkmcnt(5)
    v_smfmac_f32_16x16x64_bf16 v[32:35], v[60:63], a[24:31], v5
    s_waitcnt lgkmcnt(3)
    v_smfmac_f32_16x16x64_bf16 v[48:51], v[60:63], v[64:71], v5
    v_add_u32 v1, 0x10000, v1
    ds_read_b128 v[64:67], v1 offset:0
    ds_read_b128 v[68:71], v1 offset:1024
    v_smfmac_f32_16x16x64_bf16 v[36:39], v[60:63], a[96:103], v5
    v_smfmac_f32_16x16x64_bf16 v[40:43], v[60:63], a[168:175], v5
    s_waitcnt lgkmcnt(3)
    v_smfmac_f32_16x16x64_bf16 v[52:55], v[60:63], v[72:79], v5
    ds_read_b128 v[72:75], v1 offset:2048
    ds_read_b128 v[76:79], v1 offset:3072
    v_smfmac_f32_16x16x64_bf16 v[44:47], v[60:63], a[240:247], v5
    ds_read_b128 v[60:63], v15 offset:5120
    s_waitcnt lgkmcnt(5)
    v_smfmac_f32_16x16x64_bf16 v[32:35], v[56:59], a[32:39], v5
    s_waitcnt lgkmcnt(3)
    v_smfmac_f32_16x16x64_bf16 v[48:51], v[56:59], v[64:71], v5
    ds_read_b128 v[64:67], v1 offset:16384
    ds_read_b128 v[68:71], v1 offset:17408
    v_smfmac_f32_16x16x64_bf16 v[36:39], v[56:59], a[104:111], v5
    v_smfmac_f32_16x16x64_bf16 v[40:43], v[56:59], a[176:183], v5
    s_waitcnt lgkmcnt(3)
    v_smfmac_f32_16x16x64_bf16 v[52:55], v[56:59], v[72:79], v5
    ds_read_b128 v[72:75], v1 offset:18432
    ds_read_b128 v[76:79], v1 offset:19456
    v_smfmac_f32_16x16x64_bf16 v[44:47], v[56:59], a[248:255], v5
    ds_read_b128 v[56:59], v15 offset:6144
    s_waitcnt lgkmcnt(5)
    v_smfmac_f32_16x16x64_bf16 v[32:35], v[60:63], a[40:47], v5
    s_waitcnt lgkmcnt(3)
    v_smfmac_f32_16x16x64_bf16 v[48:51], v[60:63], v[64:71], v5
    ds_read_b128 v[64:67], v1 offset:32768
    ds_read_b128 v[68:71], v1 offset:33792
    v_smfmac_f32_16x16x64_bf16 v[36:39], v[60:63], a[112:119], v5
    v_smfmac_f32_16x16x64_bf16 v[40:43], v[60:63], a[184:191], v5
    s_waitcnt lgkmcnt(3)
    v_smfmac_f32_16x16x64_bf16 v[52:55], v[60:63], v[72:79], v5
    ds_read_b128 v[72:75], v1 offset:34816
    ds_read_b128 v[76:79], v1 offset:35840
    v_smfmac_f32_16x16x64_bf16 v[44:47], v[60:63], v[80:87], v5
    ds_read_b128 v[60:63], v15 offset:7168
    s_waitcnt lgkmcnt(5)
    v_smfmac_f32_16x16x64_bf16 v[32:35], v[56:59], a[48:55], v5
    s_waitcnt lgkmcnt(3)
    v_smfmac_f32_16x16x64_bf16 v[48:51], v[56:59], v[64:71], v5
    ds_read_b128 v[64:67], v1 offset:49152
    ds_read_b128 v[68:71], v1 offset:50176
    v_smfmac_f32_16x16x64_bf16 v[36:39], v[56:59], a[120:127], v5
    v_smfmac_f32_16x16x64_bf16 v[40:43], v[56:59], a[192:199], v5
    s_waitcnt lgkmcnt(3)
    v_smfmac_f32_16x16x64_bf16 v[52:55], v[56:59], v[72:79], v5
    ds_read_b128 v[72:75], v1 offset:51200
    ds_read_b128 v[76:79], v1 offset:52224
    v_smfmac_f32_16x16x64_bf16 v[44:47], v[56:59], v[88:95], v5
    ds_read_b128 v[56:59], v15 offset:8192
    s_waitcnt lgkmcnt(5)
    v_smfmac_f32_16x16x64_bf16 v[32:35], v[60:63], a[56:63], v5
    s_waitcnt lgkmcnt(3)
    v_smfmac_f32_16x16x64_bf16 v[48:51], v[60:63], v[64:71], v5
    v_add_u32 v1, 0x10000, v1
    ds_read_b128 v[64:67], v1 offset:0
    ds_read_b128 v[68:71], v1 offset:1024
    v_smfmac_f32_16x16x64_bf16 v[36:39], v[60:63], a[128:135], v5
    v_smfmac_f32_16x16x64_bf16 v[40:43], v[60:63], a[200:207], v5
    s_waitcnt lgkmcnt(3)
    v_smfmac_f32_16x16x64_bf16 v[52:55], v[60:63], v[72:79], v5
    ds_read_b128 v[72:75], v1 offset:2048
    ds_read_b128 v[76:79], v1 offset:3072
    v_smfmac_f32_16x16x64_bf16 v[44:47], v[60:63], v[96:103], v5
    s_waitcnt lgkmcnt(4)
    v_smfmac_f32_16x16x64_bf16 v[32:35], v[56:59], a[64:71], v5
    v_smfmac_f32_16x16x64_bf16 v[36:39], v[56:59], a[136:143], v5
    v_smfmac_f32_16x16x64_bf16 v[40:43], v[56:59], a[208:215], v5
    v_smfmac_f32_16x16x64_bf16 v[44:47], v[56:59], v[104:111], v5
    s_waitcnt lgkmcnt(2)
    v_smfmac_f32_16x16x64_bf16 v[48:51], v[56:59], v[64:71], v5
    s_waitcnt lgkmcnt(0)
    v_smfmac_f32_16x16x64_bf16 v[52:55], v[56:59], v[72:79], v5
    v_subrev_u32 v1, 0x20000, v1
    s_waitcnt vmcnt(3)
    s_branch L_cC_15
.p2align 8
L_cC_15:
    v_cvt_pk_bf16_f32 v32, v32, v33
    v_cvt_pk_bf16_f32 v33, v34, v35
    v_cvt_pk_bf16_f32 v34, v36, v37
    v_cvt_pk_bf16_f32 v35, v38, v39
    v_mfma_f32_16x16x16_bf16 v[36:39], v[32:33], v[6:7], 0
    v_cvt_pk_bf16_f32 v40, v40, v41
    v_cvt_pk_bf16_f32 v41, v42, v43
    v_mfma_f32_16x16x16_bf16 v[32:35], v[34:35], v[6:7], 0
    v_cvt_pk_bf16_f32 v42, v44, v45
    v_cvt_pk_bf16_f32 v43, v46, v47
    v_mfma_f32_16x16x16_bf16 v[44:47], v[40:41], v[6:7], 0
    s_nop 0
    v_mfma_f32_16x16x16_bf16 v[40:43], v[42:43], v[6:7], 0
    v_cvt_pk_bf16_f32 v48, v48, v49
    v_cvt_pk_bf16_f32 v49, v50, v51
    v_cvt_pk_bf16_f32 v36, v36, v37
    v_cvt_pk_bf16_f32 v37, v38, v39
    v_cvt_pk_bf16_f32 v38, v32, v33
    v_cvt_pk_bf16_f32 v39, v34, v35
    v_cvt_pk_bf16_f32 v50, v52, v53
    v_cvt_pk_bf16_f32 v51, v54, v55
    buffer_store_dwordx4 v[48:51], v4, s[8:11], s69 offen offset:1024 sc1
    v_mfma_f32_16x16x32_bf16 v[16:19], v[16:19], v[36:39], 0
    v_mfma_f32_16x16x32_bf16 v[20:23], v[20:23], v[36:39], 0
    v_cvt_pk_bf16_f32 v44, v44, v45
    v_cvt_pk_bf16_f32 v45, v46, v47
    v_cvt_pk_bf16_f32 v46, v40, v41
    v_cvt_pk_bf16_f32 v47, v42, v43
    s_cmp_eq_u32 s60, 63
    s_nop 0
    v_mfma_f32_16x16x32_bf16 v[32:35], v[44:47], v[36:39], 0
    s_nop 0
    v_cndmask_b32 v16, v16, v20, s[74:75]
    v_cndmask_b32 v17, v17, v21, s[74:75]
    v_cndmask_b32 v18, v18, v22, s[74:75]
    v_cndmask_b32 v19, v19, v23, s[74:75]
    ds_write_b128 v11, v[16:19]
    s_nop 1
    v_cndmask_b32 v32, v32, v33, s[74:75]
    v_cndmask_b32 v34, v34, v35, s[74:75]
    v_cndmask_b32 v32, v32, v34, s[76:77]
    ds_write_b32 v12, v32
    buffer_store_dwordx4 v[44:47], v4, s[8:11], s69 offen sc1
    s_cbranch_scc1 L_clx_14
    s_add_u32 s69, s69, 8192
    s_add_u32 s68, s68, 16384
    s_waitcnt lgkmcnt(0)
    s_barrier
    ds_read_b128 v[32:35], v15 offset:9216
    ds_read_b128 v[36:39], v15 offset:10240
    ds_read_b128 v[40:43], v15 offset:11264
    ds_read_b128 v[44:47], v15 offset:12288
    ds_read_b128 v[52:55], v15 offset:13312
    buffer_load_dwordx4 v[16:19], v4, s[8:11], s68 offen offset:0 sc1
    buffer_load_dwordx4 v[20:23], v4, s[8:11], s68 offen offset:1024 sc1
    s_cmp_lg_u32 s4, 3
    s_cbranch_scc1 L_nomkf_16
    s_cmp_eq_u32 s60, 0
    s_cbranch_scc1 L_nomkf_16
    s_lshl_b32 s70, s60, 2
    s_add_u32 s70, s70, s82
    s_add_u32 s70, s70, 8188
    v_mov_b32 v76, 1
    s_mov_b64 exec, 1
    buffer_store_dword v76, off, s[8:11], s70 sc1
    s_mov_b64 exec, -1
L_nomkf_16:
    s_waitcnt lgkmcnt(3)
    v_pk_add_f32 v[32:33], v[32:33], v[36:37]
    v_pk_add_f32 v[34:35], v[34:35], v[38:39]
    s_waitcnt lgkmcnt(1)
    v_pk_add_f32 v[40:41], v[40:41], v[44:45]
    v_pk_add_f32 v[42:43], v[42:43], v[46:47]
    s_waitcnt lgkmcnt(0)
    v_pk_add_f32 v[52:53], v[52:53], v[54:55]
    v_pk_add_f32 v[32:33], v[32:33], v[40:41]
    v_pk_add_f32 v[34:35], v[34:35], v[42:43]
    v_add_f32 v36, v52, v53
    v_max3_f32 v38, v32, v33, v34
    v_max3_f32 v38, v38, v35, v36
    v_mov_b64 v[56:57], 0
    v_mov_b64 v[58:59], 0
    v_max_f32_dpp v38, v38, v38 row_ror:8 row_mask:0xf bank_mask:0xf
    v_mov_b32 v39, v38
    v_mov_b64 v[60:61], 0
    v_mov_b64 v[62:63], 0
    v_permlane16_swap_b32 v38, v39
    v_max_f32 v38, v38, v39
    v_mov_b32 v39, v38
    v_mov_b64 v[64:65], 0
    v_mov_b64 v[66:67], 0
    v_permlane32_swap_b32 v38, v39
    v_max_f32 v38, v38, v39
    v_mul_f32 v38, s64, v38
    v_fma_f32 v36, v36, s64, -v38
    v_fma_f32 v32, v32, s64, -v38
    v_fma_f32 v33, v33, s64, -v38
    v_fma_f32 v34, v34, s64, -v38
    v_fma_f32 v35, v35, s64, -v38
    v_exp_f32 v36, v36
    v_exp_f32 v32, v32
    v_exp_f32 v33, v33
    v_exp_f32 v34, v34
    v_exp_f32 v35, v35
    v_mov_b32_dpp v37, v36 row_ror:8 row_mask:0xf bank_mask:0xf
    v_add_f32 v38, v32, v33
    v_add_f32 v39, v34, v35
    v_cvt_pk_bf16_f32 v32, v32, v33
    v_cvt_pk_bf16_f32 v33, v34, v35
    v_add_f32 v38, v38, v36
    v_cvt_pk_bf16_f32 v36, v36, v37
    v_mov_b32_dpp v34, v32 row_ror:8 row_mask:0xf bank_mask:0xf
    v_mov_b32_dpp v35, v33 row_ror:8 row_mask:0xf bank_mask:0xf
    v_mov_b32 v37, v36
    v_add_f32 v38, v38, v39
    v_mfma_f32_16x16x32_bf16 v[40:43], v[24:27], v[32:35], 0
    v_permlane32_swap_b32 v36, v37
    v_mfma_f32_16x16x32_bf16 v[44:47], v[28:31], v[32:35], 0
    v_add_f32_dpp v38, v38, v38 row_ror:8 row_mask:0xf bank_mask:0xf
    v_mfma_f32_16x16x16_bf16 v[40:43], v[48:49], v[36:37], v[40:43]
    v_mov_b32 v39, v38
    v_mfma_f32_16x16x16_bf16 v[44:47], v[50:51], v[36:37], v[44:47]
    v_mov_b64 v[68:69], 0
    v_permlane16_swap_b32 v38, v39
    v_add_f32 v38, v38, v39
    v_mov_b32 v39, v38
    v_mov_b64 v[70:71], 0
    v_mov_b64 v[72:73], 0
    v_permlane32_swap_b32 v38, v39
    v_add_f32 v38, v38, v39
    v_rcp_f32 v38, v38
    v_mov_b64 v[74:75], 0
    v_mul_f32 v40, v40, v38
    v_mul_f32 v41, v41, v38
    v_mul_f32 v42, v42, v38
    v_mul_f32 v43, v43, v38
    v_mul_f32_dpp v40, v44, v38 row_ror:8 row_mask:0xf bank_mask:0xc
    v_mul_f32_dpp v41, v45, v38 row_ror:8 row_mask:0xf bank_mask:0xc
    v_mul_f32_dpp v42, v46, v38 row_ror:8 row_mask:0xf bank_mask:0xc
    v_mul_f32_dpp v43, v47, v38 row_ror:8 row_mask:0xf bank_mask:0xc
    v_cvt_pk_bf16_f32 v40, v40, v41
    v_cvt_pk_bf16_f32 v41, v42, v43
    ds_write_b64 v14, v[40:41]
    s_add_u32 s70, s40, s63
    s_add_u32 s71, s70, 262144
    s_add_u32 s36, s41, s63
    s_add_u32 s37, s36, 4096
    s_add_u32 s38, s36, 8192
    s_add_u32 s39, s36, 12288
    s_mul_i32 s36, s36, s65
    s_waitcnt lgkmcnt(0)
    s_barrier
    ds_read_b128 v[48:51], v15 offset:14336
    ds_read_b128 v[52:55], v15 offset:15360
    ds_read_b128 v[32:35], v13 offset:0
    ds_read_b128 v[36:39], v13 offset:512
    ds_read_b128 v[40:43], v13 offset:1024
    ds_read_b128 v[44:47], v13 offset:1536
    v_lshrrev_b32 v78, 13, v9
    v_and_b32 v78, 4, v78
    v_and_b32 v77, 0x7fff, v9
    v_add_u32 v78, v77, v78
    s_waitcnt lgkmcnt(5)
    v_smfmac_f32_16x16x64_bf16 v[72:75], v[48:51], v[240:247], v5
    s_waitcnt lgkmcnt(4)
    v_smfmac_f32_16x16x64_bf16 v[72:75], v[52:55], v[248:255], v5
    s_waitcnt lgkmcnt(3)
    v_smfmac_f32_16x16x64_bf16 v[56:59], v[32:35], v[112:119], v5
    v_smfmac_f32_16x16x64_bf16 v[60:63], v[32:35], v[144:151], v5
    s_waitcnt lgkmcnt(2)
    v_smfmac_f32_16x16x64_bf16 v[56:59], v[36:39], v[120:127], v5
    v_smfmac_f32_16x16x64_bf16 v[60:63], v[36:39], v[152:159], v5
    s_nop 1
    v_permlane32_swap_b32 v72, v74
    v_permlane32_swap_b32 v73, v75
    s_waitcnt lgkmcnt(1)
    v_smfmac_f32_16x16x64_bf16 v[56:59], v[40:43], v[128:135], v5
    v_add_f32 v72, v72, v74
    v_add_f32 v73, v73, v75
    v_smfmac_f32_16x16x64_bf16 v[60:63], v[40:43], v[160:167], v5
    v_cvt_pk_bf16_f32 v72, v72, v73
    s_waitcnt lgkmcnt(0)
    v_smfmac_f32_16x16x64_bf16 v[56:59], v[44:47], v[136:143], v5
    v_bfi_b32 v72, 1, s42, v72
    buffer_store_dword v72, v78, s[8:11], s71 offen
    v_smfmac_f32_16x16x64_bf16 v[60:63], v[44:47], v[168:175], v5
    v_smfmac_f32_16x16x64_bf16 v[64:67], v[32:35], v[176:183], v5
    v_smfmac_f32_16x16x64_bf16 v[64:67], v[36:39], v[184:191], v5
    s_nop 2
    v_cvt_pk_bf16_f32 v56, v56, v57
    v_cvt_pk_bf16_f32 v57, v58, v59
    v_bfi_b32 v56, 1, s42, v56
    v_bfi_b32 v57, 1, s42, v57
    buffer_store_dwordx2 v[56:57], v9, s[8:11], s70 offen
    s_add_u32 s70, s70, 65536
    v_smfmac_f32_16x16x64_bf16 v[64:67], v[40:43], v[192:199], v5
    v_smfmac_f32_16x16x64_bf16 v[64:67], v[44:47], v[200:207], v5
    v_cvt_pk_bf16_f32 v60, v60, v61
    v_cvt_pk_bf16_f32 v61, v62, v63
    v_bfi_b32 v60, 1, s42, v60
    v_bfi_b32 v61, 1, s42, v61
    buffer_store_dwordx2 v[60:61], v9, s[8:11], s70 offen
    s_add_u32 s70, s70, 65536
    v_smfmac_f32_16x16x64_bf16 v[68:71], v[32:35], v[208:215], v5
    v_smfmac_f32_16x16x64_bf16 v[68:71], v[36:39], v[216:223], v5
    v_smfmac_f32_16x16x64_bf16 v[68:71], v[40:43], v[224:231], v5
    v_cvt_pk_bf16_f32 v64, v64, v65
    v_cvt_pk_bf16_f32 v65, v66, v67
    v_bfi_b32 v64, 1, s42, v64
    v_bfi_b32 v65, 1, s42, v65
    buffer_store_dwordx2 v[64:65], v9, s[8:11], s70 offen
    s_add_u32 s70, s70, 65536
    v_smfmac_f32_16x16x64_bf16 v[68:71], v[44:47], v[232:239], v5
    s_nop 7
    v_cvt_pk_bf16_f32 v68, v68, v69
    v_cvt_pk_bf16_f32 v69, v70, v71
    v_bfi_b32 v68, 1, s42, v68
    v_bfi_b32 v69, 1, s42, v69
    buffer_store_dwordx2 v[68:69], v9, s[8:11], s70 offen
    s_cmp_eq_u32 s4, 1
    s_cbranch_scc1 L_pw1_18
    s_cmp_eq_u32 s4, 3
    s_cbranch_scc1 L_pw3_20
    s_cmp_eq_u32 s4, 0
    s_cbranch_scc1 L_pw0_17
    buffer_load_dwordx4 v[32:35], v4, s[8:11], s36 offen sc1
    buffer_load_dwordx4 v[36:39], v4, s[8:11], s37 offen sc1
    buffer_load_dwordx4 v[40:43], v4, s[8:11], s38 offen sc1
    buffer_load_dwordx4 v[44:47], v4, s[8:11], s39 offen sc1
    v_add_u32 v1, 0x10000, v1
    ds_read_b128 v[64:67], v1 offset:0
    ds_read_b128 v[68:71], v1 offset:1024
    ds_read_b128 v[72:75], v1 offset:2048
    ds_read_b128 v[76:79], v1 offset:3072
    s_lshl_b64 s[80:81], s[78:79], 0
    v_cndmask_b32 v48, 0, v0, s[80:81]
    s_lshl_b64 s[80:81], s[78:79], 2
    v_cndmask_b32 v49, 0, v0, s[80:81]
    s_lshl_b64 s[80:81], s[78:79], 4
    v_cndmask_b32 v50, 0, v0, s[80:81]
    s_lshl_b64 s[80:81], s[78:79], 6
    v_cndmask_b32 v51, 0, v0, s[80:81]
    s_lshl_b32 s29, s67, 7
    s_add_u32 s27, s29, s62
    s_add_u32 s29, s29, s61
    s_mov_b32 s59, 0
L_rs_21:
    s_waitcnt vmcnt(0)
    v_bitop3_b32 v56, v32, v33, s42 bitop3:0x7e
    v_bitop3_b32 v57, v34, v35, s42 bitop3:0x7e
    v_mfma_f32_16x16x32_bf16 v[52:55], v[48:51], v[32:35], 0
    v_bitop3_b32 v58, v36, v37, s42 bitop3:0x7e
    v_bitop3_b32 v59, v38, v39, s42 bitop3:0x7e
    v_mfma_f32_16x16x32_bf16 v[52:55], v[48:51], v[36:39], v[52:55]
    v_or3_b32 v28, v56, v57, v58
    v_bitop3_b32 v60, v40, v41, s42 bitop3:0x7e
    v_bitop3_b32 v61, v42, v43, s42 bitop3:0x7e
    v_mfma_f32_16x16x32_bf16 v[52:55], v[48:51], v[40:43], v[52:55]
    v_or3_b32 v29, v59, v60, v61
    v_bitop3_b32 v62, v44, v45, s42 bitop3:0x7e
    v_bitop3_b32 v63, v46, v47, s42 bitop3:0x7e
    v_mfma_f32_16x16x32_bf16 v[52:55], v[48:51], v[44:47], v[52:55]
    v_or3_b32 v28, v28, v62, v63
    v_bitop3_b32 v28, v28, v29, 1 bitop3:0xa8
    v_cmp_ne_u32 vcc, 0, v28
    s_cbranch_vccnz L_rsx_24
L_rss_22:
    s_nop 3
    v_add_f32_dpp v52, v52, v52 row_ror:8 row_mask:0xf bank_mask:0xf
    v_add_f32_dpp v53, v53, v53 row_ror:8 row_mask:0xf bank_mask:0xf
    v_add_f32_dpp v54, v54, v54 row_ror:8 row_mask:0xf bank_mask:0xf
    v_add_f32_dpp v55, v55, v55 row_ror:8 row_mask:0xf bank_mask:0xf
    v_permlane16_swap_b32 v52, v53
    s_nop 0
    v_permlane16_swap_b32 v54, v55
    v_cvt_pk_bf16_f32 v52, v52, v53
    v_cvt_pk_bf16_f32 v54, v54, v55
    v_cndmask_b32 v52, v52, v54, s[74:75]
    buffer_store_dword v52, v10, s[8:11], s27 offen
    s_barrier
    s_add_u32 s70, s62, 4096
    s_nop 15
    buffer_load_dwordx4 v[24:27], v8, s[8:11], s70 offen offset:0 sc1
    buffer_load_dwordx4 v[28:31], v8, s[8:11], s70 offen offset:1024 sc1
    v_mov_b64 v[48:49], 0
    v_mov_b64 v[50:51], 0
    v_mov_b64 v[52:53], 0
    v_mov_b64 v[54:55], 0
    s_add_u32 s60, s60, 1
    s_mov_b32 s61, s62
    s_add_u32 s62, s62, 9216
    s_cmp_eq_u32 s62, 93184
    s_cselect_b32 s62, 65536, s62
    s_sub_u32 s63, 491520, s63
    s_bfe_u32 s42, s60, 0x10001
    s_mov_b32 s59, 0
    s_nop 15
    s_nop 15
    buffer_load_dwordx4 v[24:27], v8, s[8:11], s70 offen offset:0 sc1
    buffer_load_dwordx4 v[28:31], v8, s[8:11], s70 offen offset:1024 sc1
    v_mov_b32 v2, -1
    buffer_store_dword v2, v10, s[8:11], s29 offen
    s_waitcnt vmcnt(6)
    v_mov_b64 v[32:33], 0
    v_mov_b64 v[34:35], 0
    v_mov_b64 v[36:37], 0
    v_mov_b64 v[38:39], 0
    v_mov_b64 v[40:41], 0
    v_mov_b64 v[42:43], 0
    v_mov_b64 v[44:45], 0
    v_mov_b64 v[46:47], 0
L_gat_25:
    s_waitcnt vmcnt(3)
    v_max3_u32 v60, v24, v25, v26
    v_max_u32 v60, v60, v27
    v_max3_u32 v61, v28, v29, v30
    v_max_u32 v61, v61, v31
    v_max_u32 v63, v60, v61
    v_cmp_eq_u32 vcc, -1, v63
    s_cbranch_vccnz L_gatx_26
L_gat_25_ok:
    s_waitcnt lgkmcnt(0)
    ds_write_b128 v15, v[24:27] offset:4096
    ds_write_b128 v15, v[28:31] offset:5120
    v_smfmac_f32_16x16x64_bf16 v[32:35], v[24:27], a[32:39], v5
    v_smfmac_f32_16x16x64_bf16 v[48:51], v[24:27], v[64:71], v5
    ds_read_b128 v[64:67], v1 offset:16384
    ds_read_b128 v[68:71], v1 offset:17408
    v_smfmac_f32_16x16x64_bf16 v[36:39], v[24:27], a[104:111], v5
    v_smfmac_f32_16x16x64_bf16 v[40:43], v[24:27], a[176:183], v5
    v_smfmac_f32_16x16x64_bf16 v[52:55], v[24:27], v[72:79], v5
    ds_read_b128 v[72:75], v1 offset:18432
    ds_read_b128 v[76:79], v1 offset:19456
    v_smfmac_f32_16x16x64_bf16 v[44:47], v[24:27], a[248:255], v5
    v_smfmac_f32_16x16x64_bf16 v[32:35], v[28:31], a[40:47], v5
    s_waitcnt lgkmcnt(2)
    v_smfmac_f32_16x16x64_bf16 v[48:51], v[28:31], v[64:71], v5
    v_subrev_u32 v1, 0x10000, v1
    ds_read_b128 v[64:67], v1 offset:0
    ds_read_b128 v[68:71], v1 offset:1024
    v_smfmac_f32_16x16x64_bf16 v[36:39], v[28:31], a[112:119], v5
    v_smfmac_f32_16x16x64_bf16 v[40:43], v[28:31], a[184:191], v5
    s_waitcnt lgkmcnt(2)
    v_smfmac_f32_16x16x64_bf16 v[52:55], v[28:31], v[72:79], v5
    ds_read_b128 v[72:75], v1 offset:2048
    ds_read_b128 v[76:79], v1 offset:3072
    v_smfmac_f32_16x16x64_bf16 v[44:47], v[28:31], v[80:87], v5
    s_barrier
    ds_read_b128 v[56:59], v15 offset:0
    ds_read_b128 v[60:63], v15 offset:1024
    buffer_load_dwordx4 v[24:27], v4, s[8:11], s68 offen offset:2048 sc1
    buffer_load_dwordx4 v[28:31], v4, s[8:11], s68 offen offset:3072 sc1
    s_waitcnt lgkmcnt(1)
    v_smfmac_f32_16x16x64_bf16 v[32:35], v[56:59], a[0:7], v5
    v_smfmac_f32_16x16x64_bf16 v[48:51], v[56:59], v[64:71], v5
    ds_read_b128 v[64:67], v1 offset:16384
    ds_read_b128 v[68:71], v1 offset:17408
    v_smfmac_f32_16x16x64_bf16 v[36:39], v[56:59], a[72:79], v5
    v_smfmac_f32_16x16x64_bf16 v[40:43], v[56:59], a[144:151], v5
    v_smfmac_f32_16x16x64_bf16 v[52:55], v[56:59], v[72:79], v5
    ds_read_b128 v[72:75], v1 offset:18432
    ds_read_b128 v[76:79], v1 offset:19456
    v_smfmac_f32_16x16x64_bf16 v[44:47], v[56:59], a[216:223], v5
    ds_read_b128 v[56:59], v15 offset:2048
    s_add_u32 s70, s68, 32768
    buffer_load_dword v2, v3, s[8:11], s70 offen
    s_waitcnt lgkmcnt(5)
    v_smfmac_f32_16x16x64_bf16 v[32:35], v[60:63], a[8:15], v5
    s_waitcnt lgkmcnt(3)
    v_smfmac_f32_16x16x64_bf16 v[48:51], v[60:63], v[64:71], v5
    ds_read_b128 v[64:67], v1 offset:32768
    ds_read_b128 v[68:71], v1 offset:33792
    v_smfmac_f32_16x16x64_bf16 v[36:39], v[60:63], a[80:87], v5
    v_smfmac_f32_16x16x64_bf16 v[40:43], v[60:63], a[152:159], v5
    s_waitcnt lgkmcnt(3)
    v_smfmac_f32_16x16x64_bf16 v[52:55], v[60:63], v[72:79], v5
    ds_read_b128 v[72:75], v1 offset:34816
    ds_read_b128 v[76:79], v1 offset:35840
    v_smfmac_f32_16x16x64_bf16 v[44:47], v[60:63], a[224:231], v5
    ds_read_b128 v[60:63], v15 offset:3072
    s_waitcnt lgkmcnt(5)
    v_smfmac_f32_16x16x64_bf16 v[32:35], v[56:59], a[16:23], v5
    s_waitcnt lgkmcnt(3)
    v_smfmac_f32_16x16x64_bf16 v[48:51], v[56:59], v[64:71], v5
    ds_read_b128 v[64:67], v1 offset:49152
    ds_read_b128 v[68:71], v1 offset:50176
    v_smfmac_f32_16x16x64_bf16 v[36:39], v[56:59], a[88:95], v5
    v_smfmac_f32_16x16x64_bf16 v[40:43], v[56:59], a[160:167], v5
    s_waitcnt lgkmcnt(3)
    v_smfmac_f32_16x16x64_bf16 v[52:55], v[56:59], v[72:79], v5
    ds_read_b128 v[72:75], v1 offset:51200
    ds_read_b128 v[76:79], v1 offset:52224
    v_smfmac_f32_16x16x64_bf16 v[44:47], v[56:59], a[232:239], v5
    ds_read_b128 v[56:59], v15 offset:8192
    s_waitcnt lgkmcnt(5)
    v_smfmac_f32_16x16x64_bf16 v[32:35], v[60:63], a[24:31], v5
    s_waitcnt lgkmcnt(3)
    v_smfmac_f32_16x16x64_bf16 v[48:51], v[60:63], v[64:71], v5
    v_add_u32 v1, 0x20000, v1
    ds_read_b128 v[64:67], v1 offset:0
    ds_read_b128 v[68:71], v1 offset:1024
    v_smfmac_f32_16x16x64_bf16 v[36:39], v[60:63], a[96:103], v5
    v_smfmac_f32_16x16x64_bf16 v[40:43], v[60:63], a[168:175], v5
    s_waitcnt lgkmcnt(3)
    v_smfmac_f32_16x16x64_bf16 v[52:55], v[60:63], v[72:79], v5
    ds_read_b128 v[72:75], v1 offset:2048
    ds_read_b128 v[76:79], v1 offset:3072
    v_smfmac_f32_16x16x64_bf16 v[44:47], v[60:63], a[240:247], v5
    ds_read_b128 v[60:63], v15 offset:6144
    s_waitcnt lgkmcnt(5)
    v_smfmac_f32_16x16x64_bf16 v[32:35], v[56:59], a[64:71], v5
    s_waitcnt lgkmcnt(3)
    v_smfmac_f32_16x16x64_bf16 v[48:51], v[56:59], v[64:71], v5
    v_subrev_u32 v1, 0x10000, v1
    ds_read_b128 v[64:67], v1 offset:32768
    ds_read_b128 v[68:71], v1 offset:33792
    v_smfmac_f32_16x16x64_bf16 v[36:39], v[56:59], a[136:143], v5
    v_smfmac_f32_16x16x64_bf16 v[40:43], v[56:59], a[208:215], v5
    s_waitcnt lgkmcnt(3)
    v_smfmac_f32_16x16x64_bf16 v[52:55], v[56:59], v[72:79], v5
    ds_read_b128 v[72:75], v1 offset:34816
    ds_read_b128 v[76:79], v1 offset:35840
    v_smfmac_f32_16x16x64_bf16 v[44:47], v[56:59], v[104:111], v5
    ds_read_b128 v[56:59], v15 offset:7168
    s_waitcnt lgkmcnt(5)
    v_smfmac_f32_16x16x64_bf16 v[32:35], v[60:63], a[48:55], v5
    s_waitcnt lgkmcnt(3)
    v_smfmac_f32_16x16x64_bf16 v[48:51], v[60:63], v[64:71], v5
    ds_read_b128 v[64:67], v1 offset:49152
    ds_read_b128 v[68:71], v1 offset:50176
    v_smfmac_f32_16x16x64_bf16 v[36:39], v[60:63], a[120:127], v5
    v_smfmac_f32_16x16x64_bf16 v[40:43], v[60:63], a[192:199], v5
    s_waitcnt lgkmcnt(3)
    v_smfmac_f32_16x16x64_bf16 v[52:55], v[60:63], v[72:79], v5
    ds_read_b128 v[72:75], v1 offset:51200
    ds_read_b128 v[76:79], v1 offset:52224
    v_smfmac_f32_16x16x64_bf16 v[44:47], v[60:63], v[88:95], v5
    s_waitcnt lgkmcnt(4)
    v_smfmac_f32_16x16x64_bf16 v[32:35], v[56:59], a[56:63], v5
    v_smfmac_f32_16x16x64_bf16 v[36:39], v[56:59], a[128:135], v5
    v_smfmac_f32_16x16x64_bf16 v[40:43], v[56:59], a[200:207], v5
    v_smfmac_f32_16x16x64_bf16 v[44:47], v[56:59], v[96:103], v5
    s_waitcnt lgkmcnt(2)
    v_smfmac_f32_16x16x64_bf16 v[48:51], v[56:59], v[64:71], v5
    s_waitcnt lgkmcnt(0)
    v_smfmac_f32_16x16x64_bf16 v[52:55], v[56:59], v[72:79], v5
    v_subrev_u32 v1, 0x10000, v1
    s_waitcnt vmcnt(1)
    s_branch L_cC_15
L_rsx_24:
    v_bitop3_b32 v28, v56, v57, 1 bitop3:0xa8
    v_bitop3_b32 v29, v58, v59, 1 bitop3:0xa8
    v_bitop3_b32 v30, v60, v61, 1 bitop3:0xa8
    v_bitop3_b32 v31, v62, v63, 1 bitop3:0xa8
    v_cmp_ne_u32 s[16:17], 0, v28
    v_cmp_ne_u32 s[18:19], 0, v29
    v_cmp_ne_u32 s[20:21], 0, v30
    v_cmp_ne_u32 s[22:23], 0, v31
    s_mov_b64 exec, s[16:17]
    buffer_load_dwordx4 v[32:35], v4, s[8:11], s36 offen sc1
    s_mov_b64 exec, s[18:19]
    buffer_load_dwordx4 v[36:39], v4, s[8:11], s37 offen sc1
    s_mov_b64 exec, s[20:21]
    buffer_load_dwordx4 v[40:43], v4, s[8:11], s38 offen sc1
    s_mov_b64 exec, s[22:23]
    buffer_load_dwordx4 v[44:47], v4, s[8:11], s39 offen sc1
    s_mov_b64 exec, -1
    s_add_u32 s59, s59, 1
    s_cmp_lt_u32 s59, s58
    s_cbranch_scc1 L_rs_21
    s_mov_b32 s58, 0
    s_branch L_rss_22
L_gatx_26:
    v_cmp_eq_u32 s[16:17], -1, v60
    v_cmp_eq_u32 s[18:19], -1, v61
    s_mov_b64 exec, s[16:17]
    buffer_load_dwordx4 v[24:27], v8, s[8:11], s70 offen offset:0 sc1
    s_mov_b64 exec, s[18:19]
    buffer_load_dwordx4 v[28:31], v8, s[8:11], s70 offen offset:1024 sc1
    s_mov_b64 exec, -1
    s_add_u32 s59, s59, 1
    s_cmp_lt_u32 s59, s58
    s_cbranch_scc1 L_gat_25
    s_mov_b32 s58, 0
    s_branch L_gat_25_ok
L_pw1_18:
    buffer_load_dwordx4 v[32:35], v4, s[8:11], s36 offen sc1
    buffer_load_dwordx4 v[36:39], v4, s[8:11], s37 offen sc1
    buffer_load_dwordx4 v[40:43], v4, s[8:11], s38 offen sc1
    buffer_load_dwordx4 v[44:47], v4, s[8:11], s39 offen sc1
    ds_read_b128 v[64:67], v1 offset:32768
    ds_read_b128 v[68:71], v1 offset:33792
    ds_read_b128 v[72:75], v1 offset:34816
    ds_read_b128 v[76:79], v1 offset:35840
    s_lshl_b64 s[80:81], s[78:79], 0
    v_cndmask_b32 v48, 0, v0, s[80:81]
    s_lshl_b64 s[80:81], s[78:79], 2
    v_cndmask_b32 v49, 0, v0, s[80:81]
    s_lshl_b64 s[80:81], s[78:79], 4
    v_cndmask_b32 v50, 0, v0, s[80:81]
    s_lshl_b64 s[80:81], s[78:79], 6
    v_cndmask_b32 v51, 0, v0, s[80:81]
    s_lshl_b32 s29, s67, 7
    s_add_u32 s27, s29, s62
    s_add_u32 s29, s29, s61
    s_mov_b32 s59, 0
    s_nop 15
    s_nop 15
    s_nop 15
    s_nop 15
    buffer_load_dwordx4 v[32:35], v4, s[8:11], s36 offen sc1
    buffer_load_dwordx4 v[36:39], v4, s[8:11], s37 offen sc1
    buffer_load_dwordx4 v[40:43], v4, s[8:11], s38 offen sc1
    buffer_load_dwordx4 v[44:47], v4, s[8:11], s39 offen sc1
L_rs_27:
    s_waitcnt vmcnt(4)
    v_bitop3_b32 v56, v32, v33, s42 bitop3:0x7e
    v_bitop3_b32 v57, v34, v35, s42 bitop3:0x7e
    v_mfma_f32_16x16x32_bf16 v[52:55], v[48:51], v[32:35], 0
    v_bitop3_b32 v58, v36, v37, s42 bitop3:0x7e
    v_bitop3_b32 v59, v38, v39, s42 bitop3:0x7e
    v_mfma_f32_16x16x32_bf16 v[52:55], v[48:51], v[36:39], v[52:55]
    v_or3_b32 v28, v56, v57, v58
    v_bitop3_b32 v60, v40, v41, s42 bitop3:0x7e
    v_bitop3_b32 v61, v42, v43, s42 bitop3:0x7e
    v_mfma_f32_16x16x32_bf16 v[52:55], v[48:51], v[40:43], v[52:55]
    v_or3_b32 v29, v59, v60, v61
    v_bitop3_b32 v62, v44, v45, s42 bitop3:0x7e
    v_bitop3_b32 v63, v46, v47, s42 bitop3:0x7e
    v_mfma_f32_16x16x32_bf16 v[52:55], v[48:51], v[44:47], v[52:55]
    v_or3_b32 v28, v28, v62, v63
    v_bitop3_b32 v28, v28, v29, 1 bitop3:0xa8
    v_cmp_ne_u32 vcc, 0, v28
    s_cbranch_vccnz L_rsx_30
L_rss_28:
    s_nop 3
    v_add_f32_dpp v52, v52, v52 row_ror:8 row_mask:0xf bank_mask:0xf
    v_add_f32_dpp v53, v53, v53 row_ror:8 row_mask:0xf bank_mask:0xf
    v_add_f32_dpp v54, v54, v54 row_ror:8 row_mask:0xf bank_mask:0xf
    v_add_f32_dpp v55, v55, v55 row_ror:8 row_mask:0xf bank_mask:0xf
    v_permlane16_swap_b32 v52, v53
    s_nop 0
    v_permlane16_swap_b32 v54, v55
    v_cvt_pk_bf16_f32 v52, v52, v53
    v_cvt_pk_bf16_f32 v54, v54, v55
    v_cndmask_b32 v52, v52, v54, s[74:75]
    buffer_store_dword v52, v10, s[8:11], s27 offen
    s_barrier
    s_add_u32 s70, s62, 2048
    s_nop 15
    buffer_load_dwordx4 v[24:27], v8, s[8:11], s70 offen offset:0 sc1
    buffer_load_dwordx4 v[28:31], v8, s[8:11], s70 offen offset:1024 sc1
    v_mov_b64 v[48:49], 0
    v_mov_b64 v[50:51], 0
    v_mov_b64 v[52:53], 0
    v_mov_b64 v[54:55], 0
    s_add_u32 s60, s60, 1
    s_mov_b32 s61, s62
    s_add_u32 s62, s62, 9216
    s_cmp_eq_u32 s62, 93184
    s_cselect_b32 s62, 65536, s62
    s_sub_u32 s63, 491520, s63
    s_bfe_u32 s42, s60, 0x10001
    s_mov_b32 s59, 0
    s_nop 15
    s_nop 15
    buffer_load_dwordx4 v[24:27], v8, s[8:11], s70 offen offset:0 sc1
    buffer_load_dwordx4 v[28:31], v8, s[8:11], s70 offen offset:1024 sc1
    v_mov_b32 v2, -1
    buffer_store_dword v2, v10, s[8:11], s29 offen
    s_waitcnt vmcnt(6)
    v_mov_b64 v[32:33], 0
    v_mov_b64 v[34:35], 0
    v_mov_b64 v[36:37], 0
    v_mov_b64 v[38:39], 0
    v_mov_b64 v[40:41], 0
    v_mov_b64 v[42:43], 0
    v_mov_b64 v[44:45], 0
    v_mov_b64 v[46:47], 0
L_gat_31:
    s_waitcnt vmcnt(3)
    v_max3_u32 v60, v24, v25, v26
    v_max_u32 v60, v60, v27
    v_max3_u32 v61, v28, v29, v30
    v_max_u32 v61, v61, v31
    v_max_u32 v63, v60, v61
    v_cmp_eq_u32 vcc, -1, v63
    s_cbranch_vccnz L_gatx_32
L_gat_31_ok:
    s_waitcnt lgkmcnt(0)
    ds_write_b128 v15, v[24:27] offset:2048
    ds_write_b128 v15, v[28:31] offset:3072
    v_smfmac_f32_16x16x64_bf16 v[32:35], v[24:27], a[16:23], v5
    v_smfmac_f32_16x16x64_bf16 v[48:51], v[24:27], v[64:71], v5
    ds_read_b128 v[64:67], v1 offset:49152
    ds_read_b128 v[68:71], v1 offset:50176
    v_smfmac_f32_16x16x64_bf16 v[36:39], v[24:27], a[88:95], v5
    v_smfmac_f32_16x16x64_bf16 v[40:43], v[24:27], a[160:167], v5
    v_smfmac_f32_16x16x64_bf16 v[52:55], v[24:27], v[72:79], v5
    ds_read_b128 v[72:75], v1 offset:51200
    ds_read_b128 v[76:79], v1 offset:52224
    v_smfmac_f32_16x16x64_bf16 v[44:47], v[24:27], a[232:239], v5
    v_smfmac_f32_16x16x64_bf16 v[32:35], v[28:31], a[24:31], v5
    s_waitcnt lgkmcnt(2)
    v_smfmac_f32_16x16x64_bf16 v[48:51], v[28:31], v[64:71], v5
    ds_read_b128 v[64:67], v1 offset:0
    ds_read_b128 v[68:71], v1 offset:1024
    v_smfmac_f32_16x16x64_bf16 v[36:39], v[28:31], a[96:103], v5
    v_smfmac_f32_16x16x64_bf16 v[40:43], v[28:31], a[168:175], v5
    s_waitcnt lgkmcnt(2)
    v_smfmac_f32_16x16x64_bf16 v[52:55], v[28:31], v[72:79], v5
    ds_read_b128 v[72:75], v1 offset:2048
    ds_read_b128 v[76:79], v1 offset:3072
    v_smfmac_f32_16x16x64_bf16 v[44:47], v[28:31], a[240:247], v5
    s_barrier
    ds_read_b128 v[56:59], v15 offset:0
    ds_read_b128 v[60:63], v15 offset:1024
    buffer_load_dwordx4 v[24:27], v4, s[8:11], s68 offen offset:2048 sc1
    buffer_load_dwordx4 v[28:31], v4, s[8:11], s68 offen offset:3072 sc1
    s_waitcnt lgkmcnt(1)
    v_smfmac_f32_16x16x64_bf16 v[32:35], v[56:59], a[0:7], v5
    v_smfmac_f32_16x16x64_bf16 v[48:51], v[56:59], v[64:71], v5
    ds_read_b128 v[64:67], v1 offset:16384
    ds_read_b128 v[68:71], v1 offset:17408
    v_smfmac_f32_16x16x64_bf16 v[36:39], v[56:59], a[72:79], v5
    v_smfmac_f32_16x16x64_bf16 v[40:43], v[56:59], a[144:151], v5
    v_smfmac_f32_16x16x64_bf16 v[52:55], v[56:59], v[72:79], v5
    ds_read_b128 v[72:75], v1 offset:18432
    ds_read_b128 v[76:79], v1 offset:19456
    v_smfmac_f32_16x16x64_bf16 v[44:47], v[56:59], a[216:223], v5
    ds_read_b128 v[56:59], v15 offset:8192
    s_add_u32 s70, s68, 32768
    buffer_load_dword v2, v3, s[8:11], s70 offen
    s_waitcnt lgkmcnt(5)
    v_smfmac_f32_16x16x64_bf16 v[32:35], v[60:63], a[8:15], v5
    s_waitcnt lgkmcnt(3)
    v_smfmac_f32_16x16x64_bf16 v[48:51], v[60:63], v[64:71], v5
    v_add_u32 v1, 0x20000, v1
    ds_read_b128 v[64:67], v1 offset:0
    ds_read_b128 v[68:71], v1 offset:1024
    v_smfmac_f32_16x16x64_bf16 v[36:39], v[60:63], a[80:87], v5
    v_smfmac_f32_16x16x64_bf16 v[40:43], v[60:63], a[152:159], v5
    s_waitcnt lgkmcnt(3)
    v_smfmac_f32_16x16x64_bf16 v[52:55], v[60:63], v[72:79], v5
    ds_read_b128 v[72:75], v1 offset:2048
    ds_read_b128 v[76:79], v1 offset:3072
    v_smfmac_f32_16x16x64_bf16 v[44:47], v[60:63], a[224:231], v5
    ds_read_b128 v[60:63], v15 offset:4096
    s_waitcnt lgkmcnt(5)
    v_smfmac_f32_16x16x64_bf16 v[32:35], v[56:59], a[64:71], v5
    s_waitcnt lgkmcnt(3)
    v_smfmac_f32_16x16x64_bf16 v[48:51], v[56:59], v[64:71], v5
    v_subrev_u32 v1, 0x10000, v1
    ds_read_b128 v[64:67], v1 offset:0
    ds_read_b128 v[68:71], v1 offset:1024
    v_smfmac_f32_16x16x64_bf16 v[36:39], v[56:59], a[136:143], v5
    v_smfmac_f32_16x16x64_bf16 v[40:43], v[56:59], a[208:215], v5
    s_waitcnt lgkmcnt(3)
    v_smfmac_f32_16x16x64_bf16 v[52:55], v[56:59], v[72:79], v5
    ds_read_b128 v[72:75], v1 offset:2048
    ds_read_b128 v[76:79], v1 offset:3072
    v_smfmac_f32_16x16x64_bf16 v[44:47], v[56:59], v[104:111], v5
    ds_read_b128 v[56:59], v15 offset:5120
    s_waitcnt lgkmcnt(5)
    v_smfmac_f32_16x16x64_bf16 v[32:35], v[60:63], a[32:39], v5
    s_waitcnt lgkmcnt(3)
    v_smfmac_f32_16x16x64_bf16 v[48:51], v[60:63], v[64:71], v5
    ds_read_b128 v[64:67], v1 offset:16384
    ds_read_b128 v[68:71], v1 offset:17408
    v_smfmac_f32_16x16x64_bf16 v[36:39], v[60:63], a[104:111], v5
    v_smfmac_f32_16x16x64_bf16 v[40:43], v[60:63], a[176:183], v5
    s_waitcnt lgkmcnt(3)
    v_smfmac_f32_16x16x64_bf16 v[52:55], v[60:63], v[72:79], v5
    ds_read_b128 v[72:75], v1 offset:18432
    ds_read_b128 v[76:79], v1 offset:19456
    v_smfmac_f32_16x16x64_bf16 v[44:47], v[60:63], a[248:255], v5
    ds_read_b128 v[60:63], v15 offset:6144
    s_waitcnt lgkmcnt(5)
    v_smfmac_f32_16x16x64_bf16 v[32:35], v[56:59], a[40:47], v5
    s_waitcnt lgkmcnt(3)
    v_smfmac_f32_16x16x64_bf16 v[48:51], v[56:59], v[64:71], v5
    ds_read_b128 v[64:67], v1 offset:32768
    ds_read_b128 v[68:71], v1 offset:33792
    v_smfmac_f32_16x16x64_bf16 v[36:39], v[56:59], a[112:119], v5
    v_smfmac_f32_16x16x64_bf16 v[40:43], v[56:59], a[184:191], v5
    s_waitcnt lgkmcnt(3)
    v_smfmac_f32_16x16x64_bf16 v[52:55], v[56:59], v[72:79], v5
    ds_read_b128 v[72:75], v1 offset:34816
    ds_read_b128 v[76:79], v1 offset:35840
    v_smfmac_f32_16x16x64_bf16 v[44:47], v[56:59], v[80:87], v5
    ds_read_b128 v[56:59], v15 offset:7168
    s_waitcnt lgkmcnt(5)
    v_smfmac_f32_16x16x64_bf16 v[32:35], v[60:63], a[48:55], v5
    s_waitcnt lgkmcnt(3)
    v_smfmac_f32_16x16x64_bf16 v[48:51], v[60:63], v[64:71], v5
    ds_read_b128 v[64:67], v1 offset:49152
    ds_read_b128 v[68:71], v1 offset:50176
    v_smfmac_f32_16x16x64_bf16 v[36:39], v[60:63], a[120:127], v5
    v_smfmac_f32_16x16x64_bf16 v[40:43], v[60:63], a[192:199], v5
    s_waitcnt lgkmcnt(3)
    v_smfmac_f32_16x16x64_bf16 v[52:55], v[60:63], v[72:79], v5
    ds_read_b128 v[72:75], v1 offset:51200
    ds_read_b128 v[76:79], v1 offset:52224
    v_smfmac_f32_16x16x64_bf16 v[44:47], v[60:63], v[88:95], v5
    s_waitcnt lgkmcnt(4)
    v_smfmac_f32_16x16x64_bf16 v[32:35], v[56:59], a[56:63], v5
    v_smfmac_f32_16x16x64_bf16 v[36:39], v[56:59], a[128:135], v5
    v_smfmac_f32_16x16x64_bf16 v[40:43], v[56:59], a[200:207], v5
    v_smfmac_f32_16x16x64_bf16 v[44:47], v[56:59], v[96:103], v5
    s_waitcnt lgkmcnt(2)
    v_smfmac_f32_16x16x64_bf16 v[48:51], v[56:59], v[64:71], v5
    s_waitcnt lgkmcnt(0)
    v_smfmac_f32_16x16x64_bf16 v[52:55], v[56:59], v[72:79], v5
    v_subrev_u32 v1, 0x10000, v1
    s_waitcnt vmcnt(1)
    s_branch L_cC_15
L_rsx_30:
    v_bitop3_b32 v28, v56, v57, 1 bitop3:0xa8
    v_bitop3_b32 v29, v58, v59, 1 bitop3:0xa8
    v_bitop3_b32 v30, v60, v61, 1 bitop3:0xa8
    v_bitop3_b32 v31, v62, v63, 1 bitop3:0xa8
    v_cmp_ne_u32 s[16:17], 0, v28
    v_cmp_ne_u32 s[18:19], 0, v29
    v_cmp_ne_u32 s[20:21], 0, v30
    v_cmp_ne_u32 s[22:23], 0, v31
    s_mov_b64 exec, s[16:17]
    buffer_load_dwordx4 v[32:35], v4, s[8:11], s36 offen sc1
    s_mov_b64 exec, s[18:19]
    buffer_load_dwordx4 v[36:39], v4, s[8:11], s37 offen sc1
    s_mov_b64 exec, s[20:21]
    buffer_load_dwordx4 v[40:43], v4, s[8:11], s38 offen sc1
    s_mov_b64 exec, s[22:23]
    buffer_load_dwordx4 v[44:47], v4, s[8:11], s39 offen sc1
    s_mov_b64 exec, -1
    s_add_u32 s59, s59, 1
    s_cmp_lt_u32 s59, s58
    s_cbranch_scc1 L_rs_27
    s_mov_b32 s58, 0
    s_branch L_rss_28
L_gatx_32:
    v_cmp_eq_u32 s[16:17], -1, v60
    v_cmp_eq_u32 s[18:19], -1, v61
    s_mov_b64 exec, s[16:17]
    buffer_load_dwordx4 v[24:27], v8, s[8:11], s70 offen offset:0 sc1
    s_mov_b64 exec, s[18:19]
    buffer_load_dwordx4 v[28:31], v8, s[8:11], s70 offen offset:1024 sc1
    s_mov_b64 exec, -1
    s_add_u32 s59, s59, 1
    s_cmp_lt_u32 s59, s58
    s_cbranch_scc1 L_gat_31
    s_mov_b32 s58, 0
    s_branch L_gat_31_ok
L_pw0_17:
    s_cmp_eq_u32 s65, 0
    s_cbranch_scc1 L_nored_33
    buffer_load_dwordx4 v[32:35], v4, s[8:11], s36 offen sc1
    buffer_load_dwordx4 v[36:39], v4, s[8:11], s37 offen sc1
    buffer_load_dwordx4 v[40:43], v4, s[8:11], s38 offen sc1
    buffer_load_dwordx4 v[44:47], v4, s[8:11], s39 offen sc1
    ds_read_b128 v[64:67], v1 offset:0
    ds_read_b128 v[68:71], v1 offset:1024
    ds_read_b128 v[72:75], v1 offset:2048
    ds_read_b128 v[76:79], v1 offset:3072
    s_lshl_b64 s[80:81], s[78:79], 0
    v_cndmask_b32 v48, 0, v0, s[80:81]
    s_lshl_b64 s[80:81], s[78:79], 2
    v_cndmask_b32 v49, 0, v0, s[80:81]
    s_lshl_b64 s[80:81], s[78:79], 4
    v_cndmask_b32 v50, 0, v0, s[80:81]
    s_lshl_b64 s[80:81], s[78:79], 6
    v_cndmask_b32 v51, 0, v0, s[80:81]
    s_lshl_b32 s29, s67, 7
    s_add_u32 s27, s29, s62
    s_add_u32 s29, s29, s61
    s_mov_b32 s59, 0
L_rs_35:
    s_waitcnt vmcnt(0)
    v_bitop3_b32 v56, v32, v33, s42 bitop3:0x7e
    v_bitop3_b32 v57, v34, v35, s42 bitop3:0x7e
    v_mfma_f32_16x16x32_bf16 v[52:55], v[48:51], v[32:35], 0
    v_bitop3_b32 v58, v36, v37, s42 bitop3:0x7e
    v_bitop3_b32 v59, v38, v39, s42 bitop3:0x7e
    v_mfma_f32_16x16x32_bf16 v[52:55], v[48:51], v[36:39], v[52:55]
    v_or3_b32 v28, v56, v57, v58
    v_bitop3_b32 v60, v40, v41, s42 bitop3:0x7e
    v_bitop3_b32 v61, v42, v43, s42 bitop3:0x7e
    v_mfma_f32_16x16x32_bf16 v[52:55], v[48:51], v[40:43], v[52:55]
    v_or3_b32 v29, v59, v60, v61
    v_bitop3_b32 v62, v44, v45, s42 bitop3:0x7e
    v_bitop3_b32 v63, v46, v47, s42 bitop3:0x7e
    v_mfma_f32_16x16x32_bf16 v[52:55], v[48:51], v[44:47], v[52:55]
    v_or3_b32 v28, v28, v62, v63
    v_bitop3_b32 v28, v28, v29, 1 bitop3:0xa8
    v_cmp_ne_u32 vcc, 0, v28
    s_cbranch_vccnz L_rsx_38
L_rss_36:
    s_nop 3
    v_add_f32_dpp v52, v52, v52 row_ror:8 row_mask:0xf bank_mask:0xf
    v_add_f32_dpp v53, v53, v53 row_ror:8 row_mask:0xf bank_mask:0xf
    v_add_f32_dpp v54, v54, v54 row_ror:8 row_mask:0xf bank_mask:0xf
    v_add_f32_dpp v55, v55, v55 row_ror:8 row_mask:0xf bank_mask:0xf
    v_permlane16_swap_b32 v52, v53
    s_nop 0
    v_permlane16_swap_b32 v54, v55
    v_cvt_pk_bf16_f32 v52, v52, v53
    v_cvt_pk_bf16_f32 v54, v54, v55
    v_cndmask_b32 v52, v52, v54, s[74:75]
    buffer_store_dword v52, v10, s[8:11], s27 offen
L_redj_34:
    s_barrier
    s_add_u32 s70, s62, 0
    s_add_u32 s71, s62, 8192
    s_nop 15
    buffer_load_dwordx4 v[24:27], v8, s[8:11], s70 offen offset:0 sc1
    buffer_load_dwordx4 v[28:31], v8, s[8:11], s70 offen offset:1024 sc1
    buffer_load_dwordx4 v[56:59], v8, s[8:11], s71 offen offset:0 sc1
    v_mov_b64 v[48:49], 0
    v_mov_b64 v[50:51], 0
    v_mov_b64 v[52:53], 0
    v_mov_b64 v[54:55], 0
    s_add_u32 s60, s60, 1
    s_mov_b32 s61, s62
    s_add_u32 s62, s62, 9216
    s_cmp_eq_u32 s62, 93184
    s_cselect_b32 s62, 65536, s62
    s_sub_u32 s63, 491520, s63
    s_bfe_u32 s42, s60, 0x10001
    s_mov_b32 s59, 0
    s_nop 15
    s_nop 15
    buffer_load_dwordx4 v[24:27], v8, s[8:11], s70 offen offset:0 sc1
    buffer_load_dwordx4 v[28:31], v8, s[8:11], s70 offen offset:1024 sc1
    buffer_load_dwordx4 v[56:59], v8, s[8:11], s71 offen offset:0 sc1
    s_waitcnt vmcnt(7)
    v_mov_b64 v[32:33], 0
    v_mov_b64 v[34:35], 0
    v_mov_b64 v[36:37], 0
    v_mov_b64 v[38:39], 0
    v_mov_b64 v[40:41], 0
    v_mov_b64 v[42:43], 0
    v_mov_b64 v[44:45], 0
    v_mov_b64 v[46:47], 0
L_gat_39:
    s_waitcnt vmcnt(3)
    v_max3_u32 v60, v24, v25, v26
    v_max_u32 v60, v60, v27
    v_max3_u32 v61, v28, v29, v30
    v_max_u32 v61, v61, v31
    v_max3_u32 v62, v56, v57, v58
    v_max_u32 v62, v62, v59
    v_max3_u32 v63, v60, v61, v62
    v_cmp_eq_u32 vcc, -1, v63
    s_cbranch_vccnz L_gatx_40
L_gat_39_ok:
    s_waitcnt lgkmcnt(0)
    ds_write_b128 v15, v[24:27] offset:0
    ds_write_b128 v15, v[28:31] offset:1024
    ds_write_b128 v15, v[56:59] offset:8192
    v_smfmac_f32_16x16x64_bf16 v[32:35], v[24:27], a[0:7], v5
    v_smfmac_f32_16x16x64_bf16 v[48:51], v[24:27], v[64:71], v5
    ds_read_b128 v[64:67], v1 offset:16384
    ds_read_b128 v[68:71], v1 offset:17408
    v_smfmac_f32_16x16x64_bf16 v[36:39], v[24:27], a[72:79], v5
    v_smfmac_f32_16x16x64_bf16 v[40:43], v[24:27], a[144:151], v5
    v_smfmac_f32_16x16x64_bf16 v[52:55], v[24:27], v[72:79], v5
    ds_read_b128 v[72:75], v1 offset:18432
    ds_read_b128 v[76:79], v1 offset:19456
    v_smfmac_f32_16x16x64_bf16 v[44:47], v[24:27], a[216:223], v5
    v_smfmac_f32_16x16x64_bf16 v[32:35], v[28:31], a[8:15], v5
    s_waitcnt lgkmcnt(2)
    v_smfmac_f32_16x16x64_bf16 v[48:51], v[28:31], v[64:71], v5
    v_add_u32 v1, 0x20000, v1
    ds_read_b128 v[64:67], v1 offset:0
    ds_read_b128 v[68:71], v1 offset:1024
    v_smfmac_f32_16x16x64_bf16 v[36:39], v[28:31], a[80:87], v5
    v_smfmac_f32_16x16x64_bf16 v[40:43], v[28:31], a[152:159], v5
    s_waitcnt lgkmcnt(2)
    v_smfmac_f32_16x16x64_bf16 v[52:55], v[28:31], v[72:79], v5
    ds_read_b128 v[72:75], v1 offset:2048
    ds_read_b128 v[76:79], v1 offset:3072
    v_smfmac_f32_16x16x64_bf16 v[44:47], v[28:31], a[224:231], v5
    s_barrier
    ds_read_b128 v[60:63], v15 offset:2048
    s_waitcnt vmcnt(0)
    s_cmp_eq_u32 s36, 0
    s_cbranch_scc1 L_norst_41
    v_mov_b32 v2, -1
    buffer_store_dword v2, v10, s[8:11], s29 offen
L_norst_41:
    buffer_load_dwordx4 v[24:27], v4, s[8:11], s68 offen offset:2048 sc1
    buffer_load_dwordx4 v[28:31], v4, s[8:11], s68 offen offset:3072 sc1
    v_smfmac_f32_16x16x64_bf16 v[32:35], v[56:59], a[64:71], v5
    s_waitcnt lgkmcnt(3)
    v_smfmac_f32_16x16x64_bf16 v[48:51], v[56:59], v[64:71], v5
    v_subrev_u32 v1, 0x20000, v1
    ds_read_b128 v[64:67], v1 offset:32768
    ds_read_b128 v[68:71], v1 offset:33792
    v_smfmac_f32_16x16x64_bf16 v[36:39], v[56:59], a[136:143], v5
    v_smfmac_f32_16x16x64_bf16 v[40:43], v[56:59], a[208:215], v5
    s_waitcnt lgkmcnt(3)
    v_smfmac_f32_16x16x64_bf16 v[52:55], v[56:59], v[72:79], v5
    ds_read_b128 v[72:75], v1 offset:34816
    ds_read_b128 v[76:79], v1 offset:35840
    v_smfmac_f32_16x16x64_bf16 v[44:47], v[56:59], v[104:111], v5
    ds_read_b128 v[56:59], v15 offset:3072
    s_add_u32 s70, s68, 32768
    buffer_load_dword v2, v3, s[8:11], s70 offen
    s_waitcnt lgkmcnt(5)
    v_smfmac_f32_16x16x64_bf16 v[32:35], v[60:63], a[16:23], v5
    s_waitcnt lgkmcnt(3)
    v_smfmac_f32_16x16x64_bf16 v[48:51], v[60:63], v[64:71], v5
    ds_read_b128 v[64:67], v1 offset:49152
    ds_read_b128 v[68:71], v1 offset:50176
    v_smfmac_f32_16x16x64_bf16 v[36:39], v[60:63], a[88:95], v5
    v_smfmac_f32_16x16x64_bf16 v[40:43], v[60:63], a[160:167], v5
    s_waitcnt lgkmcnt(3)
    v_smfmac_f32_16x16x64_bf16 v[52:55], v[60:63], v[72:79], v5
    ds_read_b128 v[72:75], v1 offset:51200
    ds_read_b128 v[76:79], v1 offset:52224
    v_smfmac_f32_16x16x64_bf16 v[44:47], v[60:63], a[232:239], v5
    ds_read_b128 v[60:63], v15 offset:4096
    s_waitcnt lgkmcnt(5)
    v_smfmac_f32_16x16x64_bf16 v[32:35], v[56:59], a[24:31], v5
    s_waitcnt lgkmcnt(3)
    v_smfmac_f32_16x16x64_bf16 v[48:51], v[56:59], v[64:71], v5
    v_add_u32 v1, 0x10000, v1
    ds_read_b128 v[64:67], v1 offset:0
    ds_read_b128 v[68:71], v1 offset:1024
    v_smfmac_f32_16x16x64_bf16 v[36:39], v[56:59], a[96:103], v5
    v_smfmac_f32_16x16x64_bf16 v[40:43], v[56:59], a[168:175], v5
    s_waitcnt lgkmcnt(3)
    v_smfmac_f32_16x16x64_bf16 v[52:55], v[56:59], v[72:79], v5
    ds_read_b128 v[72:75], v1 offset:2048
    ds_read_b128 v[76:79], v1 offset:3072
    v_smfmac_f32_16x16x64_bf16 v[44:47], v[56:59], a[240:247], v5
    ds_read_b128 v[56:59], v15 offset:5120
    s_waitcnt lgkmcnt(5)
    v_smfmac_f32_16x16x64_bf16 v[32:35], v[60:63], a[32:39], v5
    s_waitcnt lgkmcnt(3)
    v_smfmac_f32_16x16x64_bf16 v[48:51], v[60:63], v[64:71], v5
    ds_read_b128 v[64:67], v1 offset:16384
    ds_read_b128 v[68:71], v1 offset:17408
    v_smfmac_f32_16x16x64_bf16 v[36:39], v[60:63], a[104:111], v5
    v_smfmac_f32_16x16x64_bf16 v[40:43], v[60:63], a[176:183], v5
    s_waitcnt lgkmcnt(3)
    v_smfmac_f32_16x16x64_bf16 v[52:55], v[60:63], v[72:79], v5
    ds_read_b128 v[72:75], v1 offset:18432
    ds_read_b128 v[76:79], v1 offset:19456
    v_smfmac_f32_16x16x64_bf16 v[44:47], v[60:63], a[248:255], v5
    ds_read_b128 v[60:63], v15 offset:6144
    s_waitcnt lgkmcnt(5)
    v_smfmac_f32_16x16x64_bf16 v[32:35], v[56:59], a[40:47], v5
    s_waitcnt lgkmcnt(3)
    v_smfmac_f32_16x16x64_bf16 v[48:51], v[56:59], v[64:71], v5
    ds_read_b128 v[64:67], v1 offset:32768
    ds_read_b128 v[68:71], v1 offset:33792
    v_smfmac_f32_16x16x64_bf16 v[36:39], v[56:59], a[112:119], v5
    v_smfmac_f32_16x16x64_bf16 v[40:43], v[56:59], a[184:191], v5
    s_waitcnt lgkmcnt(3)
    v_smfmac_f32_16x16x64_bf16 v[52:55], v[56:59], v[72:79], v5
    ds_read_b128 v[72:75], v1 offset:34816
    ds_read_b128 v[76:79], v1 offset:35840
    v_smfmac_f32_16x16x64_bf16 v[44:47], v[56:59], v[80:87], v5
    ds_read_b128 v[56:59], v15 offset:7168
    s_waitcnt lgkmcnt(5)
    v_smfmac_f32_16x16x64_bf16 v[32:35], v[60:63], a[48:55], v5
    s_waitcnt lgkmcnt(3)
    v_smfmac_f32_16x16x64_bf16 v[48:51], v[60:63], v[64:71], v5
    ds_read_b128 v[64:67], v1 offset:49152
    ds_read_b128 v[68:71], v1 offset:50176
    v_smfmac_f32_16x16x64_bf16 v[36:39], v[60:63], a[120:127], v5
    v_smfmac_f32_16x16x64_bf16 v[40:43], v[60:63], a[192:199], v5
    s_waitcnt lgkmcnt(3)
    v_smfmac_f32_16x16x64_bf16 v[52:55], v[60:63], v[72:79], v5
    ds_read_b128 v[72:75], v1 offset:51200
    ds_read_b128 v[76:79], v1 offset:52224
    v_smfmac_f32_16x16x64_bf16 v[44:47], v[60:63], v[88:95], v5
    s_waitcnt lgkmcnt(4)
    v_smfmac_f32_16x16x64_bf16 v[32:35], v[56:59], a[56:63], v5
    v_smfmac_f32_16x16x64_bf16 v[36:39], v[56:59], a[128:135], v5
    v_smfmac_f32_16x16x64_bf16 v[40:43], v[56:59], a[200:207], v5
    v_smfmac_f32_16x16x64_bf16 v[44:47], v[56:59], v[96:103], v5
    s_waitcnt lgkmcnt(2)
    v_smfmac_f32_16x16x64_bf16 v[48:51], v[56:59], v[64:71], v5
    s_waitcnt lgkmcnt(0)
    v_smfmac_f32_16x16x64_bf16 v[52:55], v[56:59], v[72:79], v5
    v_subrev_u32 v1, 0x10000, v1
    s_waitcnt vmcnt(1)
    s_branch L_cC_15
L_rsx_38:
    v_bitop3_b32 v28, v56, v57, 1 bitop3:0xa8
    v_bitop3_b32 v29, v58, v59, 1 bitop3:0xa8
    v_bitop3_b32 v30, v60, v61, 1 bitop3:0xa8
    v_bitop3_b32 v31, v62, v63, 1 bitop3:0xa8
    v_cmp_ne_u32 s[16:17], 0, v28
    v_cmp_ne_u32 s[18:19], 0, v29
    v_cmp_ne_u32 s[20:21], 0, v30
    v_cmp_ne_u32 s[22:23], 0, v31
    s_mov_b64 exec, s[16:17]
    buffer_load_dwordx4 v[32:35], v4, s[8:11], s36 offen sc1
    s_mov_b64 exec, s[18:19]
    buffer_load_dwordx4 v[36:39], v4, s[8:11], s37 offen sc1
    s_mov_b64 exec, s[20:21]
    buffer_load_dwordx4 v[40:43], v4, s[8:11], s38 offen sc1
    s_mov_b64 exec, s[22:23]
    buffer_load_dwordx4 v[44:47], v4, s[8:11], s39 offen sc1
    s_mov_b64 exec, -1
    s_add_u32 s59, s59, 1
    s_cmp_lt_u32 s59, s58
    s_cbranch_scc1 L_rs_35
    s_mov_b32 s58, 0
    s_branch L_rss_36
L_nored_33:
    ds_read_b128 v[64:67], v1 offset:0
    ds_read_b128 v[68:71], v1 offset:1024
    ds_read_b128 v[72:75], v1 offset:2048
    ds_read_b128 v[76:79], v1 offset:3072
    s_branch L_redj_34
L_gatx_40:
    v_cmp_eq_u32 s[16:17], -1, v60
    v_cmp_eq_u32 s[18:19], -1, v61
    v_cmp_eq_u32 s[20:21], -1, v62
    s_mov_b64 exec, s[16:17]
    buffer_load_dwordx4 v[24:27], v8, s[8:11], s70 offen offset:0 sc1
    s_mov_b64 exec, s[18:19]
    buffer_load_dwordx4 v[28:31], v8, s[8:11], s70 offen offset:1024 sc1
    s_mov_b64 exec, s[20:21]
    buffer_load_dwordx4 v[56:59], v8, s[8:11], s71 offen offset:0 sc1
    s_mov_b64 exec, -1
    s_add_u32 s59, s59, 1
    s_cmp_lt_u32 s59, s58
    s_cbranch_scc1 L_gat_39
    s_mov_b32 s58, 0
    s_branch L_gat_39_ok
L_pw3_20:
    v_add_u32 v1, 0x10000, v1
    ds_read_b128 v[64:67], v1 offset:32768
    ds_read_b128 v[68:71], v1 offset:33792
    ds_read_b128 v[72:75], v1 offset:34816
    ds_read_b128 v[76:79], v1 offset:35840
    v_mov_b64 v[32:33], 0
    v_mov_b64 v[34:35], 0
    v_mov_b64 v[36:37], 0
    v_mov_b64 v[38:39], 0
    v_mov_b64 v[40:41], 0
    v_mov_b64 v[42:43], 0
    v_mov_b64 v[44:45], 0
    v_mov_b64 v[46:47], 0
    v_mov_b64 v[48:49], 0
    v_mov_b64 v[50:51], 0
    v_mov_b64 v[52:53], 0
    v_mov_b64 v[54:55], 0
    s_add_u32 s71, s60, 3
    s_min_u32 s71, s71, 63
    s_lshl_b32 s70, s71, 2
    s_add_u32 s70, s70, s82
    s_waitcnt vmcnt(7)
    v_cmp_ne_u32 vcc, 1, v2
    s_cbranch_vccnz L_kvw_43
L_kvok_42:
    s_barrier
    s_add_u32 s70, s62, 6144
    s_nop 15
    buffer_load_dwordx4 v[24:27], v8, s[8:11], s70 offen offset:0 sc1
    buffer_load_dwordx4 v[28:31], v8, s[8:11], s70 offen offset:1024 sc1
    s_add_u32 s60, s60, 1
    s_mov_b32 s61, s62
    s_add_u32 s62, s62, 9216
    s_cmp_eq_u32 s62, 93184
    s_cselect_b32 s62, 65536, s62
    s_sub_u32 s63, 491520, s63
    s_bfe_u32 s42, s60, 0x10001
    s_mov_b32 s59, 0
    s_nop 15
    s_nop 15
    buffer_load_dwordx4 v[24:27], v8, s[8:11], s70 offen offset:0 sc1
    buffer_load_dwordx4 v[28:31], v8, s[8:11], s70 offen offset:1024 sc1
L_gat_44:
    s_waitcnt vmcnt(2)
    v_max3_u32 v60, v24, v25, v26
    v_max_u32 v60, v60, v27
    v_max3_u32 v61, v28, v29, v30
    v_max_u32 v61, v61, v31
    v_max_u32 v63, v60, v61
    v_cmp_eq_u32 vcc, -1, v63
    s_cbranch_vccnz L_gatx_45
L_gat_44_ok:
    s_waitcnt lgkmcnt(0)
    ds_write_b128 v15, v[24:27] offset:6144
    ds_write_b128 v15, v[28:31] offset:7168
    v_smfmac_f32_16x16x64_bf16 v[32:35], v[24:27], a[48:55], v5
    v_smfmac_f32_16x16x64_bf16 v[48:51], v[24:27], v[64:71], v5
    ds_read_b128 v[64:67], v1 offset:49152
    ds_read_b128 v[68:71], v1 offset:50176
    v_smfmac_f32_16x16x64_bf16 v[36:39], v[24:27], a[120:127], v5
    v_smfmac_f32_16x16x64_bf16 v[40:43], v[24:27], a[192:199], v5
    v_smfmac_f32_16x16x64_bf16 v[52:55], v[24:27], v[72:79], v5
    ds_read_b128 v[72:75], v1 offset:51200
    ds_read_b128 v[76:79], v1 offset:52224
    v_smfmac_f32_16x16x64_bf16 v[44:47], v[24:27], v[88:95], v5
    v_smfmac_f32_16x16x64_bf16 v[32:35], v[28:31], a[56:63], v5
    s_waitcnt lgkmcnt(2)
    v_smfmac_f32_16x16x64_bf16 v[48:51], v[28:31], v[64:71], v5
    v_subrev_u32 v1, 0x10000, v1
    ds_read_b128 v[64:67], v1 offset:0
    ds_read_b128 v[68:71], v1 offset:1024
    v_smfmac_f32_16x16x64_bf16 v[36:39], v[28:31], a[128:135], v5
    v_smfmac_f32_16x16x64_bf16 v[40:43], v[28:31], a[200:207], v5
    s_waitcnt lgkmcnt(2)
    v_smfmac_f32_16x16x64_bf16 v[52:55], v[28:31], v[72:79], v5
    ds_read_b128 v[72:75], v1 offset:2048
    ds_read_b128 v[76:79], v1 offset:3072
    v_smfmac_f32_16x16x64_bf16 v[44:47], v[28:31], v[96:103], v5
    s_barrier
    ds_read_b128 v[56:59], v15 offset:0
    ds_read_b128 v[60:63], v15 offset:1024
    buffer_load_dwordx4 v[24:27], v4, s[8:11], s68 offen offset:2048 sc1
    buffer_load_dwordx4 v[28:31], v4, s[8:11], s68 offen offset:3072 sc1
    s_waitcnt lgkmcnt(1)
    v_smfmac_f32_16x16x64_bf16 v[32:35], v[56:59], a[0:7], v5
    v_smfmac_f32_16x16x64_bf16 v[48:51], v[56:59], v[64:71], v5
    ds_read_b128 v[64:67], v1 offset:16384
    ds_read_b128 v[68:71], v1 offset:17408
    v_smfmac_f32_16x16x64_bf16 v[36:39], v[56:59], a[72:79], v5
    v_smfmac_f32_16x16x64_bf16 v[40:43], v[56:59], a[144:151], v5
    v_smfmac_f32_16x16x64_bf16 v[52:55], v[56:59], v[72:79], v5
    ds_read_b128 v[72:75], v1 offset:18432
    ds_read_b128 v[76:79], v1 offset:19456
    v_smfmac_f32_16x16x64_bf16 v[44:47], v[56:59], a[216:223], v5
    ds_read_b128 v[56:59], v15 offset:2048
    s_add_u32 s70, s68, 32768
    buffer_load_dword v2, v3, s[8:11], s70 offen
    s_add_u32 s71, s60, 3
    s_min_u32 s71, s71, 63
    s_lshl_b32 s71, s71, 2
    s_add_u32 s71, s71, s82
    buffer_load_dword v2, off, s[8:11], s71 sc1
    s_waitcnt lgkmcnt(5)
    v_smfmac_f32_16x16x64_bf16 v[32:35], v[60:63], a[8:15], v5
    s_waitcnt lgkmcnt(3)
    v_smfmac_f32_16x16x64_bf16 v[48:51], v[60:63], v[64:71], v5
    ds_read_b128 v[64:67], v1 offset:32768
    ds_read_b128 v[68:71], v1 offset:33792
    v_smfmac_f32_16x16x64_bf16 v[36:39], v[60:63], a[80:87], v5
    v_smfmac_f32_16x16x64_bf16 v[40:43], v[60:63], a[152:159], v5
    s_waitcnt lgkmcnt(3)
    v_smfmac_f32_16x16x64_bf16 v[52:55], v[60:63], v[72:79], v5
    ds_read_b128 v[72:75], v1 offset:34816
    ds_read_b128 v[76:79], v1 offset:35840
    v_smfmac_f32_16x16x64_bf16 v[44:47], v[60:63], a[224:231], v5
    ds_read_b128 v[60:63], v15 offset:3072
    s_waitcnt lgkmcnt(5)
    v_smfmac_f32_16x16x64_bf16 v[32:35], v[56:59], a[16:23], v5
    s_waitcnt lgkmcnt(3)
    v_smfmac_f32_16x16x64_bf16 v[48:51], v[56:59], v[64:71], v5
    ds_read_b128 v[64:67], v1 offset:49152
    ds_read_b128 v[68:71], v1 offset:50176
    v_smfmac_f32_16x16x64_bf16 v[36:39], v[56:59], a[88:95], v5
    v_smfmac_f32_16x16x64_bf16 v[40:43], v[56:59], a[160:167], v5
    s_waitcnt lgkmcnt(3)
    v_smfmac_f32_16x16x64_bf16 v[52:55], v[56:59], v[72:79], v5
    ds_read_b128 v[72:75], v1 offset:51200
    ds_read_b128 v[76:79], v1 offset:52224
    v_smfmac_f32_16x16x64_bf16 v[44:47], v[56:59], a[232:239], v5
    ds_read_b128 v[56:59], v15 offset:8192
    s_waitcnt lgkmcnt(5)
    v_smfmac_f32_16x16x64_bf16 v[32:35], v[60:63], a[24:31], v5
    s_waitcnt lgkmcnt(3)
    v_smfmac_f32_16x16x64_bf16 v[48:51], v[60:63], v[64:71], v5
    v_add_u32 v1, 0x20000, v1
    ds_read_b128 v[64:67], v1 offset:0
    ds_read_b128 v[68:71], v1 offset:1024
    v_smfmac_f32_16x16x64_bf16 v[36:39], v[60:63], a[96:103], v5
    v_smfmac_f32_16x16x64_bf16 v[40:43], v[60:63], a[168:175], v5
    s_waitcnt lgkmcnt(3)
    v_smfmac_f32_16x16x64_bf16 v[52:55], v[60:63], v[72:79], v5
    ds_read_b128 v[72:75], v1 offset:2048
    ds_read_b128 v[76:79], v1 offset:3072
    v_smfmac_f32_16x16x64_bf16 v[44:47], v[60:63], a[240:247], v5
    ds_read_b128 v[60:63], v15 offset:4096
    s_waitcnt lgkmcnt(5)
    v_smfmac_f32_16x16x64_bf16 v[32:35], v[56:59], a[64:71], v5
    s_waitcnt lgkmcnt(3)
    v_smfmac_f32_16x16x64_bf16 v[48:51], v[56:59], v[64:71], v5
    v_subrev_u32 v1, 0x10000, v1
    ds_read_b128 v[64:67], v1 offset:0
    ds_read_b128 v[68:71], v1 offset:1024
    v_smfmac_f32_16x16x64_bf16 v[36:39], v[56:59], a[136:143], v5
    v_smfmac_f32_16x16x64_bf16 v[40:43], v[56:59], a[208:215], v5
    s_waitcnt lgkmcnt(3)
    v_smfmac_f32_16x16x64_bf16 v[52:55], v[56:59], v[72:79], v5
    ds_read_b128 v[72:75], v1 offset:2048
    ds_read_b128 v[76:79], v1 offset:3072
    v_smfmac_f32_16x16x64_bf16 v[44:47], v[56:59], v[104:111], v5
    ds_read_b128 v[56:59], v15 offset:5120
    s_waitcnt lgkmcnt(5)
    v_smfmac_f32_16x16x64_bf16 v[32:35], v[60:63], a[32:39], v5
    s_waitcnt lgkmcnt(3)
    v_smfmac_f32_16x16x64_bf16 v[48:51], v[60:63], v[64:71], v5
    ds_read_b128 v[64:67], v1 offset:16384
    ds_read_b128 v[68:71], v1 offset:17408
    v_smfmac_f32_16x16x64_bf16 v[36:39], v[60:63], a[104:111], v5
    v_smfmac_f32_16x16x64_bf16 v[40:43], v[60:63], a[176:183], v5
    s_waitcnt lgkmcnt(3)
    v_smfmac_f32_16x16x64_bf16 v[52:55], v[60:63], v[72:79], v5
    ds_read_b128 v[72:75], v1 offset:18432
    ds_read_b128 v[76:79], v1 offset:19456
    v_smfmac_f32_16x16x64_bf16 v[44:47], v[60:63], a[248:255], v5
    s_waitcnt lgkmcnt(4)
    v_smfmac_f32_16x16x64_bf16 v[32:35], v[56:59], a[40:47], v5
    v_smfmac_f32_16x16x64_bf16 v[36:39], v[56:59], a[112:119], v5
    v_smfmac_f32_16x16x64_bf16 v[40:43], v[56:59], a[184:191], v5
    v_smfmac_f32_16x16x64_bf16 v[44:47], v[56:59], v[80:87], v5
    s_waitcnt lgkmcnt(2)
    v_smfmac_f32_16x16x64_bf16 v[48:51], v[56:59], v[64:71], v5
    s_waitcnt lgkmcnt(0)
    v_smfmac_f32_16x16x64_bf16 v[52:55], v[56:59], v[72:79], v5
    v_subrev_u32 v1, 0x10000, v1
    s_waitcnt vmcnt(2)
    s_branch L_cC_15
L_kvw_43:
    s_mov_b32 s59, 0
L_kv_46:
    buffer_load_dword v2, off, s[8:11], s70 sc1
    s_waitcnt vmcnt(0)
    v_cmp_ne_u32 vcc, 1, v2
    s_cbranch_vccz L_kv_ok_47
    s_add_u32 s59, s59, 1
    s_cmp_lt_u32 s59, s58
    s_cbranch_scc1 L_kv_46
    s_mov_b32 s58, 0
L_kv_ok_47:
    s_branch L_kvok_42
L_gatx_45:
    v_cmp_eq_u32 s[16:17], -1, v60
    v_cmp_eq_u32 s[18:19], -1, v61
    s_mov_b64 exec, s[16:17]
    buffer_load_dwordx4 v[24:27], v8, s[8:11], s70 offen offset:0 sc1
    s_mov_b64 exec, s[18:19]
    buffer_load_dwordx4 v[28:31], v8, s[8:11], s70 offen offset:1024 sc1
    s_mov_b64 exec, -1
    s_add_u32 s59, s59, 1
    s_cmp_lt_u32 s59, s58
    s_cbranch_scc1 L_gat_44
    s_mov_b32 s58, 0
    s_branch L_gat_44_ok
L_clx_14:
    s_waitcnt vmcnt(0)
    s_barrier
    s_cmp_lg_u32 s4, 3
    s_cbranch_scc1 L_fin_48
    s_lshl_b32 s70, s60, 2
    s_add_u32 s70, s70, s82
    s_add_u32 s70, s70, 8188
    v_mov_b32 v56, 1
    s_mov_b64 exec, 1
    buffer_store_dword v56, off, s[8:11], s70 sc1
    buffer_store_dword v56, off, s[8:11], s70 offset:4 sc1
    s_mov_b64 exec, -1
L_fin_48:
    s_waitcnt vmcnt(0)
    s_waitcnt vmcnt(0)
    s_barrier
    s_cmp_lg_u32 s4, 0
    s_cbranch_scc1 L_nowb_49
    s_lshl_b32 s60, s5, 5
    s_add_u32 s60, s60, 16
    v_mov_b32 v4, 1
    s_mov_b64 exec, 1
    buffer_atomic_add v4, off, s[12:15], s60 sc0 sc1
    s_waitcnt vmcnt(0)
    v_readfirstlane_b32 s61, v4
    s_mov_b64 exec, -1
    s_cmp_lg_u32 s61, 31
    s_cbranch_scc1 L_nowb_49
    buffer_wbl2 sc1
L_nowb_49:
    s_branch L_chain_done
L_chain_slow_12:
    s_branch L_cl_50
.p2align 8
L_cl_50:
    ds_read_b128 v[56:59], v15
    ds_read_b128 v[60:63], v15 offset:1024
    s_add_u32 s70, s68, 32768
    buffer_load_dword v2, v3, s[8:11], s70 offen
    s_add_u32 s71, s60, 3
    s_min_u32 s71, s71, 63
    s_lshl_b32 s71, s71, 2
    s_add_u32 s71, s71, s82
    buffer_load_dword v2, off, s[8:11], s71 sc1
    s_waitcnt lgkmcnt(1)
    v_smfmac_f32_16x16x64_bf16 v[32:35], v[56:59], a[0:7], v5
    v_smfmac_f32_16x16x64_bf16 v[48:51], v[56:59], v[64:71], v5
    ds_read_b128 v[64:67], v1 offset:16384
    ds_read_b128 v[68:71], v1 offset:17408
    v_smfmac_f32_16x16x64_bf16 v[36:39], v[56:59], a[72:79], v5
    v_smfmac_f32_16x16x64_bf16 v[40:43], v[56:59], a[144:151], v5
    v_smfmac_f32_16x16x64_bf16 v[52:55], v[56:59], v[72:79], v5
    ds_read_b128 v[72:75], v1 offset:18432
    ds_read_b128 v[76:79], v1 offset:19456
    v_smfmac_f32_16x16x64_bf16 v[44:47], v[56:59], a[216:223], v5
    ds_read_b128 v[56:59], v15 offset:2048
    s_waitcnt lgkmcnt(5)
    v_smfmac_f32_16x16x64_bf16 v[32:35], v[60:63], a[8:15], v5
    s_waitcnt lgkmcnt(3)
    v_smfmac_f32_16x16x64_bf16 v[48:51], v[60:63], v[64:71], v5
    ds_read_b128 v[64:67], v1 offset:32768
    ds_read_b128 v[68:71], v1 offset:33792
    v_smfmac_f32_16x16x64_bf16 v[36:39], v[60:63], a[80:87], v5
    v_smfmac_f32_16x16x64_bf16 v[40:43], v[60:63], a[152:159], v5
    s_waitcnt lgkmcnt(3)
    v_smfmac_f32_16x16x64_bf16 v[52:55], v[60:63], v[72:79], v5
    ds_read_b128 v[72:75], v1 offset:34816
    ds_read_b128 v[76:79], v1 offset:35840
    v_smfmac_f32_16x16x64_bf16 v[44:47], v[60:63], a[224:231], v5
    ds_read_b128 v[60:63], v15 offset:3072
    s_waitcnt lgkmcnt(5)
    v_smfmac_f32_16x16x64_bf16 v[32:35], v[56:59], a[16:23], v5
    s_waitcnt lgkmcnt(3)
    v_smfmac_f32_16x16x64_bf16 v[48:51], v[56:59], v[64:71], v5
    ds_read_b128 v[64:67], v1 offset:49152
    ds_read_b128 v[68:71], v1 offset:50176
    v_smfmac_f32_16x16x64_bf16 v[36:39], v[56:59], a[88:95], v5
    v_smfmac_f32_16x16x64_bf16 v[40:43], v[56:59], a[160:167], v5
    s_waitcnt lgkmcnt(3)
    v_smfmac_f32_16x16x64_bf16 v[52:55], v[56:59], v[72:79], v5
    ds_read_b128 v[72:75], v1 offset:51200
    ds_read_b128 v[76:79], v1 offset:52224
    v_smfmac_f32_16x16x64_bf16 v[44:47], v[56:59], a[232:239], v5
    ds_read_b128 v[56:59], v15 offset:4096
    s_waitcnt lgkmcnt(5)
    v_smfmac_f32_16x16x64_bf16 v[32:35], v[60:63], a[24:31], v5
    s_waitcnt lgkmcnt(3)
    v_smfmac_f32_16x16x64_bf16 v[48:51], v[60:63], v[64:71], v5
    v_add_u32 v1, 0x10000, v1
    ds_read_b128 v[64:67], v1 offset:0
    ds_read_b128 v[68:71], v1 offset:1024
    v_smfmac_f32_16x16x64_bf16 v[36:39], v[60:63], a[96:103], v5
    v_smfmac_f32_16x16x64_bf16 v[40:43], v[60:63], a[168:175], v5
    s_waitcnt lgkmcnt(3)
    v_smfmac_f32_16x16x64_bf16 v[52:55], v[60:63], v[72:79], v5
    ds_read_b128 v[72:75], v1 offset:2048
    ds_read_b128 v[76:79], v1 offset:3072
    v_smfmac_f32_16x16x64_bf16 v[44:47], v[60:63], a[240:247], v5
    ds_read_b128 v[60:63], v15 offset:5120
    s_waitcnt lgkmcnt(5)
    v_smfmac_f32_16x16x64_bf16 v[32:35], v[56:59], a[32:39], v5
    s_waitcnt lgkmcnt(3)
    v_smfmac_f32_16x16x64_bf16 v[48:51], v[56:59], v[64:71], v5
    ds_read_b128 v[64:67], v1 offset:16384
    ds_read_b128 v[68:71], v1 offset:17408
    v_smfmac_f32_16x16x64_bf16 v[36:39], v[56:59], a[104:111], v5
    v_smfmac_f32_16x16x64_bf16 v[40:43], v[56:59], a[176:183], v5
    s_waitcnt lgkmcnt(3)
    v_smfmac_f32_16x16x64_bf16 v[52:55], v[56:59], v[72:79], v5
    ds_read_b128 v[72:75], v1 offset:18432
    ds_read_b128 v[76:79], v1 offset:19456
    v_smfmac_f32_16x16x64_bf16 v[44:47], v[56:59], a[248:255], v5
    ds_read_b128 v[56:59], v15 offset:6144
    s_waitcnt lgkmcnt(5)
    v_smfmac_f32_16x16x64_bf16 v[32:35], v[60:63], a[40:47], v5
    s_waitcnt lgkmcnt(3)
    v_smfmac_f32_16x16x64_bf16 v[48:51], v[60:63], v[64:71], v5
    ds_read_b128 v[64:67], v1 offset:32768
    ds_read_b128 v[68:71], v1 offset:33792
    v_smfmac_f32_16x16x64_bf16 v[36:39], v[60:63], a[112:119], v5
    v_smfmac_f32_16x16x64_bf16 v[40:43], v[60:63], a[184:191], v5
    s_waitcnt lgkmcnt(3)
    v_smfmac_f32_16x16x64_bf16 v[52:55], v[60:63], v[72:79], v5
    ds_read_b128 v[72:75], v1 offset:34816
    ds_read_b128 v[76:79], v1 offset:35840
    v_smfmac_f32_16x16x64_bf16 v[44:47], v[60:63], v[80:87], v5
    ds_read_b128 v[60:63], v15 offset:7168
    s_waitcnt lgkmcnt(5)
    v_smfmac_f32_16x16x64_bf16 v[32:35], v[56:59], a[48:55], v5
    s_waitcnt lgkmcnt(3)
    v_smfmac_f32_16x16x64_bf16 v[48:51], v[56:59], v[64:71], v5
    ds_read_b128 v[64:67], v1 offset:49152
    ds_read_b128 v[68:71], v1 offset:50176
    v_smfmac_f32_16x16x64_bf16 v[36:39], v[56:59], a[120:127], v5
    v_smfmac_f32_16x16x64_bf16 v[40:43], v[56:59], a[192:199], v5
    s_waitcnt lgkmcnt(3)
    v_smfmac_f32_16x16x64_bf16 v[52:55], v[56:59], v[72:79], v5
    ds_read_b128 v[72:75], v1 offset:51200
    ds_read_b128 v[76:79], v1 offset:52224
    v_smfmac_f32_16x16x64_bf16 v[44:47], v[56:59], v[88:95], v5
    ds_read_b128 v[56:59], v15 offset:8192
    s_waitcnt lgkmcnt(5)
    v_smfmac_f32_16x16x64_bf16 v[32:35], v[60:63], a[56:63], v5
    s_waitcnt lgkmcnt(3)
    v_smfmac_f32_16x16x64_bf16 v[48:51], v[60:63], v[64:71], v5
    v_add_u32 v1, 0x10000, v1
    ds_read_b128 v[64:67], v1 offset:0
    ds_read_b128 v[68:71], v1 offset:1024
    v_smfmac_f32_16x16x64_bf16 v[36:39], v[60:63], a[128:135], v5
    v_smfmac_f32_16x16x64_bf16 v[40:43], v[60:63], a[200:207], v5
    s_waitcnt lgkmcnt(3)
    v_smfmac_f32_16x16x64_bf16 v[52:55], v[60:63], v[72:79], v5
    ds_read_b128 v[72:75], v1 offset:2048
    ds_read_b128 v[76:79], v1 offset:3072
    v_smfmac_f32_16x16x64_bf16 v[44:47], v[60:63], v[96:103], v5
    s_waitcnt lgkmcnt(4)
    v_smfmac_f32_16x16x64_bf16 v[32:35], v[56:59], a[64:71], v5
    v_smfmac_f32_16x16x64_bf16 v[36:39], v[56:59], a[136:143], v5
    v_smfmac_f32_16x16x64_bf16 v[40:43], v[56:59], a[208:215], v5
    v_smfmac_f32_16x16x64_bf16 v[44:47], v[56:59], v[104:111], v5
    s_waitcnt lgkmcnt(2)
    v_smfmac_f32_16x16x64_bf16 v[48:51], v[56:59], v[64:71], v5
    s_waitcnt lgkmcnt(0)
    v_smfmac_f32_16x16x64_bf16 v[52:55], v[56:59], v[72:79], v5
    v_subrev_u32 v1, 0x20000, v1
    s_waitcnt vmcnt(3)
    s_branch L_cC_52
.p2align 8
L_cC_52:
    v_cvt_pk_bf16_f32 v32, v32, v33
    v_cvt_pk_bf16_f32 v33, v34, v35
    v_cvt_pk_bf16_f32 v34, v36, v37
    v_cvt_pk_bf16_f32 v35, v38, v39
    v_mfma_f32_16x16x16_bf16 v[36:39], v[32:33], v[6:7], 0
    v_cvt_pk_bf16_f32 v40, v40, v41
    v_cvt_pk_bf16_f32 v41, v42, v43
    v_mfma_f32_16x16x16_bf16 v[32:35], v[34:35], v[6:7], 0
    v_cvt_pk_bf16_f32 v42, v44, v45
    v_cvt_pk_bf16_f32 v43, v46, v47
    v_mfma_f32_16x16x16_bf16 v[44:47], v[40:41], v[6:7], 0
    s_nop 0
    v_mfma_f32_16x16x16_bf16 v[40:43], v[42:43], v[6:7], 0
    v_cvt_pk_bf16_f32 v48, v48, v49
    v_cvt_pk_bf16_f32 v49, v50, v51
    v_cvt_pk_bf16_f32 v36, v36, v37
    v_cvt_pk_bf16_f32 v37, v38, v39
    v_cvt_pk_bf16_f32 v38, v32, v33
    v_cvt_pk_bf16_f32 v39, v34, v35
    v_cvt_pk_bf16_f32 v50, v52, v53
    v_cvt_pk_bf16_f32 v51, v54, v55
    buffer_store_dwordx4 v[48:51], v4, s[8:11], s69 offen offset:1024 sc1
    v_mfma_f32_16x16x32_bf16 v[16:19], v[16:19], v[36:39], 0
    v_mfma_f32_16x16x32_bf16 v[20:23], v[20:23], v[36:39], 0
    v_cvt_pk_bf16_f32 v44, v44, v45
    v_cvt_pk_bf16_f32 v45, v46, v47
    v_cvt_pk_bf16_f32 v46, v40, v41
    v_cvt_pk_bf16_f32 v47, v42, v43
    s_cmp_eq_u32 s60, 63
    s_nop 0
    v_mfma_f32_16x16x32_bf16 v[32:35], v[44:47], v[36:39], 0
    s_nop 0
    v_cndmask_b32 v16, v16, v20, s[74:75]
    v_cndmask_b32 v17, v17, v21, s[74:75]
    v_cndmask_b32 v18, v18, v22, s[74:75]
    v_cndmask_b32 v19, v19, v23, s[74:75]
    ds_write_b128 v11, v[16:19]
    s_nop 1
    v_cndmask_b32 v32, v32, v33, s[74:75]
    v_cndmask_b32 v34, v34, v35, s[74:75]
    v_cndmask_b32 v32, v32, v34, s[76:77]
    ds_write_b32 v12, v32
    buffer_store_dwordx4 v[44:47], v4, s[8:11], s69 offen sc1
    s_cbranch_scc1 L_clx_51
    s_add_u32 s69, s69, 8192
    s_add_u32 s68, s68, 16384
    s_waitcnt lgkmcnt(0)
    s_barrier
    ds_read_b128 v[32:35], v15 offset:9216
    ds_read_b128 v[36:39], v15 offset:10240
    ds_read_b128 v[40:43], v15 offset:11264
    ds_read_b128 v[44:47], v15 offset:12288
    ds_read_b128 v[52:55], v15 offset:13312
    buffer_load_dwordx4 v[16:19], v4, s[8:11], s68 offen offset:0 sc1
    buffer_load_dwordx4 v[20:23], v4, s[8:11], s68 offen offset:1024 sc1
    s_cmp_lg_u32 s4, 3
    s_cbranch_scc1 L_nomkf_53
    s_cmp_eq_u32 s60, 0
    s_cbranch_scc1 L_nomkf_53
    s_lshl_b32 s70, s60, 2
    s_add_u32 s70, s70, s82
    s_add_u32 s70, s70, 8188
    v_mov_b32 v76, 1
    s_mov_b64 exec, 1
    buffer_store_dword v76, off, s[8:11], s70 sc1
    s_mov_b64 exec, -1
L_nomkf_53:
    s_waitcnt lgkmcnt(3)
    v_pk_add_f32 v[32:33], v[32:33], v[36:37]
    v_pk_add_f32 v[34:35], v[34:35], v[38:39]
    s_waitcnt lgkmcnt(1)
    v_pk_add_f32 v[40:41], v[40:41], v[44:45]
    v_pk_add_f32 v[42:43], v[42:43], v[46:47]
    s_waitcnt lgkmcnt(0)
    v_pk_add_f32 v[52:53], v[52:53], v[54:55]
    v_pk_add_f32 v[32:33], v[32:33], v[40:41]
    v_pk_add_f32 v[34:35], v[34:35], v[42:43]
    v_add_f32 v36, v52, v53
    v_max3_f32 v38, v32, v33, v34
    v_max3_f32 v38, v38, v35, v36
    v_mov_b64 v[56:57], 0
    v_mov_b64 v[58:59], 0
    v_max_f32_dpp v38, v38, v38 row_ror:8 row_mask:0xf bank_mask:0xf
    v_mov_b32 v39, v38
    v_mov_b64 v[60:61], 0
    v_mov_b64 v[62:63], 0
    v_permlane16_swap_b32 v38, v39
    v_max_f32 v38, v38, v39
    v_mov_b32 v39, v38
    v_mov_b64 v[64:65], 0
    v_mov_b64 v[66:67], 0
    v_permlane32_swap_b32 v38, v39
    v_max_f32 v38, v38, v39
    v_mul_f32 v38, s64, v38
    v_fma_f32 v36, v36, s64, -v38
    v_fma_f32 v32, v32, s64, -v38
    v_fma_f32 v33, v33, s64, -v38
    v_fma_f32 v34, v34, s64, -v38
    v_fma_f32 v35, v35, s64, -v38
    v_exp_f32 v36, v36
    v_exp_f32 v32, v32
    v_exp_f32 v33, v33
    v_exp_f32 v34, v34
    v_exp_f32 v35, v35
    v_mov_b32_dpp v37, v36 row_ror:8 row_mask:0xf bank_mask:0xf
    v_add_f32 v38, v32, v33
    v_add_f32 v39, v34, v35
    v_cvt_pk_bf16_f32 v32, v32, v33
    v_cvt_pk_bf16_f32 v33, v34, v35
    v_add_f32 v38, v38, v36
    v_cvt_pk_bf16_f32 v36, v36, v37
    v_mov_b32_dpp v34, v32 row_ror:8 row_mask:0xf bank_mask:0xf
    v_mov_b32_dpp v35, v33 row_ror:8 row_mask:0xf bank_mask:0xf
    v_mov_b32 v37, v36
    v_add_f32 v38, v38, v39
    v_mfma_f32_16x16x32_bf16 v[40:43], v[24:27], v[32:35], 0
    v_permlane32_swap_b32 v36, v37
    v_mfma_f32_16x16x32_bf16 v[44:47], v[28:31], v[32:35], 0
    v_add_f32_dpp v38, v38, v38 row_ror:8 row_mask:0xf bank_mask:0xf
    v_mfma_f32_16x16x16_bf16 v[40:43], v[48:49], v[36:37], v[40:43]
    v_mov_b32 v39, v38
    v_mfma_f32_16x16x16_bf16 v[44:47], v[50:51], v[36:37], v[44:47]
    v_mov_b64 v[68:69], 0
    v_permlane16_swap_b32 v38, v39
    v_add_f32 v38, v38, v39
    v_mov_b32 v39, v38
    v_mov_b64 v[70:71], 0
    v_mov_b64 v[72:73], 0
    v_permlane32_swap_b32 v38, v39
    v_add_f32 v38, v38, v39
    v_rcp_f32 v38, v38
    v_mov_b64 v[74:75], 0
    v_mul_f32 v40, v40, v38
    v_mul_f32 v41, v41, v38
    v_mul_f32 v42, v42, v38
    v_mul_f32 v43, v43, v38
    v_mul_f32_dpp v40, v44, v38 row_ror:8 row_mask:0xf bank_mask:0xc
    v_mul_f32_dpp v41, v45, v38 row_ror:8 row_mask:0xf bank_mask:0xc
    v_mul_f32_dpp v42, v46, v38 row_ror:8 row_mask:0xf bank_mask:0xc
    v_mul_f32_dpp v43, v47, v38 row_ror:8 row_mask:0xf bank_mask:0xc
    v_cvt_pk_bf16_f32 v40, v40, v41
    v_cvt_pk_bf16_f32 v41, v42, v43
    ds_write_b64 v14, v[40:41]
    s_add_u32 s70, s40, s63
    s_add_u32 s71, s70, 262144
    s_add_u32 s36, s41, s63
    s_add_u32 s37, s36, 4096
    s_add_u32 s38, s36, 8192
    s_add_u32 s39, s36, 12288
    s_mul_i32 s36, s36, s65
    s_waitcnt lgkmcnt(0)
    s_barrier
    ds_read_b128 v[48:51], v15 offset:14336
    ds_read_b128 v[52:55], v15 offset:15360
    ds_read_b128 v[32:35], v13 offset:0
    ds_read_b128 v[36:39], v13 offset:512
    ds_read_b128 v[40:43], v13 offset:1024
    ds_read_b128 v[44:47], v13 offset:1536
    v_lshrrev_b32 v78, 13, v9
    v_and_b32 v78, 4, v78
    v_and_b32 v77, 0x7fff, v9
    v_add_u32 v78, v77, v78
    s_waitcnt lgkmcnt(5)
    v_smfmac_f32_16x16x64_bf16 v[72:75], v[48:51], v[240:247], v5
    s_waitcnt lgkmcnt(4)
    v_smfmac_f32_16x16x64_bf16 v[72:75], v[52:55], v[248:255], v5
    s_waitcnt lgkmcnt(3)
    v_smfmac_f32_16x16x64_bf16 v[56:59], v[32:35], v[112:119], v5
    v_smfmac_f32_16x16x64_bf16 v[60:63], v[32:35], v[144:151], v5
    s_waitcnt lgkmcnt(2)
    v_smfmac_f32_16x16x64_bf16 v[56:59], v[36:39], v[120:127], v5
    v_smfmac_f32_16x16x64_bf16 v[60:63], v[36:39], v[152:159], v5
    s_nop 1
    v_permlane32_swap_b32 v72, v74
    v_permlane32_swap_b32 v73, v75
    s_waitcnt lgkmcnt(1)
    v_smfmac_f32_16x16x64_bf16 v[56:59], v[40:43], v[128:135], v5
    v_add_f32 v72, v72, v74
    v_add_f32 v73, v73, v75
    v_smfmac_f32_16x16x64_bf16 v[60:63], v[40:43], v[160:167], v5
    v_cvt_pk_bf16_f32 v72, v72, v73
    s_waitcnt lgkmcnt(0)
    v_smfmac_f32_16x16x64_bf16 v[56:59], v[44:47], v[136:143], v5
    v_bfi_b32 v72, 1, s42, v72
    buffer_store_dword v72, v78, s[8:11], s71 offen sc1
    v_smfmac_f32_16x16x64_bf16 v[60:63], v[44:47], v[168:175], v5
    v_smfmac_f32_16x16x64_bf16 v[64:67], v[32:35], v[176:183], v5
    v_smfmac_f32_16x16x64_bf16 v[64:67], v[36:39], v[184:191], v5
    s_nop 2
    v_cvt_pk_bf16_f32 v56, v56, v57
    v_cvt_pk_bf16_f32 v57, v58, v59
    v_bfi_b32 v56, 1, s42, v56
    v_bfi_b32 v57, 1, s42, v57
    buffer_store_dwordx2 v[56:57], v9, s[8:11], s70 offen sc1
    s_add_u32 s70, s70, 65536
    v_smfmac_f32_16x16x64_bf16 v[64:67], v[40:43], v[192:199], v5
    v_smfmac_f32_16x16x64_bf16 v[64:67], v[44:47], v[200:207], v5
    v_cvt_pk_bf16_f32 v60, v60, v61
    v_cvt_pk_bf16_f32 v61, v62, v63
    v_bfi_b32 v60, 1, s42, v60
    v_bfi_b32 v61, 1, s42, v61
    buffer_store_dwordx2 v[60:61], v9, s[8:11], s70 offen sc1
    s_add_u32 s70, s70, 65536
    v_smfmac_f32_16x16x64_bf16 v[68:71], v[32:35], v[208:215], v5
    v_smfmac_f32_16x16x64_bf16 v[68:71], v[36:39], v[216:223], v5
    v_smfmac_f32_16x16x64_bf16 v[68:71], v[40:43], v[224:231], v5
    v_cvt_pk_bf16_f32 v64, v64, v65
    v_cvt_pk_bf16_f32 v65, v66, v67
    v_bfi_b32 v64, 1, s42, v64
    v_bfi_b32 v65, 1, s42, v65
    buffer_store_dwordx2 v[64:65], v9, s[8:11], s70 offen sc1
    s_add_u32 s70, s70, 65536
    v_smfmac_f32_16x16x64_bf16 v[68:71], v[44:47], v[232:239], v5
    s_nop 7
    v_cvt_pk_bf16_f32 v68, v68, v69
    v_cvt_pk_bf16_f32 v69, v70, v71
    v_bfi_b32 v68, 1, s42, v68
    v_bfi_b32 v69, 1, s42, v69
    buffer_store_dwordx2 v[68:69], v9, s[8:11], s70 offen sc1
    s_cmp_eq_u32 s4, 1
    s_cbranch_scc1 L_pw1_55
    s_cmp_eq_u32 s4, 3
    s_cbranch_scc1 L_pw3_57
    s_cmp_eq_u32 s4, 0
    s_cbranch_scc1 L_pw0_54
    buffer_load_dwordx4 v[32:35], v4, s[8:11], s36 offen sc1
    buffer_load_dwordx4 v[36:39], v4, s[8:11], s37 offen sc1
    buffer_load_dwordx4 v[40:43], v4, s[8:11], s38 offen sc1
    buffer_load_dwordx4 v[44:47], v4, s[8:11], s39 offen sc1
    v_add_u32 v1, 0x10000, v1
    ds_read_b128 v[64:67], v1 offset:0
    ds_read_b128 v[68:71], v1 offset:1024
    ds_read_b128 v[72:75], v1 offset:2048
    ds_read_b128 v[76:79], v1 offset:3072
    s_lshl_b64 s[80:81], s[78:79], 0
    v_cndmask_b32 v48, 0, v0, s[80:81]
    s_lshl_b64 s[80:81], s[78:79], 2
    v_cndmask_b32 v49, 0, v0, s[80:81]
    s_lshl_b64 s[80:81], s[78:79], 4
    v_cndmask_b32 v50, 0, v0, s[80:81]
    s_lshl_b64 s[80:81], s[78:79], 6
    v_cndmask_b32 v51, 0, v0, s[80:81]
    s_lshl_b32 s29, s67, 7
    s_add_u32 s27, s29, s62
    s_add_u32 s29, s29, s61
    s_mov_b32 s59, 0
L_rs_58:
    s_waitcnt vmcnt(0)
    v_bitop3_b32 v56, v32, v33, s42 bitop3:0x7e
    v_bitop3_b32 v57, v34, v35, s42 bitop3:0x7e
    v_mfma_f32_16x16x32_bf16 v[52:55], v[48:51], v[32:35], 0
    v_bitop3_b32 v58, v36, v37, s42 bitop3:0x7e
    v_bitop3_b32 v59, v38, v39, s42 bitop3:0x7e
    v_mfma_f32_16x16x32_bf16 v[52:55], v[48:51], v[36:39], v[52:55]
    v_or3_b32 v28, v56, v57, v58
    v_bitop3_b32 v60, v40, v41, s42 bitop3:0x7e
    v_bitop3_b32 v61, v42, v43, s42 bitop3:0x7e
    v_mfma_f32_16x16x32_bf16 v[52:55], v[48:51], v[40:43], v[52:55]
    v_or3_b32 v29, v59, v60, v61
    v_bitop3_b32 v62, v44, v45, s42 bitop3:0x7e
    v_bitop3_b32 v63, v46, v47, s42 bitop3:0x7e
    v_mfma_f32_16x16x32_bf16 v[52:55], v[48:51], v[44:47], v[52:55]
    v_or3_b32 v28, v28, v62, v63
    v_bitop3_b32 v28, v28, v29, 1 bitop3:0xa8
    v_cmp_ne_u32 vcc, 0, v28
    s_cbranch_vccnz L_rsx_61
L_rss_59:
    s_nop 3
    v_add_f32_dpp v52, v52, v52 row_ror:8 row_mask:0xf bank_mask:0xf
    v_add_f32_dpp v53, v53, v53 row_ror:8 row_mask:0xf bank_mask:0xf
    v_add_f32_dpp v54, v54, v54 row_ror:8 row_mask:0xf bank_mask:0xf
    v_add_f32_dpp v55, v55, v55 row_ror:8 row_mask:0xf bank_mask:0xf
    v_permlane16_swap_b32 v52, v53
    s_nop 0
    v_permlane16_swap_b32 v54, v55
    v_cvt_pk_bf16_f32 v52, v52, v53
    v_cvt_pk_bf16_f32 v54, v54, v55
    v_cndmask_b32 v52, v52, v54, s[74:75]
    buffer_store_dword v52, v10, s[8:11], s27 offen sc1
    s_barrier
    s_add_u32 s70, s62, 4096
    s_nop 15
    buffer_load_dwordx4 v[24:27], v8, s[8:11], s70 offen offset:0 sc1
    buffer_load_dwordx4 v[28:31], v8, s[8:11], s70 offen offset:1024 sc1
    v_mov_b64 v[48:49], 0
    v_mov_b64 v[50:51], 0
    v_mov_b64 v[52:53], 0
    v_mov_b64 v[54:55], 0
    s_add_u32 s60, s60, 1
    s_mov_b32 s61, s62
    s_add_u32 s62, s62, 9216
    s_cmp_eq_u32 s62, 93184
    s_cselect_b32 s62, 65536, s62
    s_sub_u32 s63, 491520, s63
    s_bfe_u32 s42, s60, 0x10001
    s_mov_b32 s59, 0
    s_nop 15
    s_nop 15
    buffer_load_dwordx4 v[24:27], v8, s[8:11], s70 offen offset:0 sc1
    buffer_load_dwordx4 v[28:31], v8, s[8:11], s70 offen offset:1024 sc1
    v_mov_b32 v2, -1
    buffer_store_dword v2, v10, s[8:11], s29 offen sc1
    s_waitcnt vmcnt(6)
    v_mov_b64 v[32:33], 0
    v_mov_b64 v[34:35], 0
    v_mov_b64 v[36:37], 0
    v_mov_b64 v[38:39], 0
    v_mov_b64 v[40:41], 0
    v_mov_b64 v[42:43], 0
    v_mov_b64 v[44:45], 0
    v_mov_b64 v[46:47], 0
L_gat_62:
    s_waitcnt vmcnt(3)
    v_max3_u32 v60, v24, v25, v26
    v_max_u32 v60, v60, v27
    v_max3_u32 v61, v28, v29, v30
    v_max_u32 v61, v61, v31
    v_max_u32 v63, v60, v61
    v_cmp_eq_u32 vcc, -1, v63
    s_cbranch_vccnz L_gatx_63
L_gat_62_ok:
    s_waitcnt lgkmcnt(0)
    ds_write_b128 v15, v[24:27] offset:4096
    ds_write_b128 v15, v[28:31] offset:5120
    v_smfmac_f32_16x16x64_bf16 v[32:35], v[24:27], a[32:39], v5
    v_smfmac_f32_16x16x64_bf16 v[48:51], v[24:27], v[64:71], v5
    ds_read_b128 v[64:67], v1 offset:16384
    ds_read_b128 v[68:71], v1 offset:17408
    v_smfmac_f32_16x16x64_bf16 v[36:39], v[24:27], a[104:111], v5
    v_smfmac_f32_16x16x64_bf16 v[40:43], v[24:27], a[176:183], v5
    v_smfmac_f32_16x16x64_bf16 v[52:55], v[24:27], v[72:79], v5
    ds_read_b128 v[72:75], v1 offset:18432
    ds_read_b128 v[76:79], v1 offset:19456
    v_smfmac_f32_16x16x64_bf16 v[44:47], v[24:27], a[248:255], v5
    v_smfmac_f32_16x16x64_bf16 v[32:35], v[28:31], a[40:47], v5
    s_waitcnt lgkmcnt(2)
    v_smfmac_f32_16x16x64_bf16 v[48:51], v[28:31], v[64:71], v5
    v_subrev_u32 v1, 0x10000, v1
    ds_read_b128 v[64:67], v1 offset:0
    ds_read_b128 v[68:71], v1 offset:1024
    v_smfmac_f32_16x16x64_bf16 v[36:39], v[28:31], a[112:119], v5
    v_smfmac_f32_16x16x64_bf16 v[40:43], v[28:31], a[184:191], v5
    s_waitcnt lgkmcnt(2)
    v_smfmac_f32_16x16x64_bf16 v[52:55], v[28:31], v[72:79], v5
    ds_read_b128 v[72:75], v1 offset:2048
    ds_read_b128 v[76:79], v1 offset:3072
    v_smfmac_f32_16x16x64_bf16 v[44:47], v[28:31], v[80:87], v5
    s_barrier
    ds_read_b128 v[56:59], v15 offset:0
    ds_read_b128 v[60:63], v15 offset:1024
    buffer_load_dwordx4 v[24:27], v4, s[8:11], s68 offen offset:2048 sc1
    buffer_load_dwordx4 v[28:31], v4, s[8:11], s68 offen offset:3072 sc1
    s_waitcnt lgkmcnt(1)
    v_smfmac_f32_16x16x64_bf16 v[32:35], v[56:59], a[0:7], v5
    v_smfmac_f32_16x16x64_bf16 v[48:51], v[56:59], v[64:71], v5
    ds_read_b128 v[64:67], v1 offset:16384
    ds_read_b128 v[68:71], v1 offset:17408
    v_smfmac_f32_16x16x64_bf16 v[36:39], v[56:59], a[72:79], v5
    v_smfmac_f32_16x16x64_bf16 v[40:43], v[56:59], a[144:151], v5
    v_smfmac_f32_16x16x64_bf16 v[52:55], v[56:59], v[72:79], v5
    ds_read_b128 v[72:75], v1 offset:18432
    ds_read_b128 v[76:79], v1 offset:19456
    v_smfmac_f32_16x16x64_bf16 v[44:47], v[56:59], a[216:223], v5
    ds_read_b128 v[56:59], v15 offset:2048
    s_add_u32 s70, s68, 32768
    buffer_load_dword v2, v3, s[8:11], s70 offen
    s_waitcnt lgkmcnt(5)
    v_smfmac_f32_16x16x64_bf16 v[32:35], v[60:63], a[8:15], v5
    s_waitcnt lgkmcnt(3)
    v_smfmac_f32_16x16x64_bf16 v[48:51], v[60:63], v[64:71], v5
    ds_read_b128 v[64:67], v1 offset:32768
    ds_read_b128 v[68:71], v1 offset:33792
    v_smfmac_f32_16x16x64_bf16 v[36:39], v[60:63], a[80:87], v5
    v_smfmac_f32_16x16x64_bf16 v[40:43], v[60:63], a[152:159], v5
    s_waitcnt lgkmcnt(3)
    v_smfmac_f32_16x16x64_bf16 v[52:55], v[60:63], v[72:79], v5
    ds_read_b128 v[72:75], v1 offset:34816
    ds_read_b128 v[76:79], v1 offset:35840
    v_smfmac_f32_16x16x64_bf16 v[44:47], v[60:63], a[224:231], v5
    ds_read_b128 v[60:63], v15 offset:3072
    s_waitcnt lgkmcnt(5)
    v_smfmac_f32_16x16x64_bf16 v[32:35], v[56:59], a[16:23], v5
    s_waitcnt lgkmcnt(3)
    v_smfmac_f32_16x16x64_bf16 v[48:51], v[56:59], v[64:71], v5
    ds_read_b128 v[64:67], v1 offset:49152
    ds_read_b128 v[68:71], v1 offset:50176
    v_smfmac_f32_16x16x64_bf16 v[36:39], v[56:59], a[88:95], v5
    v_smfmac_f32_16x16x64_bf16 v[40:43], v[56:59], a[160:167], v5
    s_waitcnt lgkmcnt(3)
    v_smfmac_f32_16x16x64_bf16 v[52:55], v[56:59], v[72:79], v5
    ds_read_b128 v[72:75], v1 offset:51200
    ds_read_b128 v[76:79], v1 offset:52224
    v_smfmac_f32_16x16x64_bf16 v[44:47], v[56:59], a[232:239], v5
    ds_read_b128 v[56:59], v15 offset:8192
    s_waitcnt lgkmcnt(5)
    v_smfmac_f32_16x16x64_bf16 v[32:35], v[60:63], a[24:31], v5
    s_waitcnt lgkmcnt(3)
    v_smfmac_f32_16x16x64_bf16 v[48:51], v[60:63], v[64:71], v5
    v_add_u32 v1, 0x20000, v1
    ds_read_b128 v[64:67], v1 offset:0
    ds_read_b128 v[68:71], v1 offset:1024
    v_smfmac_f32_16x16x64_bf16 v[36:39], v[60:63], a[96:103], v5
    v_smfmac_f32_16x16x64_bf16 v[40:43], v[60:63], a[168:175], v5
    s_waitcnt lgkmcnt(3)
    v_smfmac_f32_16x16x64_bf16 v[52:55], v[60:63], v[72:79], v5
    ds_read_b128 v[72:75], v1 offset:2048
    ds_read_b128 v[76:79], v1 offset:3072
    v_smfmac_f32_16x16x64_bf16 v[44:47], v[60:63], a[240:247], v5
    ds_read_b128 v[60:63], v15 offset:6144
    s_waitcnt lgkmcnt(5)
    v_smfmac_f32_16x16x64_bf16 v[32:35], v[56:59], a[64:71], v5
    s_waitcnt lgkmcnt(3)
    v_smfmac_f32_16x16x64_bf16 v[48:51], v[56:59], v[64:71], v5
    v_subrev_u32 v1, 0x10000, v1
    ds_read_b128 v[64:67], v1 offset:32768
    ds_read_b128 v[68:71], v1 offset:33792
    v_smfmac_f32_16x16x64_bf16 v[36:39], v[56:59], a[136:143], v5
    v_smfmac_f32_16x16x64_bf16 v[40:43], v[56:59], a[208:215], v5
    s_waitcnt lgkmcnt(3)
    v_smfmac_f32_16x16x64_bf16 v[52:55], v[56:59], v[72:79], v5
    ds_read_b128 v[72:75], v1 offset:34816
    ds_read_b128 v[76:79], v1 offset:35840
    v_smfmac_f32_16x16x64_bf16 v[44:47], v[56:59], v[104:111], v5
    ds_read_b128 v[56:59], v15 offset:7168
    s_waitcnt lgkmcnt(5)
    v_smfmac_f32_16x16x64_bf16 v[32:35], v[60:63], a[48:55], v5
    s_waitcnt lgkmcnt(3)
    v_smfmac_f32_16x16x64_bf16 v[48:51], v[60:63], v[64:71], v5
    ds_read_b128 v[64:67], v1 offset:49152
    ds_read_b128 v[68:71], v1 offset:50176
    v_smfmac_f32_16x16x64_bf16 v[36:39], v[60:63], a[120:127], v5
    v_smfmac_f32_16x16x64_bf16 v[40:43], v[60:63], a[192:199], v5
    s_waitcnt lgkmcnt(3)
    v_smfmac_f32_16x16x64_bf16 v[52:55], v[60:63], v[72:79], v5
    ds_read_b128 v[72:75], v1 offset:51200
    ds_read_b128 v[76:79], v1 offset:52224
    v_smfmac_f32_16x16x64_bf16 v[44:47], v[60:63], v[88:95], v5
    s_waitcnt lgkmcnt(4)
    v_smfmac_f32_16x16x64_bf16 v[32:35], v[56:59], a[56:63], v5
    v_smfmac_f32_16x16x64_bf16 v[36:39], v[56:59], a[128:135], v5
    v_smfmac_f32_16x16x64_bf16 v[40:43], v[56:59], a[200:207], v5
    v_smfmac_f32_16x16x64_bf16 v[44:47], v[56:59], v[96:103], v5
    s_waitcnt lgkmcnt(2)
    v_smfmac_f32_16x16x64_bf16 v[48:51], v[56:59], v[64:71], v5
    s_waitcnt lgkmcnt(0)
    v_smfmac_f32_16x16x64_bf16 v[52:55], v[56:59], v[72:79], v5
    v_subrev_u32 v1, 0x10000, v1
    s_waitcnt vmcnt(1)
    s_branch L_cC_52
L_rsx_61:
    v_bitop3_b32 v28, v56, v57, 1 bitop3:0xa8
    v_bitop3_b32 v29, v58, v59, 1 bitop3:0xa8
    v_bitop3_b32 v30, v60, v61, 1 bitop3:0xa8
    v_bitop3_b32 v31, v62, v63, 1 bitop3:0xa8
    v_cmp_ne_u32 s[16:17], 0, v28
    v_cmp_ne_u32 s[18:19], 0, v29
    v_cmp_ne_u32 s[20:21], 0, v30
    v_cmp_ne_u32 s[22:23], 0, v31
    s_mov_b64 exec, s[16:17]
    buffer_load_dwordx4 v[32:35], v4, s[8:11], s36 offen sc1
    s_mov_b64 exec, s[18:19]
    buffer_load_dwordx4 v[36:39], v4, s[8:11], s37 offen sc1
    s_mov_b64 exec, s[20:21]
    buffer_load_dwordx4 v[40:43], v4, s[8:11], s38 offen sc1
    s_mov_b64 exec, s[22:23]
    buffer_load_dwordx4 v[44:47], v4, s[8:11], s39 offen sc1
    s_mov_b64 exec, -1
    s_add_u32 s59, s59, 1
    s_cmp_lt_u32 s59, s58
    s_cbranch_scc1 L_rs_58
    s_mov_b32 s58, 0
    s_branch L_rss_59
L_gatx_63:
    v_cmp_eq_u32 s[16:17], -1, v60
    v_cmp_eq_u32 s[18:19], -1, v61
    s_mov_b64 exec, s[16:17]
    buffer_load_dwordx4 v[24:27], v8, s[8:11], s70 offen offset:0 sc1
    s_mov_b64 exec, s[18:19]
    buffer_load_dwordx4 v[28:31], v8, s[8:11], s70 offen offset:1024 sc1
    s_mov_b64 exec, -1
    s_add_u32 s59, s59, 1
    s_cmp_lt_u32 s59, s58
    s_cbranch_scc1 L_gat_62
    s_mov_b32 s58, 0
    s_branch L_gat_62_ok
L_pw1_55:
    buffer_load_dwordx4 v[32:35], v4, s[8:11], s36 offen sc1
    buffer_load_dwordx4 v[36:39], v4, s[8:11], s37 offen sc1
    buffer_load_dwordx4 v[40:43], v4, s[8:11], s38 offen sc1
    buffer_load_dwordx4 v[44:47], v4, s[8:11], s39 offen sc1
    ds_read_b128 v[64:67], v1 offset:32768
    ds_read_b128 v[68:71], v1 offset:33792
    ds_read_b128 v[72:75], v1 offset:34816
    ds_read_b128 v[76:79], v1 offset:35840
    s_lshl_b64 s[80:81], s[78:79], 0
    v_cndmask_b32 v48, 0, v0, s[80:81]
    s_lshl_b64 s[80:81], s[78:79], 2
    v_cndmask_b32 v49, 0, v0, s[80:81]
    s_lshl_b64 s[80:81], s[78:79], 4
    v_cndmask_b32 v50, 0, v0, s[80:81]
    s_lshl_b64 s[80:81], s[78:79], 6
    v_cndmask_b32 v51, 0, v0, s[80:81]
    s_lshl_b32 s29, s67, 7
    s_add_u32 s27, s29, s62
    s_add_u32 s29, s29, s61
    s_mov_b32 s59, 0
    s_nop 15
    s_nop 15
    s_nop 15
    s_nop 15
    buffer_load_dwordx4 v[32:35], v4, s[8:11], s36 offen sc1
    buffer_load_dwordx4 v[36:39], v4, s[8:11], s37 offen sc1
    buffer_load_dwordx4 v[40:43], v4, s[8:11], s38 offen sc1
    buffer_load_dwordx4 v[44:47], v4, s[8:11], s39 offen sc1
L_rs_64:
    s_waitcnt vmcnt(4)
    v_bitop3_b32 v56, v32, v33, s42 bitop3:0x7e
    v_bitop3_b32 v57, v34, v35, s42 bitop3:0x7e
    v_mfma_f32_16x16x32_bf16 v[52:55], v[48:51], v[32:35], 0
    v_bitop3_b32 v58, v36, v37, s42 bitop3:0x7e
    v_bitop3_b32 v59, v38, v39, s42 bitop3:0x7e
    v_mfma_f32_16x16x32_bf16 v[52:55], v[48:51], v[36:39], v[52:55]
    v_or3_b32 v28, v56, v57, v58
    v_bitop3_b32 v60, v40, v41, s42 bitop3:0x7e
    v_bitop3_b32 v61, v42, v43, s42 bitop3:0x7e
    v_mfma_f32_16x16x32_bf16 v[52:55], v[48:51], v[40:43], v[52:55]
    v_or3_b32 v29, v59, v60, v61
    v_bitop3_b32 v62, v44, v45, s42 bitop3:0x7e
    v_bitop3_b32 v63, v46, v47, s42 bitop3:0x7e
    v_mfma_f32_16x16x32_bf16 v[52:55], v[48:51], v[44:47], v[52:55]
    v_or3_b32 v28, v28, v62, v63
    v_bitop3_b32 v28, v28, v29, 1 bitop3:0xa8
    v_cmp_ne_u32 vcc, 0, v28
    s_cbranch_vccnz L_rsx_67
L_rss_65:
    s_nop 3
    v_add_f32_dpp v52, v52, v52 row_ror:8 row_mask:0xf bank_mask:0xf
    v_add_f32_dpp v53, v53, v53 row_ror:8 row_mask:0xf bank_mask:0xf
    v_add_f32_dpp v54, v54, v54 row_ror:8 row_mask:0xf bank_mask:0xf
    v_add_f32_dpp v55, v55, v55 row_ror:8 row_mask:0xf bank_mask:0xf
    v_permlane16_swap_b32 v52, v53
    s_nop 0
    v_permlane16_swap_b32 v54, v55
    v_cvt_pk_bf16_f32 v52, v52, v53
    v_cvt_pk_bf16_f32 v54, v54, v55
    v_cndmask_b32 v52, v52, v54, s[74:75]
    buffer_store_dword v52, v10, s[8:11], s27 offen sc1
    s_barrier
    s_add_u32 s70, s62, 2048
    s_nop 15
    buffer_load_dwordx4 v[24:27], v8, s[8:11], s70 offen offset:0 sc1
    buffer_load_dwordx4 v[28:31], v8, s[8:11], s70 offen offset:1024 sc1
    v_mov_b64 v[48:49], 0
    v_mov_b64 v[50:51], 0
    v_mov_b64 v[52:53], 0
    v_mov_b64 v[54:55], 0
    s_add_u32 s60, s60, 1
    s_mov_b32 s61, s62
    s_add_u32 s62, s62, 9216
    s_cmp_eq_u32 s62, 93184
    s_cselect_b32 s62, 65536, s62
    s_sub_u32 s63, 491520, s63
    s_bfe_u32 s42, s60, 0x10001
    s_mov_b32 s59, 0
    s_nop 15
    s_nop 15
    buffer_load_dwordx4 v[24:27], v8, s[8:11], s70 offen offset:0 sc1
    buffer_load_dwordx4 v[28:31], v8, s[8:11], s70 offen offset:1024 sc1
    v_mov_b32 v2, -1
    buffer_store_dword v2, v10, s[8:11], s29 offen sc1
    s_waitcnt vmcnt(6)
    v_mov_b64 v[32:33], 0
    v_mov_b64 v[34:35], 0
    v_mov_b64 v[36:37], 0
    v_mov_b64 v[38:39], 0
    v_mov_b64 v[40:41], 0
    v_mov_b64 v[42:43], 0
    v_mov_b64 v[44:45], 0
    v_mov_b64 v[46:47], 0
L_gat_68:
    s_waitcnt vmcnt(3)
    v_max3_u32 v60, v24, v25, v26
    v_max_u32 v60, v60, v27
    v_max3_u32 v61, v28, v29, v30
    v_max_u32 v61, v61, v31
    v_max_u32 v63, v60, v61
    v_cmp_eq_u32 vcc, -1, v63
    s_cbranch_vccnz L_gatx_69
L_gat_68_ok:
    s_waitcnt lgkmcnt(0)
    ds_write_b128 v15, v[24:27] offset:2048
    ds_write_b128 v15, v[28:31] offset:3072
    v_smfmac_f32_16x16x64_bf16 v[32:35], v[24:27], a[16:23], v5
    v_smfmac_f32_16x16x64_bf16 v[48:51], v[24:27], v[64:71], v5
    ds_read_b128 v[64:67], v1 offset:49152
    ds_read_b128 v[68:71], v1 offset:50176
    v_smfmac_f32_16x16x64_bf16 v[36:39], v[24:27], a[88:95], v5
    v_smfmac_f32_16x16x64_bf16 v[40:43], v[24:27], a[160:167], v5
    v_smfmac_f32_16x16x64_bf16 v[52:55], v[24:27], v[72:79], v5
    ds_read_b128 v[72:75], v1 offset:51200
    ds_read_b128 v[76:79], v1 offset:52224
    v_smfmac_f32_16x16x64_bf16 v[44:47], v[24:27], a[232:239], v5
    v_smfmac_f32_16x16x64_bf16 v[32:35], v[28:31], a[24:31], v5
    s_waitcnt lgkmcnt(2)
    v_smfmac_f32_16x16x64_bf16 v[48:51], v[28:31], v[64:71], v5
    ds_read_b128 v[64:67], v1 offset:0
    ds_read_b128 v[68:71], v1 offset:1024
    v_smfmac_f32_16x16x64_bf16 v[36:39], v[28:31], a[96:103], v5
    v_smfmac_f32_16x16x64_bf16 v[40:43], v[28:31], a[168:175], v5
    s_waitcnt lgkmcnt(2)
    v_smfmac_f32_16x16x64_bf16 v[52:55], v[28:31], v[72:79], v5
    ds_read_b128 v[72:75], v1 offset:2048
    ds_read_b128 v[76:79], v1 offset:3072
    v_smfmac_f32_16x16x64_bf16 v[44:47], v[28:31], a[240:247], v5
    s_barrier
    ds_read_b128 v[56:59], v15 offset:0
    ds_read_b128 v[60:63], v15 offset:1024
    buffer_load_dwordx4 v[24:27], v4, s[8:11], s68 offen offset:2048 sc1
    buffer_load_dwordx4 v[28:31], v4, s[8:11], s68 offen offset:3072 sc1
    s_waitcnt lgkmcnt(1)
    v_smfmac_f32_16x16x64_bf16 v[32:35], v[56:59], a[0:7], v5
    v_smfmac_f32_16x16x64_bf16 v[48:51], v[56:59], v[64:71], v5
    ds_read_b128 v[64:67], v1 offset:16384
    ds_read_b128 v[68:71], v1 offset:17408
    v_smfmac_f32_16x16x64_bf16 v[36:39], v[56:59], a[72:79], v5
    v_smfmac_f32_16x16x64_bf16 v[40:43], v[56:59], a[144:151], v5
    v_smfmac_f32_16x16x64_bf16 v[52:55], v[56:59], v[72:79], v5
    ds_read_b128 v[72:75], v1 offset:18432
    ds_read_b128 v[76:79], v1 offset:19456
    v_smfmac_f32_16x16x64_bf16 v[44:47], v[56:59], a[216:223], v5
    ds_read_b128 v[56:59], v15 offset:8192
    s_add_u32 s70, s68, 32768
    buffer_load_dword v2, v3, s[8:11], s70 offen
    s_waitcnt lgkmcnt(5)
    v_smfmac_f32_16x16x64_bf16 v[32:35], v[60:63], a[8:15], v5
    s_waitcnt lgkmcnt(3)
    v_smfmac_f32_16x16x64_bf16 v[48:51], v[60:63], v[64:71], v5
    v_add_u32 v1, 0x20000, v1
    ds_read_b128 v[64:67], v1 offset:0
    ds_read_b128 v[68:71], v1 offset:1024
    v_smfmac_f32_16x16x64_bf16 v[36:39], v[60:63], a[80:87], v5
    v_smfmac_f32_16x16x64_bf16 v[40:43], v[60:63], a[152:159], v5
    s_waitcnt lgkmcnt(3)
    v_smfmac_f32_16x16x64_bf16 v[52:55], v[60:63], v[72:79], v5
    ds_read_b128 v[72:75], v1 offset:2048
    ds_read_b128 v[76:79], v1 offset:3072
    v_smfmac_f32_16x16x64_bf16 v[44:47], v[60:63], a[224:231], v5
    ds_read_b128 v[60:63], v15 offset:4096
    s_waitcnt lgkmcnt(5)
    v_smfmac_f32_16x16x64_bf16 v[32:35], v[56:59], a[64:71], v5
    s_waitcnt lgkmcnt(3)
    v_smfmac_f32_16x16x64_bf16 v[48:51], v[56:59], v[64:71], v5
    v_subrev_u32 v1, 0x10000, v1
    ds_read_b128 v[64:67], v1 offset:0
    ds_read_b128 v[68:71], v1 offset:1024
    v_smfmac_f32_16x16x64_bf16 v[36:39], v[56:59], a[136:143], v5
    v_smfmac_f32_16x16x64_bf16 v[40:43], v[56:59], a[208:215], v5
    s_waitcnt lgkmcnt(3)
    v_smfmac_f32_16x16x64_bf16 v[52:55], v[56:59], v[72:79], v5
    ds_read_b128 v[72:75], v1 offset:2048
    ds_read_b128 v[76:79], v1 offset:3072
    v_smfmac_f32_16x16x64_bf16 v[44:47], v[56:59], v[104:111], v5
    ds_read_b128 v[56:59], v15 offset:5120
    s_waitcnt lgkmcnt(5)
    v_smfmac_f32_16x16x64_bf16 v[32:35], v[60:63], a[32:39], v5
    s_waitcnt lgkmcnt(3)
    v_smfmac_f32_16x16x64_bf16 v[48:51], v[60:63], v[64:71], v5
    ds_read_b128 v[64:67], v1 offset:16384
    ds_read_b128 v[68:71], v1 offset:17408
    v_smfmac_f32_16x16x64_bf16 v[36:39], v[60:63], a[104:111], v5
    v_smfmac_f32_16x16x64_bf16 v[40:43], v[60:63], a[176:183], v5
    s_waitcnt lgkmcnt(3)
    v_smfmac_f32_16x16x64_bf16 v[52:55], v[60:63], v[72:79], v5
    ds_read_b128 v[72:75], v1 offset:18432
    ds_read_b128 v[76:79], v1 offset:19456
    v_smfmac_f32_16x16x64_bf16 v[44:47], v[60:63], a[248:255], v5
    ds_read_b128 v[60:63], v15 offset:6144
    s_waitcnt lgkmcnt(5)
    v_smfmac_f32_16x16x64_bf16 v[32:35], v[56:59], a[40:47], v5
    s_waitcnt lgkmcnt(3)
    v_smfmac_f32_16x16x64_bf16 v[48:51], v[56:59], v[64:71], v5
    ds_read_b128 v[64:67], v1 offset:32768
    ds_read_b128 v[68:71], v1 offset:33792
    v_smfmac_f32_16x16x64_bf16 v[36:39], v[56:59], a[112:119], v5
    v_smfmac_f32_16x16x64_bf16 v[40:43], v[56:59], a[184:191], v5
    s_waitcnt lgkmcnt(3)
    v_smfmac_f32_16x16x64_bf16 v[52:55], v[56:59], v[72:79], v5
    ds_read_b128 v[72:75], v1 offset:34816
    ds_read_b128 v[76:79], v1 offset:35840
    v_smfmac_f32_16x16x64_bf16 v[44:47], v[56:59], v[80:87], v5
    ds_read_b128 v[56:59], v15 offset:7168
    s_waitcnt lgkmcnt(5)
    v_smfmac_f32_16x16x64_bf16 v[32:35], v[60:63], a[48:55], v5
    s_waitcnt lgkmcnt(3)
    v_smfmac_f32_16x16x64_bf16 v[48:51], v[60:63], v[64:71], v5
    ds_read_b128 v[64:67], v1 offset:49152
    ds_read_b128 v[68:71], v1 offset:50176
    v_smfmac_f32_16x16x64_bf16 v[36:39], v[60:63], a[120:127], v5
    v_smfmac_f32_16x16x64_bf16 v[40:43], v[60:63], a[192:199], v5
    s_waitcnt lgkmcnt(3)
    v_smfmac_f32_16x16x64_bf16 v[52:55], v[60:63], v[72:79], v5
    ds_read_b128 v[72:75], v1 offset:51200
    ds_read_b128 v[76:79], v1 offset:52224
    v_smfmac_f32_16x16x64_bf16 v[44:47], v[60:63], v[88:95], v5
    s_waitcnt lgkmcnt(4)
    v_smfmac_f32_16x16x64_bf16 v[32:35], v[56:59], a[56:63], v5
    v_smfmac_f32_16x16x64_bf16 v[36:39], v[56:59], a[128:135], v5
    v_smfmac_f32_16x16x64_bf16 v[40:43], v[56:59], a[200:207], v5
    v_smfmac_f32_16x16x64_bf16 v[44:47], v[56:59], v[96:103], v5
    s_waitcnt lgkmcnt(2)
    v_smfmac_f32_16x16x64_bf16 v[48:51], v[56:59], v[64:71], v5
    s_waitcnt lgkmcnt(0)
    v_smfmac_f32_16x16x64_bf16 v[52:55], v[56:59], v[72:79], v5
    v_subrev_u32 v1, 0x10000, v1
    s_waitcnt vmcnt(1)
    s_branch L_cC_52
L_rsx_67:
    v_bitop3_b32 v28, v56, v57, 1 bitop3:0xa8
    v_bitop3_b32 v29, v58, v59, 1 bitop3:0xa8
    v_bitop3_b32 v30, v60, v61, 1 bitop3:0xa8
    v_bitop3_b32 v31, v62, v63, 1 bitop3:0xa8
    v_cmp_ne_u32 s[16:17], 0, v28
    v_cmp_ne_u32 s[18:19], 0, v29
    v_cmp_ne_u32 s[20:21], 0, v30
    v_cmp_ne_u32 s[22:23], 0, v31
    s_mov_b64 exec, s[16:17]
    buffer_load_dwordx4 v[32:35], v4, s[8:11], s36 offen sc1
    s_mov_b64 exec, s[18:19]
    buffer_load_dwordx4 v[36:39], v4, s[8:11], s37 offen sc1
    s_mov_b64 exec, s[20:21]
    buffer_load_dwordx4 v[40:43], v4, s[8:11], s38 offen sc1
    s_mov_b64 exec, s[22:23]
    buffer_load_dwordx4 v[44:47], v4, s[8:11], s39 offen sc1
    s_mov_b64 exec, -1
    s_add_u32 s59, s59, 1
    s_cmp_lt_u32 s59, s58
    s_cbranch_scc1 L_rs_64
    s_mov_b32 s58, 0
    s_branch L_rss_65
L_gatx_69:
    v_cmp_eq_u32 s[16:17], -1, v60
    v_cmp_eq_u32 s[18:19], -1, v61
    s_mov_b64 exec, s[16:17]
    buffer_load_dwordx4 v[24:27], v8, s[8:11], s70 offen offset:0 sc1
    s_mov_b64 exec, s[18:19]
    buffer_load_dwordx4 v[28:31], v8, s[8:11], s70 offen offset:1024 sc1
    s_mov_b64 exec, -1
    s_add_u32 s59, s59, 1
    s_cmp_lt_u32 s59, s58
    s_cbranch_scc1 L_gat_68
    s_mov_b32 s58, 0
    s_branch L_gat_68_ok
L_pw0_54:
    s_cmp_eq_u32 s65, 0
    s_cbranch_scc1 L_nored_70
    buffer_load_dwordx4 v[32:35], v4, s[8:11], s36 offen sc1
    buffer_load_dwordx4 v[36:39], v4, s[8:11], s37 offen sc1
    buffer_load_dwordx4 v[40:43], v4, s[8:11], s38 offen sc1
    buffer_load_dwordx4 v[44:47], v4, s[8:11], s39 offen sc1
    ds_read_b128 v[64:67], v1 offset:0
    ds_read_b128 v[68:71], v1 offset:1024
    ds_read_b128 v[72:75], v1 offset:2048
    ds_read_b128 v[76:79], v1 offset:3072
    s_lshl_b64 s[80:81], s[78:79], 0
    v_cndmask_b32 v48, 0, v0, s[80:81]
    s_lshl_b64 s[80:81], s[78:79], 2
    v_cndmask_b32 v49, 0, v0, s[80:81]
    s_lshl_b64 s[80:81], s[78:79], 4
    v_cndmask_b32 v50, 0, v0, s[80:81]
    s_lshl_b64 s[80:81], s[78:79], 6
    v_cndmask_b32 v51, 0, v0, s[80:81]
    s_lshl_b32 s29, s67, 7
    s_add_u32 s27, s29, s62
    s_add_u32 s29, s29, s61
    s_mov_b32 s59, 0
L_rs_72:
    s_waitcnt vmcnt(0)
    v_bitop3_b32 v56, v32, v33, s42 bitop3:0x7e
    v_bitop3_b32 v57, v34, v35, s42 bitop3:0x7e
    v_mfma_f32_16x16x32_bf16 v[52:55], v[48:51], v[32:35], 0
    v_bitop3_b32 v58, v36, v37, s42 bitop3:0x7e
    v_bitop3_b32 v59, v38, v39, s42 bitop3:0x7e
    v_mfma_f32_16x16x32_bf16 v[52:55], v[48:51], v[36:39], v[52:55]
    v_or3_b32 v28, v56, v57, v58
    v_bitop3_b32 v60, v40, v41, s42 bitop3:0x7e
    v_bitop3_b32 v61, v42, v43, s42 bitop3:0x7e
    v_mfma_f32_16x16x32_bf16 v[52:55], v[48:51], v[40:43], v[52:55]
    v_or3_b32 v29, v59, v60, v61
    v_bitop3_b32 v62, v44, v45, s42 bitop3:0x7e
    v_bitop3_b32 v63, v46, v47, s42 bitop3:0x7e
    v_mfma_f32_16x16x32_bf16 v[52:55], v[48:51], v[44:47], v[52:55]
    v_or3_b32 v28, v28, v62, v63
    v_bitop3_b32 v28, v28, v29, 1 bitop3:0xa8
    v_cmp_ne_u32 vcc, 0, v28
    s_cbranch_vccnz L_rsx_75
L_rss_73:
    s_nop 3
    v_add_f32_dpp v52, v52, v52 row_ror:8 row_mask:0xf bank_mask:0xf
    v_add_f32_dpp v53, v53, v53 row_ror:8 row_mask:0xf bank_mask:0xf
    v_add_f32_dpp v54, v54, v54 row_ror:8 row_mask:0xf bank_mask:0xf
    v_add_f32_dpp v55, v55, v55 row_ror:8 row_mask:0xf bank_mask:0xf
    v_permlane16_swap_b32 v52, v53
    s_nop 0
    v_permlane16_swap_b32 v54, v55
    v_cvt_pk_bf16_f32 v52, v52, v53
    v_cvt_pk_bf16_f32 v54, v54, v55
    v_cndmask_b32 v52, v52, v54, s[74:75]
    buffer_store_dword v52, v10, s[8:11], s27 offen sc1
L_redj_71:
    s_barrier
    s_add_u32 s70, s62, 0
    s_add_u32 s71, s62, 8192
    s_nop 15
    buffer_load_dwordx4 v[24:27], v8, s[8:11], s70 offen offset:0 sc1
    buffer_load_dwordx4 v[28:31], v8, s[8:11], s70 offen offset:1024 sc1
    buffer_load_dwordx4 v[56:59], v8, s[8:11], s71 offen offset:0 sc1
    v_mov_b64 v[48:49], 0
    v_mov_b64 v[50:51], 0
    v_mov_b64 v[52:53], 0
    v_mov_b64 v[54:55], 0
    s_add_u32 s60, s60, 1
    s_mov_b32 s61, s62
    s_add_u32 s62, s62, 9216
    s_cmp_eq_u32 s62, 93184
    s_cselect_b32 s62, 65536, s62
    s_sub_u32 s63, 491520, s63
    s_bfe_u32 s42, s60, 0x10001
    s_mov_b32 s59, 0
    s_nop 15
    s_nop 15
    buffer_load_dwordx4 v[24:27], v8, s[8:11], s70 offen offset:0 sc1
    buffer_load_dwordx4 v[28:31], v8, s[8:11], s70 offen offset:1024 sc1
    buffer_load_dwordx4 v[56:59], v8, s[8:11], s71 offen offset:0 sc1
    s_waitcnt vmcnt(7)
    v_mov_b64 v[32:33], 0
    v_mov_b64 v[34:35], 0
    v_mov_b64 v[36:37], 0
    v_mov_b64 v[38:39], 0
    v_mov_b64 v[40:41], 0
    v_mov_b64 v[42:43], 0
    v_mov_b64 v[44:45], 0
    v_mov_b64 v[46:47], 0
L_gat_76:
    s_waitcnt vmcnt(3)
    v_max3_u32 v60, v24, v25, v26
    v_max_u32 v60, v60, v27
    v_max3_u32 v61, v28, v29, v30
    v_max_u32 v61, v61, v31
    v_max3_u32 v62, v56, v57, v58
    v_max_u32 v62, v62, v59
    v_max3_u32 v63, v60, v61, v62
    v_cmp_eq_u32 vcc, -1, v63
    s_cbranch_vccnz L_gatx_77
L_gat_76_ok:
    s_waitcnt lgkmcnt(0)
    ds_write_b128 v15, v[24:27] offset:0
    ds_write_b128 v15, v[28:31] offset:1024
    ds_write_b128 v15, v[56:59] offset:8192
    v_smfmac_f32_16x16x64_bf16 v[32:35], v[24:27], a[0:7], v5
    v_smfmac_f32_16x16x64_bf16 v[48:51], v[24:27], v[64:71], v5
    ds_read_b128 v[64:67], v1 offset:16384
    ds_read_b128 v[68:71], v1 offset:17408
    v_smfmac_f32_16x16x64_bf16 v[36:39], v[24:27], a[72:79], v5
    v_smfmac_f32_16x16x64_bf16 v[40:43], v[24:27], a[144:151], v5
    v_smfmac_f32_16x16x64_bf16 v[52:55], v[24:27], v[72:79], v5
    ds_read_b128 v[72:75], v1 offset:18432
    ds_read_b128 v[76:79], v1 offset:19456
    v_smfmac_f32_16x16x64_bf16 v[44:47], v[24:27], a[216:223], v5
    v_smfmac_f32_16x16x64_bf16 v[32:35], v[28:31], a[8:15], v5
    s_waitcnt lgkmcnt(2)
    v_smfmac_f32_16x16x64_bf16 v[48:51], v[28:31], v[64:71], v5
    v_add_u32 v1, 0x20000, v1
    ds_read_b128 v[64:67], v1 offset:0
    ds_read_b128 v[68:71], v1 offset:1024
    v_smfmac_f32_16x16x64_bf16 v[36:39], v[28:31], a[80:87], v5
    v_smfmac_f32_16x16x64_bf16 v[40:43], v[28:31], a[152:159], v5
    s_waitcnt lgkmcnt(2)
    v_smfmac_f32_16x16x64_bf16 v[52:55], v[28:31], v[72:79], v5
    ds_read_b128 v[72:75], v1 offset:2048
    ds_read_b128 v[76:79], v1 offset:3072
    v_smfmac_f32_16x16x64_bf16 v[44:47], v[28:31], a[224:231], v5
    s_barrier
    ds_read_b128 v[60:63], v15 offset:2048
    s_waitcnt vmcnt(0)
    s_cmp_eq_u32 s36, 0
    s_cbranch_scc1 L_norst_78
    v_mov_b32 v2, -1
    buffer_store_dword v2, v10, s[8:11], s29 offen sc1
L_norst_78:
    buffer_load_dwordx4 v[24:27], v4, s[8:11], s68 offen offset:2048 sc1
    buffer_load_dwordx4 v[28:31], v4, s[8:11], s68 offen offset:3072 sc1
    v_smfmac_f32_16x16x64_bf16 v[32:35], v[56:59], a[64:71], v5
    s_waitcnt lgkmcnt(3)
    v_smfmac_f32_16x16x64_bf16 v[48:51], v[56:59], v[64:71], v5
    v_subrev_u32 v1, 0x20000, v1
    ds_read_b128 v[64:67], v1 offset:32768
    ds_read_b128 v[68:71], v1 offset:33792
    v_smfmac_f32_16x16x64_bf16 v[36:39], v[56:59], a[136:143], v5
    v_smfmac_f32_16x16x64_bf16 v[40:43], v[56:59], a[208:215], v5
    s_waitcnt lgkmcnt(3)
    v_smfmac_f32_16x16x64_bf16 v[52:55], v[56:59], v[72:79], v5
    ds_read_b128 v[72:75], v1 offset:34816
    ds_read_b128 v[76:79], v1 offset:35840
    v_smfmac_f32_16x16x64_bf16 v[44:47], v[56:59], v[104:111], v5
    ds_read_b128 v[56:59], v15 offset:3072
    s_add_u32 s70, s68, 32768
    buffer_load_dword v2, v3, s[8:11], s70 offen
    s_waitcnt lgkmcnt(5)
    v_smfmac_f32_16x16x64_bf16 v[32:35], v[60:63], a[16:23], v5
    s_waitcnt lgkmcnt(3)
    v_smfmac_f32_16x16x64_bf16 v[48:51], v[60:63], v[64:71], v5
    ds_read_b128 v[64:67], v1 offset:49152
    ds_read_b128 v[68:71], v1 offset:50176
    v_smfmac_f32_16x16x64_bf16 v[36:39], v[60:63], a[88:95], v5
    v_smfmac_f32_16x16x64_bf16 v[40:43], v[60:63], a[160:167], v5
    s_waitcnt lgkmcnt(3)
    v_smfmac_f32_16x16x64_bf16 v[52:55], v[60:63], v[72:79], v5
    ds_read_b128 v[72:75], v1 offset:51200
    ds_read_b128 v[76:79], v1 offset:52224
    v_smfmac_f32_16x16x64_bf16 v[44:47], v[60:63], a[232:239], v5
    ds_read_b128 v[60:63], v15 offset:4096
    s_waitcnt lgkmcnt(5)
    v_smfmac_f32_16x16x64_bf16 v[32:35], v[56:59], a[24:31], v5
    s_waitcnt lgkmcnt(3)
    v_smfmac_f32_16x16x64_bf16 v[48:51], v[56:59], v[64:71], v5
    v_add_u32 v1, 0x10000, v1
    ds_read_b128 v[64:67], v1 offset:0
    ds_read_b128 v[68:71], v1 offset:1024
    v_smfmac_f32_16x16x64_bf16 v[36:39], v[56:59], a[96:103], v5
    v_smfmac_f32_16x16x64_bf16 v[40:43], v[56:59], a[168:175], v5
    s_waitcnt lgkmcnt(3)
    v_smfmac_f32_16x16x64_bf16 v[52:55], v[56:59], v[72:79], v5
    ds_read_b128 v[72:75], v1 offset:2048
    ds_read_b128 v[76:79], v1 offset:3072
    v_smfmac_f32_16x16x64_bf16 v[44:47], v[56:59], a[240:247], v5
    ds_read_b128 v[56:59], v15 offset:5120
    s_waitcnt lgkmcnt(5)
    v_smfmac_f32_16x16x64_bf16 v[32:35], v[60:63], a[32:39], v5
    s_waitcnt lgkmcnt(3)
    v_smfmac_f32_16x16x64_bf16 v[48:51], v[60:63], v[64:71], v5
    ds_read_b128 v[64:67], v1 offset:16384
    ds_read_b128 v[68:71], v1 offset:17408
    v_smfmac_f32_16x16x64_bf16 v[36:39], v[60:63], a[104:111], v5
    v_smfmac_f32_16x16x64_bf16 v[40:43], v[60:63], a[176:183], v5
    s_waitcnt lgkmcnt(3)
    v_smfmac_f32_16x16x64_bf16 v[52:55], v[60:63], v[72:79], v5
    ds_read_b128 v[72:75], v1 offset:18432
    ds_read_b128 v[76:79], v1 offset:19456
    v_smfmac_f32_16x16x64_bf16 v[44:47], v[60:63], a[248:255], v5
    ds_read_b128 v[60:63], v15 offset:6144
    s_waitcnt lgkmcnt(5)
    v_smfmac_f32_16x16x64_bf16 v[32:35], v[56:59], a[40:47], v5
    s_waitcnt lgkmcnt(3)
    v_smfmac_f32_16x16x64_bf16 v[48:51], v[56:59], v[64:71], v5
    ds_read_b128 v[64:67], v1 offset:32768
    ds_read_b128 v[68:71], v1 offset:33792
    v_smfmac_f32_16x16x64_bf16 v[36:39], v[56:59], a[112:119], v5
    v_smfmac_f32_16x16x64_bf16 v[40:43], v[56:59], a[184:191], v5
    s_waitcnt lgkmcnt(3)
    v_smfmac_f32_16x16x64_bf16 v[52:55], v[56:59], v[72:79], v5
    ds_read_b128 v[72:75], v1 offset:34816
    ds_read_b128 v[76:79], v1 offset:35840
    v_smfmac_f32_16x16x64_bf16 v[44:47], v[56:59], v[80:87], v5
    ds_read_b128 v[56:59], v15 offset:7168
    s_waitcnt lgkmcnt(5)
    v_smfmac_f32_16x16x64_bf16 v[32:35], v[60:63], a[48:55], v5
    s_waitcnt lgkmcnt(3)
    v_smfmac_f32_16x16x64_bf16 v[48:51], v[60:63], v[64:71], v5
    ds_read_b128 v[64:67], v1 offset:49152
    ds_read_b128 v[68:71], v1 offset:50176
    v_smfmac_f32_16x16x64_bf16 v[36:39], v[60:63], a[120:127], v5
    v_smfmac_f32_16x16x64_bf16 v[40:43], v[60:63], a[192:199], v5
    s_waitcnt lgkmcnt(3)
    v_smfmac_f32_16x16x64_bf16 v[52:55], v[60:63], v[72:79], v5
    ds_read_b128 v[72:75], v1 offset:51200
    ds_read_b128 v[76:79], v1 offset:52224
    v_smfmac_f32_16x16x64_bf16 v[44:47], v[60:63], v[88:95], v5
    s_waitcnt lgkmcnt(4)
    v_smfmac_f32_16x16x64_bf16 v[32:35], v[56:59], a[56:63], v5
    v_smfmac_f32_16x16x64_bf16 v[36:39], v[56:59], a[128:135], v5
    v_smfmac_f32_16x16x64_bf16 v[40:43], v[56:59], a[200:207], v5
    v_smfmac_f32_16x16x64_bf16 v[44:47], v[56:59], v[96:103], v5
    s_waitcnt lgkmcnt(2)
    v_smfmac_f32_16x16x64_bf16 v[48:51], v[56:59], v[64:71], v5
    s_waitcnt lgkmcnt(0)
    v_smfmac_f32_16x16x64_bf16 v[52:55], v[56:59], v[72:79], v5
    v_subrev_u32 v1, 0x10000, v1
    s_waitcnt vmcnt(1)
    s_branch L_cC_52
L_rsx_75:
    v_bitop3_b32 v28, v56, v57, 1 bitop3:0xa8
    v_bitop3_b32 v29, v58, v59, 1 bitop3:0xa8
    v_bitop3_b32 v30, v60, v61, 1 bitop3:0xa8
    v_bitop3_b32 v31, v62, v63, 1 bitop3:0xa8
    v_cmp_ne_u32 s[16:17], 0, v28
    v_cmp_ne_u32 s[18:19], 0, v29
    v_cmp_ne_u32 s[20:21], 0, v30
    v_cmp_ne_u32 s[22:23], 0, v31
    s_mov_b64 exec, s[16:17]
    buffer_load_dwordx4 v[32:35], v4, s[8:11], s36 offen sc1
    s_mov_b64 exec, s[18:19]
    buffer_load_dwordx4 v[36:39], v4, s[8:11], s37 offen sc1
    s_mov_b64 exec, s[20:21]
    buffer_load_dwordx4 v[40:43], v4, s[8:11], s38 offen sc1
    s_mov_b64 exec, s[22:23]
    buffer_load_dwordx4 v[44:47], v4, s[8:11], s39 offen sc1
    s_mov_b64 exec, -1
    s_add_u32 s59, s59, 1
    s_cmp_lt_u32 s59, s58
    s_cbranch_scc1 L_rs_72
    s_mov_b32 s58, 0
    s_branch L_rss_73
L_nored_70:
    ds_read_b128 v[64:67], v1 offset:0
    ds_read_b128 v[68:71], v1 offset:1024
    ds_read_b128 v[72:75], v1 offset:2048
    ds_read_b128 v[76:79], v1 offset:3072
    s_branch L_redj_71
L_gatx_77:
    v_cmp_eq_u32 s[16:17], -1, v60
    v_cmp_eq_u32 s[18:19], -1, v61
    v_cmp_eq_u32 s[20:21], -1, v62
    s_mov_b64 exec, s[16:17]
    buffer_load_dwordx4 v[24:27], v8, s[8:11], s70 offen offset:0 sc1
    s_mov_b64 exec, s[18:19]
    buffer_load_dwordx4 v[28:31], v8, s[8:11], s70 offen offset:1024 sc1
    s_mov_b64 exec, s[20:21]
    buffer_load_dwordx4 v[56:59], v8, s[8:11], s71 offen offset:0 sc1
    s_mov_b64 exec, -1
    s_add_u32 s59, s59, 1
    s_cmp_lt_u32 s59, s58
    s_cbranch_scc1 L_gat_76
    s_mov_b32 s58, 0
    s_branch L_gat_76_ok
L_pw3_57:
    v_add_u32 v1, 0x10000, v1
    ds_read_b128 v[64:67], v1 offset:32768
    ds_read_b128 v[68:71], v1 offset:33792
    ds_read_b128 v[72:75], v1 offset:34816
    ds_read_b128 v[76:79], v1 offset:35840
    v_mov_b64 v[32:33], 0
    v_mov_b64 v[34:35], 0
    v_mov_b64 v[36:37], 0
    v_mov_b64 v[38:39], 0
    v_mov_b64 v[40:41], 0
    v_mov_b64 v[42:43], 0
    v_mov_b64 v[44:45], 0
    v_mov_b64 v[46:47], 0
    v_mov_b64 v[48:49], 0
    v_mov_b64 v[50:51], 0
    v_mov_b64 v[52:53], 0
    v_mov_b64 v[54:55], 0
    s_add_u32 s71, s60, 3
    s_min_u32 s71, s71, 63
    s_lshl_b32 s70, s71, 2
    s_add_u32 s70, s70, s82
    s_waitcnt vmcnt(7)
    v_cmp_ne_u32 vcc, 1, v2
    s_cbranch_vccnz L_kvw_80
L_kvok_79:
    s_barrier
    s_add_u32 s70, s62, 6144
    s_nop 15
    buffer_load_dwordx4 v[24:27], v8, s[8:11], s70 offen offset:0 sc1
    buffer_load_dwordx4 v[28:31], v8, s[8:11], s70 offen offset:1024 sc1
    s_add_u32 s60, s60, 1
    s_mov_b32 s61, s62
    s_add_u32 s62, s62, 9216
    s_cmp_eq_u32 s62, 93184
    s_cselect_b32 s62, 65536, s62
    s_sub_u32 s63, 491520, s63
    s_bfe_u32 s42, s60, 0x10001
    s_mov_b32 s59, 0
    s_nop 15
    s_nop 15
    buffer_load_dwordx4 v[24:27], v8, s[8:11], s70 offen offset:0 sc1
    buffer_load_dwordx4 v[28:31], v8, s[8:11], s70 offen offset:1024 sc1
L_gat_81:
    s_waitcnt vmcnt(2)
    v_max3_u32 v60, v24, v25, v26
    v_max_u32 v60, v60, v27
    v_max3_u32 v61, v28, v29, v30
    v_max_u32 v61, v61, v31
    v_max_u32 v63, v60, v61
    v_cmp_eq_u32 vcc, -1, v63
    s_cbranch_vccnz L_gatx_82
L_gat_81_ok:
    s_waitcnt lgkmcnt(0)
    ds_write_b128 v15, v[24:27] offset:6144
    ds_write_b128 v15, v[28:31] offset:7168
    v_smfmac_f32_16x16x64_bf16 v[32:35], v[24:27], a[48:55], v5
    v_smfmac_f32_16x16x64_bf16 v[48:51], v[24:27], v[64:71], v5
    ds_read_b128 v[64:67], v1 offset:49152
    ds_read_b128 v[68:71], v1 offset:50176
    v_smfmac_f32_16x16x64_bf16 v[36:39], v[24:27], a[120:127], v5
    v_smfmac_f32_16x16x64_bf16 v[40:43], v[24:27], a[192:199], v5
    v_smfmac_f32_16x16x64_bf16 v[52:55], v[24:27], v[72:79], v5
    ds_read_b128 v[72:75], v1 offset:51200
    ds_read_b128 v[76:79], v1 offset:52224
    v_smfmac_f32_16x16x64_bf16 v[44:47], v[24:27], v[88:95], v5
    v_smfmac_f32_16x16x64_bf16 v[32:35], v[28:31], a[56:63], v5
    s_waitcnt lgkmcnt(2)
    v_smfmac_f32_16x16x64_bf16 v[48:51], v[28:31], v[64:71], v5
    v_subrev_u32 v1, 0x10000, v1
    ds_read_b128 v[64:67], v1 offset:0
    ds_read_b128 v[68:71], v1 offset:1024
    v_smfmac_f32_16x16x64_bf16 v[36:39], v[28:31], a[128:135], v5
    v_smfmac_f32_16x16x64_bf16 v[40:43], v[28:31], a[200:207], v5
    s_waitcnt lgkmcnt(2)
    v_smfmac_f32_16x16x64_bf16 v[52:55], v[28:31], v[72:79], v5
    ds_read_b128 v[72:75], v1 offset:2048
    ds_read_b128 v[76:79], v1 offset:3072
    v_smfmac_f32_16x16x64_bf16 v[44:47], v[28:31], v[96:103], v5
    s_barrier
    ds_read_b128 v[56:59], v15 offset:0
    ds_read_b128 v[60:63], v15 offset:1024
    buffer_load_dwordx4 v[24:27], v4, s[8:11], s68 offen offset:2048 sc1
    buffer_load_dwordx4 v[28:31], v4, s[8:11], s68 offen offset:3072 sc1
    s_waitcnt lgkmcnt(1)
    v_smfmac_f32_16x16x64_bf16 v[32:35], v[56:59], a[0:7], v5
    v_smfmac_f32_16x16x64_bf16 v[48:51], v[56:59], v[64:71], v5
    ds_read_b128 v[64:67], v1 offset:16384
    ds_read_b128 v[68:71], v1 offset:17408
    v_smfmac_f32_16x16x64_bf16 v[36:39], v[56:59], a[72:79], v5
    v_smfmac_f32_16x16x64_bf16 v[40:43], v[56:59], a[144:151], v5
    v_smfmac_f32_16x16x64_bf16 v[52:55], v[56:59], v[72:79], v5
    ds_read_b128 v[72:75], v1 offset:18432
    ds_read_b128 v[76:79], v1 offset:19456
    v_smfmac_f32_16x16x64_bf16 v[44:47], v[56:59], a[216:223], v5
    ds_read_b128 v[56:59], v15 offset:2048
    s_add_u32 s70, s68, 32768
    buffer_load_dword v2, v3, s[8:11], s70 offen
    s_add_u32 s71, s60, 3
    s_min_u32 s71, s71, 63
    s_lshl_b32 s71, s71, 2
    s_add_u32 s71, s71, s82
    buffer_load_dword v2, off, s[8:11], s71 sc1
    s_waitcnt lgkmcnt(5)
    v_smfmac_f32_16x16x64_bf16 v[32:35], v[60:63], a[8:15], v5
    s_waitcnt lgkmcnt(3)
    v_smfmac_f32_16x16x64_bf16 v[48:51], v[60:63], v[64:71], v5
    ds_read_b128 v[64:67], v1 offset:32768
    ds_read_b128 v[68:71], v1 offset:33792
    v_smfmac_f32_16x16x64_bf16 v[36:39], v[60:63], a[80:87], v5
    v_smfmac_f32_16x16x64_bf16 v[40:43], v[60:63], a[152:159], v5
    s_waitcnt lgkmcnt(3)
    v_smfmac_f32_16x16x64_bf16 v[52:55], v[60:63], v[72:79], v5
    ds_read_b128 v[72:75], v1 offset:34816
    ds_read_b128 v[76:79], v1 offset:35840
    v_smfmac_f32_16x16x64_bf16 v[44:47], v[60:63], a[224:231], v5
    ds_read_b128 v[60:63], v15 offset:3072
    s_waitcnt lgkmcnt(5)
    v_smfmac_f32_16x16x64_bf16 v[32:35], v[56:59], a[16:23], v5
    s_waitcnt lgkmcnt(3)
    v_smfmac_f32_16x16x64_bf16 v[48:51], v[56:59], v[64:71], v5
    ds_read_b128 v[64:67], v1 offset:49152
    ds_read_b128 v[68:71], v1 offset:50176
    v_smfmac_f32_16x16x64_bf16 v[36:39], v[56:59], a[88:95], v5
    v_smfmac_f32_16x16x64_bf16 v[40:43], v[56:59], a[160:167], v5
    s_waitcnt lgkmcnt(3)
    v_smfmac_f32_16x16x64_bf16 v[52:55], v[56:59], v[72:79], v5
    ds_read_b128 v[72:75], v1 offset:51200
    ds_read_b128 v[76:79], v1 offset:52224
    v_smfmac_f32_16x16x64_bf16 v[44:47], v[56:59], a[232:239], v5
    ds_read_b128 v[56:59], v15 offset:8192
    s_waitcnt lgkmcnt(5)
    v_smfmac_f32_16x16x64_bf16 v[32:35], v[60:63], a[24:31], v5
    s_waitcnt lgkmcnt(3)
    v_smfmac_f32_16x16x64_bf16 v[48:51], v[60:63], v[64:71], v5
    v_add_u32 v1, 0x20000, v1
    ds_read_b128 v[64:67], v1 offset:0
    ds_read_b128 v[68:71], v1 offset:1024
    v_smfmac_f32_16x16x64_bf16 v[36:39], v[60:63], a[96:103], v5
    v_smfmac_f32_16x16x64_bf16 v[40:43], v[60:63], a[168:175], v5
    s_waitcnt lgkmcnt(3)
    v_smfmac_f32_16x16x64_bf16 v[52:55], v[60:63], v[72:79], v5
    ds_read_b128 v[72:75], v1 offset:2048
    ds_read_b128 v[76:79], v1 offset:3072
    v_smfmac_f32_16x16x64_bf16 v[44:47], v[60:63], a[240:247], v5
    ds_read_b128 v[60:63], v15 offset:4096
    s_waitcnt lgkmcnt(5)
    v_smfmac_f32_16x16x64_bf16 v[32:35], v[56:59], a[64:71], v5
    s_waitcnt lgkmcnt(3)
    v_smfmac_f32_16x16x64_bf16 v[48:51], v[56:59], v[64:71], v5
    v_subrev_u32 v1, 0x10000, v1
    ds_read_b128 v[64:67], v1 offset:0
    ds_read_b128 v[68:71], v1 offset:1024
    v_smfmac_f32_16x16x64_bf16 v[36:39], v[56:59], a[136:143], v5
    v_smfmac_f32_16x16x64_bf16 v[40:43], v[56:59], a[208:215], v5
    s_waitcnt lgkmcnt(3)
    v_smfmac_f32_16x16x64_bf16 v[52:55], v[56:59], v[72:79], v5
    ds_read_b128 v[72:75], v1 offset:2048
    ds_read_b128 v[76:79], v1 offset:3072
    v_smfmac_f32_16x16x64_bf16 v[44:47], v[56:59], v[104:111], v5
    ds_read_b128 v[56:59], v15 offset:5120
    s_waitcnt lgkmcnt(5)
    v_smfmac_f32_16x16x64_bf16 v[32:35], v[60:63], a[32:39], v5
    s_waitcnt lgkmcnt(3)
    v_smfmac_f32_16x16x64_bf16 v[48:51], v[60:63], v[64:71], v5
    ds_read_b128 v[64:67], v1 offset:16384
    ds_read_b128 v[68:71], v1 offset:17408
    v_smfmac_f32_16x16x64_bf16 v[36:39], v[60:63], a[104:111], v5
    v_smfmac_f32_16x16x64_bf16 v[40:43], v[60:63], a[176:183], v5
    s_waitcnt lgkmcnt(3)
    v_smfmac_f32_16x16x64_bf16 v[52:55], v[60:63], v[72:79], v5
    ds_read_b128 v[72:75], v1 offset:18432
    ds_read_b128 v[76:79], v1 offset:19456
    v_smfmac_f32_16x16x64_bf16 v[44:47], v[60:63], a[248:255], v5
    s_waitcnt lgkmcnt(4)
    v_smfmac_f32_16x16x64_bf16 v[32:35], v[56:59], a[40:47], v5
    v_smfmac_f32_16x16x64_bf16 v[36:39], v[56:59], a[112:119], v5
    v_smfmac_f32_16x16x64_bf16 v[40:43], v[56:59], a[184:191], v5
    v_smfmac_f32_16x16x64_bf16 v[44:47], v[56:59], v[80:87], v5
    s_waitcnt lgkmcnt(2)
    v_smfmac_f32_16x16x64_bf16 v[48:51], v[56:59], v[64:71], v5
    s_waitcnt lgkmcnt(0)
    v_smfmac_f32_16x16x64_bf16 v[52:55], v[56:59], v[72:79], v5
    v_subrev_u32 v1, 0x10000, v1
    s_waitcnt vmcnt(2)
    s_branch L_cC_52
L_kvw_80:
    s_mov_b32 s59, 0
L_kv_83:
    buffer_load_dword v2, off, s[8:11], s70 sc1
    s_waitcnt vmcnt(0)
    v_cmp_ne_u32 vcc, 1, v2
    s_cbranch_vccz L_kv_ok_84
    s_add_u32 s59, s59, 1
    s_cmp_lt_u32 s59, s58
    s_cbranch_scc1 L_kv_83
    s_mov_b32 s58, 0
L_kv_ok_84:
    s_branch L_kvok_79
L_gatx_82:
    v_cmp_eq_u32 s[16:17], -1, v60
    v_cmp_eq_u32 s[18:19], -1, v61
    s_mov_b64 exec, s[16:17]
    buffer_load_dwordx4 v[24:27], v8, s[8:11], s70 offen offset:0 sc1
    s_mov_b64 exec, s[18:19]
    buffer_load_dwordx4 v[28:31], v8, s[8:11], s70 offen offset:1024 sc1
    s_mov_b64 exec, -1
    s_add_u32 s59, s59, 1
    s_cmp_lt_u32 s59, s58
    s_cbranch_scc1 L_gat_81
    s_mov_b32 s58, 0
    s_branch L_gat_81_ok
L_clx_51:
    s_waitcnt vmcnt(0)
    s_barrier
    s_cmp_lg_u32 s4, 3
    s_cbranch_scc1 L_fin_85
    s_lshl_b32 s70, s60, 2
    s_add_u32 s70, s70, s82
    s_add_u32 s70, s70, 8188
    v_mov_b32 v56, 1
    s_mov_b64 exec, 1
    buffer_store_dword v56, off, s[8:11], s70 sc1
    buffer_store_dword v56, off, s[8:11], s70 offset:4 sc1
    s_mov_b64 exec, -1
L_fin_85:
    s_waitcnt vmcnt(0)
    s_waitcnt vmcnt(0)
    s_barrier
    s_cmp_lg_u32 s4, 0
    s_cbranch_scc1 L_nowb_86
    s_lshl_b32 s60, s5, 5
    s_add_u32 s60, s60, 16
    v_mov_b32 v4, 1
    s_mov_b64 exec, 1
    buffer_atomic_add v4, off, s[12:15], s60 sc0 sc1
    s_waitcnt vmcnt(0)
    v_readfirstlane_b32 s61, v4
    s_mov_b64 exec, -1
    s_cmp_lg_u32 s61, 31
    s_cbranch_scc1 L_nowb_86
    buffer_wbl2 sc1
L_nowb_86:
L_chain_done:
    s_endpgm
.p2align 8
L_xrole:
    v_and_b32 v1, 63, v0
    v_and_b32 v2, 15, v0
    v_lshrrev_b32 v3, 4, v1
    s_sub_u32 s70, s5, 1
    v_lshlrev_b32 v24, 1, v3
    v_xor_b32 v24, v24, v2
    s_mov_b32 s60, 8192
    v_mul_lo_u32 v25, v3, s60
    v_xor_b32 v16, 0, v24
    v_lshl_add_u32 v16, v16, 4, v25
    v_xor_b32 v17, 0, v24
    v_lshl_add_u32 v17, v17, 4, v25
    v_xor_b32 v18, 8, v24
    v_lshl_add_u32 v18, v18, 4, v25
    v_xor_b32 v19, 8, v24
    v_lshl_add_u32 v19, v19, 4, v25
    v_lshrrev_b32 v24, 2, v2
    v_lshl_add_u32 v25, v3, 3, v24
    v_and_b32 v26, 1, v3
    v_lshlrev_b32 v26, 3, v26
    v_lshl_add_u32 v26, v24, 1, v26
    v_bfe_u32 v27, v2, 1, 1
    s_lshl_b32 s60, s4, 2
    v_add_u32 v27, s60, v27
    v_and_b32 v28, 1, v2
    v_lshlrev_b32 v28, 3, v28
    v_lshl_add_u32 v28, v25, 8, v28
    v_add_u32 v29, 0, v27
    v_xor_b32 v29, v29, v26
    v_lshl_add_u32 v20, v29, 4, v28
    v_add_u32 v29, 2, v27
    v_xor_b32 v29, v29, v26
    v_lshl_add_u32 v21, v29, 4, v28
    s_lshl_b32 s65, s4, 12
    s_lshl_b32 s66, s6, 8
    s_lshl_b32 s67, s4, 17
    s_add_u32 s66, s66, s67
    s_mov_b32 s16, s44
    s_mov_b32 s17, s45
    s_mov_b32 s18, 4718592
    s_mov_b32 s19, 0x00020000
    s_mov_b32 s20, s46
    s_mov_b32 s21, s47
    s_mov_b32 s22, 4718592
    s_mov_b32 s23, 0x00020000
    s_add_u32 m0, s65, 0
    s_add_u32 s64, s66, 0
    buffer_load_dwordx4 v16, s[16:19], s64 offen lds
    s_add_u32 m0, s65, 1024
    s_add_u32 s64, s66, 32768
    buffer_load_dwordx4 v17, s[16:19], s64 offen lds
    s_add_u32 m0, s65, 2048
    s_add_u32 s64, s66, 65536
    buffer_load_dwordx4 v18, s[16:19], s64 offen lds
    s_add_u32 m0, s65, 3072
    s_add_u32 s64, s66, 98304
    buffer_load_dwordx4 v19, s[16:19], s64 offen lds
    s_add_u32 m0, s65, 16384
    s_add_u32 s64, s66, 524288
    buffer_load_dwordx4 v16, s[16:19], s64 offen lds
    s_add_u32 m0, s65, 17408
    s_add_u32 s64, s66, 557056
    buffer_load_dwordx4 v17, s[16:19], s64 offen lds
    s_add_u32 m0, s65, 18432
    s_add_u32 s64, s66, 589824
    buffer_load_dwordx4 v18, s[16:19], s64 offen lds
    s_add_u32 m0, s65, 19456
    s_add_u32 s64, s66, 622592
    buffer_load_dwordx4 v19, s[16:19], s64 offen lds
    s_add_u32 m0, s65, 32768
    s_add_u32 s64, s66, 1048576
    buffer_load_dwordx4 v16, s[16:19], s64 offen lds
    s_add_u32 m0, s65, 33792
    s_add_u32 s64, s66, 1081344
    buffer_load_dwordx4 v17, s[16:19], s64 offen lds
    s_add_u32 m0, s65, 34816
    s_add_u32 s64, s66, 1114112
    buffer_load_dwordx4 v18, s[16:19], s64 offen lds
    s_add_u32 m0, s65, 35840
    s_add_u32 s64, s66, 1146880
    buffer_load_dwordx4 v19, s[16:19], s64 offen lds
    s_add_u32 m0, s65, 49152
    s_add_u32 s64, s66, 1572864
    buffer_load_dwordx4 v16, s[16:19], s64 offen lds
    s_add_u32 m0, s65, 50176
    s_add_u32 s64, s66, 1605632
    buffer_load_dwordx4 v17, s[16:19], s64 offen lds
    s_add_u32 m0, s65, 51200
    s_add_u32 s64, s66, 1638400
    buffer_load_dwordx4 v18, s[16:19], s64 offen lds
    s_add_u32 m0, s65, 52224
    s_add_u32 s64, s66, 1671168
    buffer_load_dwordx4 v19, s[16:19], s64 offen lds
    s_add_u32 m0, s65, 65536
    s_add_u32 s64, s66, 2097152
    buffer_load_dwordx4 v16, s[16:19], s64 offen lds
    s_add_u32 m0, s65, 66560
    s_add_u32 s64, s66, 2129920
    buffer_load_dwordx4 v17, s[16:19], s64 offen lds
    s_add_u32 m0, s65, 67584
    s_add_u32 s64, s66, 2162688
    buffer_load_dwordx4 v18, s[16:19], s64 offen lds
    s_add_u32 m0, s65, 68608
    s_add_u32 s64, s66, 2195456
    buffer_load_dwordx4 v19, s[16:19], s64 offen lds
    s_add_u32 m0, s65, 81920
    s_add_u32 s64, s66, 2621440
    buffer_load_dwordx4 v16, s[16:19], s64 offen lds
    s_add_u32 m0, s65, 82944
    s_add_u32 s64, s66, 2654208
    buffer_load_dwordx4 v17, s[16:19], s64 offen lds
    s_add_u32 m0, s65, 83968
    s_add_u32 s64, s66, 2686976
    buffer_load_dwordx4 v18, s[16:19], s64 offen lds
    s_add_u32 m0, s65, 84992
    s_add_u32 s64, s66, 2719744
    buffer_load_dwordx4 v19, s[16:19], s64 offen lds
    s_add_u32 m0, s65, 98304
    s_add_u32 s64, s66, 3145728
    buffer_load_dwordx4 v16, s[16:19], s64 offen lds
    s_add_u32 m0, s65, 99328
    s_add_u32 s64, s66, 3178496
    buffer_load_dwordx4 v17, s[16:19], s64 offen lds
    s_add_u32 m0, s65, 100352
    s_add_u32 s64, s66, 3211264
    buffer_load_dwordx4 v18, s[16:19], s64 offen lds
    s_add_u32 m0, s65, 101376
    s_add_u32 s64, s66, 3244032
    buffer_load_dwordx4 v19, s[16:19], s64 offen lds
    s_add_u32 m0, s65, 114688
    s_add_u32 s64, s66, 3670016
    buffer_load_dwordx4 v16, s[16:19], s64 offen lds
    s_add_u32 m0, s65, 115712
    s_add_u32 s64, s66, 3702784
    buffer_load_dwordx4 v17, s[16:19], s64 offen lds
    s_add_u32 m0, s65, 116736
    s_add_u32 s64, s66, 3735552
    buffer_load_dwordx4 v18, s[16:19], s64 offen lds
    s_add_u32 m0, s65, 117760
    s_add_u32 s64, s66, 3768320
    buffer_load_dwordx4 v19, s[16:19], s64 offen lds
    s_waitcnt vmcnt(28) lgkmcnt(0)
    s_barrier
    s_add_u32 m0, s65, 131072
    s_add_u32 s64, s66, 4194304
    buffer_load_dwordx4 v16, s[16:19], s64 offen lds
    s_add_u32 m0, s65, 132096
    s_add_u32 s64, s66, 4227072
    buffer_load_dwordx4 v17, s[16:19], s64 offen lds
    s_add_u32 m0, s65, 133120
    s_add_u32 s64, s66, 4259840
    buffer_load_dwordx4 v18, s[16:19], s64 offen lds
    s_add_u32 m0, s65, 134144
    s_add_u32 s64, s66, 4292608
    buffer_load_dwordx4 v19, s[16:19], s64 offen lds
    v_add_u32 v22, 0, v20
    v_add_u32 v23, 0, v21
    ds_read_b64_tr_b16 a[0:1], v22 offset:0
    ds_read_b64_tr_b16 a[2:3], v22 offset:1024
    ds_read_b64_tr_b16 a[72:73], v23 offset:0
    ds_read_b64_tr_b16 a[74:75], v23 offset:1024
    ds_read_b64_tr_b16 a[4:5], v22 offset:8192
    ds_read_b64_tr_b16 a[6:7], v22 offset:9216
    ds_read_b64_tr_b16 a[76:77], v23 offset:8192
    ds_read_b64_tr_b16 a[78:79], v23 offset:9216
    s_cmp_lg_u32 s4, 0
    s_cbranch_scc1 L_noann_87
    s_lshl_b32 s60, s3, 3
    s_lshl_b64 s[62:63], 1, s60
    v_mov_b32 v8, s62
    v_mov_b32 v9, s63
    s_lshl_b32 s60, s5, 5
    s_mov_b64 exec, 1
    buffer_atomic_add_x2 v[8:9], off, s[12:15], s60 sc1
    s_mov_b64 exec, -1
L_noann_87:
    s_waitcnt vmcnt(28) lgkmcnt(0)
    s_barrier
    s_add_u32 m0, s65, 0
    s_add_u32 s64, s66, 0
    buffer_load_dwordx4 v16, s[20:23], s64 offen lds
    s_add_u32 m0, s65, 1024
    s_add_u32 s64, s66, 32768
    buffer_load_dwordx4 v17, s[20:23], s64 offen lds
    s_add_u32 m0, s65, 2048
    s_add_u32 s64, s66, 65536
    buffer_load_dwordx4 v18, s[20:23], s64 offen lds
    s_add_u32 m0, s65, 3072
    s_add_u32 s64, s66, 98304
    buffer_load_dwordx4 v19, s[20:23], s64 offen lds
    v_add_u32 v22, 16384, v20
    v_add_u32 v23, 16384, v21
    ds_read_b64_tr_b16 a[8:9], v22 offset:0
    ds_read_b64_tr_b16 a[10:11], v22 offset:1024
    ds_read_b64_tr_b16 a[80:81], v23 offset:0
    ds_read_b64_tr_b16 a[82:83], v23 offset:1024
    ds_read_b64_tr_b16 a[12:13], v22 offset:8192
    ds_read_b64_tr_b16 a[14:15], v22 offset:9216
    ds_read_b64_tr_b16 a[84:85], v23 offset:8192
    ds_read_b64_tr_b16 a[86:87], v23 offset:9216
    s_waitcnt vmcnt(28) lgkmcnt(0)
    s_barrier
    s_add_u32 m0, s65, 16384
    s_add_u32 s64, s66, 524288
    buffer_load_dwordx4 v16, s[20:23], s64 offen lds
    s_add_u32 m0, s65, 17408
    s_add_u32 s64, s66, 557056
    buffer_load_dwordx4 v17, s[20:23], s64 offen lds
    s_add_u32 m0, s65, 18432
    s_add_u32 s64, s66, 589824
    buffer_load_dwordx4 v18, s[20:23], s64 offen lds
    s_add_u32 m0, s65, 19456
    s_add_u32 s64, s66, 622592
    buffer_load_dwordx4 v19, s[20:23], s64 offen lds
    v_add_u32 v22, 32768, v20
    v_add_u32 v23, 32768, v21
    ds_read_b64_tr_b16 a[16:17], v22 offset:0
    ds_read_b64_tr_b16 a[18:19], v22 offset:1024
    ds_read_b64_tr_b16 a[88:89], v23 offset:0
    ds_read_b64_tr_b16 a[90:91], v23 offset:1024
    ds_read_b64_tr_b16 a[20:21], v22 offset:8192
    ds_read_b64_tr_b16 a[22:23], v22 offset:9216
    ds_read_b64_tr_b16 a[92:93], v23 offset:8192
    ds_read_b64_tr_b16 a[94:95], v23 offset:9216
    s_waitcnt vmcnt(28) lgkmcnt(0)
    s_barrier
    s_add_u32 m0, s65, 32768
    s_add_u32 s64, s66, 1048576
    buffer_load_dwordx4 v16, s[20:23], s64 offen lds
    s_add_u32 m0, s65, 33792
    s_add_u32 s64, s66, 1081344
    buffer_load_dwordx4 v17, s[20:23], s64 offen lds
    s_add_u32 m0, s65, 34816
    s_add_u32 s64, s66, 1114112
    buffer_load_dwordx4 v18, s[20:23], s64 offen lds
    s_add_u32 m0, s65, 35840
    s_add_u32 s64, s66, 1146880
    buffer_load_dwordx4 v19, s[20:23], s64 offen lds
    v_add_u32 v22, 49152, v20
    v_add_u32 v23, 49152, v21
    ds_read_b64_tr_b16 a[24:25], v22 offset:0
    ds_read_b64_tr_b16 a[26:27], v22 offset:1024
    ds_read_b64_tr_b16 a[96:97], v23 offset:0
    ds_read_b64_tr_b16 a[98:99], v23 offset:1024
    ds_read_b64_tr_b16 a[28:29], v22 offset:8192
    ds_read_b64_tr_b16 a[30:31], v22 offset:9216
    ds_read_b64_tr_b16 a[100:101], v23 offset:8192
    ds_read_b64_tr_b16 a[102:103], v23 offset:9216
    s_waitcnt vmcnt(28) lgkmcnt(0)
    s_barrier
    s_add_u32 m0, s65, 49152
    s_add_u32 s64, s66, 1572864
    buffer_load_dwordx4 v16, s[20:23], s64 offen lds
    s_add_u32 m0, s65, 50176
    s_add_u32 s64, s66, 1605632
    buffer_load_dwordx4 v17, s[20:23], s64 offen lds
    s_add_u32 m0, s65, 51200
    s_add_u32 s64, s66, 1638400
    buffer_load_dwordx4 v18, s[20:23], s64 offen lds
    s_add_u32 m0, s65, 52224
    s_add_u32 s64, s66, 1671168
    buffer_load_dwordx4 v19, s[20:23], s64 offen lds
    v_add_u32 v22, 65536, v20
    v_add_u32 v23, 65536, v21
    ds_read_b64_tr_b16 a[32:33], v22 offset:0
    ds_read_b64_tr_b16 a[34:35], v22 offset:1024
    ds_read_b64_tr_b16 a[104:105], v23 offset:0
    ds_read_b64_tr_b16 a[106:107], v23 offset:1024
    ds_read_b64_tr_b16 a[36:37], v22 offset:8192
    ds_read_b64_tr_b16 a[38:39], v22 offset:9216
    ds_read_b64_tr_b16 a[108:109], v23 offset:8192
    ds_read_b64_tr_b16 a[110:111], v23 offset:9216
    s_waitcnt vmcnt(28) lgkmcnt(0)
    s_barrier
    s_add_u32 m0, s65, 65536
    s_add_u32 s64, s66, 2097152
    buffer_load_dwordx4 v16, s[20:23], s64 offen lds
    s_add_u32 m0, s65, 66560
    s_add_u32 s64, s66, 2129920
    buffer_load_dwordx4 v17, s[20:23], s64 offen lds
    s_add_u32 m0, s65, 67584
    s_add_u32 s64, s66, 2162688
    buffer_load_dwordx4 v18, s[20:23], s64 offen lds
    s_add_u32 m0, s65, 68608
    s_add_u32 s64, s66, 2195456
    buffer_load_dwordx4 v19, s[20:23], s64 offen lds
    v_add_u32 v22, 81920, v20
    v_add_u32 v23, 81920, v21
    ds_read_b64_tr_b16 a[40:41], v22 offset:0
    ds_read_b64_tr_b16 a[42:43], v22 offset:1024
    ds_read_b64_tr_b16 a[112:113], v23 offset:0
    ds_read_b64_tr_b16 a[114:115], v23 offset:1024
    ds_read_b64_tr_b16 a[44:45], v22 offset:8192
    ds_read_b64_tr_b16 a[46:47], v22 offset:9216
    ds_read_b64_tr_b16 a[116:117], v23 offset:8192
    ds_read_b64_tr_b16 a[118:119], v23 offset:9216
    s_waitcnt vmcnt(28) lgkmcnt(0)
    s_barrier
    s_add_u32 m0, s65, 81920
    s_add_u32 s64, s66, 2621440
    buffer_load_dwordx4 v16, s[20:23], s64 offen lds
    s_add_u32 m0, s65, 82944
    s_add_u32 s64, s66, 2654208
    buffer_load_dwordx4 v17, s[20:23], s64 offen lds
    s_add_u32 m0, s65, 83968
    s_add_u32 s64, s66, 2686976
    buffer_load_dwordx4 v18, s[20:23], s64 offen lds
    s_add_u32 m0, s65, 84992
    s_add_u32 s64, s66, 2719744
    buffer_load_dwordx4 v19, s[20:23], s64 offen lds
    v_add_u32 v22, 98304, v20
    v_add_u32 v23, 98304, v21
    ds_read_b64_tr_b16 a[48:49], v22 offset:0
    ds_read_b64_tr_b16 a[50:51], v22 offset:1024
    ds_read_b64_tr_b16 a[120:121], v23 offset:0
    ds_read_b64_tr_b16 a[122:123], v23 offset:1024
    ds_read_b64_tr_b16 a[52:53], v22 offset:8192
    ds_read_b64_tr_b16 a[54:55], v22 offset:9216
    ds_read_b64_tr_b16 a[124:125], v23 offset:8192
    ds_read_b64_tr_b16 a[126:127], v23 offset:9216
    s_waitcnt vmcnt(28) lgkmcnt(0)
    s_barrier
    s_add_u32 m0, s65, 98304
    s_add_u32 s64, s66, 3145728
    buffer_load_dwordx4 v16, s[20:23], s64 offen lds
    s_add_u32 m0, s65, 99328
    s_add_u32 s64, s66, 3178496
    buffer_load_dwordx4 v17, s[20:23], s64 offen lds
    s_add_u32 m0, s65, 100352
    s_add_u32 s64, s66, 3211264
    buffer_load_dwordx4 v18, s[20:23], s64 offen lds
    s_add_u32 m0, s65, 101376
    s_add_u32 s64, s66, 3244032
    buffer_load_dwordx4 v19, s[20:23], s64 offen lds
    v_add_u32 v22, 114688, v20
    v_add_u32 v23, 114688, v21
    ds_read_b64_tr_b16 a[56:57], v22 offset:0
    ds_read_b64_tr_b16 a[58:59], v22 offset:1024
    ds_read_b64_tr_b16 a[128:129], v23 offset:0
    ds_read_b64_tr_b16 a[130:131], v23 offset:1024
    ds_read_b64_tr_b16 a[60:61], v22 offset:8192
    ds_read_b64_tr_b16 a[62:63], v22 offset:9216
    ds_read_b64_tr_b16 a[132:133], v23 offset:8192
    ds_read_b64_tr_b16 a[134:135], v23 offset:9216
    s_waitcnt vmcnt(28) lgkmcnt(0)
    s_barrier
    s_add_u32 m0, s65, 114688
    s_add_u32 s64, s66, 3670016
    buffer_load_dwordx4 v16, s[20:23], s64 offen lds
    s_add_u32 m0, s65, 115712
    s_add_u32 s64, s66, 3702784
    buffer_load_dwordx4 v17, s[20:23], s64 offen lds
    s_add_u32 m0, s65, 116736
    s_add_u32 s64, s66, 3735552
    buffer_load_dwordx4 v18, s[20:23], s64 offen lds
    s_add_u32 m0, s65, 117760
    s_add_u32 s64, s66, 3768320
    buffer_load_dwordx4 v19, s[20:23], s64 offen lds
    v_add_u32 v22, 131072, v20
    v_add_u32 v23, 131072, v21
    ds_read_b64_tr_b16 a[64:65], v22 offset:0
    ds_read_b64_tr_b16 a[66:67], v22 offset:1024
    ds_read_b64_tr_b16 a[136:137], v23 offset:0
    ds_read_b64_tr_b16 a[138:139], v23 offset:1024
    ds_read_b64_tr_b16 a[68:69], v22 offset:8192
    ds_read_b64_tr_b16 a[70:71], v22 offset:9216
    ds_read_b64_tr_b16 a[140:141], v23 offset:8192
    ds_read_b64_tr_b16 a[142:143], v23 offset:9216
    s_waitcnt vmcnt(28) lgkmcnt(0)
    s_barrier
    s_add_u32 m0, s65, 131072
    s_add_u32 s64, s66, 4194304
    buffer_load_dwordx4 v16, s[20:23], s64 offen lds
    s_add_u32 m0, s65, 132096
    s_add_u32 s64, s66, 4227072
    buffer_load_dwordx4 v17, s[20:23], s64 offen lds
    s_add_u32 m0, s65, 133120
    s_add_u32 s64, s66, 4259840
    buffer_load_dwordx4 v18, s[20:23], s64 offen lds
    s_add_u32 m0, s65, 134144
    s_add_u32 s64, s66, 4292608
    buffer_load_dwordx4 v19, s[20:23], s64 offen lds
    v_add_u32 v22, 0, v20
    v_add_u32 v23, 0, v21
    ds_read_b64_tr_b16 a[144:145], v22 offset:0
    ds_read_b64_tr_b16 a[146:147], v22 offset:1024
    ds_read_b64_tr_b16 v[184:185], v23 offset:0
    ds_read_b64_tr_b16 v[186:187], v23 offset:1024
    ds_read_b64_tr_b16 a[148:149], v22 offset:8192
    ds_read_b64_tr_b16 a[150:151], v22 offset:9216
    ds_read_b64_tr_b16 v[188:189], v23 offset:8192
    ds_read_b64_tr_b16 v[190:191], v23 offset:9216
    s_waitcnt vmcnt(28) lgkmcnt(0)
    s_barrier
    v_add_u32 v22, 16384, v20
    v_add_u32 v23, 16384, v21
    ds_read_b64_tr_b16 a[152:153], v22 offset:0
    ds_read_b64_tr_b16 a[154:155], v22 offset:1024
    ds_read_b64_tr_b16 v[192:193], v23 offset:0
    ds_read_b64_tr_b16 v[194:195], v23 offset:1024
    ds_read_b64_tr_b16 a[156:157], v22 offset:8192
    ds_read_b64_tr_b16 a[158:159], v22 offset:9216
    ds_read_b64_tr_b16 v[196:197], v23 offset:8192
    ds_read_b64_tr_b16 v[198:199], v23 offset:9216
    s_waitcnt vmcnt(24) lgkmcnt(0)
    s_barrier
    v_add_u32 v22, 32768, v20
    v_add_u32 v23, 32768, v21
    ds_read_b64_tr_b16 a[160:161], v22 offset:0
    ds_read_b64_tr_b16 a[162:163], v22 offset:1024
    ds_read_b64_tr_b16 v[200:201], v23 offset:0
    ds_read_b64_tr_b16 v[202:203], v23 offset:1024
    ds_read_b64_tr_b16 a[164:165], v22 offset:8192
    ds_read_b64_tr_b16 a[166:167], v22 offset:9216
    ds_read_b64_tr_b16 v[204:205], v23 offset:8192
    ds_read_b64_tr_b16 v[206:207], v23 offset:9216
    s_waitcnt vmcnt(20) lgkmcnt(0)
    s_barrier
    v_add_u32 v22, 49152, v20
    v_add_u32 v23, 49152, v21
    ds_read_b64_tr_b16 a[168:169], v22 offset:0
    ds_read_b64_tr_b16 a[170:171], v22 offset:1024
    ds_read_b64_tr_b16 v[208:209], v23 offset:0
    ds_read_b64_tr_b16 v[210:211], v23 offset:1024
    ds_read_b64_tr_b16 a[172:173], v22 offset:8192
    ds_read_b64_tr_b16 a[174:175], v22 offset:9216
    ds_read_b64_tr_b16 v[212:213], v23 offset:8192
    ds_read_b64_tr_b16 v[214:215], v23 offset:9216
    s_waitcnt vmcnt(16) lgkmcnt(0)
    s_barrier
    v_add_u32 v22, 65536, v20
    v_add_u32 v23, 65536, v21
    ds_read_b64_tr_b16 a[176:177], v22 offset:0
    ds_read_b64_tr_b16 a[178:179], v22 offset:1024
    ds_read_b64_tr_b16 v[216:217], v23 offset:0
    ds_read_b64_tr_b16 v[218:219], v23 offset:1024
    ds_read_b64_tr_b16 a[180:181], v22 offset:8192
    ds_read_b64_tr_b16 a[182:183], v22 offset:9216
    ds_read_b64_tr_b16 v[220:221], v23 offset:8192
    ds_read_b64_tr_b16 v[222:223], v23 offset:9216
    s_waitcnt vmcnt(12) lgkmcnt(0)
    s_barrier
    v_add_u32 v22, 81920, v20
    v_add_u32 v23, 81920, v21
    ds_read_b64_tr_b16 a[184:185], v22 offset:0
    ds_read_b64_tr_b16 a[186:187], v22 offset:1024
    ds_read_b64_tr_b16 v[224:225], v23 offset:0
    ds_read_b64_tr_b16 v[226:227], v23 offset:1024
    ds_read_b64_tr_b16 a[188:189], v22 offset:8192
    ds_read_b64_tr_b16 a[190:191], v22 offset:9216
    ds_read_b64_tr_b16 v[228:229], v23 offset:8192
    ds_read_b64_tr_b16 v[230:231], v23 offset:9216
    s_waitcnt vmcnt(8) lgkmcnt(0)
    s_barrier
    v_add_u32 v22, 98304, v20
    v_add_u32 v23, 98304, v21
    ds_read_b64_tr_b16 a[192:193], v22 offset:0
    ds_read_b64_tr_b16 a[194:195], v22 offset:1024
    ds_read_b64_tr_b16 v[232:233], v23 offset:0
    ds_read_b64_tr_b16 v[234:235], v23 offset:1024
    ds_read_b64_tr_b16 a[196:197], v22 offset:8192
    ds_read_b64_tr_b16 a[198:199], v22 offset:9216
    ds_read_b64_tr_b16 v[236:237], v23 offset:8192
    ds_read_b64_tr_b16 v[238:239], v23 offset:9216
    s_waitcnt vmcnt(4) lgkmcnt(0)
    s_barrier
    v_add_u32 v22, 114688, v20
    v_add_u32 v23, 114688, v21
    ds_read_b64_tr_b16 a[200:201], v22 offset:0
    ds_read_b64_tr_b16 a[202:203], v22 offset:1024
    ds_read_b64_tr_b16 v[240:241], v23 offset:0
    ds_read_b64_tr_b16 v[242:243], v23 offset:1024
    ds_read_b64_tr_b16 a[204:205], v22 offset:8192
    ds_read_b64_tr_b16 a[206:207], v22 offset:9216
    ds_read_b64_tr_b16 v[244:245], v23 offset:8192
    ds_read_b64_tr_b16 v[246:247], v23 offset:9216
    s_waitcnt vmcnt(0) lgkmcnt(0)
    s_barrier
    v_add_u32 v22, 131072, v20
    v_add_u32 v23, 131072, v21
    ds_read_b64_tr_b16 a[208:209], v22 offset:0
    ds_read_b64_tr_b16 a[210:211], v22 offset:1024
    ds_read_b64_tr_b16 v[248:249], v23 offset:0
    ds_read_b64_tr_b16 v[250:251], v23 offset:1024
    ds_read_b64_tr_b16 a[212:213], v22 offset:8192
    ds_read_b64_tr_b16 a[214:215], v22 offset:9216
    ds_read_b64_tr_b16 v[252:253], v23 offset:8192
    ds_read_b64_tr_b16 v[254:255], v23 offset:9216
    s_waitcnt lgkmcnt(0)
    s_barrier
    s_mov_b32 s24, s38
    s_mov_b32 s25, s39
    s_mov_b32 s26, 2359296
    s_mov_b32 s27, 0x00020000
    s_movk_i32 s60, 1152
    v_mul_lo_u32 v4, v2, s60
    v_lshl_add_u32 v4, v3, 4, v4
    v_lshlrev_b32 v5, 4, v1
    s_lshr_b32 s60, s4, 1
    s_mul_i32 s77, s60, 18432
    s_and_b32 s60, s4, 1
    s_mul_i32 s60, s60, 576
    s_add_u32 s77, s77, s60
    s_mul_i32 s79, s4, 9216
    s_mov_b32 s71, s70
    s_mov_b32 s74, 0
    s_mov_b32 s75, 0
    s_mul_i32 s76, s71, 36864
    s_add_u32 s76, s76, s77
    s_add_u32 s78, s74, s79
    s_add_u32 m0, s78, 0
    s_add_u32 s64, s76, 0
    buffer_load_dwordx4 v4, s[24:27], s64 offen lds
    s_add_u32 m0, s78, 1024
    s_add_u32 s64, s76, 64
    buffer_load_dwordx4 v4, s[24:27], s64 offen lds
    s_add_u32 m0, s78, 2048
    s_add_u32 s64, s76, 128
    buffer_load_dwordx4 v4, s[24:27], s64 offen lds
    s_add_u32 m0, s78, 3072
    s_add_u32 s64, s76, 192
    buffer_load_dwordx4 v4, s[24:27], s64 offen lds
    s_add_u32 m0, s78, 4096
    s_add_u32 s64, s76, 256
    buffer_load_dwordx4 v4, s[24:27], s64 offen lds
    s_add_u32 m0, s78, 5120
    s_add_u32 s64, s76, 320
    buffer_load_dwordx4 v4, s[24:27], s64 offen lds
    s_add_u32 m0, s78, 6144
    s_add_u32 s64, s76, 384
    buffer_load_dwordx4 v4, s[24:27], s64 offen lds
    s_add_u32 m0, s78, 7168
    s_add_u32 s64, s76, 448
    buffer_load_dwordx4 v4, s[24:27], s64 offen lds
    s_add_u32 m0, s78, 8192
    s_add_u32 s64, s76, 512
    buffer_load_dwordx4 v4, s[24:27], s64 offen lds
    s_add_u32 s81, s71, 3
    s_min_u32 s81, s81, 63
    s_mov_b32 s82, 36864
    s_mul_i32 s76, s81, 36864
    s_add_u32 s76, s76, s77
    s_add_u32 s78, s82, s79
    s_add_u32 m0, s78, 0
    s_add_u32 s64, s76, 0
    buffer_load_dwordx4 v4, s[24:27], s64 offen lds
    s_add_u32 m0, s78, 1024
    s_add_u32 s64, s76, 64
    buffer_load_dwordx4 v4, s[24:27], s64 offen lds
    s_add_u32 m0, s78, 2048
    s_add_u32 s64, s76, 128
    buffer_load_dwordx4 v4, s[24:27], s64 offen lds
    s_add_u32 m0, s78, 3072
    s_add_u32 s64, s76, 192
    buffer_load_dwordx4 v4, s[24:27], s64 offen lds
    s_add_u32 m0, s78, 4096
    s_add_u32 s64, s76, 256
    buffer_load_dwordx4 v4, s[24:27], s64 offen lds
    s_add_u32 m0, s78, 5120
    s_add_u32 s64, s76, 320
    buffer_load_dwordx4 v4, s[24:27], s64 offen lds
    s_add_u32 m0, s78, 6144
    s_add_u32 s64, s76, 384
    buffer_load_dwordx4 v4, s[24:27], s64 offen lds
    s_add_u32 m0, s78, 7168
    s_add_u32 s64, s76, 448
    buffer_load_dwordx4 v4, s[24:27], s64 offen lds
    s_add_u32 m0, s78, 8192
    s_add_u32 s64, s76, 512
    buffer_load_dwordx4 v4, s[24:27], s64 offen lds
    v_and_b32 v8, 7, v0
    v_lshlrev_b32 v8, 5, v8
    s_mov_b32 s59, 0
L_init_88:
    buffer_load_dwordx2 v[10:11], v8, s[12:15], 0 offen sc1
    s_waitcnt vmcnt(0)
    v_sad_u8 v9, v10, 0, 0
    v_sad_u8 v9, v11, 0, v9
    v_cmp_ne_u32 vcc, 32, v9
    s_cbranch_vccz L_init_ok_89
    s_add_u32 s59, s59, 1
    s_cmp_lt_u32 s59, s58
    s_cbranch_scc1 L_init_88
    s_mov_b32 s58, 0
L_init_ok_89:
    v_or_b32 v9, v10, v11
    v_and_b32 v9, 0x20202020, v9
    s_nop 0
    v_readlane_b32 s7, v9, s5
    s_lshl_b32 s80, s6, 8
    s_add_u32 s80, s80, 0
    v_mov_b32 v6, 1
    v_mov_b32 v7, 0
    v_mov_b32 v12, -1
    v_mov_b32 v13, -1
    v_mov_b32 v14, -1
    v_mov_b32 v15, -1
L_x1_90:
    s_waitcnt vmcnt(13)
    s_barrier
    s_cmp_lt_u32 s75, 2
    s_cbranch_scc1 L_nf_92
    s_cmp_lg_u32 s4, 0
    s_cbranch_scc1 L_nf_92
    s_sub_u32 s60, s71, 6
    s_lshl_b32 s60, s60, 2
    s_add_u32 s60, s60, s80
    s_mov_b64 exec, 1
    buffer_store_dword v6, v7, s[8:11], s60 offen sc1
    s_mov_b64 exec, -1
L_nf_92:
    s_add_u32 s81, s71, 6
    s_min_u32 s81, s81, 63
    s_add_u32 s82, s74, 73728
    s_cmp_ge_u32 s82, 110592
    s_cselect_b32 s83, 110592, 0
    s_sub_u32 s82, s82, s83
    s_mul_i32 s76, s81, 36864
    s_add_u32 s76, s76, s77
    s_add_u32 s78, s82, s79
    v_add_u32 v8, s74, v5
    ds_read_b128 v[64:67], v8 offset:0
    ds_read_b128 v[68:71], v8 offset:18432
    ds_read_b128 v[72:75], v8 offset:1024
    ds_read_b128 v[76:79], v8 offset:19456
    s_waitcnt lgkmcnt(2)
    s_add_u32 m0, s78, 0
    s_add_u32 s64, s76, 0
    buffer_load_dwordx4 v4, s[24:27], s64 offen lds
    v_mfma_f32_16x16x32_bf16 v[32:35], a[0:3], v[64:67], 0
    v_mfma_f32_16x16x32_bf16 v[36:39], a[0:3], v[68:71], 0
    v_mfma_f32_16x16x32_bf16 v[40:43], a[72:75], v[64:67], 0
    v_mfma_f32_16x16x32_bf16 v[44:47], a[72:75], v[68:71], 0
    v_mfma_f32_16x16x32_bf16 v[48:51], v[64:67], a[144:147], 0
    v_mfma_f32_16x16x32_bf16 v[56:59], v[68:71], a[144:147], 0
    v_mfma_f32_16x16x32_bf16 v[52:55], v[64:67], v[184:187], 0
    v_mfma_f32_16x16x32_bf16 v[60:63], v[68:71], v[184:187], 0
    ds_read_b128 v[64:67], v8 offset:2048
    ds_read_b128 v[68:71], v8 offset:20480
    s_waitcnt lgkmcnt(2)
    s_add_u32 m0, s78, 1024
    s_add_u32 s64, s76, 64
    buffer_load_dwordx4 v4, s[24:27], s64 offen lds
    v_mfma_f32_16x16x32_bf16 v[32:35], a[4:7], v[72:75], v[32:35]
    v_mfma_f32_16x16x32_bf16 v[36:39], a[4:7], v[76:79], v[36:39]
    v_mfma_f32_16x16x32_bf16 v[40:43], a[76:79], v[72:75], v[40:43]
    v_mfma_f32_16x16x32_bf16 v[44:47], a[76:79], v[76:79], v[44:47]
    v_mfma_f32_16x16x32_bf16 v[48:51], v[72:75], a[148:151], v[48:51]
    v_mfma_f32_16x16x32_bf16 v[56:59], v[76:79], a[148:151], v[56:59]
    v_mfma_f32_16x16x32_bf16 v[52:55], v[72:75], v[188:191], v[52:55]
    v_mfma_f32_16x16x32_bf16 v[60:63], v[76:79], v[188:191], v[60:63]
    ds_read_b128 v[72:75], v8 offset:3072
    ds_read_b128 v[76:79], v8 offset:21504
    s_waitcnt lgkmcnt(2)
    s_add_u32 m0, s78, 2048
    s_add_u32 s64, s76, 128
    buffer_load_dwordx4 v4, s[24:27], s64 offen lds
    v_mfma_f32_16x16x32_bf16 v[32:35], a[8:11], v[64:67], v[32:35]
    v_mfma_f32_16x16x32_bf16 v[36:39], a[8:11], v[68:71], v[36:39]
    v_mfma_f32_16x16x32_bf16 v[40:43], a[80:83], v[64:67], v[40:43]
    v_mfma_f32_16x16x32_bf16 v[44:47], a[80:83], v[68:71], v[44:47]
    v_mfma_f32_16x16x32_bf16 v[48:51], v[64:67], a[152:155], v[48:51]
    v_mfma_f32_16x16x32_bf16 v[56:59], v[68:71], a[152:155], v[56:59]
    v_mfma_f32_16x16x32_bf16 v[52:55], v[64:67], v[192:195], v[52:55]
    v_mfma_f32_16x16x32_bf16 v[60:63], v[68:71], v[192:195], v[60:63]
    ds_read_b128 v[64:67], v8 offset:4096
    ds_read_b128 v[68:71], v8 offset:22528
    s_waitcnt lgkmcnt(2)
    s_add_u32 m0, s78, 3072
    s_add_u32 s64, s76, 192
    buffer_load_dwordx4 v4, s[24:27], s64 offen lds
    v_mfma_f32_16x16x32_bf16 v[32:35], a[12:15], v[72:75], v[32:35]
    v_mfma_f32_16x16x32_bf16 v[36:39], a[12:15], v[76:79], v[36:39]
    v_mfma_f32_16x16x32_bf16 v[40:43], a[84:87], v[72:75], v[40:43]
    v_mfma_f32_16x16x32_bf16 v[44:47], a[84:87], v[76:79], v[44:47]
    v_mfma_f32_16x16x32_bf16 v[48:51], v[72:75], a[156:159], v[48:51]
    v_mfma_f32_16x16x32_bf16 v[56:59], v[76:79], a[156:159], v[56:59]
    v_mfma_f32_16x16x32_bf16 v[52:55], v[72:75], v[196:199], v[52:55]
    v_mfma_f32_16x16x32_bf16 v[60:63], v[76:79], v[196:199], v[60:63]
    ds_read_b128 v[72:75], v8 offset:5120
    ds_read_b128 v[76:79], v8 offset:23552
    s_waitcnt lgkmcnt(2)
    s_add_u32 m0, s78, 4096
    s_add_u32 s64, s76, 256
    buffer_load_dwordx4 v4, s[24:27], s64 offen lds
    v_mfma_f32_16x16x32_bf16 v[32:35], a[16:19], v[64:67], v[32:35]
    v_mfma_f32_16x16x32_bf16 v[36:39], a[16:19], v[68:71], v[36:39]
    v_mfma_f32_16x16x32_bf16 v[40:43], a[88:91], v[64:67], v[40:43]
    v_mfma_f32_16x16x32_bf16 v[44:47], a[88:91], v[68:71], v[44:47]
    v_mfma_f32_16x16x32_bf16 v[48:51], v[64:67], a[160:163], v[48:51]
    v_mfma_f32_16x16x32_bf16 v[56:59], v[68:71], a[160:163], v[56:59]
    v_mfma_f32_16x16x32_bf16 v[52:55], v[64:67], v[200:203], v[52:55]
    v_mfma_f32_16x16x32_bf16 v[60:63], v[68:71], v[200:203], v[60:63]
    ds_read_b128 v[64:67], v8 offset:6144
    ds_read_b128 v[68:71], v8 offset:24576
    s_waitcnt lgkmcnt(2)
    s_add_u32 m0, s78, 5120
    s_add_u32 s64, s76, 320
    buffer_load_dwordx4 v4, s[24:27], s64 offen lds
    v_mfma_f32_16x16x32_bf16 v[32:35], a[20:23], v[72:75], v[32:35]
    v_mfma_f32_16x16x32_bf16 v[36:39], a[20:23], v[76:79], v[36:39]
    v_mfma_f32_16x16x32_bf16 v[40:43], a[92:95], v[72:75], v[40:43]
    v_mfma_f32_16x16x32_bf16 v[44:47], a[92:95], v[76:79], v[44:47]
    v_mfma_f32_16x16x32_bf16 v[48:51], v[72:75], a[164:167], v[48:51]
    v_mfma_f32_16x16x32_bf16 v[56:59], v[76:79], a[164:167], v[56:59]
    v_mfma_f32_16x16x32_bf16 v[52:55], v[72:75], v[204:207], v[52:55]
    v_mfma_f32_16x16x32_bf16 v[60:63], v[76:79], v[204:207], v[60:63]
    ds_read_b128 v[72:75], v8 offset:7168
    ds_read_b128 v[76:79], v8 offset:25600
    s_waitcnt lgkmcnt(2)
    s_add_u32 m0, s78, 6144
    s_add_u32 s64, s76, 384
    buffer_load_dwordx4 v4, s[24:27], s64 offen lds
    v_mfma_f32_16x16x32_bf16 v[32:35], a[24:27], v[64:67], v[32:35]
    v_mfma_f32_16x16x32_bf16 v[36:39], a[24:27], v[68:71], v[36:39]
    v_mfma_f32_16x16x32_bf16 v[40:43], a[96:99], v[64:67], v[40:43]
    v_mfma_f32_16x16x32_bf16 v[44:47], a[96:99], v[68:71], v[44:47]
    v_mfma_f32_16x16x32_bf16 v[48:51], v[64:67], a[168:171], v[48:51]
    v_mfma_f32_16x16x32_bf16 v[56:59], v[68:71], a[168:171], v[56:59]
    v_mfma_f32_16x16x32_bf16 v[52:55], v[64:67], v[208:211], v[52:55]
    v_mfma_f32_16x16x32_bf16 v[60:63], v[68:71], v[208:211], v[60:63]
    ds_read_b128 v[64:67], v8 offset:8192
    ds_read_b128 v[68:71], v8 offset:26624
    s_waitcnt lgkmcnt(2)
    s_add_u32 m0, s78, 7168
    s_add_u32 s64, s76, 448
    buffer_load_dwordx4 v4, s[24:27], s64 offen lds
    v_mfma_f32_16x16x32_bf16 v[32:35], a[28:31], v[72:75], v[32:35]
    v_mfma_f32_16x16x32_bf16 v[36:39], a[28:31], v[76:79], v[36:39]
    v_mfma_f32_16x16x32_bf16 v[40:43], a[100:103], v[72:75], v[40:43]
    v_mfma_f32_16x16x32_bf16 v[44:47], a[100:103], v[76:79], v[44:47]
    v_mfma_f32_16x16x32_bf16 v[48:51], v[72:75], a[172:175], v[48:51]
    v_mfma_f32_16x16x32_bf16 v[56:59], v[76:79], a[172:175], v[56:59]
    v_mfma_f32_16x16x32_bf16 v[52:55], v[72:75], v[212:215], v[52:55]
    v_mfma_f32_16x16x32_bf16 v[60:63], v[76:79], v[212:215], v[60:63]
    ds_read_b128 v[72:75], v8 offset:9216
    ds_read_b128 v[76:79], v8 offset:27648
    s_waitcnt lgkmcnt(2)
    s_add_u32 m0, s78, 8192
    s_add_u32 s64, s76, 512
    buffer_load_dwordx4 v4, s[24:27], s64 offen lds
    v_mfma_f32_16x16x32_bf16 v[32:35], a[32:35], v[64:67], v[32:35]
    v_mfma_f32_16x16x32_bf16 v[36:39], a[32:35], v[68:71], v[36:39]
    v_mfma_f32_16x16x32_bf16 v[40:43], a[104:107], v[64:67], v[40:43]
    v_mfma_f32_16x16x32_bf16 v[44:47], a[104:107], v[68:71], v[44:47]
    v_mfma_f32_16x16x32_bf16 v[48:51], v[64:67], a[176:179], v[48:51]
    v_mfma_f32_16x16x32_bf16 v[56:59], v[68:71], a[176:179], v[56:59]
    v_mfma_f32_16x16x32_bf16 v[52:55], v[64:67], v[216:219], v[52:55]
    v_mfma_f32_16x16x32_bf16 v[60:63], v[68:71], v[216:219], v[60:63]
    ds_read_b128 v[64:67], v8 offset:10240
    ds_read_b128 v[68:71], v8 offset:28672
    s_waitcnt lgkmcnt(2)
    v_mfma_f32_16x16x32_bf16 v[32:35], a[36:39], v[72:75], v[32:35]
    v_mfma_f32_16x16x32_bf16 v[36:39], a[36:39], v[76:79], v[36:39]
    v_mfma_f32_16x16x32_bf16 v[40:43], a[108:111], v[72:75], v[40:43]
    v_mfma_f32_16x16x32_bf16 v[44:47], a[108:111], v[76:79], v[44:47]
    v_mfma_f32_16x16x32_bf16 v[48:51], v[72:75], a[180:183], v[48:51]
    v_mfma_f32_16x16x32_bf16 v[56:59], v[76:79], a[180:183], v[56:59]
    v_mfma_f32_16x16x32_bf16 v[52:55], v[72:75], v[220:223], v[52:55]
    v_mfma_f32_16x16x32_bf16 v[60:63], v[76:79], v[220:223], v[60:63]
    ds_read_b128 v[72:75], v8 offset:11264
    ds_read_b128 v[76:79], v8 offset:29696
    s_waitcnt lgkmcnt(2)
    v_mfma_f32_16x16x32_bf16 v[32:35], a[40:43], v[64:67], v[32:35]
    v_mfma_f32_16x16x32_bf16 v[36:39], a[40:43], v[68:71], v[36:39]
    v_mfma_f32_16x16x32_bf16 v[40:43], a[112:115], v[64:67], v[40:43]
    v_mfma_f32_16x16x32_bf16 v[44:47], a[112:115], v[68:71], v[44:47]
    v_mfma_f32_16x16x32_bf16 v[48:51], v[64:67], a[184:187], v[48:51]
    v_mfma_f32_16x16x32_bf16 v[56:59], v[68:71], a[184:187], v[56:59]
    v_mfma_f32_16x16x32_bf16 v[52:55], v[64:67], v[224:227], v[52:55]
    v_mfma_f32_16x16x32_bf16 v[60:63], v[68:71], v[224:227], v[60:63]
    ds_read_b128 v[64:67], v8 offset:12288
    ds_read_b128 v[68:71], v8 offset:30720
    s_waitcnt lgkmcnt(2)
    v_mfma_f32_16x16x32_bf16 v[32:35], a[44:47], v[72:75], v[32:35]
    v_mfma_f32_16x16x32_bf16 v[36:39], a[44:47], v[76:79], v[36:39]
    v_mfma_f32_16x16x32_bf16 v[40:43], a[116:119], v[72:75], v[40:43]
    v_mfma_f32_16x16x32_bf16 v[44:47], a[116:119], v[76:79], v[44:47]
    v_mfma_f32_16x16x32_bf16 v[48:51], v[72:75], a[188:191], v[48:51]
    v_mfma_f32_16x16x32_bf16 v[56:59], v[76:79], a[188:191], v[56:59]
    v_mfma_f32_16x16x32_bf16 v[52:55], v[72:75], v[228:231], v[52:55]
    v_mfma_f32_16x16x32_bf16 v[60:63], v[76:79], v[228:231], v[60:63]
    ds_read_b128 v[72:75], v8 offset:13312
    ds_read_b128 v[76:79], v8 offset:31744
    s_waitcnt lgkmcnt(2)
    v_mfma_f32_16x16x32_bf16 v[32:35], a[48:51], v[64:67], v[32:35]
    v_mfma_f32_16x16x32_bf16 v[36:39], a[48:51], v[68:71], v[36:39]
    v_mfma_f32_16x16x32_bf16 v[40:43], a[120:123], v[64:67], v[40:43]
    v_mfma_f32_16x16x32_bf16 v[44:47], a[120:123], v[68:71], v[44:47]
    v_mfma_f32_16x16x32_bf16 v[48:51], v[64:67], a[192:195], v[48:51]
    v_mfma_f32_16x16x32_bf16 v[56:59], v[68:71], a[192:195], v[56:59]
    v_mfma_f32_16x16x32_bf16 v[52:55], v[64:67], v[232:235], v[52:55]
    v_mfma_f32_16x16x32_bf16 v[60:63], v[68:71], v[232:235], v[60:63]
    ds_read_b128 v[64:67], v8 offset:14336
    ds_read_b128 v[68:71], v8 offset:32768
    s_waitcnt lgkmcnt(2)
    v_mfma_f32_16x16x32_bf16 v[32:35], a[52:55], v[72:75], v[32:35]
    v_mfma_f32_16x16x32_bf16 v[36:39], a[52:55], v[76:79], v[36:39]
    v_mfma_f32_16x16x32_bf16 v[40:43], a[124:127], v[72:75], v[40:43]
    v_mfma_f32_16x16x32_bf16 v[44:47], a[124:127], v[76:79], v[44:47]
    v_mfma_f32_16x16x32_bf16 v[48:51], v[72:75], a[196:199], v[48:51]
    v_mfma_f32_16x16x32_bf16 v[56:59], v[76:79], a[196:199], v[56:59]
    v_mfma_f32_16x16x32_bf16 v[52:55], v[72:75], v[236:239], v[52:55]
    v_mfma_f32_16x16x32_bf16 v[60:63], v[76:79], v[236:239], v[60:63]
    ds_read_b128 v[72:75], v8 offset:15360
    ds_read_b128 v[76:79], v8 offset:33792
    s_waitcnt lgkmcnt(2)
    v_mfma_f32_16x16x32_bf16 v[32:35], a[56:59], v[64:67], v[32:35]
    v_mfma_f32_16x16x32_bf16 v[36:39], a[56:59], v[68:71], v[36:39]
    v_mfma_f32_16x16x32_bf16 v[40:43], a[128:131], v[64:67], v[40:43]
    v_mfma_f32_16x16x32_bf16 v[44:47], a[128:131], v[68:71], v[44:47]
    v_mfma_f32_16x16x32_bf16 v[48:51], v[64:67], a[200:203], v[48:51]
    v_mfma_f32_16x16x32_bf16 v[56:59], v[68:71], a[200:203], v[56:59]
    v_mfma_f32_16x16x32_bf16 v[52:55], v[64:67], v[240:243], v[52:55]
    v_mfma_f32_16x16x32_bf16 v[60:63], v[68:71], v[240:243], v[60:63]
    ds_read_b128 v[64:67], v8 offset:16384
    ds_read_b128 v[68:71], v8 offset:34816
    s_waitcnt lgkmcnt(2)
    v_mfma_f32_16x16x32_bf16 v[32:35], a[60:63], v[72:75], v[32:35]
    v_mfma_f32_16x16x32_bf16 v[36:39], a[60:63], v[76:79], v[36:39]
    v_mfma_f32_16x16x32_bf16 v[40:43], a[132:135], v[72:75], v[40:43]
    v_mfma_f32_16x16x32_bf16 v[44:47], a[132:135], v[76:79], v[44:47]
    v_mfma_f32_16x16x32_bf16 v[48:51], v[72:75], a[204:207], v[48:51]
    v_mfma_f32_16x16x32_bf16 v[56:59], v[76:79], a[204:207], v[56:59]
    v_mfma_f32_16x16x32_bf16 v[52:55], v[72:75], v[244:247], v[52:55]
    v_mfma_f32_16x16x32_bf16 v[60:63], v[76:79], v[244:247], v[60:63]
    ds_read_b128 v[72:75], v8 offset:17408
    ds_read_b128 v[76:79], v8 offset:35840
    s_waitcnt lgkmcnt(2)
    v_mfma_f32_16x16x32_bf16 v[32:35], a[64:67], v[64:67], v[32:35]
    v_mfma_f32_16x16x32_bf16 v[36:39], a[64:67], v[68:71], v[36:39]
    v_mfma_f32_16x16x32_bf16 v[40:43], a[136:139], v[64:67], v[40:43]
    v_mfma_f32_16x16x32_bf16 v[44:47], a[136:139], v[68:71], v[44:47]
    v_mfma_f32_16x16x32_bf16 v[48:51], v[64:67], a[208:211], v[48:51]
    v_mfma_f32_16x16x32_bf16 v[56:59], v[68:71], a[208:211], v[56:59]
    v_mfma_f32_16x16x32_bf16 v[52:55], v[64:67], v[248:251], v[52:55]
    v_mfma_f32_16x16x32_bf16 v[60:63], v[68:71], v[248:251], v[60:63]
    s_waitcnt lgkmcnt(0)
    v_mfma_f32_16x16x32_bf16 v[32:35], a[68:71], v[72:75], v[32:35]
    v_mfma_f32_16x16x32_bf16 v[36:39], a[68:71], v[76:79], v[36:39]
    v_mfma_f32_16x16x32_bf16 v[40:43], a[140:143], v[72:75], v[40:43]
    v_mfma_f32_16x16x32_bf16 v[44:47], a[140:143], v[76:79], v[44:47]
    v_mfma_f32_16x16x32_bf16 v[48:51], v[72:75], a[212:215], v[48:51]
    v_mfma_f32_16x16x32_bf16 v[56:59], v[76:79], a[212:215], v[56:59]
    v_mfma_f32_16x16x32_bf16 v[52:55], v[72:75], v[252:255], v[52:55]
    v_mfma_f32_16x16x32_bf16 v[60:63], v[76:79], v[252:255], v[60:63]
    s_nop 0
    v_cvt_pk_bf16_f32 v80, v32, v33
    v_cvt_pk_bf16_f32 v81, v34, v35
    v_cvt_pk_bf16_f32 v82, v40, v41
    v_cvt_pk_bf16_f32 v83, v42, v43
    v_cvt_pk_bf16_f32 v84, v36, v37
    v_cvt_pk_bf16_f32 v85, v38, v39
    v_cvt_pk_bf16_f32 v86, v44, v45
    v_cvt_pk_bf16_f32 v87, v46, v47
    v_cvt_pk_bf16_f32 v88, v48, v49
    v_cvt_pk_bf16_f32 v89, v50, v51
    v_cvt_pk_bf16_f32 v90, v56, v57
    v_cvt_pk_bf16_f32 v91, v58, v59
    v_cvt_pk_bf16_f32 v92, v52, v53
    v_cvt_pk_bf16_f32 v93, v54, v55
    v_cvt_pk_bf16_f32 v94, v60, v61
    v_cvt_pk_bf16_f32 v95, v62, v63
    s_lshl_b32 s60, s6, 6
    s_add_u32 s60, s60, s71
    s_lshl_b32 s60, s60, 2
    s_add_u32 s60, s60, s4
    s_lshl_b32 s60, s60, 12
    s_add_u32 s60, s60, 1048576
    buffer_store_dwordx4 v[80:83], v5, s[8:11], s60 offen offset:0 sc1
    buffer_store_dwordx4 v[84:87], v5, s[8:11], s60 offen offset:1024 sc1
    buffer_store_dwordx4 v[88:91], v5, s[8:11], s60 offen offset:2048 sc1
    buffer_store_dwordx4 v[92:95], v5, s[8:11], s60 offen offset:3072 sc1
    s_add_u32 s71, s71, 3
    s_add_u32 s74, s74, 36864
    s_cmp_ge_u32 s74, 110592
    s_cselect_b32 s74, 0, s74
    s_add_u32 s75, s75, 1
    s_cmp_lt_u32 s71, 64
    s_cbranch_scc1 L_x1_90
    v_mov_b32 v8, -1
    v_mov_b32 v9, -1
    v_mov_b32 v10, -1
    v_mov_b32 v11, -1
    s_sub_u32 s60, s71, 6
    s_lshl_b32 s60, s60, 13
    s_lshl_b32 s61, s6, 19
    s_add_u32 s60, s60, s61
    s_lshl_b32 s61, s4, 11
    s_add_u32 s60, s60, s61
    s_add_u32 s60, s60, 35651584
    buffer_store_dwordx4 v[8:11], v5, s[8:11], s60 offen offset:0 sc1
    buffer_store_dwordx4 v[8:11], v5, s[8:11], s60 offen offset:1024 sc1
    s_sub_u32 s60, s71, 3
    s_lshl_b32 s60, s60, 13
    s_lshl_b32 s61, s6, 19
    s_add_u32 s60, s60, s61
    s_lshl_b32 s61, s4, 11
    s_add_u32 s60, s60, s61
    s_add_u32 s60, s60, 35651584
    buffer_store_dwordx4 v[8:11], v5, s[8:11], s60 offen offset:0 sc1
    buffer_store_dwordx4 v[8:11], v5, s[8:11], s60 offen offset:1024 sc1
    s_waitcnt vmcnt(0)
    s_barrier
    s_cmp_lg_u32 s4, 0
    s_cbranch_scc1 L_nf2_93
    s_mov_b64 exec, 1
    s_sub_i32 s60, s71, 6
    s_cmp_lt_i32 s60, 0
    s_cbranch_scc1 L_sk_94
    s_lshl_b32 s60, s60, 2
    s_add_u32 s60, s60, s80
    buffer_store_dword v6, v7, s[8:11], s60 offen sc1
L_sk_94:
    s_sub_i32 s60, s71, 3
    s_cmp_lt_i32 s60, 0
    s_cbranch_scc1 L_sk_95
    s_lshl_b32 s60, s60, 2
    s_add_u32 s60, s60, s80
    buffer_store_dword v6, v7, s[8:11], s60 offen sc1
L_sk_95:
    s_mov_b64 exec, -1
L_nf2_93:
    v_and_b32 v1, 63, v0
    v_and_b32 v2, 15, v0
    v_lshrrev_b32 v3, 4, v1
    v_lshlrev_b32 v24, 1, v3
    v_xor_b32 v24, v24, v2
    s_mov_b32 s60, 8192
    v_mul_lo_u32 v25, v3, s60
    v_xor_b32 v16, 0, v24
    v_lshl_add_u32 v16, v16, 4, v25
    v_xor_b32 v17, 0, v24
    v_lshl_add_u32 v17, v17, 4, v25
    v_xor_b32 v18, 8, v24
    v_lshl_add_u32 v18, v18, 4, v25
    v_xor_b32 v19, 8, v24
    v_lshl_add_u32 v19, v19, 4, v25
    v_lshrrev_b32 v24, 2, v2
    v_lshl_add_u32 v25, v3, 3, v24
    v_and_b32 v26, 1, v3
    v_lshlrev_b32 v26, 3, v26
    v_lshl_add_u32 v26, v24, 1, v26
    v_bfe_u32 v27, v2, 1, 1
    s_lshl_b32 s60, s4, 2
    v_add_u32 v27, s60, v27
    v_and_b32 v28, 1, v2
    v_lshlrev_b32 v28, 3, v28
    v_lshl_add_u32 v28, v25, 8, v28
    v_add_u32 v29, 0, v27
    v_xor_b32 v29, v29, v26
    v_lshl_add_u32 v20, v29, 4, v28
    v_add_u32 v29, 2, v27
    v_xor_b32 v29, v29, v26
    v_lshl_add_u32 v21, v29, 4, v28
    v_lshrrev_b32 v40, 3, v1
    v_and_b32 v41, 7, v1
    v_and_b32 v42, 6, v40
    v_xor_b32 v41, v41, v42
    s_movk_i32 s60, 1152
    v_mul_lo_u32 v40, v40, s60
    v_lshl_add_u32 v32, v41, 4, v40
    v_lshrrev_b32 v40, 2, v2
    v_lshl_add_u32 v41, v3, 2, v40
    v_and_b32 v42, 6, v41
    v_bfe_u32 v43, v2, 1, 1
    s_lshl_b32 s60, s4, 1
    v_add_u32 v43, s60, v43
    v_xor_b32 v43, v43, v42
    v_and_b32 v44, 1, v2
    v_lshlrev_b32 v44, 3, v44
    v_lshl_add_u32 v44, v41, 7, v44
    v_lshl_add_u32 v36, v43, 4, v44
    s_lshl_b32 s65, s4, 12
    s_lshl_b32 s66, s6, 8
    s_lshl_b32 s67, s4, 17
    s_add_u32 s66, s66, s67
    s_mul_i32 s67, s6, 147456
    s_mul_i32 s68, s4, 36864
    s_add_u32 s67, s67, s68
    s_mov_b32 s16, s42
    s_mov_b32 s17, s43
    s_mov_b32 s18, 4718592
    s_mov_b32 s19, 0x00020000
    s_mov_b32 s20, s48
    s_mov_b32 s21, s49
    s_mov_b32 s22, 4718592
    s_mov_b32 s23, 0x00020000
    s_add_u32 m0, s65, 0
    s_add_u32 s64, s66, 0
    buffer_load_dwordx4 v16, s[16:19], s64 offen lds
    s_add_u32 m0, s65, 1024
    s_add_u32 s64, s66, 32768
    buffer_load_dwordx4 v17, s[16:19], s64 offen lds
    s_add_u32 m0, s65, 2048
    s_add_u32 s64, s66, 65536
    buffer_load_dwordx4 v18, s[16:19], s64 offen lds
    s_add_u32 m0, s65, 3072
    s_add_u32 s64, s66, 98304
    buffer_load_dwordx4 v19, s[16:19], s64 offen lds
    s_add_u32 m0, s65, 16384
    s_add_u32 s64, s66, 524288
    buffer_load_dwordx4 v16, s[16:19], s64 offen lds
    s_add_u32 m0, s65, 17408
    s_add_u32 s64, s66, 557056
    buffer_load_dwordx4 v17, s[16:19], s64 offen lds
    s_add_u32 m0, s65, 18432
    s_add_u32 s64, s66, 589824
    buffer_load_dwordx4 v18, s[16:19], s64 offen lds
    s_add_u32 m0, s65, 19456
    s_add_u32 s64, s66, 622592
    buffer_load_dwordx4 v19, s[16:19], s64 offen lds
    s_add_u32 m0, s65, 32768
    s_add_u32 s64, s66, 1048576
    buffer_load_dwordx4 v16, s[16:19], s64 offen lds
    s_add_u32 m0, s65, 33792
    s_add_u32 s64, s66, 1081344
    buffer_load_dwordx4 v17, s[16:19], s64 offen lds
    s_add_u32 m0, s65, 34816
    s_add_u32 s64, s66, 1114112
    buffer_load_dwordx4 v18, s[16:19], s64 offen lds
    s_add_u32 m0, s65, 35840
    s_add_u32 s64, s66, 1146880
    buffer_load_dwordx4 v19, s[16:19], s64 offen lds
    s_add_u32 m0, s65, 49152
    s_add_u32 s64, s66, 1572864
    buffer_load_dwordx4 v16, s[16:19], s64 offen lds
    s_add_u32 m0, s65, 50176
    s_add_u32 s64, s66, 1605632
    buffer_load_dwordx4 v17, s[16:19], s64 offen lds
    s_add_u32 m0, s65, 51200
    s_add_u32 s64, s66, 1638400
    buffer_load_dwordx4 v18, s[16:19], s64 offen lds
    s_add_u32 m0, s65, 52224
    s_add_u32 s64, s66, 1671168
    buffer_load_dwordx4 v19, s[16:19], s64 offen lds
    s_add_u32 m0, s65, 65536
    s_add_u32 s64, s66, 2097152
    buffer_load_dwordx4 v16, s[16:19], s64 offen lds
    s_add_u32 m0, s65, 66560
    s_add_u32 s64, s66, 2129920
    buffer_load_dwordx4 v17, s[16:19], s64 offen lds
    s_add_u32 m0, s65, 67584
    s_add_u32 s64, s66, 2162688
    buffer_load_dwordx4 v18, s[16:19], s64 offen lds
    s_add_u32 m0, s65, 68608
    s_add_u32 s64, s66, 2195456
    buffer_load_dwordx4 v19, s[16:19], s64 offen lds
    s_add_u32 m0, s65, 81920
    s_add_u32 s64, s66, 2621440
    buffer_load_dwordx4 v16, s[16:19], s64 offen lds
    s_add_u32 m0, s65, 82944
    s_add_u32 s64, s66, 2654208
    buffer_load_dwordx4 v17, s[16:19], s64 offen lds
    s_add_u32 m0, s65, 83968
    s_add_u32 s64, s66, 2686976
    buffer_load_dwordx4 v18, s[16:19], s64 offen lds
    s_add_u32 m0, s65, 84992
    s_add_u32 s64, s66, 2719744
    buffer_load_dwordx4 v19, s[16:19], s64 offen lds
    s_add_u32 m0, s65, 98304
    s_add_u32 s64, s66, 3145728
    buffer_load_dwordx4 v16, s[16:19], s64 offen lds
    s_add_u32 m0, s65, 99328
    s_add_u32 s64, s66, 3178496
    buffer_load_dwordx4 v17, s[16:19], s64 offen lds
    s_add_u32 m0, s65, 100352
    s_add_u32 s64, s66, 3211264
    buffer_load_dwordx4 v18, s[16:19], s64 offen lds
    s_add_u32 m0, s65, 101376
    s_add_u32 s64, s66, 3244032
    buffer_load_dwordx4 v19, s[16:19], s64 offen lds
    s_add_u32 m0, s65, 114688
    s_add_u32 s64, s66, 3670016
    buffer_load_dwordx4 v16, s[16:19], s64 offen lds
    s_add_u32 m0, s65, 115712
    s_add_u32 s64, s66, 3702784
    buffer_load_dwordx4 v17, s[16:19], s64 offen lds
    s_add_u32 m0, s65, 116736
    s_add_u32 s64, s66, 3735552
    buffer_load_dwordx4 v18, s[16:19], s64 offen lds
    s_add_u32 m0, s65, 117760
    s_add_u32 s64, s66, 3768320
    buffer_load_dwordx4 v19, s[16:19], s64 offen lds
    s_waitcnt vmcnt(28) lgkmcnt(0)
    s_barrier
    s_add_u32 m0, s65, 131072
    s_add_u32 s64, s66, 4194304
    buffer_load_dwordx4 v16, s[16:19], s64 offen lds
    s_add_u32 m0, s65, 132096
    s_add_u32 s64, s66, 4227072
    buffer_load_dwordx4 v17, s[16:19], s64 offen lds
    s_add_u32 m0, s65, 133120
    s_add_u32 s64, s66, 4259840
    buffer_load_dwordx4 v18, s[16:19], s64 offen lds
    s_add_u32 m0, s65, 134144
    s_add_u32 s64, s66, 4292608
    buffer_load_dwordx4 v19, s[16:19], s64 offen lds
    v_add_u32 v22, 0, v20
    v_add_u32 v23, 0, v21
    ds_read_b64_tr_b16 a[0:1], v22 offset:0
    ds_read_b64_tr_b16 a[2:3], v22 offset:1024
    ds_read_b64_tr_b16 a[72:73], v23 offset:0
    ds_read_b64_tr_b16 a[74:75], v23 offset:1024
    ds_read_b64_tr_b16 a[4:5], v22 offset:8192
    ds_read_b64_tr_b16 a[6:7], v22 offset:9216
    ds_read_b64_tr_b16 a[76:77], v23 offset:8192
    ds_read_b64_tr_b16 a[78:79], v23 offset:9216
    s_waitcnt vmcnt(28) lgkmcnt(0)
    s_barrier
    s_add_u32 m0, s65, 0
    s_add_u32 s64, s67, 0
    buffer_load_dwordx4 v32, s[20:23], s64 offen lds
    s_add_u32 m0, s65, 1024
    s_add_u32 s64, s67, 9216
    buffer_load_dwordx4 v32, s[20:23], s64 offen lds
    s_add_u32 m0, s65, 2048
    s_add_u32 s64, s67, 18432
    buffer_load_dwordx4 v32, s[20:23], s64 offen lds
    s_add_u32 m0, s65, 3072
    s_add_u32 s64, s67, 27648
    buffer_load_dwordx4 v32, s[20:23], s64 offen lds
    v_add_u32 v22, 16384, v20
    v_add_u32 v23, 16384, v21
    ds_read_b64_tr_b16 a[8:9], v22 offset:0
    ds_read_b64_tr_b16 a[10:11], v22 offset:1024
    ds_read_b64_tr_b16 a[80:81], v23 offset:0
    ds_read_b64_tr_b16 a[82:83], v23 offset:1024
    ds_read_b64_tr_b16 a[12:13], v22 offset:8192
    ds_read_b64_tr_b16 a[14:15], v22 offset:9216
    ds_read_b64_tr_b16 a[84:85], v23 offset:8192
    ds_read_b64_tr_b16 a[86:87], v23 offset:9216
    s_waitcnt vmcnt(28) lgkmcnt(0)
    s_barrier
    s_add_u32 m0, s65, 16384
    s_add_u32 s64, s67, 128
    buffer_load_dwordx4 v32, s[20:23], s64 offen lds
    s_add_u32 m0, s65, 17408
    s_add_u32 s64, s67, 9344
    buffer_load_dwordx4 v32, s[20:23], s64 offen lds
    s_add_u32 m0, s65, 18432
    s_add_u32 s64, s67, 18560
    buffer_load_dwordx4 v32, s[20:23], s64 offen lds
    s_add_u32 m0, s65, 19456
    s_add_u32 s64, s67, 27776
    buffer_load_dwordx4 v32, s[20:23], s64 offen lds
    v_add_u32 v22, 32768, v20
    v_add_u32 v23, 32768, v21
    ds_read_b64_tr_b16 a[16:17], v22 offset:0
    ds_read_b64_tr_b16 a[18:19], v22 offset:1024
    ds_read_b64_tr_b16 a[88:89], v23 offset:0
    ds_read_b64_tr_b16 a[90:91], v23 offset:1024
    ds_read_b64_tr_b16 a[20:21], v22 offset:8192
    ds_read_b64_tr_b16 a[22:23], v22 offset:9216
    ds_read_b64_tr_b16 a[92:93], v23 offset:8192
    ds_read_b64_tr_b16 a[94:95], v23 offset:9216
    s_waitcnt vmcnt(28) lgkmcnt(0)
    s_barrier
    s_add_u32 m0, s65, 32768
    s_add_u32 s64, s67, 256
    buffer_load_dwordx4 v32, s[20:23], s64 offen lds
    s_add_u32 m0, s65, 33792
    s_add_u32 s64, s67, 9472
    buffer_load_dwordx4 v32, s[20:23], s64 offen lds
    s_add_u32 m0, s65, 34816
    s_add_u32 s64, s67, 18688
    buffer_load_dwordx4 v32, s[20:23], s64 offen lds
    s_add_u32 m0, s65, 35840
    s_add_u32 s64, s67, 27904
    buffer_load_dwordx4 v32, s[20:23], s64 offen lds
    v_add_u32 v22, 49152, v20
    v_add_u32 v23, 49152, v21
    ds_read_b64_tr_b16 a[24:25], v22 offset:0
    ds_read_b64_tr_b16 a[26:27], v22 offset:1024
    ds_read_b64_tr_b16 a[96:97], v23 offset:0
    ds_read_b64_tr_b16 a[98:99], v23 offset:1024
    ds_read_b64_tr_b16 a[28:29], v22 offset:8192
    ds_read_b64_tr_b16 a[30:31], v22 offset:9216
    ds_read_b64_tr_b16 a[100:101], v23 offset:8192
    ds_read_b64_tr_b16 a[102:103], v23 offset:9216
    s_waitcnt vmcnt(28) lgkmcnt(0)
    s_barrier
    s_add_u32 m0, s65, 49152
    s_add_u32 s64, s67, 384
    buffer_load_dwordx4 v32, s[20:23], s64 offen lds
    s_add_u32 m0, s65, 50176
    s_add_u32 s64, s67, 9600
    buffer_load_dwordx4 v32, s[20:23], s64 offen lds
    s_add_u32 m0, s65, 51200
    s_add_u32 s64, s67, 18816
    buffer_load_dwordx4 v32, s[20:23], s64 offen lds
    s_add_u32 m0, s65, 52224
    s_add_u32 s64, s67, 28032
    buffer_load_dwordx4 v32, s[20:23], s64 offen lds
    v_add_u32 v22, 65536, v20
    v_add_u32 v23, 65536, v21
    ds_read_b64_tr_b16 a[32:33], v22 offset:0
    ds_read_b64_tr_b16 a[34:35], v22 offset:1024
    ds_read_b64_tr_b16 a[104:105], v23 offset:0
    ds_read_b64_tr_b16 a[106:107], v23 offset:1024
    ds_read_b64_tr_b16 a[36:37], v22 offset:8192
    ds_read_b64_tr_b16 a[38:39], v22 offset:9216
    ds_read_b64_tr_b16 a[108:109], v23 offset:8192
    ds_read_b64_tr_b16 a[110:111], v23 offset:9216
    s_waitcnt vmcnt(28) lgkmcnt(0)
    s_barrier
    s_add_u32 m0, s65, 65536
    s_add_u32 s64, s67, 512
    buffer_load_dwordx4 v32, s[20:23], s64 offen lds
    s_add_u32 m0, s65, 66560
    s_add_u32 s64, s67, 9728
    buffer_load_dwordx4 v32, s[20:23], s64 offen lds
    s_add_u32 m0, s65, 67584
    s_add_u32 s64, s67, 18944
    buffer_load_dwordx4 v32, s[20:23], s64 offen lds
    s_add_u32 m0, s65, 68608
    s_add_u32 s64, s67, 28160
    buffer_load_dwordx4 v32, s[20:23], s64 offen lds
    v_add_u32 v22, 81920, v20
    v_add_u32 v23, 81920, v21
    ds_read_b64_tr_b16 a[40:41], v22 offset:0
    ds_read_b64_tr_b16 a[42:43], v22 offset:1024
    ds_read_b64_tr_b16 a[112:113], v23 offset:0
    ds_read_b64_tr_b16 a[114:115], v23 offset:1024
    ds_read_b64_tr_b16 a[44:45], v22 offset:8192
    ds_read_b64_tr_b16 a[46:47], v22 offset:9216
    ds_read_b64_tr_b16 a[116:117], v23 offset:8192
    ds_read_b64_tr_b16 a[118:119], v23 offset:9216
    s_waitcnt vmcnt(28) lgkmcnt(0)
    s_barrier
    s_add_u32 m0, s65, 81920
    s_add_u32 s64, s67, 640
    buffer_load_dwordx4 v32, s[20:23], s64 offen lds
    s_add_u32 m0, s65, 82944
    s_add_u32 s64, s67, 9856
    buffer_load_dwordx4 v32, s[20:23], s64 offen lds
    s_add_u32 m0, s65, 83968
    s_add_u32 s64, s67, 19072
    buffer_load_dwordx4 v32, s[20:23], s64 offen lds
    s_add_u32 m0, s65, 84992
    s_add_u32 s64, s67, 28288
    buffer_load_dwordx4 v32, s[20:23], s64 offen lds
    v_add_u32 v22, 98304, v20
    v_add_u32 v23, 98304, v21
    ds_read_b64_tr_b16 a[48:49], v22 offset:0
    ds_read_b64_tr_b16 a[50:51], v22 offset:1024
    ds_read_b64_tr_b16 a[120:121], v23 offset:0
    ds_read_b64_tr_b16 a[122:123], v23 offset:1024
    ds_read_b64_tr_b16 a[52:53], v22 offset:8192
    ds_read_b64_tr_b16 a[54:55], v22 offset:9216
    ds_read_b64_tr_b16 a[124:125], v23 offset:8192
    ds_read_b64_tr_b16 a[126:127], v23 offset:9216
    s_waitcnt vmcnt(28) lgkmcnt(0)
    s_barrier
    s_add_u32 m0, s65, 98304
    s_add_u32 s64, s67, 768
    buffer_load_dwordx4 v32, s[20:23], s64 offen lds
    s_add_u32 m0, s65, 99328
    s_add_u32 s64, s67, 9984
    buffer_load_dwordx4 v32, s[20:23], s64 offen lds
    s_add_u32 m0, s65, 100352
    s_add_u32 s64, s67, 19200
    buffer_load_dwordx4 v32, s[20:23], s64 offen lds
    s_add_u32 m0, s65, 101376
    s_add_u32 s64, s67, 28416
    buffer_load_dwordx4 v32, s[20:23], s64 offen lds
    v_add_u32 v22, 114688, v20
    v_add_u32 v23, 114688, v21
    ds_read_b64_tr_b16 a[56:57], v22 offset:0
    ds_read_b64_tr_b16 a[58:59], v22 offset:1024
    ds_read_b64_tr_b16 a[128:129], v23 offset:0
    ds_read_b64_tr_b16 a[130:131], v23 offset:1024
    ds_read_b64_tr_b16 a[60:61], v22 offset:8192
    ds_read_b64_tr_b16 a[62:63], v22 offset:9216
    ds_read_b64_tr_b16 a[132:133], v23 offset:8192
    ds_read_b64_tr_b16 a[134:135], v23 offset:9216
    s_waitcnt vmcnt(28) lgkmcnt(0)
    s_barrier
    s_add_u32 m0, s65, 114688
    s_add_u32 s64, s67, 896
    buffer_load_dwordx4 v32, s[20:23], s64 offen lds
    s_add_u32 m0, s65, 115712
    s_add_u32 s64, s67, 10112
    buffer_load_dwordx4 v32, s[20:23], s64 offen lds
    s_add_u32 m0, s65, 116736
    s_add_u32 s64, s67, 19328
    buffer_load_dwordx4 v32, s[20:23], s64 offen lds
    s_add_u32 m0, s65, 117760
    s_add_u32 s64, s67, 28544
    buffer_load_dwordx4 v32, s[20:23], s64 offen lds
    v_add_u32 v22, 131072, v20
    v_add_u32 v23, 131072, v21
    ds_read_b64_tr_b16 a[64:65], v22 offset:0
    ds_read_b64_tr_b16 a[66:67], v22 offset:1024
    ds_read_b64_tr_b16 a[136:137], v23 offset:0
    ds_read_b64_tr_b16 a[138:139], v23 offset:1024
    ds_read_b64_tr_b16 a[68:69], v22 offset:8192
    ds_read_b64_tr_b16 a[70:71], v22 offset:9216
    ds_read_b64_tr_b16 a[140:141], v23 offset:8192
    ds_read_b64_tr_b16 a[142:143], v23 offset:9216
    s_waitcnt vmcnt(28) lgkmcnt(0)
    s_barrier
    s_add_u32 m0, s65, 131072
    s_add_u32 s64, s67, 1024
    buffer_load_dwordx4 v32, s[20:23], s64 offen lds
    s_add_u32 m0, s65, 132096
    s_add_u32 s64, s67, 10240
    buffer_load_dwordx4 v32, s[20:23], s64 offen lds
    s_add_u32 m0, s65, 133120
    s_add_u32 s64, s67, 19456
    buffer_load_dwordx4 v32, s[20:23], s64 offen lds
    s_add_u32 m0, s65, 134144
    s_add_u32 s64, s67, 28672
    buffer_load_dwordx4 v32, s[20:23], s64 offen lds
    v_add_u32 v37, 0, v36
    ds_read_b64_tr_b16 a[144:145], v37 offset:0
    ds_read_b64_tr_b16 a[146:147], v37 offset:2048
    ds_read_b64_tr_b16 a[148:149], v37 offset:4096
    ds_read_b64_tr_b16 a[150:151], v37 offset:6144
    ds_read_b64_tr_b16 a[152:153], v37 offset:8192
    ds_read_b64_tr_b16 a[154:155], v37 offset:10240
    ds_read_b64_tr_b16 a[156:157], v37 offset:12288
    ds_read_b64_tr_b16 a[158:159], v37 offset:14336
    s_waitcnt vmcnt(28) lgkmcnt(0)
    s_barrier
    v_add_u32 v37, 16384, v36
    ds_read_b64_tr_b16 a[160:161], v37 offset:0
    ds_read_b64_tr_b16 a[162:163], v37 offset:2048
    ds_read_b64_tr_b16 a[164:165], v37 offset:4096
    ds_read_b64_tr_b16 a[166:167], v37 offset:6144
    ds_read_b64_tr_b16 a[168:169], v37 offset:8192
    ds_read_b64_tr_b16 a[170:171], v37 offset:10240
    ds_read_b64_tr_b16 a[172:173], v37 offset:12288
    ds_read_b64_tr_b16 a[174:175], v37 offset:14336
    s_waitcnt vmcnt(24) lgkmcnt(0)
    s_barrier
    v_add_u32 v37, 32768, v36
    ds_read_b64_tr_b16 a[176:177], v37 offset:0
    ds_read_b64_tr_b16 a[178:179], v37 offset:2048
    ds_read_b64_tr_b16 a[180:181], v37 offset:4096
    ds_read_b64_tr_b16 a[182:183], v37 offset:6144
    ds_read_b64_tr_b16 a[184:185], v37 offset:8192
    ds_read_b64_tr_b16 a[186:187], v37 offset:10240
    ds_read_b64_tr_b16 a[188:189], v37 offset:12288
    ds_read_b64_tr_b16 a[190:191], v37 offset:14336
    s_waitcnt vmcnt(20) lgkmcnt(0)
    s_barrier
    v_add_u32 v37, 49152, v36
    ds_read_b64_tr_b16 a[192:193], v37 offset:0
    ds_read_b64_tr_b16 a[194:195], v37 offset:2048
    ds_read_b64_tr_b16 a[196:197], v37 offset:4096
    ds_read_b64_tr_b16 a[198:199], v37 offset:6144
    ds_read_b64_tr_b16 a[200:201], v37 offset:8192
    ds_read_b64_tr_b16 a[202:203], v37 offset:10240
    ds_read_b64_tr_b16 a[204:205], v37 offset:12288
    ds_read_b64_tr_b16 a[206:207], v37 offset:14336
    s_waitcnt vmcnt(16) lgkmcnt(0)
    s_barrier
    v_add_u32 v37, 65536, v36
    ds_read_b64_tr_b16 a[208:209], v37 offset:0
    ds_read_b64_tr_b16 a[210:211], v37 offset:2048
    ds_read_b64_tr_b16 a[212:213], v37 offset:4096
    ds_read_b64_tr_b16 a[214:215], v37 offset:6144
    ds_read_b64_tr_b16 a[216:217], v37 offset:8192
    ds_read_b64_tr_b16 a[218:219], v37 offset:10240
    ds_read_b64_tr_b16 a[220:221], v37 offset:12288
    ds_read_b64_tr_b16 a[222:223], v37 offset:14336
    s_waitcnt vmcnt(12) lgkmcnt(0)
    s_barrier
    v_add_u32 v37, 81920, v36
    ds_read_b64_tr_b16 a[224:225], v37 offset:0
    ds_read_b64_tr_b16 a[226:227], v37 offset:2048
    ds_read_b64_tr_b16 a[228:229], v37 offset:4096
    ds_read_b64_tr_b16 a[230:231], v37 offset:6144
    ds_read_b64_tr_b16 a[232:233], v37 offset:8192
    ds_read_b64_tr_b16 a[234:235], v37 offset:10240
    ds_read_b64_tr_b16 a[236:237], v37 offset:12288
    ds_read_b64_tr_b16 a[238:239], v37 offset:14336
    s_waitcnt vmcnt(8) lgkmcnt(0)
    s_barrier
    v_add_u32 v37, 98304, v36
    ds_read_b64_tr_b16 a[240:241], v37 offset:0
    ds_read_b64_tr_b16 a[242:243], v37 offset:2048
    ds_read_b64_tr_b16 a[244:245], v37 offset:4096
    ds_read_b64_tr_b16 a[246:247], v37 offset:6144
    ds_read_b64_tr_b16 a[248:249], v37 offset:8192
    ds_read_b64_tr_b16 a[250:251], v37 offset:10240
    ds_read_b64_tr_b16 a[252:253], v37 offset:12288
    ds_read_b64_tr_b16 a[254:255], v37 offset:14336
    s_waitcnt vmcnt(4) lgkmcnt(0)
    s_barrier
    v_add_u32 v37, 114688, v36
    ds_read_b64_tr_b16 v[224:225], v37 offset:0
    ds_read_b64_tr_b16 v[226:227], v37 offset:2048
    ds_read_b64_tr_b16 v[228:229], v37 offset:4096
    ds_read_b64_tr_b16 v[230:231], v37 offset:6144
    ds_read_b64_tr_b16 v[232:233], v37 offset:8192
    ds_read_b64_tr_b16 v[234:235], v37 offset:10240
    ds_read_b64_tr_b16 v[236:237], v37 offset:12288
    ds_read_b64_tr_b16 v[238:239], v37 offset:14336
    s_waitcnt vmcnt(0) lgkmcnt(0)
    s_barrier
    v_add_u32 v37, 131072, v36
    ds_read_b64_tr_b16 v[240:241], v37 offset:0
    ds_read_b64_tr_b16 v[242:243], v37 offset:2048
    ds_read_b64_tr_b16 v[244:245], v37 offset:4096
    ds_read_b64_tr_b16 v[246:247], v37 offset:6144
    ds_read_b64_tr_b16 v[248:249], v37 offset:8192
    ds_read_b64_tr_b16 v[250:251], v37 offset:10240
    ds_read_b64_tr_b16 v[252:253], v37 offset:12288
    ds_read_b64_tr_b16 v[254:255], v37 offset:14336
    s_waitcnt lgkmcnt(0)
    s_barrier
    s_movk_i32 s60, 1152
    v_mul_lo_u32 v4, v2, s60
    v_lshl_add_u32 v4, v3, 4, v4
    v_lshlrev_b32 v5, 4, v1
    v_lshlrev_b32 v6, 13, v3
    v_lshl_add_u32 v6, v2, 4, v6
    v_lshl_add_u32 v40, v3, 4, v2
    s_movk_i32 s60, 2304
    v_mul_lo_u32 v40, v40, s60
    v_add_u32 v40, 1152, v40
    v_mov_b32 v41, 0x80000000
    v_cmp_gt_u32 vcc, 2, v3
    s_nop 1
    v_cndmask_b32 v7, v41, v40, vcc
    v_mov_b32 v40, 0x3f80
    v_mov_b32 v41, 0x3f800000
    v_and_b32 v42, 1, v2
    v_cmp_eq_u32 vcc, 1, v42
    s_nop 1
    v_cndmask_b32 v8, v40, v41, vcc
    s_and_b32 s68, s4, 1
    s_lshr_b32 s69, s4, 1
    v_lshlrev_b32 v40, 2, v3
    v_sub_u32 v40, v2, v40
    s_lshl_b32 s60, s68, 4
    v_add_u32 v40, s60, v40
    v_mov_b32 v41, 0xf149f2ca
    v_cmp_le_i32 vcc, 0, v40
    v_mov_b32 v42, 0
    s_nop 0
    v_cndmask_b32 v16, v41, v42, vcc
    v_cmp_le_i32 vcc, 1, v40
    v_mov_b32 v42, 0
    s_nop 0
    v_cndmask_b32 v17, v41, v42, vcc
    v_cmp_le_i32 vcc, 2, v40
    v_mov_b32 v42, 0
    s_nop 0
    v_cndmask_b32 v18, v41, v42, vcc
    v_cmp_le_i32 vcc, 3, v40
    v_mov_b32 v42, 0
    s_nop 0
    v_cndmask_b32 v19, v41, v42, vcc
    v_cmp_le_i32 vcc, 16, v40
    v_mov_b32 v42, 0
    s_nop 0
    v_cndmask_b32 v20, v41, v42, vcc
    v_cmp_le_i32 vcc, 17, v40
    v_mov_b32 v42, 0
    s_nop 0
    v_cndmask_b32 v21, v41, v42, vcc
    v_cmp_le_i32 vcc, 18, v40
    v_mov_b32 v42, 0
    s_nop 0
    v_cndmask_b32 v22, v41, v42, vcc
    v_cmp_le_i32 vcc, 19, v40
    v_mov_b32 v42, 0
    s_nop 0
    v_cndmask_b32 v23, v41, v42, vcc
    v_mov_b32 v24, 0x3f803f80
    v_mov_b32 v25, 0x3f803f80
    v_mov_b32 v26, 0x3f803f80
    v_mov_b32 v27, 0x3f803f80
    v_mov_b32 v28, 0x3f003f00
    v_mov_b32 v29, 0x3f003f00
    s_lshl_b32 s60, s68, 12
    s_add_u32 s60, s60, 114688
    v_add_u32 v11, s60, v5
    v_add_u32 v12, 73728, v5
    s_lshl_b32 s60, s69, 13
    v_add_u32 v13, s60, v12
    s_lshl_b32 s60, s68, 12
    s_lshl_b32 s61, s69, 11
    s_add_u32 s60, s60, s61
    s_add_u32 s60, s60, 122880
    v_add_u32 v14, s60, v5
    v_add_u32 v15, 122880, v5
    s_mov_b32 s24, s38
    s_mov_b32 s25, s39
    s_mov_b32 s26, 2359296
    s_mov_b32 s27, 0x00020000
    s_mov_b32 s28, s52
    s_mov_b32 s29, s53
    s_mov_b32 s30, 4718592
    s_mov_b32 s31, 0x00020000
    s_sub_u32 s71, s5, 1
    s_lshr_b32 s60, s4, 1
    s_mul_i32 s77, s60, 18432
    s_and_b32 s60, s4, 1
    s_mul_i32 s60, s60, 576
    s_add_u32 s77, s77, s60
    s_lshl_b32 s79, s6, 20
    s_lshl_b32 s60, s4, 12
    s_add_u32 s79, s79, s60
    s_add_u32 s79, s79, 1048576
    s_lshl_b32 s80, s6, 19
    s_lshl_b32 s60, s4, 11
    s_add_u32 s80, s80, s60
    s_add_u32 s80, s80, 35651584
    s_lshl_b32 s81, s6, 8
    s_add_u32 s81, s81, 8192
    s_lshl_b32 s82, s6, 8
    s_lshl_b32 s60, s4, 15
    s_add_u32 s82, s82, s60
    s_add_u32 s82, s82, 54525952
    s_mov_b32 s83, 0x3e0293ee
    s_lshl_b32 s74, s6, 2
    s_add_u32 s74, s74, s4
    s_lshr_b32 s34, s74, 3
    s_add_u32 s34, s34, 128
    s_mov_b64 s[32:33], -1
    v_lshrrev_b32 v31, 2, v5
    v_and_b32 v31, 127, v31
    v_mov_b32 v30, 0
    s_mov_b32 s72, 0
    s_mov_b32 s73, 0
    s_mul_i32 s66, s4, 9216
    s_lshl_b32 s67, s4, 12
    s_add_u32 s67, s67, 73728
    s_mul_i32 s76, s71, 36864
    s_add_u32 s76, s76, s77
    s_add_u32 m0, s66, 0
    s_add_u32 s64, s76, 0
    buffer_load_dwordx4 v4, s[24:27], s64 offen lds
    s_add_u32 m0, s66, 1024
    s_add_u32 s64, s76, 64
    buffer_load_dwordx4 v4, s[24:27], s64 offen lds
    s_add_u32 m0, s66, 2048
    s_add_u32 s64, s76, 128
    buffer_load_dwordx4 v4, s[24:27], s64 offen lds
    s_add_u32 m0, s66, 3072
    s_add_u32 s64, s76, 192
    buffer_load_dwordx4 v4, s[24:27], s64 offen lds
    s_add_u32 m0, s66, 4096
    s_add_u32 s64, s76, 256
    buffer_load_dwordx4 v4, s[24:27], s64 offen lds
    s_add_u32 m0, s66, 5120
    s_add_u32 s64, s76, 320
    buffer_load_dwordx4 v4, s[24:27], s64 offen lds
    s_add_u32 m0, s66, 6144
    s_add_u32 s64, s76, 384
    buffer_load_dwordx4 v4, s[24:27], s64 offen lds
    s_add_u32 m0, s66, 7168
    s_add_u32 s64, s76, 448
    buffer_load_dwordx4 v4, s[24:27], s64 offen lds
    s_add_u32 m0, s66, 8192
    s_add_u32 s64, s76, 512
    buffer_load_dwordx4 v4, s[24:27], s64 offen lds
    s_lshl_b32 s78, s71, 14
    s_add_u32 s78, s78, s79
    s_add_u32 m0, s67, 0
    s_add_u32 s64, s78, 0
    buffer_load_dwordx4 v5, s[8:11], s64 offen sc1 lds
    s_add_u32 m0, s67, 1024
    s_add_u32 s64, s78, 1024
    buffer_load_dwordx4 v5, s[8:11], s64 offen sc1 lds
    s_add_u32 m0, s67, 2048
    s_add_u32 s64, s78, 2048
    buffer_load_dwordx4 v5, s[8:11], s64 offen sc1 lds
    s_add_u32 m0, s67, 3072
    s_add_u32 s64, s78, 3072
    buffer_load_dwordx4 v5, s[8:11], s64 offen sc1 lds
    s_lshl_b32 s78, s71, 2
    s_add_u32 s78, s78, s81
    buffer_load_dword v9, off, s[8:11], s78 sc1
    s_waitcnt vmcnt(0)
    s_cmp_eq_u32 s7, 0
    s_cbranch_scc1 L_x2slow_96
L_x2_97:
    s_barrier
    s_mov_b32 s70, 0
    s_cmp_lt_u32 s71, 61
    s_cbranch_scc1 L_nfill_100
    s_mov_b64 s[32:33], 0
    s_sub_u32 s61, s71, 6
    s_max_i32 s61, s61, 0
    s_lshl_b32 s61, s61, 7
    s_add_u32 s61, s61, 16384
    buffer_load_dword v30, v31, s[8:11], s61 offen sc1
    s_mul_i32 s60, s71, 1179648
    s_add_u32 s60, s60, s82
    v_mov_b32 v48, -1
    v_mov_b32 v49, -1
    v_mov_b32 v50, -1
    v_mov_b32 v51, -1
    buffer_store_dwordx4 v[48:51], v6, s[8:11], s60 offen
    s_add_u32 s60, s60, 131072
    buffer_store_dwordx4 v[48:51], v6, s[8:11], s60 offen
    s_add_u32 s60, s60, 131072
    buffer_store_dwordx4 v[48:51], v6, s[8:11], s60 offen
    s_add_u32 s60, s60, 131072
    buffer_store_dwordx4 v[48:51], v6, s[8:11], s60 offen
    s_add_u32 s60, s60, 131072
    buffer_store_dwordx4 v[48:51], v6, s[8:11], s60 offen
    s_add_u32 s60, s60, 131072
    buffer_store_dwordx4 v[48:51], v6, s[8:11], s60 offen
    s_add_u32 s60, s60, 131072
    buffer_store_dwordx4 v[48:51], v6, s[8:11], s60 offen
    s_add_u32 s60, s60, 131072
    buffer_store_dwordx4 v[48:51], v6, s[8:11], s60 offen
    s_add_u32 s60, s60, 131072
    buffer_store_dwordx4 v[48:51], v6, s[8:11], s60 offen
L_nfill_100:
    s_cmp_ge_u32 s71, 58
    s_cbranch_scc1 L_ne_99
    v_cmp_ne_u32 vcc, 1, v9
    s_cbranch_vccnz L_ne_99
    s_lshl_b32 s64, s71, 13
    s_add_u32 s64, s64, s80
    s_lshl_b32 s65, s4, 11
    s_add_u32 m0, s65, 106496
    s_nop 0
    buffer_load_dwordx4 v5, s[8:11], s64 offen sc1 lds
    s_add_u32 m0, s65, 107520
    s_add_u32 s64, s64, 1024
    buffer_load_dwordx4 v5, s[8:11], s64 offen sc1 lds
    s_mov_b32 s70, 1
L_ne_99:
    s_add_u32 s78, s71, 3
    s_min_u32 s78, s78, 63
    s_mul_i32 s76, s78, 36864
    s_add_u32 s76, s76, s77
    s_lshl_b32 s78, s78, 14
    s_add_u32 s78, s78, s79
    s_sub_u32 s66, 36864, s72
    s_mul_i32 s60, s4, 9216
    s_add_u32 s66, s66, s60
    s_xor_b32 s67, s73, 16384
    s_lshl_b32 s60, s4, 12
    s_add_u32 s67, s67, s60
    s_add_u32 s67, s67, 73728
    v_add_u32 v10, s72, v5
    ds_read_b128 v[32:35], v10 offset:0
    ds_read_b128 v[36:39], v10 offset:18432
    ds_read_b128 v[40:43], v10 offset:1024
    ds_read_b128 v[44:47], v10 offset:19456
    s_waitcnt lgkmcnt(2)
    s_mov_b64 exec, s[32:33]
    s_add_u32 m0, s66, 0
    s_add_u32 s64, s76, 0
    buffer_load_dwordx4 v4, s[24:27], s64 offen lds
    s_mov_b64 exec, -1
    v_mfma_f32_16x16x32_bf16 v[48:51], a[0:3], v[32:35], 0
    v_mfma_f32_16x16x32_bf16 v[56:59], a[0:3], v[36:39], 0
    v_mfma_f32_16x16x32_bf16 v[52:55], a[72:75], v[32:35], 0
    v_mfma_f32_16x16x32_bf16 v[60:63], a[72:75], v[36:39], 0
    ds_read_b128 v[32:35], v10 offset:2048
    ds_read_b128 v[36:39], v10 offset:20480
    s_waitcnt lgkmcnt(2)
    s_mov_b64 exec, s[32:33]
    s_add_u32 m0, s66, 1024
    s_add_u32 s64, s76, 64
    buffer_load_dwordx4 v4, s[24:27], s64 offen lds
    s_mov_b64 exec, -1
    v_mfma_f32_16x16x32_bf16 v[48:51], a[4:7], v[40:43], v[48:51]
    v_mfma_f32_16x16x32_bf16 v[56:59], a[4:7], v[44:47], v[56:59]
    v_mfma_f32_16x16x32_bf16 v[52:55], a[76:79], v[40:43], v[52:55]
    v_mfma_f32_16x16x32_bf16 v[60:63], a[76:79], v[44:47], v[60:63]
    ds_read_b128 v[40:43], v10 offset:3072
    ds_read_b128 v[44:47], v10 offset:21504
    s_waitcnt lgkmcnt(2)
    s_mov_b64 exec, s[32:33]
    s_add_u32 m0, s66, 2048
    s_add_u32 s64, s76, 128
    buffer_load_dwordx4 v4, s[24:27], s64 offen lds
    s_mov_b64 exec, -1
    v_mfma_f32_16x16x32_bf16 v[48:51], a[8:11], v[32:35], v[48:51]
    v_mfma_f32_16x16x32_bf16 v[56:59], a[8:11], v[36:39], v[56:59]
    v_mfma_f32_16x16x32_bf16 v[52:55], a[80:83], v[32:35], v[52:55]
    v_mfma_f32_16x16x32_bf16 v[60:63], a[80:83], v[36:39], v[60:63]
    ds_read_b128 v[32:35], v10 offset:4096
    ds_read_b128 v[36:39], v10 offset:22528
    s_waitcnt lgkmcnt(2)
    s_mov_b64 exec, s[32:33]
    s_add_u32 m0, s66, 3072
    s_add_u32 s64, s76, 192
    buffer_load_dwordx4 v4, s[24:27], s64 offen lds
    s_mov_b64 exec, -1
    v_mfma_f32_16x16x32_bf16 v[48:51], a[12:15], v[40:43], v[48:51]
    v_mfma_f32_16x16x32_bf16 v[56:59], a[12:15], v[44:47], v[56:59]
    v_mfma_f32_16x16x32_bf16 v[52:55], a[84:87], v[40:43], v[52:55]
    v_mfma_f32_16x16x32_bf16 v[60:63], a[84:87], v[44:47], v[60:63]
    ds_read_b128 v[40:43], v10 offset:5120
    ds_read_b128 v[44:47], v10 offset:23552
    s_waitcnt lgkmcnt(2)
    s_mov_b64 exec, s[32:33]
    s_add_u32 m0, s66, 4096
    s_add_u32 s64, s76, 256
    buffer_load_dwordx4 v4, s[24:27], s64 offen lds
    s_mov_b64 exec, -1
    v_mfma_f32_16x16x32_bf16 v[48:51], a[16:19], v[32:35], v[48:51]
    v_mfma_f32_16x16x32_bf16 v[56:59], a[16:19], v[36:39], v[56:59]
    v_mfma_f32_16x16x32_bf16 v[52:55], a[88:91], v[32:35], v[52:55]
    v_mfma_f32_16x16x32_bf16 v[60:63], a[88:91], v[36:39], v[60:63]
    ds_read_b128 v[32:35], v10 offset:6144
    ds_read_b128 v[36:39], v10 offset:24576
    s_waitcnt lgkmcnt(2)
    s_mov_b64 exec, s[32:33]
    s_add_u32 m0, s66, 5120
    s_add_u32 s64, s76, 320
    buffer_load_dwordx4 v4, s[24:27], s64 offen lds
    s_mov_b64 exec, -1
    v_mfma_f32_16x16x32_bf16 v[48:51], a[20:23], v[40:43], v[48:51]
    v_mfma_f32_16x16x32_bf16 v[56:59], a[20:23], v[44:47], v[56:59]
    v_mfma_f32_16x16x32_bf16 v[52:55], a[92:95], v[40:43], v[52:55]
    v_mfma_f32_16x16x32_bf16 v[60:63], a[92:95], v[44:47], v[60:63]
    ds_read_b128 v[40:43], v10 offset:7168
    ds_read_b128 v[44:47], v10 offset:25600
    s_waitcnt lgkmcnt(2)
    s_mov_b64 exec, s[32:33]
    s_add_u32 m0, s66, 6144
    s_add_u32 s64, s76, 384
    buffer_load_dwordx4 v4, s[24:27], s64 offen lds
    s_mov_b64 exec, -1
    v_mfma_f32_16x16x32_bf16 v[48:51], a[24:27], v[32:35], v[48:51]
    v_mfma_f32_16x16x32_bf16 v[56:59], a[24:27], v[36:39], v[56:59]
    v_mfma_f32_16x16x32_bf16 v[52:55], a[96:99], v[32:35], v[52:55]
    v_mfma_f32_16x16x32_bf16 v[60:63], a[96:99], v[36:39], v[60:63]
    ds_read_b128 v[32:35], v10 offset:8192
    ds_read_b128 v[36:39], v10 offset:26624
    s_waitcnt lgkmcnt(2)
    s_mov_b64 exec, s[32:33]
    s_add_u32 m0, s66, 7168
    s_add_u32 s64, s76, 448
    buffer_load_dwordx4 v4, s[24:27], s64 offen lds
    s_mov_b64 exec, -1
    v_mfma_f32_16x16x32_bf16 v[48:51], a[28:31], v[40:43], v[48:51]
    v_mfma_f32_16x16x32_bf16 v[56:59], a[28:31], v[44:47], v[56:59]
    v_mfma_f32_16x16x32_bf16 v[52:55], a[100:103], v[40:43], v[52:55]
    v_mfma_f32_16x16x32_bf16 v[60:63], a[100:103], v[44:47], v[60:63]
    ds_read_b128 v[40:43], v10 offset:9216
    ds_read_b128 v[44:47], v10 offset:27648
    s_waitcnt lgkmcnt(2)
    s_mov_b64 exec, s[32:33]
    s_add_u32 m0, s66, 8192
    s_add_u32 s64, s76, 512
    buffer_load_dwordx4 v4, s[24:27], s64 offen lds
    s_mov_b64 exec, -1
    v_mfma_f32_16x16x32_bf16 v[48:51], a[32:35], v[32:35], v[48:51]
    v_mfma_f32_16x16x32_bf16 v[56:59], a[32:35], v[36:39], v[56:59]
    v_mfma_f32_16x16x32_bf16 v[52:55], a[104:107], v[32:35], v[52:55]
    v_mfma_f32_16x16x32_bf16 v[60:63], a[104:107], v[36:39], v[60:63]
    ds_read_b128 v[32:35], v10 offset:10240
    ds_read_b128 v[36:39], v10 offset:28672
    s_waitcnt lgkmcnt(2)
    s_mov_b64 exec, s[32:33]
    s_add_u32 m0, s67, 0
    s_add_u32 s64, s78, 0
    buffer_load_dwordx4 v5, s[8:11], s64 offen sc1 lds
    s_mov_b64 exec, -1
    v_mfma_f32_16x16x32_bf16 v[48:51], a[36:39], v[40:43], v[48:51]
    v_mfma_f32_16x16x32_bf16 v[56:59], a[36:39], v[44:47], v[56:59]
    v_mfma_f32_16x16x32_bf16 v[52:55], a[108:111], v[40:43], v[52:55]
    v_mfma_f32_16x16x32_bf16 v[60:63], a[108:111], v[44:47], v[60:63]
    ds_read_b128 v[40:43], v10 offset:11264
    ds_read_b128 v[44:47], v10 offset:29696
    s_waitcnt lgkmcnt(2)
    s_mov_b64 exec, s[32:33]
    s_add_u32 m0, s67, 1024
    s_add_u32 s64, s78, 1024
    buffer_load_dwordx4 v5, s[8:11], s64 offen sc1 lds
    s_mov_b64 exec, -1
    v_mfma_f32_16x16x32_bf16 v[48:51], a[40:43], v[32:35], v[48:51]
    v_mfma_f32_16x16x32_bf16 v[56:59], a[40:43], v[36:39], v[56:59]
    v_mfma_f32_16x16x32_bf16 v[52:55], a[112:115], v[32:35], v[52:55]
    v_mfma_f32_16x16x32_bf16 v[60:63], a[112:115], v[36:39], v[60:63]
    ds_read_b128 v[32:35], v10 offset:12288
    ds_read_b128 v[36:39], v10 offset:30720
    s_waitcnt lgkmcnt(2)
    s_mov_b64 exec, s[32:33]
    s_add_u32 m0, s67, 2048
    s_add_u32 s64, s78, 2048
    buffer_load_dwordx4 v5, s[8:11], s64 offen sc1 lds
    s_mov_b64 exec, -1
    v_mfma_f32_16x16x32_bf16 v[48:51], a[44:47], v[40:43], v[48:51]
    v_mfma_f32_16x16x32_bf16 v[56:59], a[44:47], v[44:47], v[56:59]
    v_mfma_f32_16x16x32_bf16 v[52:55], a[116:119], v[40:43], v[52:55]
    v_mfma_f32_16x16x32_bf16 v[60:63], a[116:119], v[44:47], v[60:63]
    ds_read_b128 v[40:43], v10 offset:13312
    ds_read_b128 v[44:47], v10 offset:31744
    s_waitcnt lgkmcnt(2)
    s_mov_b64 exec, s[32:33]
    s_add_u32 m0, s67, 3072
    s_add_u32 s64, s78, 3072
    buffer_load_dwordx4 v5, s[8:11], s64 offen sc1 lds
    s_mov_b64 exec, -1
    v_mfma_f32_16x16x32_bf16 v[48:51], a[48:51], v[32:35], v[48:51]
    v_mfma_f32_16x16x32_bf16 v[56:59], a[48:51], v[36:39], v[56:59]
    v_mfma_f32_16x16x32_bf16 v[52:55], a[120:123], v[32:35], v[52:55]
    v_mfma_f32_16x16x32_bf16 v[60:63], a[120:123], v[36:39], v[60:63]
    ds_read_b128 v[32:35], v10 offset:14336
    ds_read_b128 v[36:39], v10 offset:32768
    s_waitcnt lgkmcnt(2)
    v_mfma_f32_16x16x32_bf16 v[48:51], a[52:55], v[40:43], v[48:51]
    v_mfma_f32_16x16x32_bf16 v[56:59], a[52:55], v[44:47], v[56:59]
    v_mfma_f32_16x16x32_bf16 v[52:55], a[124:127], v[40:43], v[52:55]
    v_mfma_f32_16x16x32_bf16 v[60:63], a[124:127], v[44:47], v[60:63]
    ds_read_b128 v[40:43], v10 offset:15360
    ds_read_b128 v[44:47], v10 offset:33792
    s_waitcnt lgkmcnt(2)
    v_mfma_f32_16x16x32_bf16 v[48:51], a[56:59], v[32:35], v[48:51]
    v_mfma_f32_16x16x32_bf16 v[56:59], a[56:59], v[36:39], v[56:59]
    v_mfma_f32_16x16x32_bf16 v[52:55], a[128:131], v[32:35], v[52:55]
    v_mfma_f32_16x16x32_bf16 v[60:63], a[128:131], v[36:39], v[60:63]
    ds_read_b128 v[32:35], v10 offset:16384
    ds_read_b128 v[36:39], v10 offset:34816
    s_waitcnt lgkmcnt(2)
    v_mfma_f32_16x16x32_bf16 v[48:51], a[60:63], v[40:43], v[48:51]
    v_mfma_f32_16x16x32_bf16 v[56:59], a[60:63], v[44:47], v[56:59]
    v_mfma_f32_16x16x32_bf16 v[52:55], a[132:135], v[40:43], v[52:55]
    v_mfma_f32_16x16x32_bf16 v[60:63], a[132:135], v[44:47], v[60:63]
    ds_read_b128 v[40:43], v10 offset:17408
    ds_read_b128 v[44:47], v10 offset:35840
    s_waitcnt lgkmcnt(2)
    v_mfma_f32_16x16x32_bf16 v[48:51], a[64:67], v[32:35], v[48:51]
    v_mfma_f32_16x16x32_bf16 v[56:59], a[64:67], v[36:39], v[56:59]
    v_mfma_f32_16x16x32_bf16 v[52:55], a[136:139], v[32:35], v[52:55]
    v_mfma_f32_16x16x32_bf16 v[60:63], a[136:139], v[36:39], v[60:63]
    s_waitcnt lgkmcnt(0)
    v_mfma_f32_16x16x32_bf16 v[48:51], a[68:71], v[40:43], v[48:51]
    v_mfma_f32_16x16x32_bf16 v[56:59], a[68:71], v[44:47], v[56:59]
    v_mfma_f32_16x16x32_bf16 v[52:55], a[140:143], v[40:43], v[52:55]
    v_mfma_f32_16x16x32_bf16 v[60:63], a[140:143], v[44:47], v[60:63]
    s_nop 4
    v_cvt_pk_bf16_f32 v48, v48, v49
    v_cvt_pk_bf16_f32 v49, v50, v51
    v_cvt_pk_bf16_f32 v50, v52, v53
    v_cvt_pk_bf16_f32 v51, v54, v55
    v_cvt_pk_bf16_f32 v56, v56, v57
    v_cvt_pk_bf16_f32 v57, v58, v59
    v_cvt_pk_bf16_f32 v58, v60, v61
    v_cvt_pk_bf16_f32 v59, v62, v63
    s_lshl_b32 s60, s4, 10
    s_add_u32 s60, s60, 114688
    v_add_u32 v32, s60, v5
    ds_write_b128 v32, v[48:51]
    ds_write_b128 v32, v[56:59] offset:4096
    s_cmp_eq_u32 s70, 0
    s_cbranch_scc1 L_late_102
    s_waitcnt vmcnt(13) lgkmcnt(0)
    s_branch L_rdy_101
L_late_102:
    s_cmp_lt_u32 s71, 58
    s_cbranch_scc1 L_flg_103
    s_cmp_lt_u32 s71, 61
    s_cbranch_scc1 L_dpl_104
    s_sub_u32 s78, s71, 6
    s_sub_u32 s76, s71, 3
    s_waitcnt vmcnt(0)
    s_barrier
    s_cmp_lt_u32 s71, 3
    s_cbranch_scc1 L_np_105
    s_cmp_lg_u32 s4, 0
    s_cbranch_scc1 L_np_105
    s_sub_u32 s60, s71, 3
    s_lshl_b32 s60, s60, 7
    s_lshl_b32 s61, s6, 2
    s_add_u32 s60, s60, s61
    s_add_u32 s60, s60, 16384
    v_mov_b32 v32, 1
    s_mov_b64 exec, 1
    buffer_store_dword v32, off, s[8:11], s60
    s_mov_b64 exec, -1
L_np_105:
    v_cmp_ne_u32 vcc, 1, v30
    s_cbranch_vccz L_xok_106
    s_lshl_b32 s61, s78, 7
    s_add_u32 s61, s61, 16384
    s_mov_b32 s59, 0
L_xrs_107:
    buffer_load_dword v30, v31, s[8:11], s61 offen sc1
    s_waitcnt vmcnt(0)
    v_cmp_ne_u32 vcc, 1, v30
    s_cbranch_vccz L_xrs_ok_108
    s_add_u32 s59, s59, 1
    s_cmp_lt_u32 s59, s58
    s_cbranch_scc1 L_xrs_107
    s_mov_b32 s58, 0
L_xrs_ok_108:
L_xok_106:
    s_mul_i32 s61, s78, 1179648
    s_lshl_b32 s64, s74, 13
    s_add_u32 s61, s61, s64
    s_add_u32 s61, s61, 54525952
    buffer_load_dwordx4 v[160:163], v5, s[8:11], s61 offen offset:0
    buffer_load_dwordx4 v[164:167], v5, s[8:11], s61 offen offset:1024
    buffer_load_dwordx4 v[168:171], v5, s[8:11], s61 offen offset:2048
    buffer_load_dwordx4 v[172:175], v5, s[8:11], s61 offen offset:3072
    s_add_u32 s61, s61, 4096
    buffer_load_dwordx4 v[176:179], v5, s[8:11], s61 offen offset:0
    buffer_load_dwordx4 v[180:183], v5, s[8:11], s61 offen offset:1024
    buffer_load_dwordx4 v[184:187], v5, s[8:11], s61 offen offset:2048
    buffer_load_dwordx4 v[188:191], v5, s[8:11], s61 offen offset:3072
    s_mov_b32 s75, 1
    s_and_b32 s64, s74, 7
    s_cbranch_scc1 L_u2_109
    s_mul_i32 s61, s78, 1179648
    s_lshl_b32 s64, s34, 13
    s_add_u32 s61, s61, s64
    s_add_u32 s61, s61, 54525952
    buffer_load_dwordx4 v[192:195], v5, s[8:11], s61 offen offset:0
    buffer_load_dwordx4 v[196:199], v5, s[8:11], s61 offen offset:1024
    buffer_load_dwordx4 v[200:203], v5, s[8:11], s61 offen offset:2048
    buffer_load_dwordx4 v[204:207], v5, s[8:11], s61 offen offset:3072
    s_add_u32 s61, s61, 4096
    buffer_load_dwordx4 v[208:211], v5, s[8:11], s61 offen offset:0
    buffer_load_dwordx4 v[212:215], v5, s[8:11], s61 offen offset:1024
    buffer_load_dwordx4 v[216:219], v5, s[8:11], s61 offen offset:2048
    buffer_load_dwordx4 v[220:223], v5, s[8:11], s61 offen offset:3072
    s_mov_b32 s75, 2
L_u2_109:
    s_lshl_b32 s61, s76, 7
    s_add_u32 s61, s61, 16384
    s_mov_b32 s59, 0
L_xrs2_110:
    buffer_load_dword v30, v31, s[8:11], s61 offen sc1
    s_waitcnt vmcnt(0)
    v_cmp_ne_u32 vcc, 1, v30
    s_cbranch_vccz L_xrs2_ok_111
    s_add_u32 s59, s59, 1
    s_cmp_lt_u32 s59, s58
    s_cbranch_scc1 L_xrs2_110
    s_mov_b32 s58, 0
L_xrs2_ok_111:
    s_mul_i32 s61, s76, 1179648
    s_lshl_b32 s64, s74, 13
    s_add_u32 s61, s61, s64
    s_add_u32 s61, s61, 54525952
    buffer_load_dwordx4 v[64:67], v5, s[8:11], s61 offen offset:0
    buffer_load_dwordx4 v[68:71], v5, s[8:11], s61 offen offset:1024
    buffer_load_dwordx4 v[72:75], v5, s[8:11], s61 offen offset:2048
    buffer_load_dwordx4 v[76:79], v5, s[8:11], s61 offen offset:3072
    s_add_u32 s61, s61, 4096
    buffer_load_dwordx4 v[80:83], v5, s[8:11], s61 offen offset:0
    buffer_load_dwordx4 v[84:87], v5, s[8:11], s61 offen offset:1024
    buffer_load_dwordx4 v[88:91], v5, s[8:11], s61 offen offset:2048
    buffer_load_dwordx4 v[92:95], v5, s[8:11], s61 offen offset:3072
    s_mov_b32 s75, 1
    s_and_b32 s64, s74, 7
    s_cbranch_scc1 L_u2_112
    s_mul_i32 s61, s76, 1179648
    s_lshl_b32 s64, s34, 13
    s_add_u32 s61, s61, s64
    s_add_u32 s61, s61, 54525952
    buffer_load_dwordx4 v[96:99], v5, s[8:11], s61 offen offset:0
    buffer_load_dwordx4 v[100:103], v5, s[8:11], s61 offen offset:1024
    buffer_load_dwordx4 v[104:107], v5, s[8:11], s61 offen offset:2048
    buffer_load_dwordx4 v[108:111], v5, s[8:11], s61 offen offset:3072
    s_add_u32 s61, s61, 4096
    buffer_load_dwordx4 v[112:115], v5, s[8:11], s61 offen offset:0
    buffer_load_dwordx4 v[116:119], v5, s[8:11], s61 offen offset:1024
    buffer_load_dwordx4 v[120:123], v5, s[8:11], s61 offen offset:2048
    buffer_load_dwordx4 v[124:127], v5, s[8:11], s61 offen offset:3072
    s_mov_b32 s75, 2
L_u2_112:
    s_mov_b32 s62, 0x00030003
    s_mov_b32 s63, 0x00030003
    v_cndmask_b32 v128, 0, v8, s[62:63]
    s_lshl_b64 s[62:63], s[62:63], 2
    v_cndmask_b32 v129, 0, v8, s[62:63]
    s_lshl_b64 s[62:63], s[62:63], 2
    v_cndmask_b32 v130, 0, v8, s[62:63]
    s_lshl_b64 s[62:63], s[62:63], 2
    v_cndmask_b32 v131, 0, v8, s[62:63]
    s_nop 1
    v_mfma_f32_16x16x32_bf16 v[132:135], v[128:131], v[160:163], 0
    v_mfma_f32_16x16x32_bf16 v[132:135], v[128:131], v[164:167], v[132:135]
    v_mfma_f32_16x16x32_bf16 v[132:135], v[128:131], v[168:171], v[132:135]
    v_mfma_f32_16x16x32_bf16 v[132:135], v[128:131], v[172:175], v[132:135]
    v_mfma_f32_16x16x32_bf16 v[132:135], v[128:131], v[176:179], v[132:135]
    v_mfma_f32_16x16x32_bf16 v[132:135], v[128:131], v[180:183], v[132:135]
    v_mfma_f32_16x16x32_bf16 v[132:135], v[128:131], v[184:187], v[132:135]
    v_mfma_f32_16x16x32_bf16 v[132:135], v[128:131], v[188:191], v[132:135]
    s_mul_i32 s61, s78, 73728
    s_lshl_b32 s64, s74, 3
    s_add_u32 s61, s61, s64
    s_nop 4
    v_cvt_pk_bf16_f32 v132, v132, v133
    v_cvt_pk_bf16_f32 v133, v134, v135
    buffer_store_dwordx2 v[132:133], v7, s[28:31], s61 offen
    s_cmp_lt_u32 s75, 2
    s_cbranch_scc1 L_f2_113
    v_mfma_f32_16x16x32_bf16 v[132:135], v[128:131], v[192:195], 0
    v_mfma_f32_16x16x32_bf16 v[132:135], v[128:131], v[196:199], v[132:135]
    v_mfma_f32_16x16x32_bf16 v[132:135], v[128:131], v[200:203], v[132:135]
    v_mfma_f32_16x16x32_bf16 v[132:135], v[128:131], v[204:207], v[132:135]
    v_mfma_f32_16x16x32_bf16 v[132:135], v[128:131], v[208:211], v[132:135]
    v_mfma_f32_16x16x32_bf16 v[132:135], v[128:131], v[212:215], v[132:135]
    v_mfma_f32_16x16x32_bf16 v[132:135], v[128:131], v[216:219], v[132:135]
    v_mfma_f32_16x16x32_bf16 v[132:135], v[128:131], v[220:223], v[132:135]
    s_mul_i32 s61, s78, 73728
    s_lshl_b32 s64, s34, 3
    s_add_u32 s61, s61, s64
    s_nop 4
    v_cvt_pk_bf16_f32 v132, v132, v133
    v_cvt_pk_bf16_f32 v133, v134, v135
    buffer_store_dwordx2 v[132:133], v7, s[28:31], s61 offen
L_f2_113:
    s_waitcnt vmcnt(1)
    s_lshl_b32 s78, s71, 13
    s_add_u32 s78, s78, s80
    s_lshl_b32 s60, s4, 11
    s_add_u32 s60, s60, 106496
    v_add_u32 v153, s60, v5
    buffer_load_dwordx4 v[144:147], v5, s[8:11], s78 offen offset:0 sc1
    buffer_load_dwordx4 v[148:151], v5, s[8:11], s78 offen offset:1024 sc1
    s_mov_b32 s62, 0x00030003
    s_mov_b32 s63, 0x00030003
    v_cndmask_b32 v128, 0, v8, s[62:63]
    s_lshl_b64 s[62:63], s[62:63], 2
    v_cndmask_b32 v129, 0, v8, s[62:63]
    s_lshl_b64 s[62:63], s[62:63], 2
    v_cndmask_b32 v130, 0, v8, s[62:63]
    s_lshl_b64 s[62:63], s[62:63], 2
    v_cndmask_b32 v131, 0, v8, s[62:63]
    s_nop 1
    v_mfma_f32_16x16x32_bf16 v[132:135], v[128:131], v[64:67], 0
    v_mfma_f32_16x16x32_bf16 v[132:135], v[128:131], v[68:71], v[132:135]
    v_mfma_f32_16x16x32_bf16 v[132:135], v[128:131], v[72:75], v[132:135]
    v_mfma_f32_16x16x32_bf16 v[132:135], v[128:131], v[76:79], v[132:135]
    v_mfma_f32_16x16x32_bf16 v[132:135], v[128:131], v[80:83], v[132:135]
    v_mfma_f32_16x16x32_bf16 v[132:135], v[128:131], v[84:87], v[132:135]
    v_mfma_f32_16x16x32_bf16 v[132:135], v[128:131], v[88:91], v[132:135]
    v_mfma_f32_16x16x32_bf16 v[132:135], v[128:131], v[92:95], v[132:135]
    s_mul_i32 s61, s76, 73728
    s_lshl_b32 s64, s74, 3
    s_add_u32 s61, s61, s64
    s_nop 4
    v_cvt_pk_bf16_f32 v132, v132, v133
    v_cvt_pk_bf16_f32 v133, v134, v135
    buffer_store_dwordx2 v[132:133], v7, s[28:31], s61 offen
    s_cmp_lt_u32 s75, 2
    s_cbranch_scc1 L_f2_115
    v_mfma_f32_16x16x32_bf16 v[132:135], v[128:131], v[96:99], 0
    v_mfma_f32_16x16x32_bf16 v[132:135], v[128:131], v[100:103], v[132:135]
    v_mfma_f32_16x16x32_bf16 v[132:135], v[128:131], v[104:107], v[132:135]
    v_mfma_f32_16x16x32_bf16 v[132:135], v[128:131], v[108:111], v[132:135]
    v_mfma_f32_16x16x32_bf16 v[132:135], v[128:131], v[112:115], v[132:135]
    v_mfma_f32_16x16x32_bf16 v[132:135], v[128:131], v[116:119], v[132:135]
    v_mfma_f32_16x16x32_bf16 v[132:135], v[128:131], v[120:123], v[132:135]
    v_mfma_f32_16x16x32_bf16 v[132:135], v[128:131], v[124:127], v[132:135]
    s_mul_i32 s61, s76, 73728
    s_lshl_b32 s64, s34, 3
    s_add_u32 s61, s61, s64
    s_nop 4
    v_cvt_pk_bf16_f32 v132, v132, v133
    v_cvt_pk_bf16_f32 v133, v134, v135
    buffer_store_dwordx2 v[132:133], v7, s[28:31], s61 offen
L_f2_115:
    s_waitcnt vmcnt(1)
    v_max3_u32 v152, v144, v145, v146
    v_max3_u32 v152, v152, v147, v148
    v_max3_u32 v152, v152, v149, v150
    v_max_u32 v152, v152, v151
    v_cmp_eq_u32 vcc, -1, v152
    s_cbranch_vccz L_mkgot_114
L_dpl_104:
    s_lshl_b32 s78, s71, 13
    s_add_u32 s78, s78, s80
    s_lshl_b32 s60, s4, 11
    s_add_u32 s60, s60, 106496
    v_add_u32 v153, s60, v5
    s_mov_b32 s59, 0
L_mkd_116:
    buffer_load_dwordx4 v[144:147], v5, s[8:11], s78 offen offset:0 sc1
    buffer_load_dwordx4 v[148:151], v5, s[8:11], s78 offen offset:1024 sc1
    s_waitcnt vmcnt(0)
    v_max3_u32 v152, v144, v145, v146
    v_max3_u32 v152, v152, v147, v148
    v_max3_u32 v152, v152, v149, v150
    v_max_u32 v152, v152, v151
    v_cmp_eq_u32 vcc, -1, v152
    s_cbranch_vccz L_mkd_ok_117
    s_add_u32 s59, s59, 1
    s_cmp_lt_u32 s59, s58
    s_cbranch_scc1 L_mkd_116
    s_mov_b32 s58, 0
L_mkd_ok_117:
L_mkgot_114:
    ds_write_b128 v153, v[144:147]
    ds_write_b128 v153, v[148:151] offset:1024
    s_waitcnt lgkmcnt(0)
    s_branch L_rdy_101
L_flg_103:
    s_lshl_b32 s78, s71, 2
    s_add_u32 s78, s78, s81
    s_mov_b32 s59, 0
L_mk_118:
    buffer_load_dword v9, off, s[8:11], s78 sc1
    s_waitcnt vmcnt(0)
    v_cmp_ne_u32 vcc, 1, v9
    s_cbranch_vccz L_mk_ok_119
    s_add_u32 s59, s59, 1
    s_cmp_lt_u32 s59, s58
    s_cbranch_scc1 L_mk_118
    s_mov_b32 s58, 0
L_mk_ok_119:
    s_lshl_b32 s64, s71, 13
    s_add_u32 s64, s64, s80
    s_lshl_b32 s65, s4, 11
    s_add_u32 m0, s65, 106496
    s_nop 0
    buffer_load_dwordx4 v5, s[8:11], s64 offen sc1 lds
    s_add_u32 m0, s65, 107520
    s_add_u32 s64, s64, 1024
    buffer_load_dwordx4 v5, s[8:11], s64 offen sc1 lds
    s_waitcnt vmcnt(0) lgkmcnt(0)
L_rdy_101:
    s_barrier
    s_cmp_lt_u32 s71, 3
    s_cbranch_scc1 L_np_120
    s_cmp_lg_u32 s4, 0
    s_cbranch_scc1 L_np_120
    s_sub_u32 s60, s71, 3
    s_lshl_b32 s60, s60, 7
    s_lshl_b32 s61, s6, 2
    s_add_u32 s60, s60, s61
    s_add_u32 s60, s60, 16384
    v_mov_b32 v32, 1
    s_mov_b64 exec, 1
    buffer_store_dword v32, off, s[8:11], s60
    s_mov_b64 exec, -1
L_np_120:
    s_add_u32 s60, s71, 3
    s_min_u32 s60, s60, 63
    s_lshl_b32 s60, s60, 2
    s_add_u32 s60, s60, s81
    buffer_load_dword v9, off, s[8:11], s60 sc1
    s_sub_u32 s61, s71, 6
    s_max_i32 s61, s61, 0
    s_lshl_b32 s61, s61, 7
    s_add_u32 s61, s61, 16384
    buffer_load_dword v30, v31, s[8:11], s61 offen sc1
    v_add_u32 v32, s73, v12
    v_add_u32 v33, s73, v13
    v_add_u32 v34, 106496, v5
    s_lshl_b32 s60, s69, 12
    v_add_u32 v35, s60, v34
    ds_read_b128 v[64:67], v11 offset:0
    ds_read_b128 v[68:71], v11 offset:1024
    ds_read_b128 v[72:75], v11 offset:2048
    ds_read_b128 v[76:79], v11 offset:3072
    ds_read_b128 v[80:83], v32 offset:0
    ds_read_b128 v[84:87], v32 offset:1024
    ds_read_b128 v[88:91], v32 offset:4096
    ds_read_b128 v[92:95], v32 offset:5120
    ds_read_b128 v[96:99], v32 offset:8192
    ds_read_b128 v[100:103], v32 offset:9216
    ds_read_b128 v[104:107], v32 offset:12288
    ds_read_b128 v[108:111], v32 offset:13312
    ds_read_b128 v[144:147], v34 offset:0
    ds_read_b128 v[148:151], v34 offset:2048
    ds_read_b128 v[152:155], v34 offset:4096
    ds_read_b128 v[156:159], v34 offset:6144
    s_waitcnt lgkmcnt(10)
    v_mfma_f32_16x16x32_bf16 v[112:115], v[80:83], v[64:67], v[16:19]
    v_mfma_f32_16x16x32_bf16 v[116:119], v[84:87], v[64:67], v[20:23]
    s_waitcnt lgkmcnt(8)
    v_mfma_f32_16x16x32_bf16 v[112:115], v[88:91], v[68:71], v[112:115]
    v_mfma_f32_16x16x32_bf16 v[116:119], v[92:95], v[68:71], v[116:119]
    s_waitcnt lgkmcnt(6)
    v_mfma_f32_16x16x32_bf16 v[112:115], v[96:99], v[72:75], v[112:115]
    v_mfma_f32_16x16x32_bf16 v[116:119], v[100:103], v[72:75], v[116:119]
    s_waitcnt lgkmcnt(4)
    v_mfma_f32_16x16x32_bf16 v[112:115], v[104:107], v[76:79], v[112:115]
    v_mfma_f32_16x16x32_bf16 v[116:119], v[108:111], v[76:79], v[116:119]
    s_waitcnt lgkmcnt(3)
    v_mfma_f32_16x16x32_bf16 v[120:123], v[144:147], v[64:67], 0
    s_waitcnt lgkmcnt(2)
    v_mfma_f32_16x16x32_bf16 v[120:123], v[148:151], v[68:71], v[120:123]
    s_waitcnt lgkmcnt(1)
    v_mfma_f32_16x16x32_bf16 v[120:123], v[152:155], v[72:75], v[120:123]
    s_waitcnt lgkmcnt(0)
    v_mfma_f32_16x16x32_bf16 v[120:123], v[156:159], v[76:79], v[120:123]
    ds_read_b128 v[160:163], v33 offset:2048
    ds_read_b128 v[164:167], v33 offset:3072
    ds_read_b128 v[168:171], v33 offset:6144
    ds_read_b128 v[172:175], v33 offset:7168
    ds_read_b128 v[176:179], v35 offset:1024
    ds_read_b128 v[180:183], v35 offset:3072
    v_max3_f32 v130, v112, v113, v114
    v_max3_f32 v131, v115, v116, v117
    v_max3_f32 v130, v130, v118, v119
    v_max3_f32 v131, v131, v120, v121
    v_max3_f32 v130, v130, v122, v123
    v_max_f32 v130, v130, v131
    v_mov_b32 v131, v130
    s_nop 1
    v_permlane16_swap_b32 v130, v131
    v_max_f32 v130, v130, v131
    v_mov_b32 v131, v130
    s_nop 1
    v_permlane32_swap_b32 v130, v131
    v_max_f32 v130, v130, v131
    v_mul_f32 v130, s83, v130
    v_fma_f32 v112, v112, s83, -v130
    v_fma_f32 v113, v113, s83, -v130
    v_fma_f32 v114, v114, s83, -v130
    v_fma_f32 v115, v115, s83, -v130
    v_fma_f32 v116, v116, s83, -v130
    v_fma_f32 v117, v117, s83, -v130
    v_fma_f32 v118, v118, s83, -v130
    v_fma_f32 v119, v119, s83, -v130
    v_fma_f32 v120, v120, s83, -v130
    v_fma_f32 v121, v121, s83, -v130
    v_fma_f32 v122, v122, s83, -v130
    v_fma_f32 v123, v123, s83, -v130
    v_exp_f32 v112, v112
    v_exp_f32 v113, v113
    v_exp_f32 v114, v114
    v_exp_f32 v115, v115
    v_exp_f32 v116, v116
    v_exp_f32 v117, v117
    v_exp_f32 v118, v118
    v_exp_f32 v119, v119
    v_exp_f32 v120, v120
    v_exp_f32 v121, v121
    v_exp_f32 v122, v122
    v_exp_f32 v123, v123
    v_cvt_pk_bf16_f32 v124, v112, v113
    v_cvt_pk_bf16_f32 v125, v114, v115
    v_cvt_pk_bf16_f32 v126, v116, v117
    v_cvt_pk_bf16_f32 v127, v118, v119
    v_cvt_pk_bf16_f32 v128, v120, v121
    v_cvt_pk_bf16_f32 v129, v122, v123
    s_waitcnt lgkmcnt(0)
    v_mfma_f32_16x16x32_bf16 v[132:135], v[24:27], v[124:127], 0
    v_mfma_f32_16x16x32_bf16 v[136:139], v[160:163], v[124:127], 0
    v_mfma_f32_16x16x32_bf16 v[140:143], v[164:167], v[124:127], 0
    v_mfma_f32_16x16x32_bf16 v[144:147], v[168:171], v[124:127], 0
    v_mfma_f32_16x16x32_bf16 v[148:151], v[172:175], v[124:127], 0
    v_mfma_f32_16x16x16_bf16 v[132:135], v[28:29], v[128:129], v[132:135]
    v_mfma_f32_16x16x16_bf16 v[136:139], v[176:177], v[128:129], v[136:139]
    v_mfma_f32_16x16x16_bf16 v[140:143], v[178:179], v[128:129], v[140:143]
    v_mfma_f32_16x16x16_bf16 v[144:147], v[180:181], v[128:129], v[144:147]
    v_mfma_f32_16x16x16_bf16 v[148:151], v[182:183], v[128:129], v[148:151]
    s_nop 3
    v_rcp_f32 v130, v132
    s_nop 0
    v_mul_f32 v136, v136, v130
    v_mul_f32 v137, v137, v130
    v_mul_f32 v138, v138, v130
    v_mul_f32 v139, v139, v130
    v_mul_f32 v140, v140, v130
    v_mul_f32 v141, v141, v130
    v_mul_f32 v142, v142, v130
    v_mul_f32 v143, v143, v130
    v_mul_f32 v144, v144, v130
    v_mul_f32 v145, v145, v130
    v_mul_f32 v146, v146, v130
    v_mul_f32 v147, v147, v130
    v_mul_f32 v148, v148, v130
    v_mul_f32 v149, v149, v130
    v_mul_f32 v150, v150, v130
    v_mul_f32 v151, v151, v130
    v_cvt_pk_bf16_f32 v136, v136, v137
    v_cvt_pk_bf16_f32 v137, v138, v139
    v_cvt_pk_bf16_f32 v138, v140, v141
    v_cvt_pk_bf16_f32 v139, v142, v143
    v_cvt_pk_bf16_f32 v140, v144, v145
    v_cvt_pk_bf16_f32 v141, v146, v147
    v_cvt_pk_bf16_f32 v142, v148, v149
    v_cvt_pk_bf16_f32 v143, v150, v151
    ds_write_b128 v14, v[136:139]
    ds_write_b128 v14, v[140:143] offset:1024
    s_waitcnt lgkmcnt(0)
    s_barrier
    ds_read_b128 v[64:67], v15 offset:0
    ds_read_b128 v[68:71], v15 offset:1024
    ds_read_b128 v[72:75], v15 offset:2048
    ds_read_b128 v[76:79], v15 offset:3072
    ds_read_b128 v[80:83], v15 offset:4096
    ds_read_b128 v[84:87], v15 offset:5120
    ds_read_b128 v[88:91], v15 offset:6144
    ds_read_b128 v[92:95], v15 offset:7168
    s_mov_b32 s75, 0
    s_cmp_lt_u32 s71, 6
    s_cbranch_scc1 L_nr_121
    s_cmp_ge_u32 s71, 61
    s_cbranch_scc1 L_nr_121
    s_sub_u32 s60, s71, 6
    s_waitcnt vmcnt(0)
    v_cmp_ne_u32 vcc, 1, v30
    s_cbranch_vccz L_xok_123
    s_lshl_b32 s61, s60, 7
    s_add_u32 s61, s61, 16384
    s_mov_b32 s59, 0
L_xrs_124:
    buffer_load_dword v30, v31, s[8:11], s61 offen sc1
    s_waitcnt vmcnt(0)
    v_cmp_ne_u32 vcc, 1, v30
    s_cbranch_vccz L_xrs_ok_125
    s_add_u32 s59, s59, 1
    s_cmp_lt_u32 s59, s58
    s_cbranch_scc1 L_xrs_124
    s_mov_b32 s58, 0
L_xrs_ok_125:
L_xok_123:
    s_mul_i32 s61, s60, 1179648
    s_lshl_b32 s64, s74, 13
    s_add_u32 s61, s61, s64
    s_add_u32 s61, s61, 54525952
    buffer_load_dwordx4 v[160:163], v5, s[8:11], s61 offen offset:0
    buffer_load_dwordx4 v[164:167], v5, s[8:11], s61 offen offset:1024
    buffer_load_dwordx4 v[168:171], v5, s[8:11], s61 offen offset:2048
    buffer_load_dwordx4 v[172:175], v5, s[8:11], s61 offen offset:3072
    s_add_u32 s61, s61, 4096
    buffer_load_dwordx4 v[176:179], v5, s[8:11], s61 offen offset:0
    buffer_load_dwordx4 v[180:183], v5, s[8:11], s61 offen offset:1024
    buffer_load_dwordx4 v[184:187], v5, s[8:11], s61 offen offset:2048
    buffer_load_dwordx4 v[188:191], v5, s[8:11], s61 offen offset:3072
    s_mov_b32 s75, 1
    s_and_b32 s64, s74, 7
    s_cbranch_scc1 L_u2_126
    s_mul_i32 s61, s60, 1179648
    s_lshl_b32 s64, s34, 13
    s_add_u32 s61, s61, s64
    s_add_u32 s61, s61, 54525952
    buffer_load_dwordx4 v[192:195], v5, s[8:11], s61 offen offset:0
    buffer_load_dwordx4 v[196:199], v5, s[8:11], s61 offen offset:1024
    buffer_load_dwordx4 v[200:203], v5, s[8:11], s61 offen offset:2048
    buffer_load_dwordx4 v[204:207], v5, s[8:11], s61 offen offset:3072
    s_add_u32 s61, s61, 4096
    buffer_load_dwordx4 v[208:211], v5, s[8:11], s61 offen offset:0
    buffer_load_dwordx4 v[212:215], v5, s[8:11], s61 offen offset:1024
    buffer_load_dwordx4 v[216:219], v5, s[8:11], s61 offen offset:2048
    buffer_load_dwordx4 v[220:223], v5, s[8:11], s61 offen offset:3072
    s_mov_b32 s75, 2
L_u2_126:
L_nr_121:
    s_mul_i32 s78, s71, 1179648
    s_add_u32 s78, s78, s82
    s_waitcnt lgkmcnt(0)
    s_cmp_ge_u32 s71, 61
    s_cbranch_scc1 L_opl_127
    v_mfma_f32_16x16x32_bf16 v[96:99], a[144:147], v[64:67], 0
    v_mfma_f32_16x16x32_bf16 v[100:103], a[144:147], v[80:83], 0
    v_mfma_f32_16x16x32_bf16 v[96:99], a[148:151], v[68:71], v[96:99]
    v_mfma_f32_16x16x32_bf16 v[100:103], a[148:151], v[84:87], v[100:103]
    v_mfma_f32_16x16x32_bf16 v[96:99], a[152:155], v[72:75], v[96:99]
    v_mfma_f32_16x16x32_bf16 v[100:103], a[152:155], v[88:91], v[100:103]
    v_mfma_f32_16x16x32_bf16 v[96:99], a[156:159], v[76:79], v[96:99]
    v_mfma_f32_16x16x32_bf16 v[100:103], a[156:159], v[92:95], v[100:103]
    v_mfma_f32_16x16x32_bf16 v[104:107], a[160:163], v[64:67], 0
    v_mfma_f32_16x16x32_bf16 v[108:111], a[160:163], v[80:83], 0
    v_mfma_f32_16x16x32_bf16 v[104:107], a[164:167], v[68:71], v[104:107]
    v_mfma_f32_16x16x32_bf16 v[108:111], a[164:167], v[84:87], v[108:111]
    s_nop 2
    v_cvt_pk_bf16_f32 v112, v96, v97
    v_cvt_pk_bf16_f32 v113, v98, v99
    v_cvt_pk_bf16_f32 v114, v100, v101
    v_cvt_pk_bf16_f32 v115, v102, v103
    s_add_u32 s64, s78, 0
    buffer_store_dwordx4 v[112:115], v6, s[8:11], s64 offen sc1
    v_mfma_f32_16x16x32_bf16 v[104:107], a[168:171], v[72:75], v[104:107]
    v_mfma_f32_16x16x32_bf16 v[108:111], a[168:171], v[88:91], v[108:111]
    v_mfma_f32_16x16x32_bf16 v[104:107], a[172:175], v[76:79], v[104:107]
    v_mfma_f32_16x16x32_bf16 v[108:111], a[172:175], v[92:95], v[108:111]
    v_mfma_f32_16x16x32_bf16 v[96:99], a[176:179], v[64:67], 0
    v_mfma_f32_16x16x32_bf16 v[100:103], a[176:179], v[80:83], 0
    v_mfma_f32_16x16x32_bf16 v[96:99], a[180:183], v[68:71], v[96:99]
    v_mfma_f32_16x16x32_bf16 v[100:103], a[180:183], v[84:87], v[100:103]
    s_nop 2
    v_cvt_pk_bf16_f32 v116, v104, v105
    v_cvt_pk_bf16_f32 v117, v106, v107
    v_cvt_pk_bf16_f32 v118, v108, v109
    v_cvt_pk_bf16_f32 v119, v110, v111
    s_add_u32 s64, s78, 131072
    buffer_store_dwordx4 v[116:119], v6, s[8:11], s64 offen sc1
    v_mfma_f32_16x16x32_bf16 v[96:99], a[184:187], v[72:75], v[96:99]
    v_mfma_f32_16x16x32_bf16 v[100:103], a[184:187], v[88:91], v[100:103]
    v_mfma_f32_16x16x32_bf16 v[96:99], a[188:191], v[76:79], v[96:99]
    v_mfma_f32_16x16x32_bf16 v[100:103], a[188:191], v[92:95], v[100:103]
    v_mfma_f32_16x16x32_bf16 v[104:107], a[192:195], v[64:67], 0
    v_mfma_f32_16x16x32_bf16 v[108:111], a[192:195], v[80:83], 0
    v_mfma_f32_16x16x32_bf16 v[104:107], a[196:199], v[68:71], v[104:107]
    v_mfma_f32_16x16x32_bf16 v[108:111], a[196:199], v[84:87], v[108:111]
    s_nop 2
    v_cvt_pk_bf16_f32 v112, v96, v97
    v_cvt_pk_bf16_f32 v113, v98, v99
    v_cvt_pk_bf16_f32 v114, v100, v101
    v_cvt_pk_bf16_f32 v115, v102, v103
    s_add_u32 s64, s78, 262144
    buffer_store_dwordx4 v[112:115], v6, s[8:11], s64 offen sc1
    v_mfma_f32_16x16x32_bf16 v[104:107], a[200:203], v[72:75], v[104:107]
    v_mfma_f32_16x16x32_bf16 v[108:111], a[200:203], v[88:91], v[108:111]
    v_mfma_f32_16x16x32_bf16 v[104:107], a[204:207], v[76:79], v[104:107]
    v_mfma_f32_16x16x32_bf16 v[108:111], a[204:207], v[92:95], v[108:111]
    v_mfma_f32_16x16x32_bf16 v[96:99], a[208:211], v[64:67], 0
    v_mfma_f32_16x16x32_bf16 v[100:103], a[208:211], v[80:83], 0
    v_mfma_f32_16x16x32_bf16 v[96:99], a[212:215], v[68:71], v[96:99]
    v_mfma_f32_16x16x32_bf16 v[100:103], a[212:215], v[84:87], v[100:103]
    s_nop 2
    v_cvt_pk_bf16_f32 v116, v104, v105
    v_cvt_pk_bf16_f32 v117, v106, v107
    v_cvt_pk_bf16_f32 v118, v108, v109
    v_cvt_pk_bf16_f32 v119, v110, v111
    s_add_u32 s64, s78, 393216
    buffer_store_dwordx4 v[116:119], v6, s[8:11], s64 offen sc1
    v_mfma_f32_16x16x32_bf16 v[96:99], a[216:219], v[72:75], v[96:99]
    v_mfma_f32_16x16x32_bf16 v[100:103], a[216:219], v[88:91], v[100:103]
    v_mfma_f32_16x16x32_bf16 v[96:99], a[220:223], v[76:79], v[96:99]
    v_mfma_f32_16x16x32_bf16 v[100:103], a[220:223], v[92:95], v[100:103]
    v_mfma_f32_16x16x32_bf16 v[104:107], a[224:227], v[64:67], 0
    v_mfma_f32_16x16x32_bf16 v[108:111], a[224:227], v[80:83], 0
    v_mfma_f32_16x16x32_bf16 v[104:107], a[228:231], v[68:71], v[104:107]
    v_mfma_f32_16x16x32_bf16 v[108:111], a[228:231], v[84:87], v[108:111]
    s_nop 2
    v_cvt_pk_bf16_f32 v112, v96, v97
    v_cvt_pk_bf16_f32 v113, v98, v99
    v_cvt_pk_bf16_f32 v114, v100, v101
    v_cvt_pk_bf16_f32 v115, v102, v103
    s_add_u32 s64, s78, 524288
    buffer_store_dwordx4 v[112:115], v6, s[8:11], s64 offen sc1
    v_mfma_f32_16x16x32_bf16 v[104:107], a[232:235], v[72:75], v[104:107]
    v_mfma_f32_16x16x32_bf16 v[108:111], a[232:235], v[88:91], v[108:111]
    v_mfma_f32_16x16x32_bf16 v[104:107], a[236:239], v[76:79], v[104:107]
    v_mfma_f32_16x16x32_bf16 v[108:111], a[236:239], v[92:95], v[108:111]
    v_mfma_f32_16x16x32_bf16 v[96:99], a[240:243], v[64:67], 0
    v_mfma_f32_16x16x32_bf16 v[100:103], a[240:243], v[80:83], 0
    v_mfma_f32_16x16x32_bf16 v[96:99], a[244:247], v[68:71], v[96:99]
    v_mfma_f32_16x16x32_bf16 v[100:103], a[244:247], v[84:87], v[100:103]
    s_nop 2
    v_cvt_pk_bf16_f32 v116, v104, v105
    v_cvt_pk_bf16_f32 v117, v106, v107
    v_cvt_pk_bf16_f32 v118, v108, v109
    v_cvt_pk_bf16_f32 v119, v110, v111
    s_add_u32 s64, s78, 655360
    buffer_store_dwordx4 v[116:119], v6, s[8:11], s64 offen sc1
    v_mfma_f32_16x16x32_bf16 v[96:99], a[248:251], v[72:75], v[96:99]
    v_mfma_f32_16x16x32_bf16 v[100:103], a[248:251], v[88:91], v[100:103]
    v_mfma_f32_16x16x32_bf16 v[96:99], a[252:255], v[76:79], v[96:99]
    v_mfma_f32_16x16x32_bf16 v[100:103], a[252:255], v[92:95], v[100:103]
    v_mfma_f32_16x16x32_bf16 v[104:107], v[224:227], v[64:67], 0
    v_mfma_f32_16x16x32_bf16 v[108:111], v[224:227], v[80:83], 0
    v_mfma_f32_16x16x32_bf16 v[104:107], v[228:231], v[68:71], v[104:107]
    v_mfma_f32_16x16x32_bf16 v[108:111], v[228:231], v[84:87], v[108:111]
    s_nop 2
    v_cvt_pk_bf16_f32 v112, v96, v97
    v_cvt_pk_bf16_f32 v113, v98, v99
    v_cvt_pk_bf16_f32 v114, v100, v101
    v_cvt_pk_bf16_f32 v115, v102, v103
    s_add_u32 s64, s78, 786432
    buffer_store_dwordx4 v[112:115], v6, s[8:11], s64 offen sc1
    v_mfma_f32_16x16x32_bf16 v[104:107], v[232:235], v[72:75], v[104:107]
    v_mfma_f32_16x16x32_bf16 v[108:111], v[232:235], v[88:91], v[108:111]
    v_mfma_f32_16x16x32_bf16 v[104:107], v[236:239], v[76:79], v[104:107]
    v_mfma_f32_16x16x32_bf16 v[108:111], v[236:239], v[92:95], v[108:111]
    v_mfma_f32_16x16x32_bf16 v[96:99], v[240:243], v[64:67], 0
    v_mfma_f32_16x16x32_bf16 v[100:103], v[240:243], v[80:83], 0
    v_mfma_f32_16x16x32_bf16 v[96:99], v[244:247], v[68:71], v[96:99]
    v_mfma_f32_16x16x32_bf16 v[100:103], v[244:247], v[84:87], v[100:103]
    s_nop 2
    v_cvt_pk_bf16_f32 v116, v104, v105
    v_cvt_pk_bf16_f32 v117, v106, v107
    v_cvt_pk_bf16_f32 v118, v108, v109
    v_cvt_pk_bf16_f32 v119, v110, v111
    s_add_u32 s64, s78, 917504
    buffer_store_dwordx4 v[116:119], v6, s[8:11], s64 offen sc1
    v_mfma_f32_16x16x32_bf16 v[96:99], v[248:251], v[72:75], v[96:99]
    v_mfma_f32_16x16x32_bf16 v[100:103], v[248:251], v[88:91], v[100:103]
    v_mfma_f32_16x16x32_bf16 v[96:99], v[252:255], v[76:79], v[96:99]
    v_mfma_f32_16x16x32_bf16 v[100:103], v[252:255], v[92:95], v[100:103]
    s_nop 6
    v_cvt_pk_bf16_f32 v112, v96, v97
    v_cvt_pk_bf16_f32 v113, v98, v99
    v_cvt_pk_bf16_f32 v114, v100, v101
    v_cvt_pk_bf16_f32 v115, v102, v103
    s_add_u32 s64, s78, 1048576
    buffer_store_dwordx4 v[112:115], v6, s[8:11], s64 offen sc1
    s_branch L_opd_128
L_opl_127:
    v_mfma_f32_16x16x32_bf16 v[96:99], a[144:147], v[64:67], 0
    v_mfma_f32_16x16x32_bf16 v[100:103], a[144:147], v[80:83], 0
    v_mfma_f32_16x16x32_bf16 v[96:99], a[148:151], v[68:71], v[96:99]
    v_mfma_f32_16x16x32_bf16 v[100:103], a[148:151], v[84:87], v[100:103]
    v_mfma_f32_16x16x32_bf16 v[96:99], a[152:155], v[72:75], v[96:99]
    v_mfma_f32_16x16x32_bf16 v[100:103], a[152:155], v[88:91], v[100:103]
    v_mfma_f32_16x16x32_bf16 v[96:99], a[156:159], v[76:79], v[96:99]
    v_mfma_f32_16x16x32_bf16 v[100:103], a[156:159], v[92:95], v[100:103]
    v_mfma_f32_16x16x32_bf16 v[104:107], a[160:163], v[64:67], 0
    v_mfma_f32_16x16x32_bf16 v[108:111], a[160:163], v[80:83], 0
    v_mfma_f32_16x16x32_bf16 v[104:107], a[164:167], v[68:71], v[104:107]
    v_mfma_f32_16x16x32_bf16 v[108:111], a[164:167], v[84:87], v[108:111]
    s_nop 2
    v_cvt_pk_bf16_f32 v112, v96, v97
    v_cvt_pk_bf16_f32 v113, v98, v99
    v_cvt_pk_bf16_f32 v114, v100, v101
    v_cvt_pk_bf16_f32 v115, v102, v103
    s_add_u32 s64, s78, 0
    buffer_store_dwordx4 v[112:115], v6, s[8:11], s64 offen
    v_mfma_f32_16x16x32_bf16 v[104:107], a[168:171], v[72:75], v[104:107]
    v_mfma_f32_16x16x32_bf16 v[108:111], a[168:171], v[88:91], v[108:111]
    v_mfma_f32_16x16x32_bf16 v[104:107], a[172:175], v[76:79], v[104:107]
    v_mfma_f32_16x16x32_bf16 v[108:111], a[172:175], v[92:95], v[108:111]
    v_mfma_f32_16x16x32_bf16 v[96:99], a[176:179], v[64:67], 0
    v_mfma_f32_16x16x32_bf16 v[100:103], a[176:179], v[80:83], 0
    v_mfma_f32_16x16x32_bf16 v[96:99], a[180:183], v[68:71], v[96:99]
    v_mfma_f32_16x16x32_bf16 v[100:103], a[180:183], v[84:87], v[100:103]
    s_nop 2
    v_cvt_pk_bf16_f32 v116, v104, v105
    v_cvt_pk_bf16_f32 v117, v106, v107
    v_cvt_pk_bf16_f32 v118, v108, v109
    v_cvt_pk_bf16_f32 v119, v110, v111
    s_add_u32 s64, s78, 131072
    buffer_store_dwordx4 v[116:119], v6, s[8:11], s64 offen
    v_mfma_f32_16x16x32_bf16 v[96:99], a[184:187], v[72:75], v[96:99]
    v_mfma_f32_16x16x32_bf16 v[100:103], a[184:187], v[88:91], v[100:103]
    v_mfma_f32_16x16x32_bf16 v[96:99], a[188:191], v[76:79], v[96:99]
    v_mfma_f32_16x16x32_bf16 v[100:103], a[188:191], v[92:95], v[100:103]
    v_mfma_f32_16x16x32_bf16 v[104:107], a[192:195], v[64:67], 0
    v_mfma_f32_16x16x32_bf16 v[108:111], a[192:195], v[80:83], 0
    v_mfma_f32_16x16x32_bf16 v[104:107], a[196:199], v[68:71], v[104:107]
    v_mfma_f32_16x16x32_bf16 v[108:111], a[196:199], v[84:87], v[108:111]
    s_nop 2
    v_cvt_pk_bf16_f32 v112, v96, v97
    v_cvt_pk_bf16_f32 v113, v98, v99
    v_cvt_pk_bf16_f32 v114, v100, v101
    v_cvt_pk_bf16_f32 v115, v102, v103
    s_add_u32 s64, s78, 262144
    buffer_store_dwordx4 v[112:115], v6, s[8:11], s64 offen
    v_mfma_f32_16x16x32_bf16 v[104:107], a[200:203], v[72:75], v[104:107]
    v_mfma_f32_16x16x32_bf16 v[108:111], a[200:203], v[88:91], v[108:111]
    v_mfma_f32_16x16x32_bf16 v[104:107], a[204:207], v[76:79], v[104:107]
    v_mfma_f32_16x16x32_bf16 v[108:111], a[204:207], v[92:95], v[108:111]
    v_mfma_f32_16x16x32_bf16 v[96:99], a[208:211], v[64:67], 0
    v_mfma_f32_16x16x32_bf16 v[100:103], a[208:211], v[80:83], 0
    v_mfma_f32_16x16x32_bf16 v[96:99], a[212:215], v[68:71], v[96:99]
    v_mfma_f32_16x16x32_bf16 v[100:103], a[212:215], v[84:87], v[100:103]
    s_nop 2
    v_cvt_pk_bf16_f32 v116, v104, v105
    v_cvt_pk_bf16_f32 v117, v106, v107
    v_cvt_pk_bf16_f32 v118, v108, v109
    v_cvt_pk_bf16_f32 v119, v110, v111
    s_add_u32 s64, s78, 393216
    buffer_store_dwordx4 v[116:119], v6, s[8:11], s64 offen
    v_mfma_f32_16x16x32_bf16 v[96:99], a[216:219], v[72:75], v[96:99]
    v_mfma_f32_16x16x32_bf16 v[100:103], a[216:219], v[88:91], v[100:103]
    v_mfma_f32_16x16x32_bf16 v[96:99], a[220:223], v[76:79], v[96:99]
    v_mfma_f32_16x16x32_bf16 v[100:103], a[220:223], v[92:95], v[100:103]
    v_mfma_f32_16x16x32_bf16 v[104:107], a[224:227], v[64:67], 0
    v_mfma_f32_16x16x32_bf16 v[108:111], a[224:227], v[80:83], 0
    v_mfma_f32_16x16x32_bf16 v[104:107], a[228:231], v[68:71], v[104:107]
    v_mfma_f32_16x16x32_bf16 v[108:111], a[228:231], v[84:87], v[108:111]
    s_nop 2
    v_cvt_pk_bf16_f32 v112, v96, v97
    v_cvt_pk_bf16_f32 v113, v98, v99
    v_cvt_pk_bf16_f32 v114, v100, v101
    v_cvt_pk_bf16_f32 v115, v102, v103
    s_add_u32 s64, s78, 524288
    buffer_store_dwordx4 v[112:115], v6, s[8:11], s64 offen
    v_mfma_f32_16x16x32_bf16 v[104:107], a[232:235], v[72:75], v[104:107]
    v_mfma_f32_16x16x32_bf16 v[108:111], a[232:235], v[88:91], v[108:111]
    v_mfma_f32_16x16x32_bf16 v[104:107], a[236:239], v[76:79], v[104:107]
    v_mfma_f32_16x16x32_bf16 v[108:111], a[236:239], v[92:95], v[108:111]
    v_mfma_f32_16x16x32_bf16 v[96:99], a[240:243], v[64:67], 0
    v_mfma_f32_16x16x32_bf16 v[100:103], a[240:243], v[80:83], 0
    v_mfma_f32_16x16x32_bf16 v[96:99], a[244:247], v[68:71], v[96:99]
    v_mfma_f32_16x16x32_bf16 v[100:103], a[244:247], v[84:87], v[100:103]
    s_nop 2
    v_cvt_pk_bf16_f32 v116, v104, v105
    v_cvt_pk_bf16_f32 v117, v106, v107
    v_cvt_pk_bf16_f32 v118, v108, v109
    v_cvt_pk_bf16_f32 v119, v110, v111
    s_add_u32 s64, s78, 655360
    buffer_store_dwordx4 v[116:119], v6, s[8:11], s64 offen
    v_mfma_f32_16x16x32_bf16 v[96:99], a[248:251], v[72:75], v[96:99]
    v_mfma_f32_16x16x32_bf16 v[100:103], a[248:251], v[88:91], v[100:103]
    v_mfma_f32_16x16x32_bf16 v[96:99], a[252:255], v[76:79], v[96:99]
    v_mfma_f32_16x16x32_bf16 v[100:103], a[252:255], v[92:95], v[100:103]
    v_mfma_f32_16x16x32_bf16 v[104:107], v[224:227], v[64:67], 0
    v_mfma_f32_16x16x32_bf16 v[108:111], v[224:227], v[80:83], 0
    v_mfma_f32_16x16x32_bf16 v[104:107], v[228:231], v[68:71], v[104:107]
    v_mfma_f32_16x16x32_bf16 v[108:111], v[228:231], v[84:87], v[108:111]
    s_nop 2
    v_cvt_pk_bf16_f32 v112, v96, v97
    v_cvt_pk_bf16_f32 v113, v98, v99
    v_cvt_pk_bf16_f32 v114, v100, v101
    v_cvt_pk_bf16_f32 v115, v102, v103
    s_add_u32 s64, s78, 786432
    buffer_store_dwordx4 v[112:115], v6, s[8:11], s64 offen
    v_mfma_f32_16x16x32_bf16 v[104:107], v[232:235], v[72:75], v[104:107]
    v_mfma_f32_16x16x32_bf16 v[108:111], v[232:235], v[88:91], v[108:111]
    v_mfma_f32_16x16x32_bf16 v[104:107], v[236:239], v[76:79], v[104:107]
    v_mfma_f32_16x16x32_bf16 v[108:111], v[236:239], v[92:95], v[108:111]
    v_mfma_f32_16x16x32_bf16 v[96:99], v[240:243], v[64:67], 0
    v_mfma_f32_16x16x32_bf16 v[100:103], v[240:243], v[80:83], 0
    v_mfma_f32_16x16x32_bf16 v[96:99], v[244:247], v[68:71], v[96:99]
    v_mfma_f32_16x16x32_bf16 v[100:103], v[244:247], v[84:87], v[100:103]
    s_nop 2
    v_cvt_pk_bf16_f32 v116, v104, v105
    v_cvt_pk_bf16_f32 v117, v106, v107
    v_cvt_pk_bf16_f32 v118, v108, v109
    v_cvt_pk_bf16_f32 v119, v110, v111
    s_add_u32 s64, s78, 917504
    buffer_store_dwordx4 v[116:119], v6, s[8:11], s64 offen
    v_mfma_f32_16x16x32_bf16 v[96:99], v[248:251], v[72:75], v[96:99]
    v_mfma_f32_16x16x32_bf16 v[100:103], v[248:251], v[88:91], v[100:103]
    v_mfma_f32_16x16x32_bf16 v[96:99], v[252:255], v[76:79], v[96:99]
    v_mfma_f32_16x16x32_bf16 v[100:103], v[252:255], v[92:95], v[100:103]
    s_nop 6
    v_cvt_pk_bf16_f32 v112, v96, v97
    v_cvt_pk_bf16_f32 v113, v98, v99
    v_cvt_pk_bf16_f32 v114, v100, v101
    v_cvt_pk_bf16_f32 v115, v102, v103
    s_add_u32 s64, s78, 1048576
    buffer_store_dwordx4 v[112:115], v6, s[8:11], s64 offen
L_opd_128:
    s_cmp_eq_u32 s75, 0
    s_cbranch_scc1 L_nrf_129
    s_waitcnt vmcnt(9)
    s_sub_u32 s60, s71, 6
    s_mov_b32 s62, 0x00030003
    s_mov_b32 s63, 0x00030003
    v_cndmask_b32 v120, 0, v8, s[62:63]
    s_lshl_b64 s[62:63], s[62:63], 2
    v_cndmask_b32 v121, 0, v8, s[62:63]
    s_lshl_b64 s[62:63], s[62:63], 2
    v_cndmask_b32 v122, 0, v8, s[62:63]
    s_lshl_b64 s[62:63], s[62:63], 2
    v_cndmask_b32 v123, 0, v8, s[62:63]
    s_nop 1
    v_mfma_f32_16x16x32_bf16 v[124:127], v[120:123], v[160:163], 0
    v_mfma_f32_16x16x32_bf16 v[124:127], v[120:123], v[164:167], v[124:127]
    v_mfma_f32_16x16x32_bf16 v[124:127], v[120:123], v[168:171], v[124:127]
    v_mfma_f32_16x16x32_bf16 v[124:127], v[120:123], v[172:175], v[124:127]
    v_mfma_f32_16x16x32_bf16 v[124:127], v[120:123], v[176:179], v[124:127]
    v_mfma_f32_16x16x32_bf16 v[124:127], v[120:123], v[180:183], v[124:127]
    v_mfma_f32_16x16x32_bf16 v[124:127], v[120:123], v[184:187], v[124:127]
    v_mfma_f32_16x16x32_bf16 v[124:127], v[120:123], v[188:191], v[124:127]
    s_mul_i32 s61, s60, 73728
    s_lshl_b32 s64, s74, 3
    s_add_u32 s61, s61, s64
    s_nop 4
    v_cvt_pk_bf16_f32 v124, v124, v125
    v_cvt_pk_bf16_f32 v125, v126, v127
    buffer_store_dwordx2 v[124:125], v7, s[28:31], s61 offen
    s_cmp_lt_u32 s75, 2
    s_cbranch_scc1 L_f2_130
    v_mfma_f32_16x16x32_bf16 v[124:127], v[120:123], v[192:195], 0
    v_mfma_f32_16x16x32_bf16 v[124:127], v[120:123], v[196:199], v[124:127]
    v_mfma_f32_16x16x32_bf16 v[124:127], v[120:123], v[200:203], v[124:127]
    v_mfma_f32_16x16x32_bf16 v[124:127], v[120:123], v[204:207], v[124:127]
    v_mfma_f32_16x16x32_bf16 v[124:127], v[120:123], v[208:211], v[124:127]
    v_mfma_f32_16x16x32_bf16 v[124:127], v[120:123], v[212:215], v[124:127]
    v_mfma_f32_16x16x32_bf16 v[124:127], v[120:123], v[216:219], v[124:127]
    v_mfma_f32_16x16x32_bf16 v[124:127], v[120:123], v[220:223], v[124:127]
    s_mul_i32 s61, s60, 73728
    s_lshl_b32 s64, s34, 3
    s_add_u32 s61, s61, s64
    s_nop 4
    v_cvt_pk_bf16_f32 v124, v124, v125
    v_cvt_pk_bf16_f32 v125, v126, v127
    buffer_store_dwordx2 v[124:125], v7, s[28:31], s61 offen
L_f2_130:
L_nrf_129:
    s_waitcnt vmcnt(11)
    s_add_u32 s71, s71, 3
    s_sub_u32 s72, 36864, s72
    s_xor_b32 s73, s73, 16384
    s_cmp_lt_u32 s71, 64
    s_cbranch_scc1 L_x2_97
    s_sub_u32 s78, s71, 3
    s_mov_b32 s59, 0
L_xpd_131:
    s_mul_i32 s61, s78, 1179648
    s_lshl_b32 s64, s74, 13
    s_add_u32 s61, s61, s64
    s_add_u32 s61, s61, 54525952
    buffer_load_dwordx4 v[160:163], v5, s[8:11], s61 offen offset:0 sc1
    buffer_load_dwordx4 v[164:167], v5, s[8:11], s61 offen offset:1024 sc1
    buffer_load_dwordx4 v[168:171], v5, s[8:11], s61 offen offset:2048 sc1
    buffer_load_dwordx4 v[172:175], v5, s[8:11], s61 offen offset:3072 sc1
    s_add_u32 s61, s61, 4096
    buffer_load_dwordx4 v[176:179], v5, s[8:11], s61 offen offset:0 sc1
    buffer_load_dwordx4 v[180:183], v5, s[8:11], s61 offen offset:1024 sc1
    buffer_load_dwordx4 v[184:187], v5, s[8:11], s61 offen offset:2048 sc1
    buffer_load_dwordx4 v[188:191], v5, s[8:11], s61 offen offset:3072 sc1
    s_mov_b32 s75, 1
    s_and_b32 s64, s74, 7
    s_cbranch_scc1 L_u2_133
    s_mul_i32 s61, s78, 1179648
    s_lshl_b32 s64, s34, 13
    s_add_u32 s61, s61, s64
    s_add_u32 s61, s61, 54525952
    buffer_load_dwordx4 v[192:195], v5, s[8:11], s61 offen offset:0 sc1
    buffer_load_dwordx4 v[196:199], v5, s[8:11], s61 offen offset:1024 sc1
    buffer_load_dwordx4 v[200:203], v5, s[8:11], s61 offen offset:2048 sc1
    buffer_load_dwordx4 v[204:207], v5, s[8:11], s61 offen offset:3072 sc1
    s_add_u32 s61, s61, 4096
    buffer_load_dwordx4 v[208:211], v5, s[8:11], s61 offen offset:0 sc1
    buffer_load_dwordx4 v[212:215], v5, s[8:11], s61 offen offset:1024 sc1
    buffer_load_dwordx4 v[216:219], v5, s[8:11], s61 offen offset:2048 sc1
    buffer_load_dwordx4 v[220:223], v5, s[8:11], s61 offen offset:3072 sc1
    s_mov_b32 s75, 2
L_u2_133:
    s_waitcnt vmcnt(0)
    s_cmp_lt_u32 s75, 2
    s_cbranch_scc1 L_c1_134
    v_max3_u32 v96, v160, v161, v162
    v_max3_u32 v96, v96, v163, v164
    v_max3_u32 v96, v96, v165, v166
    v_max3_u32 v96, v96, v167, v168
    v_max3_u32 v96, v96, v169, v170
    v_max3_u32 v96, v96, v171, v172
    v_max3_u32 v96, v96, v173, v174
    v_max3_u32 v96, v96, v175, v176
    v_max3_u32 v96, v96, v177, v178
    v_max3_u32 v96, v96, v179, v180
    v_max3_u32 v96, v96, v181, v182
    v_max3_u32 v96, v96, v183, v184
    v_max3_u32 v96, v96, v185, v186
    v_max3_u32 v96, v96, v187, v188
    v_max3_u32 v96, v96, v189, v190
    v_max3_u32 v96, v96, v191, v192
    v_max3_u32 v96, v96, v193, v194
    v_max3_u32 v96, v96, v195, v196
    v_max3_u32 v96, v96, v197, v198
    v_max3_u32 v96, v96, v199, v200
    v_max3_u32 v96, v96, v201, v202
    v_max3_u32 v96, v96, v203, v204
    v_max3_u32 v96, v96, v205, v206
    v_max3_u32 v96, v96, v207, v208
    v_max3_u32 v96, v96, v209, v210
    v_max3_u32 v96, v96, v211, v212
    v_max3_u32 v96, v96, v213, v214
    v_max3_u32 v96, v96, v215, v216
    v_max3_u32 v96, v96, v217, v218
    v_max3_u32 v96, v96, v219, v220
    v_max3_u32 v96, v96, v221, v222
    v_max_u32 v96, v96, v223
    v_cmp_eq_u32 vcc, -1, v96
    s_branch L_c2_135
L_c1_134:
    v_max3_u32 v96, v160, v161, v162
    v_max3_u32 v96, v96, v163, v164
    v_max3_u32 v96, v96, v165, v166
    v_max3_u32 v96, v96, v167, v168
    v_max3_u32 v96, v96, v169, v170
    v_max3_u32 v96, v96, v171, v172
    v_max3_u32 v96, v96, v173, v174
    v_max3_u32 v96, v96, v175, v176
    v_max3_u32 v96, v96, v177, v178
    v_max3_u32 v96, v96, v179, v180
    v_max3_u32 v96, v96, v181, v182
    v_max3_u32 v96, v96, v183, v184
    v_max3_u32 v96, v96, v185, v186
    v_max3_u32 v96, v96, v187, v188
    v_max3_u32 v96, v96, v189, v190
    v_max_u32 v96, v96, v191
    v_cmp_eq_u32 vcc, -1, v96
L_c2_135:
    s_cbranch_vccz L_xpd_ok_132
    s_add_u32 s59, s59, 1
    s_cmp_lt_u32 s59, s58
    s_cbranch_scc1 L_xpd_131
    s_mov_b32 s58, 0
L_xpd_ok_132:
    s_mov_b32 s62, 0x00030003
    s_mov_b32 s63, 0x00030003
    v_cndmask_b32 v120, 0, v8, s[62:63]
    s_lshl_b64 s[62:63], s[62:63], 2
    v_cndmask_b32 v121, 0, v8, s[62:63]
    s_lshl_b64 s[62:63], s[62:63], 2
    v_cndmask_b32 v122, 0, v8, s[62:63]
    s_lshl_b64 s[62:63], s[62:63], 2
    v_cndmask_b32 v123, 0, v8, s[62:63]
    s_nop 1
    v_mfma_f32_16x16x32_bf16 v[124:127], v[120:123], v[160:163], 0
    v_mfma_f32_16x16x32_bf16 v[124:127], v[120:123], v[164:167], v[124:127]
    v_mfma_f32_16x16x32_bf16 v[124:127], v[120:123], v[168:171], v[124:127]
    v_mfma_f32_16x16x32_bf16 v[124:127], v[120:123], v[172:175], v[124:127]
    v_mfma_f32_16x16x32_bf16 v[124:127], v[120:123], v[176:179], v[124:127]
    v_mfma_f32_16x16x32_bf16 v[124:127], v[120:123], v[180:183], v[124:127]
    v_mfma_f32_16x16x32_bf16 v[124:127], v[120:123], v[184:187], v[124:127]
    v_mfma_f32_16x16x32_bf16 v[124:127], v[120:123], v[188:191], v[124:127]
    s_mul_i32 s61, s78, 73728
    s_lshl_b32 s64, s74, 3
    s_add_u32 s61, s61, s64
    s_nop 4
    v_cvt_pk_bf16_f32 v124, v124, v125
    v_cvt_pk_bf16_f32 v125, v126, v127
    buffer_store_dwordx2 v[124:125], v7, s[28:31], s61 offen
    s_cmp_lt_u32 s75, 2
    s_cbranch_scc1 L_f2_136
    v_mfma_f32_16x16x32_bf16 v[124:127], v[120:123], v[192:195], 0
    v_mfma_f32_16x16x32_bf16 v[124:127], v[120:123], v[196:199], v[124:127]
    v_mfma_f32_16x16x32_bf16 v[124:127], v[120:123], v[200:203], v[124:127]
    v_mfma_f32_16x16x32_bf16 v[124:127], v[120:123], v[204:207], v[124:127]
    v_mfma_f32_16x16x32_bf16 v[124:127], v[120:123], v[208:211], v[124:127]
    v_mfma_f32_16x16x32_bf16 v[124:127], v[120:123], v[212:215], v[124:127]
    v_mfma_f32_16x16x32_bf16 v[124:127], v[120:123], v[216:219], v[124:127]
    v_mfma_f32_16x16x32_bf16 v[124:127], v[120:123], v[220:223], v[124:127]
    s_mul_i32 s61, s78, 73728
    s_lshl_b32 s64, s34, 3
    s_add_u32 s61, s61, s64
    s_nop 4
    v_cvt_pk_bf16_f32 v124, v124, v125
    v_cvt_pk_bf16_f32 v125, v126, v127
    buffer_store_dwordx2 v[124:125], v7, s[28:31], s61 offen
L_f2_136:
    s_waitcnt vmcnt(0)
    s_branch L_x2end_137
L_x2slow_96:
L_x2_138:
    s_barrier
    s_mov_b32 s70, 0
    s_cmp_lt_u32 s71, 61
    s_cbranch_scc1 L_nfill_141
    s_mov_b64 s[32:33], 0
    s_sub_u32 s61, s71, 6
    s_max_i32 s61, s61, 0
    s_lshl_b32 s61, s61, 7
    s_add_u32 s61, s61, 16384
    buffer_load_dword v30, v31, s[8:11], s61 offen sc1
    s_mul_i32 s60, s71, 1179648
    s_add_u32 s60, s60, s82
    v_mov_b32 v48, -1
    v_mov_b32 v49, -1
    v_mov_b32 v50, -1
    v_mov_b32 v51, -1
    buffer_store_dwordx4 v[48:51], v6, s[8:11], s60 offen sc1
    s_add_u32 s60, s60, 131072
    buffer_store_dwordx4 v[48:51], v6, s[8:11], s60 offen sc1
    s_add_u32 s60, s60, 131072
    buffer_store_dwordx4 v[48:51], v6, s[8:11], s60 offen sc1
    s_add_u32 s60, s60, 131072
    buffer_store_dwordx4 v[48:51], v6, s[8:11], s60 offen sc1
    s_add_u32 s60, s60, 131072
    buffer_store_dwordx4 v[48:51], v6, s[8:11], s60 offen sc1
    s_add_u32 s60, s60, 131072
    buffer_store_dwordx4 v[48:51], v6, s[8:11], s60 offen sc1
    s_add_u32 s60, s60, 131072
    buffer_store_dwordx4 v[48:51], v6, s[8:11], s60 offen sc1
    s_add_u32 s60, s60, 131072
    buffer_store_dwordx4 v[48:51], v6, s[8:11], s60 offen sc1
    s_add_u32 s60, s60, 131072
    buffer_store_dwordx4 v[48:51], v6, s[8:11], s60 offen sc1
L_nfill_141:
    s_cmp_ge_u32 s71, 58
    s_cbranch_scc1 L_ne_140
    v_cmp_ne_u32 vcc, 1, v9
    s_cbranch_vccnz L_ne_140
    s_lshl_b32 s64, s71, 13
    s_add_u32 s64, s64, s80
    s_lshl_b32 s65, s4, 11
    s_add_u32 m0, s65, 106496
    s_nop 0
    buffer_load_dwordx4 v5, s[8:11], s64 offen sc1 lds
    s_add_u32 m0, s65, 107520
    s_add_u32 s64, s64, 1024
    buffer_load_dwordx4 v5, s[8:11], s64 offen sc1 lds
    s_mov_b32 s70, 1
L_ne_140:
    s_add_u32 s78, s71, 3
    s_min_u32 s78, s78, 63
    s_mul_i32 s76, s78, 36864
    s_add_u32 s76, s76, s77
    s_lshl_b32 s78, s78, 14
    s_add_u32 s78, s78, s79
    s_sub_u32 s66, 36864, s72
    s_mul_i32 s60, s4, 9216
    s_add_u32 s66, s66, s60
    s_xor_b32 s67, s73, 16384
    s_lshl_b32 s60, s4, 12
    s_add_u32 s67, s67, s60
    s_add_u32 s67, s67, 73728
    v_add_u32 v10, s72, v5
    ds_read_b128 v[32:35], v10 offset:0
    ds_read_b128 v[36:39], v10 offset:18432
    ds_read_b128 v[40:43], v10 offset:1024
    ds_read_b128 v[44:47], v10 offset:19456
    s_waitcnt lgkmcnt(2)
    s_mov_b64 exec, s[32:33]
    s_add_u32 m0, s66, 0
    s_add_u32 s64, s76, 0
    buffer_load_dwordx4 v4, s[24:27], s64 offen lds
    s_mov_b64 exec, -1
    v_mfma_f32_16x16x32_bf16 v[48:51], a[0:3], v[32:35], 0
    v_mfma_f32_16x16x32_bf16 v[56:59], a[0:3], v[36:39], 0
    v_mfma_f32_16x16x32_bf16 v[52:55], a[72:75], v[32:35], 0
    v_mfma_f32_16x16x32_bf16 v[60:63], a[72:75], v[36:39], 0
    ds_read_b128 v[32:35], v10 offset:2048
    ds_read_b128 v[36:39], v10 offset:20480
    s_waitcnt lgkmcnt(2)
    s_mov_b64 exec, s[32:33]
    s_add_u32 m0, s66, 1024
    s_add_u32 s64, s76, 64
    buffer_load_dwordx4 v4, s[24:27], s64 offen lds
    s_mov_b64 exec, -1
    v_mfma_f32_16x16x32_bf16 v[48:51], a[4:7], v[40:43], v[48:51]
    v_mfma_f32_16x16x32_bf16 v[56:59], a[4:7], v[44:47], v[56:59]
    v_mfma_f32_16x16x32_bf16 v[52:55], a[76:79], v[40:43], v[52:55]
    v_mfma_f32_16x16x32_bf16 v[60:63], a[76:79], v[44:47], v[60:63]
    ds_read_b128 v[40:43], v10 offset:3072
    ds_read_b128 v[44:47], v10 offset:21504
    s_waitcnt lgkmcnt(2)
    s_mov_b64 exec, s[32:33]
    s_add_u32 m0, s66, 2048
    s_add_u32 s64, s76, 128
    buffer_load_dwordx4 v4, s[24:27], s64 offen lds
    s_mov_b64 exec, -1
    v_mfma_f32_16x16x32_bf16 v[48:51], a[8:11], v[32:35], v[48:51]
    v_mfma_f32_16x16x32_bf16 v[56:59], a[8:11], v[36:39], v[56:59]
    v_mfma_f32_16x16x32_bf16 v[52:55], a[80:83], v[32:35], v[52:55]
    v_mfma_f32_16x16x32_bf16 v[60:63], a[80:83], v[36:39], v[60:63]
    ds_read_b128 v[32:35], v10 offset:4096
    ds_read_b128 v[36:39], v10 offset:22528
    s_waitcnt lgkmcnt(2)
    s_mov_b64 exec, s[32:33]
    s_add_u32 m0, s66, 3072
    s_add_u32 s64, s76, 192
    buffer_load_dwordx4 v4, s[24:27], s64 offen lds
    s_mov_b64 exec, -1
    v_mfma_f32_16x16x32_bf16 v[48:51], a[12:15], v[40:43], v[48:51]
    v_mfma_f32_16x16x32_bf16 v[56:59], a[12:15], v[44:47], v[56:59]
    v_mfma_f32_16x16x32_bf16 v[52:55], a[84:87], v[40:43], v[52:55]
    v_mfma_f32_16x16x32_bf16 v[60:63], a[84:87], v[44:47], v[60:63]
    ds_read_b128 v[40:43], v10 offset:5120
    ds_read_b128 v[44:47], v10 offset:23552
    s_waitcnt lgkmcnt(2)
    s_mov_b64 exec, s[32:33]
    s_add_u32 m0, s66, 4096
    s_add_u32 s64, s76, 256
    buffer_load_dwordx4 v4, s[24:27], s64 offen lds
    s_mov_b64 exec, -1
    v_mfma_f32_16x16x32_bf16 v[48:51], a[16:19], v[32:35], v[48:51]
    v_mfma_f32_16x16x32_bf16 v[56:59], a[16:19], v[36:39], v[56:59]
    v_mfma_f32_16x16x32_bf16 v[52:55], a[88:91], v[32:35], v[52:55]
    v_mfma_f32_16x16x32_bf16 v[60:63], a[88:91], v[36:39], v[60:63]
    ds_read_b128 v[32:35], v10 offset:6144
    ds_read_b128 v[36:39], v10 offset:24576
    s_waitcnt lgkmcnt(2)
    s_mov_b64 exec, s[32:33]
    s_add_u32 m0, s66, 5120
    s_add_u32 s64, s76, 320
    buffer_load_dwordx4 v4, s[24:27], s64 offen lds
    s_mov_b64 exec, -1
    v_mfma_f32_16x16x32_bf16 v[48:51], a[20:23], v[40:43], v[48:51]
    v_mfma_f32_16x16x32_bf16 v[56:59], a[20:23], v[44:47], v[56:59]
    v_mfma_f32_16x16x32_bf16 v[52:55], a[92:95], v[40:43], v[52:55]
    v_mfma_f32_16x16x32_bf16 v[60:63], a[92:95], v[44:47], v[60:63]
    ds_read_b128 v[40:43], v10 offset:7168
    ds_read_b128 v[44:47], v10 offset:25600
    s_waitcnt lgkmcnt(2)
    s_mov_b64 exec, s[32:33]
    s_add_u32 m0, s66, 6144
    s_add_u32 s64, s76, 384
    buffer_load_dwordx4 v4, s[24:27], s64 offen lds
    s_mov_b64 exec, -1
    v_mfma_f32_16x16x32_bf16 v[48:51], a[24:27], v[32:35], v[48:51]
    v_mfma_f32_16x16x32_bf16 v[56:59], a[24:27], v[36:39], v[56:59]
    v_mfma_f32_16x16x32_bf16 v[52:55], a[96:99], v[32:35], v[52:55]
    v_mfma_f32_16x16x32_bf16 v[60:63], a[96:99], v[36:39], v[60:63]
    ds_read_b128 v[32:35], v10 offset:8192
    ds_read_b128 v[36:39], v10 offset:26624
    s_waitcnt lgkmcnt(2)
    s_mov_b64 exec, s[32:33]
    s_add_u32 m0, s66, 7168
    s_add_u32 s64, s76, 448
    buffer_load_dwordx4 v4, s[24:27], s64 offen lds
    s_mov_b64 exec, -1
    v_mfma_f32_16x16x32_bf16 v[48:51], a[28:31], v[40:43], v[48:51]
    v_mfma_f32_16x16x32_bf16 v[56:59], a[28:31], v[44:47], v[56:59]
    v_mfma_f32_16x16x32_bf16 v[52:55], a[100:103], v[40:43], v[52:55]
    v_mfma_f32_16x16x32_bf16 v[60:63], a[100:103], v[44:47], v[60:63]
    ds_read_b128 v[40:43], v10 offset:9216
    ds_read_b128 v[44:47], v10 offset:27648
    s_waitcnt lgkmcnt(2)
    s_mov_b64 exec, s[32:33]
    s_add_u32 m0, s66, 8192
    s_add_u32 s64, s76, 512
    buffer_load_dwordx4 v4, s[24:27], s64 offen lds
    s_mov_b64 exec, -1
    v_mfma_f32_16x16x32_bf16 v[48:51], a[32:35], v[32:35], v[48:51]
    v_mfma_f32_16x16x32_bf16 v[56:59], a[32:35], v[36:39], v[56:59]
    v_mfma_f32_16x16x32_bf16 v[52:55], a[104:107], v[32:35], v[52:55]
    v_mfma_f32_16x16x32_bf16 v[60:63], a[104:107], v[36:39], v[60:63]
    ds_read_b128 v[32:35], v10 offset:10240
    ds_read_b128 v[36:39], v10 offset:28672
    s_waitcnt lgkmcnt(2)
    s_mov_b64 exec, s[32:33]
    s_add_u32 m0, s67, 0
    s_add_u32 s64, s78, 0
    buffer_load_dwordx4 v5, s[8:11], s64 offen sc1 lds
    s_mov_b64 exec, -1
    v_mfma_f32_16x16x32_bf16 v[48:51], a[36:39], v[40:43], v[48:51]
    v_mfma_f32_16x16x32_bf16 v[56:59], a[36:39], v[44:47], v[56:59]
    v_mfma_f32_16x16x32_bf16 v[52:55], a[108:111], v[40:43], v[52:55]
    v_mfma_f32_16x16x32_bf16 v[60:63], a[108:111], v[44:47], v[60:63]
    ds_read_b128 v[40:43], v10 offset:11264
    ds_read_b128 v[44:47], v10 offset:29696
    s_waitcnt lgkmcnt(2)
    s_mov_b64 exec, s[32:33]
    s_add_u32 m0, s67, 1024
    s_add_u32 s64, s78, 1024
    buffer_load_dwordx4 v5, s[8:11], s64 offen sc1 lds
    s_mov_b64 exec, -1
    v_mfma_f32_16x16x32_bf16 v[48:51], a[40:43], v[32:35], v[48:51]
    v_mfma_f32_16x16x32_bf16 v[56:59], a[40:43], v[36:39], v[56:59]
    v_mfma_f32_16x16x32_bf16 v[52:55], a[112:115], v[32:35], v[52:55]
    v_mfma_f32_16x16x32_bf16 v[60:63], a[112:115], v[36:39], v[60:63]
    ds_read_b128 v[32:35], v10 offset:12288
    ds_read_b128 v[36:39], v10 offset:30720
    s_waitcnt lgkmcnt(2)
    s_mov_b64 exec, s[32:33]
    s_add_u32 m0, s67, 2048
    s_add_u32 s64, s78, 2048
    buffer_load_dwordx4 v5, s[8:11], s64 offen sc1 lds
    s_mov_b64 exec, -1
    v_mfma_f32_16x16x32_bf16 v[48:51], a[44:47], v[40:43], v[48:51]
    v_mfma_f32_16x16x32_bf16 v[56:59], a[44:47], v[44:47], v[56:59]
    v_mfma_f32_16x16x32_bf16 v[52:55], a[116:119], v[40:43], v[52:55]
    v_mfma_f32_16x16x32_bf16 v[60:63], a[116:119], v[44:47], v[60:63]
    ds_read_b128 v[40:43], v10 offset:13312
    ds_read_b128 v[44:47], v10 offset:31744
    s_waitcnt lgkmcnt(2)
    s_mov_b64 exec, s[32:33]
    s_add_u32 m0, s67, 3072
    s_add_u32 s64, s78, 3072
    buffer_load_dwordx4 v5, s[8:11], s64 offen sc1 lds
    s_mov_b64 exec, -1
    v_mfma_f32_16x16x32_bf16 v[48:51], a[48:51], v[32:35], v[48:51]
    v_mfma_f32_16x16x32_bf16 v[56:59], a[48:51], v[36:39], v[56:59]
    v_mfma_f32_16x16x32_bf16 v[52:55], a[120:123], v[32:35], v[52:55]
    v_mfma_f32_16x16x32_bf16 v[60:63], a[120:123], v[36:39], v[60:63]
    ds_read_b128 v[32:35], v10 offset:14336
    ds_read_b128 v[36:39], v10 offset:32768
    s_waitcnt lgkmcnt(2)
    v_mfma_f32_16x16x32_bf16 v[48:51], a[52:55], v[40:43], v[48:51]
    v_mfma_f32_16x16x32_bf16 v[56:59], a[52:55], v[44:47], v[56:59]
    v_mfma_f32_16x16x32_bf16 v[52:55], a[124:127], v[40:43], v[52:55]
    v_mfma_f32_16x16x32_bf16 v[60:63], a[124:127], v[44:47], v[60:63]
    ds_read_b128 v[40:43], v10 offset:15360
    ds_read_b128 v[44:47], v10 offset:33792
    s_waitcnt lgkmcnt(2)
    v_mfma_f32_16x16x32_bf16 v[48:51], a[56:59], v[32:35], v[48:51]
    v_mfma_f32_16x16x32_bf16 v[56:59], a[56:59], v[36:39], v[56:59]
    v_mfma_f32_16x16x32_bf16 v[52:55], a[128:131], v[32:35], v[52:55]
    v_mfma_f32_16x16x32_bf16 v[60:63], a[128:131], v[36:39], v[60:63]
    ds_read_b128 v[32:35], v10 offset:16384
    ds_read_b128 v[36:39], v10 offset:34816
    s_waitcnt lgkmcnt(2)
    v_mfma_f32_16x16x32_bf16 v[48:51], a[60:63], v[40:43], v[48:51]
    v_mfma_f32_16x16x32_bf16 v[56:59], a[60:63], v[44:47], v[56:59]
    v_mfma_f32_16x16x32_bf16 v[52:55], a[132:135], v[40:43], v[52:55]
    v_mfma_f32_16x16x32_bf16 v[60:63], a[132:135], v[44:47], v[60:63]
    ds_read_b128 v[40:43], v10 offset:17408
    ds_read_b128 v[44:47], v10 offset:35840
    s_waitcnt lgkmcnt(2)
    v_mfma_f32_16x16x32_bf16 v[48:51], a[64:67], v[32:35], v[48:51]
    v_mfma_f32_16x16x32_bf16 v[56:59], a[64:67], v[36:39], v[56:59]
    v_mfma_f32_16x16x32_bf16 v[52:55], a[136:139], v[32:35], v[52:55]
    v_mfma_f32_16x16x32_bf16 v[60:63], a[136:139], v[36:39], v[60:63]
    s_waitcnt lgkmcnt(0)
    v_mfma_f32_16x16x32_bf16 v[48:51], a[68:71], v[40:43], v[48:51]
    v_mfma_f32_16x16x32_bf16 v[56:59], a[68:71], v[44:47], v[56:59]
    v_mfma_f32_16x16x32_bf16 v[52:55], a[140:143], v[40:43], v[52:55]
    v_mfma_f32_16x16x32_bf16 v[60:63], a[140:143], v[44:47], v[60:63]
    s_nop 4
    v_cvt_pk_bf16_f32 v48, v48, v49
    v_cvt_pk_bf16_f32 v49, v50, v51
    v_cvt_pk_bf16_f32 v50, v52, v53
    v_cvt_pk_bf16_f32 v51, v54, v55
    v_cvt_pk_bf16_f32 v56, v56, v57
    v_cvt_pk_bf16_f32 v57, v58, v59
    v_cvt_pk_bf16_f32 v58, v60, v61
    v_cvt_pk_bf16_f32 v59, v62, v63
    s_lshl_b32 s60, s4, 10
    s_add_u32 s60, s60, 114688
    v_add_u32 v32, s60, v5
    ds_write_b128 v32, v[48:51]
    ds_write_b128 v32, v[56:59] offset:4096
    s_cmp_eq_u32 s70, 0
    s_cbranch_scc1 L_late_143
    s_waitcnt vmcnt(13) lgkmcnt(0)
    s_branch L_rdy_142
L_late_143:
    s_cmp_lt_u32 s71, 58
    s_cbranch_scc1 L_flg_144
    s_cmp_lt_u32 s71, 61
    s_cbranch_scc1 L_dpl_145
    s_sub_u32 s78, s71, 6
    s_sub_u32 s76, s71, 3
    s_waitcnt vmcnt(0)
    s_barrier
    s_cmp_lt_u32 s71, 3
    s_cbranch_scc1 L_np_146
    s_cmp_lg_u32 s4, 0
    s_cbranch_scc1 L_np_146
    s_sub_u32 s60, s71, 3
    s_lshl_b32 s60, s60, 7
    s_lshl_b32 s61, s6, 2
    s_add_u32 s60, s60, s61
    s_add_u32 s60, s60, 16384
    v_mov_b32 v32, 1
    s_mov_b64 exec, 1
    buffer_store_dword v32, off, s[8:11], s60 sc1
    s_mov_b64 exec, -1
L_np_146:
    v_cmp_ne_u32 vcc, 1, v30
    s_cbranch_vccz L_xok_147
    s_lshl_b32 s61, s78, 7
    s_add_u32 s61, s61, 16384
    s_mov_b32 s59, 0
L_xrs_148:
    buffer_load_dword v30, v31, s[8:11], s61 offen sc1
    s_waitcnt vmcnt(0)
    v_cmp_ne_u32 vcc, 1, v30
    s_cbranch_vccz L_xrs_ok_149
    s_add_u32 s59, s59, 1
    s_cmp_lt_u32 s59, s58
    s_cbranch_scc1 L_xrs_148
    s_mov_b32 s58, 0
L_xrs_ok_149:
L_xok_147:
    s_mul_i32 s61, s78, 1179648
    s_lshl_b32 s64, s74, 13
    s_add_u32 s61, s61, s64
    s_add_u32 s61, s61, 54525952
    buffer_load_dwordx4 v[160:163], v5, s[8:11], s61 offen offset:0 sc1
    buffer_load_dwordx4 v[164:167], v5, s[8:11], s61 offen offset:1024 sc1
    buffer_load_dwordx4 v[168:171], v5, s[8:11], s61 offen offset:2048 sc1
    buffer_load_dwordx4 v[172:175], v5, s[8:11], s61 offen offset:3072 sc1
    s_add_u32 s61, s61, 4096
    buffer_load_dwordx4 v[176:179], v5, s[8:11], s61 offen offset:0 sc1
    buffer_load_dwordx4 v[180:183], v5, s[8:11], s61 offen offset:1024 sc1
    buffer_load_dwordx4 v[184:187], v5, s[8:11], s61 offen offset:2048 sc1
    buffer_load_dwordx4 v[188:191], v5, s[8:11], s61 offen offset:3072 sc1
    s_mov_b32 s75, 1
    s_and_b32 s64, s74, 7
    s_cbranch_scc1 L_u2_150
    s_mul_i32 s61, s78, 1179648
    s_lshl_b32 s64, s34, 13
    s_add_u32 s61, s61, s64
    s_add_u32 s61, s61, 54525952
    buffer_load_dwordx4 v[192:195], v5, s[8:11], s61 offen offset:0 sc1
    buffer_load_dwordx4 v[196:199], v5, s[8:11], s61 offen offset:1024 sc1
    buffer_load_dwordx4 v[200:203], v5, s[8:11], s61 offen offset:2048 sc1
    buffer_load_dwordx4 v[204:207], v5, s[8:11], s61 offen offset:3072 sc1
    s_add_u32 s61, s61, 4096
    buffer_load_dwordx4 v[208:211], v5, s[8:11], s61 offen offset:0 sc1
    buffer_load_dwordx4 v[212:215], v5, s[8:11], s61 offen offset:1024 sc1
    buffer_load_dwordx4 v[216:219], v5, s[8:11], s61 offen offset:2048 sc1
    buffer_load_dwordx4 v[220:223], v5, s[8:11], s61 offen offset:3072 sc1
    s_mov_b32 s75, 2
L_u2_150:
    s_lshl_b32 s61, s76, 7
    s_add_u32 s61, s61, 16384
    s_mov_b32 s59, 0
L_xrs2_151:
    buffer_load_dword v30, v31, s[8:11], s61 offen sc1
    s_waitcnt vmcnt(0)
    v_cmp_ne_u32 vcc, 1, v30
    s_cbranch_vccz L_xrs2_ok_152
    s_add_u32 s59, s59, 1
    s_cmp_lt_u32 s59, s58
    s_cbranch_scc1 L_xrs2_151
    s_mov_b32 s58, 0
L_xrs2_ok_152:
    s_mul_i32 s61, s76, 1179648
    s_lshl_b32 s64, s74, 13
    s_add_u32 s61, s61, s64
    s_add_u32 s61, s61, 54525952
    buffer_load_dwordx4 v[64:67], v5, s[8:11], s61 offen offset:0 sc1
    buffer_load_dwordx4 v[68:71], v5, s[8:11], s61 offen offset:1024 sc1
    buffer_load_dwordx4 v[72:75], v5, s[8:11], s61 offen offset:2048 sc1
    buffer_load_dwordx4 v[76:79], v5, s[8:11], s61 offen offset:3072 sc1
    s_add_u32 s61, s61, 4096
    buffer_load_dwordx4 v[80:83], v5, s[8:11], s61 offen offset:0 sc1
    buffer_load_dwordx4 v[84:87], v5, s[8:11], s61 offen offset:1024 sc1
    buffer_load_dwordx4 v[88:91], v5, s[8:11], s61 offen offset:2048 sc1
    buffer_load_dwordx4 v[92:95], v5, s[8:11], s61 offen offset:3072 sc1
    s_mov_b32 s75, 1
    s_and_b32 s64, s74, 7
    s_cbranch_scc1 L_u2_153
    s_mul_i32 s61, s76, 1179648
    s_lshl_b32 s64, s34, 13
    s_add_u32 s61, s61, s64
    s_add_u32 s61, s61, 54525952
    buffer_load_dwordx4 v[96:99], v5, s[8:11], s61 offen offset:0 sc1
    buffer_load_dwordx4 v[100:103], v5, s[8:11], s61 offen offset:1024 sc1
    buffer_load_dwordx4 v[104:107], v5, s[8:11], s61 offen offset:2048 sc1
    buffer_load_dwordx4 v[108:111], v5, s[8:11], s61 offen offset:3072 sc1
    s_add_u32 s61, s61, 4096
    buffer_load_dwordx4 v[112:115], v5, s[8:11], s61 offen offset:0 sc1
    buffer_load_dwordx4 v[116:119], v5, s[8:11], s61 offen offset:1024 sc1
    buffer_load_dwordx4 v[120:123], v5, s[8:11], s61 offen offset:2048 sc1
    buffer_load_dwordx4 v[124:127], v5, s[8:11], s61 offen offset:3072 sc1
    s_mov_b32 s75, 2
L_u2_153:
    s_mov_b32 s62, 0x00030003
    s_mov_b32 s63, 0x00030003
    v_cndmask_b32 v128, 0, v8, s[62:63]
    s_lshl_b64 s[62:63], s[62:63], 2
    v_cndmask_b32 v129, 0, v8, s[62:63]
    s_lshl_b64 s[62:63], s[62:63], 2
    v_cndmask_b32 v130, 0, v8, s[62:63]
    s_lshl_b64 s[62:63], s[62:63], 2
    v_cndmask_b32 v131, 0, v8, s[62:63]
    s_nop 1
    v_mfma_f32_16x16x32_bf16 v[132:135], v[128:131], v[160:163], 0
    v_mfma_f32_16x16x32_bf16 v[132:135], v[128:131], v[164:167], v[132:135]
    v_mfma_f32_16x16x32_bf16 v[132:135], v[128:131], v[168:171], v[132:135]
    v_mfma_f32_16x16x32_bf16 v[132:135], v[128:131], v[172:175], v[132:135]
    v_mfma_f32_16x16x32_bf16 v[132:135], v[128:131], v[176:179], v[132:135]
    v_mfma_f32_16x16x32_bf16 v[132:135], v[128:131], v[180:183], v[132:135]
    v_mfma_f32_16x16x32_bf16 v[132:135], v[128:131], v[184:187], v[132:135]
    v_mfma_f32_16x16x32_bf16 v[132:135], v[128:131], v[188:191], v[132:135]
    s_mul_i32 s61, s78, 73728
    s_lshl_b32 s64, s74, 3
    s_add_u32 s61, s61, s64
    s_nop 4
    v_cvt_pk_bf16_f32 v132, v132, v133
    v_cvt_pk_bf16_f32 v133, v134, v135
    buffer_store_dwordx2 v[132:133], v7, s[28:31], s61 offen
    s_cmp_lt_u32 s75, 2
    s_cbranch_scc1 L_f2_154
    v_mfma_f32_16x16x32_bf16 v[132:135], v[128:131], v[192:195], 0
    v_mfma_f32_16x16x32_bf16 v[132:135], v[128:131], v[196:199], v[132:135]
    v_mfma_f32_16x16x32_bf16 v[132:135], v[128:131], v[200:203], v[132:135]
    v_mfma_f32_16x16x32_bf16 v[132:135], v[128:131], v[204:207], v[132:135]
    v_mfma_f32_16x16x32_bf16 v[132:135], v[128:131], v[208:211], v[132:135]
    v_mfma_f32_16x16x32_bf16 v[132:135], v[128:131], v[212:215], v[132:135]
    v_mfma_f32_16x16x32_bf16 v[132:135], v[128:131], v[216:219], v[132:135]
    v_mfma_f32_16x16x32_bf16 v[132:135], v[128:131], v[220:223], v[132:135]
    s_mul_i32 s61, s78, 73728
    s_lshl_b32 s64, s34, 3
    s_add_u32 s61, s61, s64
    s_nop 4
    v_cvt_pk_bf16_f32 v132, v132, v133
    v_cvt_pk_bf16_f32 v133, v134, v135
    buffer_store_dwordx2 v[132:133], v7, s[28:31], s61 offen
L_f2_154:
    s_waitcnt vmcnt(1)
    s_lshl_b32 s78, s71, 13
    s_add_u32 s78, s78, s80
    s_lshl_b32 s60, s4, 11
    s_add_u32 s60, s60, 106496
    v_add_u32 v153, s60, v5
    buffer_load_dwordx4 v[144:147], v5, s[8:11], s78 offen offset:0 sc1
    buffer_load_dwordx4 v[148:151], v5, s[8:11], s78 offen offset:1024 sc1
    s_mov_b32 s62, 0x00030003
    s_mov_b32 s63, 0x00030003
    v_cndmask_b32 v128, 0, v8, s[62:63]
    s_lshl_b64 s[62:63], s[62:63], 2
    v_cndmask_b32 v129, 0, v8, s[62:63]
    s_lshl_b64 s[62:63], s[62:63], 2
    v_cndmask_b32 v130, 0, v8, s[62:63]
    s_lshl_b64 s[62:63], s[62:63], 2
    v_cndmask_b32 v131, 0, v8, s[62:63]
    s_nop 1
    v_mfma_f32_16x16x32_bf16 v[132:135], v[128:131], v[64:67], 0
    v_mfma_f32_16x16x32_bf16 v[132:135], v[128:131], v[68:71], v[132:135]
    v_mfma_f32_16x16x32_bf16 v[132:135], v[128:131], v[72:75], v[132:135]
    v_mfma_f32_16x16x32_bf16 v[132:135], v[128:131], v[76:79], v[132:135]
    v_mfma_f32_16x16x32_bf16 v[132:135], v[128:131], v[80:83], v[132:135]
    v_mfma_f32_16x16x32_bf16 v[132:135], v[128:131], v[84:87], v[132:135]
    v_mfma_f32_16x16x32_bf16 v[132:135], v[128:131], v[88:91], v[132:135]
    v_mfma_f32_16x16x32_bf16 v[132:135], v[128:131], v[92:95], v[132:135]
    s_mul_i32 s61, s76, 73728
    s_lshl_b32 s64, s74, 3
    s_add_u32 s61, s61, s64
    s_nop 4
    v_cvt_pk_bf16_f32 v132, v132, v133
    v_cvt_pk_bf16_f32 v133, v134, v135
    buffer_store_dwordx2 v[132:133], v7, s[28:31], s61 offen
    s_cmp_lt_u32 s75, 2
    s_cbranch_scc1 L_f2_156
    v_mfma_f32_16x16x32_bf16 v[132:135], v[128:131], v[96:99], 0
    v_mfma_f32_16x16x32_bf16 v[132:135], v[128:131], v[100:103], v[132:135]
    v_mfma_f32_16x16x32_bf16 v[132:135], v[128:131], v[104:107], v[132:135]
    v_mfma_f32_16x16x32_bf16 v[132:135], v[128:131], v[108:111], v[132:135]
    v_mfma_f32_16x16x32_bf16 v[132:135], v[128:131], v[112:115], v[132:135]
    v_mfma_f32_16x16x32_bf16 v[132:135], v[128:131], v[116:119], v[132:135]
    v_mfma_f32_16x16x32_bf16 v[132:135], v[128:131], v[120:123], v[132:135]
    v_mfma_f32_16x16x32_bf16 v[132:135], v[128:131], v[124:127], v[132:135]
    s_mul_i32 s61, s76, 73728
    s_lshl_b32 s64, s34, 3
    s_add_u32 s61, s61, s64
    s_nop 4
    v_cvt_pk_bf16_f32 v132, v132, v133
    v_cvt_pk_bf16_f32 v133, v134, v135
    buffer_store_dwordx2 v[132:133], v7, s[28:31], s61 offen
L_f2_156:
    s_waitcnt vmcnt(1)
    v_max3_u32 v152, v144, v145, v146
    v_max3_u32 v152, v152, v147, v148
    v_max3_u32 v152, v152, v149, v150
    v_max_u32 v152, v152, v151
    v_cmp_eq_u32 vcc, -1, v152
    s_cbranch_vccz L_mkgot_155
L_dpl_145:
    s_lshl_b32 s78, s71, 13
    s_add_u32 s78, s78, s80
    s_lshl_b32 s60, s4, 11
    s_add_u32 s60, s60, 106496
    v_add_u32 v153, s60, v5
    s_mov_b32 s59, 0
L_mkd_157:
    buffer_load_dwordx4 v[144:147], v5, s[8:11], s78 offen offset:0 sc1
    buffer_load_dwordx4 v[148:151], v5, s[8:11], s78 offen offset:1024 sc1
    s_waitcnt vmcnt(0)
    v_max3_u32 v152, v144, v145, v146
    v_max3_u32 v152, v152, v147, v148
    v_max3_u32 v152, v152, v149, v150
    v_max_u32 v152, v152, v151
    v_cmp_eq_u32 vcc, -1, v152
    s_cbranch_vccz L_mkd_ok_158
    s_add_u32 s59, s59, 1
    s_cmp_lt_u32 s59, s58
    s_cbranch_scc1 L_mkd_157
    s_mov_b32 s58, 0
L_mkd_ok_158:
L_mkgot_155:
    ds_write_b128 v153, v[144:147]
    ds_write_b128 v153, v[148:151] offset:1024
    s_waitcnt lgkmcnt(0)
    s_branch L_rdy_142
L_flg_144:
    s_lshl_b32 s78, s71, 2
    s_add_u32 s78, s78, s81
    s_mov_b32 s59, 0
L_mk_159:
    buffer_load_dword v9, off, s[8:11], s78 sc1
    s_waitcnt vmcnt(0)
    v_cmp_ne_u32 vcc, 1, v9
    s_cbranch_vccz L_mk_ok_160
    s_add_u32 s59, s59, 1
    s_cmp_lt_u32 s59, s58
    s_cbranch_scc1 L_mk_159
    s_mov_b32 s58, 0
L_mk_ok_160:
    s_lshl_b32 s64, s71, 13
    s_add_u32 s64, s64, s80
    s_lshl_b32 s65, s4, 11
    s_add_u32 m0, s65, 106496
    s_nop 0
    buffer_load_dwordx4 v5, s[8:11], s64 offen sc1 lds
    s_add_u32 m0, s65, 107520
    s_add_u32 s64, s64, 1024
    buffer_load_dwordx4 v5, s[8:11], s64 offen sc1 lds
    s_waitcnt vmcnt(0) lgkmcnt(0)
L_rdy_142:
    s_barrier
    s_cmp_lt_u32 s71, 3
    s_cbranch_scc1 L_np_161
    s_cmp_lg_u32 s4, 0
    s_cbranch_scc1 L_np_161
    s_sub_u32 s60, s71, 3
    s_lshl_b32 s60, s60, 7
    s_lshl_b32 s61, s6, 2
    s_add_u32 s60, s60, s61
    s_add_u32 s60, s60, 16384
    v_mov_b32 v32, 1
    s_mov_b64 exec, 1
    buffer_store_dword v32, off, s[8:11], s60 sc1
    s_mov_b64 exec, -1
L_np_161:
    s_add_u32 s60, s71, 3
    s_min_u32 s60, s60, 63
    s_lshl_b32 s60, s60, 2
    s_add_u32 s60, s60, s81
    buffer_load_dword v9, off, s[8:11], s60 sc1
    s_sub_u32 s61, s71, 6
    s_max_i32 s61, s61, 0
    s_lshl_b32 s61, s61, 7
    s_add_u32 s61, s61, 16384
    buffer_load_dword v30, v31, s[8:11], s61 offen sc1
    v_add_u32 v32, s73, v12
    v_add_u32 v33, s73, v13
    v_add_u32 v34, 106496, v5
    s_lshl_b32 s60, s69, 12
    v_add_u32 v35, s60, v34
    ds_read_b128 v[64:67], v11 offset:0
    ds_read_b128 v[68:71], v11 offset:1024
    ds_read_b128 v[72:75], v11 offset:2048
    ds_read_b128 v[76:79], v11 offset:3072
    ds_read_b128 v[80:83], v32 offset:0
    ds_read_b128 v[84:87], v32 offset:1024
    ds_read_b128 v[88:91], v32 offset:4096
    ds_read_b128 v[92:95], v32 offset:5120
    ds_read_b128 v[96:99], v32 offset:8192
    ds_read_b128 v[100:103], v32 offset:9216
    ds_read_b128 v[104:107], v32 offset:12288
    ds_read_b128 v[108:111], v32 offset:13312
    ds_read_b128 v[144:147], v34 offset:0
    ds_read_b128 v[148:151], v34 offset:2048
    ds_read_b128 v[152:155], v34 offset:4096
    ds_read_b128 v[156:159], v34 offset:6144
    s_waitcnt lgkmcnt(10)
    v_mfma_f32_16x16x32_bf16 v[112:115], v[80:83], v[64:67], v[16:19]
    v_mfma_f32_16x16x32_bf16 v[116:119], v[84:87], v[64:67], v[20:23]
    s_waitcnt lgkmcnt(8)
    v_mfma_f32_16x16x32_bf16 v[112:115], v[88:91], v[68:71], v[112:115]
    v_mfma_f32_16x16x32_bf16 v[116:119], v[92:95], v[68:71], v[116:119]
    s_waitcnt lgkmcnt(6)
    v_mfma_f32_16x16x32_bf16 v[112:115], v[96:99], v[72:75], v[112:115]
    v_mfma_f32_16x16x32_bf16 v[116:119], v[100:103], v[72:75], v[116:119]
    s_waitcnt lgkmcnt(4)
    v_mfma_f32_16x16x32_bf16 v[112:115], v[104:107], v[76:79], v[112:115]
    v_mfma_f32_16x16x32_bf16 v[116:119], v[108:111], v[76:79], v[116:119]
    s_waitcnt lgkmcnt(3)
    v_mfma_f32_16x16x32_bf16 v[120:123], v[144:147], v[64:67], 0
    s_waitcnt lgkmcnt(2)
    v_mfma_f32_16x16x32_bf16 v[120:123], v[148:151], v[68:71], v[120:123]
    s_waitcnt lgkmcnt(1)
    v_mfma_f32_16x16x32_bf16 v[120:123], v[152:155], v[72:75], v[120:123]
    s_waitcnt lgkmcnt(0)
    v_mfma_f32_16x16x32_bf16 v[120:123], v[156:159], v[76:79], v[120:123]
    ds_read_b128 v[160:163], v33 offset:2048
    ds_read_b128 v[164:167], v33 offset:3072
    ds_read_b128 v[168:171], v33 offset:6144
    ds_read_b128 v[172:175], v33 offset:7168
    ds_read_b128 v[176:179], v35 offset:1024
    ds_read_b128 v[180:183], v35 offset:3072
    v_max3_f32 v130, v112, v113, v114
    v_max3_f32 v131, v115, v116, v117
    v_max3_f32 v130, v130, v118, v119
    v_max3_f32 v131, v131, v120, v121
    v_max3_f32 v130, v130, v122, v123
    v_max_f32 v130, v130, v131
    v_mov_b32 v131, v130
    s_nop 1
    v_permlane16_swap_b32 v130, v131
    v_max_f32 v130, v130, v131
    v_mov_b32 v131, v130
    s_nop 1
    v_permlane32_swap_b32 v130, v131
    v_max_f32 v130, v130, v131
    v_mul_f32 v130, s83, v130
    v_fma_f32 v112, v112, s83, -v130
    v_fma_f32 v113, v113, s83, -v130
    v_fma_f32 v114, v114, s83, -v130
    v_fma_f32 v115, v115, s83, -v130
    v_fma_f32 v116, v116, s83, -v130
    v_fma_f32 v117, v117, s83, -v130
    v_fma_f32 v118, v118, s83, -v130
    v_fma_f32 v119, v119, s83, -v130
    v_fma_f32 v120, v120, s83, -v130
    v_fma_f32 v121, v121, s83, -v130
    v_fma_f32 v122, v122, s83, -v130
    v_fma_f32 v123, v123, s83, -v130
    v_exp_f32 v112, v112
    v_exp_f32 v113, v113
    v_exp_f32 v114, v114
    v_exp_f32 v115, v115
    v_exp_f32 v116, v116
    v_exp_f32 v117, v117
    v_exp_f32 v118, v118
    v_exp_f32 v119, v119
    v_exp_f32 v120, v120
    v_exp_f32 v121, v121
    v_exp_f32 v122, v122
    v_exp_f32 v123, v123
    v_cvt_pk_bf16_f32 v124, v112, v113
    v_cvt_pk_bf16_f32 v125, v114, v115
    v_cvt_pk_bf16_f32 v126, v116, v117
    v_cvt_pk_bf16_f32 v127, v118, v119
    v_cvt_pk_bf16_f32 v128, v120, v121
    v_cvt_pk_bf16_f32 v129, v122, v123
    s_waitcnt lgkmcnt(0)
    v_mfma_f32_16x16x32_bf16 v[132:135], v[24:27], v[124:127], 0
    v_mfma_f32_16x16x32_bf16 v[136:139], v[160:163], v[124:127], 0
    v_mfma_f32_16x16x32_bf16 v[140:143], v[164:167], v[124:127], 0
    v_mfma_f32_16x16x32_bf16 v[144:147], v[168:171], v[124:127], 0
    v_mfma_f32_16x16x32_bf16 v[148:151], v[172:175], v[124:127], 0
    v_mfma_f32_16x16x16_bf16 v[132:135], v[28:29], v[128:129], v[132:135]
    v_mfma_f32_16x16x16_bf16 v[136:139], v[176:177], v[128:129], v[136:139]
    v_mfma_f32_16x16x16_bf16 v[140:143], v[178:179], v[128:129], v[140:143]
    v_mfma_f32_16x16x16_bf16 v[144:147], v[180:181], v[128:129], v[144:147]
    v_mfma_f32_16x16x16_bf16 v[148:151], v[182:183], v[128:129], v[148:151]
    s_nop 3
    v_rcp_f32 v130, v132
    s_nop 0
    v_mul_f32 v136, v136, v130
    v_mul_f32 v137, v137, v130
    v_mul_f32 v138, v138, v130
    v_mul_f32 v139, v139, v130
    v_mul_f32 v140, v140, v130
    v_mul_f32 v141, v141, v130
    v_mul_f32 v142, v142, v130
    v_mul_f32 v143, v143, v130
    v_mul_f32 v144, v144, v130
    v_mul_f32 v145, v145, v130
    v_mul_f32 v146, v146, v130
    v_mul_f32 v147, v147, v130
    v_mul_f32 v148, v148, v130
    v_mul_f32 v149, v149, v130
    v_mul_f32 v150, v150, v130
    v_mul_f32 v151, v151, v130
    v_cvt_pk_bf16_f32 v136, v136, v137
    v_cvt_pk_bf16_f32 v137, v138, v139
    v_cvt_pk_bf16_f32 v138, v140, v141
    v_cvt_pk_bf16_f32 v139, v142, v143
    v_cvt_pk_bf16_f32 v140, v144, v145
    v_cvt_pk_bf16_f32 v141, v146, v147
    v_cvt_pk_bf16_f32 v142, v148, v149
    v_cvt_pk_bf16_f32 v143, v150, v151
    ds_write_b128 v14, v[136:139]
    ds_write_b128 v14, v[140:143] offset:1024
    s_waitcnt lgkmcnt(0)
    s_barrier
    ds_read_b128 v[64:67], v15 offset:0
    ds_read_b128 v[68:71], v15 offset:1024
    ds_read_b128 v[72:75], v15 offset:2048
    ds_read_b128 v[76:79], v15 offset:3072
    ds_read_b128 v[80:83], v15 offset:4096
    ds_read_b128 v[84:87], v15 offset:5120
    ds_read_b128 v[88:91], v15 offset:6144
    ds_read_b128 v[92:95], v15 offset:7168
    s_mov_b32 s75, 0
    s_cmp_lt_u32 s71, 6
    s_cbranch_scc1 L_nr_162
    s_cmp_ge_u32 s71, 61
    s_cbranch_scc1 L_nr_162
    s_sub_u32 s60, s71, 6
    s_waitcnt vmcnt(0)
    v_cmp_ne_u32 vcc, 1, v30
    s_cbranch_vccz L_xok_164
    s_lshl_b32 s61, s60, 7
    s_add_u32 s61, s61, 16384
    s_mov_b32 s59, 0
L_xrs_165:
    buffer_load_dword v30, v31, s[8:11], s61 offen sc1
    s_waitcnt vmcnt(0)
    v_cmp_ne_u32 vcc, 1, v30
    s_cbranch_vccz L_xrs_ok_166
    s_add_u32 s59, s59, 1
    s_cmp_lt_u32 s59, s58
    s_cbranch_scc1 L_xrs_165
    s_mov_b32 s58, 0
L_xrs_ok_166:
L_xok_164:
    s_mul_i32 s61, s60, 1179648
    s_lshl_b32 s64, s74, 13
    s_add_u32 s61, s61, s64
    s_add_u32 s61, s61, 54525952
    buffer_load_dwordx4 v[160:163], v5, s[8:11], s61 offen offset:0 sc1
    buffer_load_dwordx4 v[164:167], v5, s[8:11], s61 offen offset:1024 sc1
    buffer_load_dwordx4 v[168:171], v5, s[8:11], s61 offen offset:2048 sc1
    buffer_load_dwordx4 v[172:175], v5, s[8:11], s61 offen offset:3072 sc1
    s_add_u32 s61, s61, 4096
    buffer_load_dwordx4 v[176:179], v5, s[8:11], s61 offen offset:0 sc1
    buffer_load_dwordx4 v[180:183], v5, s[8:11], s61 offen offset:1024 sc1
    buffer_load_dwordx4 v[184:187], v5, s[8:11], s61 offen offset:2048 sc1
    buffer_load_dwordx4 v[188:191], v5, s[8:11], s61 offen offset:3072 sc1
    s_mov_b32 s75, 1
    s_and_b32 s64, s74, 7
    s_cbranch_scc1 L_u2_167
    s_mul_i32 s61, s60, 1179648
    s_lshl_b32 s64, s34, 13
    s_add_u32 s61, s61, s64
    s_add_u32 s61, s61, 54525952
    buffer_load_dwordx4 v[192:195], v5, s[8:11], s61 offen offset:0 sc1
    buffer_load_dwordx4 v[196:199], v5, s[8:11], s61 offen offset:1024 sc1
    buffer_load_dwordx4 v[200:203], v5, s[8:11], s61 offen offset:2048 sc1
    buffer_load_dwordx4 v[204:207], v5, s[8:11], s61 offen offset:3072 sc1
    s_add_u32 s61, s61, 4096
    buffer_load_dwordx4 v[208:211], v5, s[8:11], s61 offen offset:0 sc1
    buffer_load_dwordx4 v[212:215], v5, s[8:11], s61 offen offset:1024 sc1
    buffer_load_dwordx4 v[216:219], v5, s[8:11], s61 offen offset:2048 sc1
    buffer_load_dwordx4 v[220:223], v5, s[8:11], s61 offen offset:3072 sc1
    s_mov_b32 s75, 2
L_u2_167:
L_nr_162:
    s_mul_i32 s78, s71, 1179648
    s_add_u32 s78, s78, s82
    s_waitcnt lgkmcnt(0)
    v_mfma_f32_16x16x32_bf16 v[96:99], a[144:147], v[64:67], 0
    v_mfma_f32_16x16x32_bf16 v[100:103], a[144:147], v[80:83], 0
    v_mfma_f32_16x16x32_bf16 v[96:99], a[148:151], v[68:71], v[96:99]
    v_mfma_f32_16x16x32_bf16 v[100:103], a[148:151], v[84:87], v[100:103]
    v_mfma_f32_16x16x32_bf16 v[96:99], a[152:155], v[72:75], v[96:99]
    v_mfma_f32_16x16x32_bf16 v[100:103], a[152:155], v[88:91], v[100:103]
    v_mfma_f32_16x16x32_bf16 v[96:99], a[156:159], v[76:79], v[96:99]
    v_mfma_f32_16x16x32_bf16 v[100:103], a[156:159], v[92:95], v[100:103]
    v_mfma_f32_16x16x32_bf16 v[104:107], a[160:163], v[64:67], 0
    v_mfma_f32_16x16x32_bf16 v[108:111], a[160:163], v[80:83], 0
    v_mfma_f32_16x16x32_bf16 v[104:107], a[164:167], v[68:71], v[104:107]
    v_mfma_f32_16x16x32_bf16 v[108:111], a[164:167], v[84:87], v[108:111]
    s_nop 2
    v_cvt_pk_bf16_f32 v112, v96, v97
    v_cvt_pk_bf16_f32 v113, v98, v99
    v_cvt_pk_bf16_f32 v114, v100, v101
    v_cvt_pk_bf16_f32 v115, v102, v103
    s_add_u32 s64, s78, 0
    buffer_store_dwordx4 v[112:115], v6, s[8:11], s64 offen sc1
    v_mfma_f32_16x16x32_bf16 v[104:107], a[168:171], v[72:75], v[104:107]
    v_mfma_f32_16x16x32_bf16 v[108:111], a[168:171], v[88:91], v[108:111]
    v_mfma_f32_16x16x32_bf16 v[104:107], a[172:175], v[76:79], v[104:107]
    v_mfma_f32_16x16x32_bf16 v[108:111], a[172:175], v[92:95], v[108:111]
    v_mfma_f32_16x16x32_bf16 v[96:99], a[176:179], v[64:67], 0
    v_mfma_f32_16x16x32_bf16 v[100:103], a[176:179], v[80:83], 0
    v_mfma_f32_16x16x32_bf16 v[96:99], a[180:183], v[68:71], v[96:99]
    v_mfma_f32_16x16x32_bf16 v[100:103], a[180:183], v[84:87], v[100:103]
    s_nop 2
    v_cvt_pk_bf16_f32 v116, v104, v105
    v_cvt_pk_bf16_f32 v117, v106, v107
    v_cvt_pk_bf16_f32 v118, v108, v109
    v_cvt_pk_bf16_f32 v119, v110, v111
    s_add_u32 s64, s78, 131072
    buffer_store_dwordx4 v[116:119], v6, s[8:11], s64 offen sc1
    v_mfma_f32_16x16x32_bf16 v[96:99], a[184:187], v[72:75], v[96:99]
    v_mfma_f32_16x16x32_bf16 v[100:103], a[184:187], v[88:91], v[100:103]
    v_mfma_f32_16x16x32_bf16 v[96:99], a[188:191], v[76:79], v[96:99]
    v_mfma_f32_16x16x32_bf16 v[100:103], a[188:191], v[92:95], v[100:103]
    v_mfma_f32_16x16x32_bf16 v[104:107], a[192:195], v[64:67], 0
    v_mfma_f32_16x16x32_bf16 v[108:111], a[192:195], v[80:83], 0
    v_mfma_f32_16x16x32_bf16 v[104:107], a[196:199], v[68:71], v[104:107]
    v_mfma_f32_16x16x32_bf16 v[108:111], a[196:199], v[84:87], v[108:111]
    s_nop 2
    v_cvt_pk_bf16_f32 v112, v96, v97
    v_cvt_pk_bf16_f32 v113, v98, v99
    v_cvt_pk_bf16_f32 v114, v100, v101
    v_cvt_pk_bf16_f32 v115, v102, v103
    s_add_u32 s64, s78, 262144
    buffer_store_dwordx4 v[112:115], v6, s[8:11], s64 offen sc1
    v_mfma_f32_16x16x32_bf16 v[104:107], a[200:203], v[72:75], v[104:107]
    v_mfma_f32_16x16x32_bf16 v[108:111], a[200:203], v[88:91], v[108:111]
    v_mfma_f32_16x16x32_bf16 v[104:107], a[204:207], v[76:79], v[104:107]
    v_mfma_f32_16x16x32_bf16 v[108:111], a[204:207], v[92:95], v[108:111]
    v_mfma_f32_16x16x32_bf16 v[96:99], a[208:211], v[64:67], 0
    v_mfma_f32_16x16x32_bf16 v[100:103], a[208:211], v[80:83], 0
    v_mfma_f32_16x16x32_bf16 v[96:99], a[212:215], v[68:71], v[96:99]
    v_mfma_f32_16x16x32_bf16 v[100:103], a[212:215], v[84:87], v[100:103]
    s_nop 2
    v_cvt_pk_bf16_f32 v116, v104, v105
    v_cvt_pk_bf16_f32 v117, v106, v107
    v_cvt_pk_bf16_f32 v118, v108, v109
    v_cvt_pk_bf16_f32 v119, v110, v111
    s_add_u32 s64, s78, 393216
    buffer_store_dwordx4 v[116:119], v6, s[8:11], s64 offen sc1
    v_mfma_f32_16x16x32_bf16 v[96:99], a[216:219], v[72:75], v[96:99]
    v_mfma_f32_16x16x32_bf16 v[100:103], a[216:219], v[88:91], v[100:103]
    v_mfma_f32_16x16x32_bf16 v[96:99], a[220:223], v[76:79], v[96:99]
    v_mfma_f32_16x16x32_bf16 v[100:103], a[220:223], v[92:95], v[100:103]
    v_mfma_f32_16x16x32_bf16 v[104:107], a[224:227], v[64:67], 0
    v_mfma_f32_16x16x32_bf16 v[108:111], a[224:227], v[80:83], 0
    v_mfma_f32_16x16x32_bf16 v[104:107], a[228:231], v[68:71], v[104:107]
    v_mfma_f32_16x16x32_bf16 v[108:111], a[228:231], v[84:87], v[108:111]
    s_nop 2
    v_cvt_pk_bf16_f32 v112, v96, v97
    v_cvt_pk_bf16_f32 v113, v98, v99
    v_cvt_pk_bf16_f32 v114, v100, v101
    v_cvt_pk_bf16_f32 v115, v102, v103
    s_add_u32 s64, s78, 524288
    buffer_store_dwordx4 v[112:115], v6, s[8:11], s64 offen sc1
    v_mfma_f32_16x16x32_bf16 v[104:107], a[232:235], v[72:75], v[104:107]
    v_mfma_f32_16x16x32_bf16 v[108:111], a[232:235], v[88:91], v[108:111]
    v_mfma_f32_16x16x32_bf16 v[104:107], a[236:239], v[76:79], v[104:107]
    v_mfma_f32_16x16x32_bf16 v[108:111], a[236:239], v[92:95], v[108:111]
    v_mfma_f32_16x16x32_bf16 v[96:99], a[240:243], v[64:67], 0
    v_mfma_f32_16x16x32_bf16 v[100:103], a[240:243], v[80:83], 0
    v_mfma_f32_16x16x32_bf16 v[96:99], a[244:247], v[68:71], v[96:99]
    v_mfma_f32_16x16x32_bf16 v[100:103], a[244:247], v[84:87], v[100:103]
    s_nop 2
    v_cvt_pk_bf16_f32 v116, v104, v105
    v_cvt_pk_bf16_f32 v117, v106, v107
    v_cvt_pk_bf16_f32 v118, v108, v109
    v_cvt_pk_bf16_f32 v119, v110, v111
    s_add_u32 s64, s78, 655360
    buffer_store_dwordx4 v[116:119], v6, s[8:11], s64 offen sc1
    v_mfma_f32_16x16x32_bf16 v[96:99], a[248:251], v[72:75], v[96:99]
    v_mfma_f32_16x16x32_bf16 v[100:103], a[248:251], v[88:91], v[100:103]
    v_mfma_f32_16x16x32_bf16 v[96:99], a[252:255], v[76:79], v[96:99]
    v_mfma_f32_16x16x32_bf16 v[100:103], a[252:255], v[92:95], v[100:103]
    v_mfma_f32_16x16x32_bf16 v[104:107], v[224:227], v[64:67], 0
    v_mfma_f32_16x16x32_bf16 v[108:111], v[224:227], v[80:83], 0
    v_mfma_f32_16x16x32_bf16 v[104:107], v[228:231], v[68:71], v[104:107]
    v_mfma_f32_16x16x32_bf16 v[108:111], v[228:231], v[84:87], v[108:111]
    s_nop 2
    v_cvt_pk_bf16_f32 v112, v96, v97
    v_cvt_pk_bf16_f32 v113, v98, v99
    v_cvt_pk_bf16_f32 v114, v100, v101
    v_cvt_pk_bf16_f32 v115, v102, v103
    s_add_u32 s64, s78, 786432
    buffer_store_dwordx4 v[112:115], v6, s[8:11], s64 offen sc1
    v_mfma_f32_16x16x32_bf16 v[104:107], v[232:235], v[72:75], v[104:107]
    v_mfma_f32_16x16x32_bf16 v[108:111], v[232:235], v[88:91], v[108:111]
    v_mfma_f32_16x16x32_bf16 v[104:107], v[236:239], v[76:79], v[104:107]
    v_mfma_f32_16x16x32_bf16 v[108:111], v[236:239], v[92:95], v[108:111]
    v_mfma_f32_16x16x32_bf16 v[96:99], v[240:243], v[64:67], 0
    v_mfma_f32_16x16x32_bf16 v[100:103], v[240:243], v[80:83], 0
    v_mfma_f32_16x16x32_bf16 v[96:99], v[244:247], v[68:71], v[96:99]
    v_mfma_f32_16x16x32_bf16 v[100:103], v[244:247], v[84:87], v[100:103]
    s_nop 2
    v_cvt_pk_bf16_f32 v116, v104, v105
    v_cvt_pk_bf16_f32 v117, v106, v107
    v_cvt_pk_bf16_f32 v118, v108, v109
    v_cvt_pk_bf16_f32 v119, v110, v111
    s_add_u32 s64, s78, 917504
    buffer_store_dwordx4 v[116:119], v6, s[8:11], s64 offen sc1
    v_mfma_f32_16x16x32_bf16 v[96:99], v[248:251], v[72:75], v[96:99]
    v_mfma_f32_16x16x32_bf16 v[100:103], v[248:251], v[88:91], v[100:103]
    v_mfma_f32_16x16x32_bf16 v[96:99], v[252:255], v[76:79], v[96:99]
    v_mfma_f32_16x16x32_bf16 v[100:103], v[252:255], v[92:95], v[100:103]
    s_nop 6
    v_cvt_pk_bf16_f32 v112, v96, v97
    v_cvt_pk_bf16_f32 v113, v98, v99
    v_cvt_pk_bf16_f32 v114, v100, v101
    v_cvt_pk_bf16_f32 v115, v102, v103
    s_add_u32 s64, s78, 1048576
    buffer_store_dwordx4 v[112:115], v6, s[8:11], s64 offen sc1
    s_cmp_eq_u32 s75, 0
    s_cbranch_scc1 L_nrf_168
    s_waitcnt vmcnt(9)
    s_sub_u32 s60, s71, 6
    s_mov_b32 s62, 0x00030003
    s_mov_b32 s63, 0x00030003
    v_cndmask_b32 v120, 0, v8, s[62:63]
    s_lshl_b64 s[62:63], s[62:63], 2
    v_cndmask_b32 v121, 0, v8, s[62:63]
    s_lshl_b64 s[62:63], s[62:63], 2
    v_cndmask_b32 v122, 0, v8, s[62:63]
    s_lshl_b64 s[62:63], s[62:63], 2
    v_cndmask_b32 v123, 0, v8, s[62:63]
    s_nop 1
    v_mfma_f32_16x16x32_bf16 v[124:127], v[120:123], v[160:163], 0
    v_mfma_f32_16x16x32_bf16 v[124:127], v[120:123], v[164:167], v[124:127]
    v_mfma_f32_16x16x32_bf16 v[124:127], v[120:123], v[168:171], v[124:127]
    v_mfma_f32_16x16x32_bf16 v[124:127], v[120:123], v[172:175], v[124:127]
    v_mfma_f32_16x16x32_bf16 v[124:127], v[120:123], v[176:179], v[124:127]
    v_mfma_f32_16x16x32_bf16 v[124:127], v[120:123], v[180:183], v[124:127]
    v_mfma_f32_16x16x32_bf16 v[124:127], v[120:123], v[184:187], v[124:127]
    v_mfma_f32_16x16x32_bf16 v[124:127], v[120:123], v[188:191], v[124:127]
    s_mul_i32 s61, s60, 73728
    s_lshl_b32 s64, s74, 3
    s_add_u32 s61, s61, s64
    s_nop 4
    v_cvt_pk_bf16_f32 v124, v124, v125
    v_cvt_pk_bf16_f32 v125, v126, v127
    buffer_store_dwordx2 v[124:125], v7, s[28:31], s61 offen
    s_cmp_lt_u32 s75, 2
    s_cbranch_scc1 L_f2_169
    v_mfma_f32_16x16x32_bf16 v[124:127], v[120:123], v[192:195], 0
    v_mfma_f32_16x16x32_bf16 v[124:127], v[120:123], v[196:199], v[124:127]
    v_mfma_f32_16x16x32_bf16 v[124:127], v[120:123], v[200:203], v[124:127]
    v_mfma_f32_16x16x32_bf16 v[124:127], v[120:123], v[204:207], v[124:127]
    v_mfma_f32_16x16x32_bf16 v[124:127], v[120:123], v[208:211], v[124:127]
    v_mfma_f32_16x16x32_bf16 v[124:127], v[120:123], v[212:215], v[124:127]
    v_mfma_f32_16x16x32_bf16 v[124:127], v[120:123], v[216:219], v[124:127]
    v_mfma_f32_16x16x32_bf16 v[124:127], v[120:123], v[220:223], v[124:127]
    s_mul_i32 s61, s60, 73728
    s_lshl_b32 s64, s34, 3
    s_add_u32 s61, s61, s64
    s_nop 4
    v_cvt_pk_bf16_f32 v124, v124, v125
    v_cvt_pk_bf16_f32 v125, v126, v127
    buffer_store_dwordx2 v[124:125], v7, s[28:31], s61 offen
L_f2_169:
L_nrf_168:
    s_waitcnt vmcnt(11)
    s_add_u32 s71, s71, 3
    s_sub_u32 s72, 36864, s72
    s_xor_b32 s73, s73, 16384
    s_cmp_lt_u32 s71, 64
    s_cbranch_scc1 L_x2_138
    s_sub_u32 s78, s71, 3
    s_mov_b32 s59, 0
L_xpd_170:
    s_mul_i32 s61, s78, 1179648
    s_lshl_b32 s64, s74, 13
    s_add_u32 s61, s61, s64
    s_add_u32 s61, s61, 54525952
    buffer_load_dwordx4 v[160:163], v5, s[8:11], s61 offen offset:0 sc1
    buffer_load_dwordx4 v[164:167], v5, s[8:11], s61 offen offset:1024 sc1
    buffer_load_dwordx4 v[168:171], v5, s[8:11], s61 offen offset:2048 sc1
    buffer_load_dwordx4 v[172:175], v5, s[8:11], s61 offen offset:3072 sc1
    s_add_u32 s61, s61, 4096
    buffer_load_dwordx4 v[176:179], v5, s[8:11], s61 offen offset:0 sc1
    buffer_load_dwordx4 v[180:183], v5, s[8:11], s61 offen offset:1024 sc1
    buffer_load_dwordx4 v[184:187], v5, s[8:11], s61 offen offset:2048 sc1
    buffer_load_dwordx4 v[188:191], v5, s[8:11], s61 offen offset:3072 sc1
    s_mov_b32 s75, 1
    s_and_b32 s64, s74, 7
    s_cbranch_scc1 L_u2_172
    s_mul_i32 s61, s78, 1179648
    s_lshl_b32 s64, s34, 13
    s_add_u32 s61, s61, s64
    s_add_u32 s61, s61, 54525952
    buffer_load_dwordx4 v[192:195], v5, s[8:11], s61 offen offset:0 sc1
    buffer_load_dwordx4 v[196:199], v5, s[8:11], s61 offen offset:1024 sc1
    buffer_load_dwordx4 v[200:203], v5, s[8:11], s61 offen offset:2048 sc1
    buffer_load_dwordx4 v[204:207], v5, s[8:11], s61 offen offset:3072 sc1
    s_add_u32 s61, s61, 4096
    buffer_load_dwordx4 v[208:211], v5, s[8:11], s61 offen offset:0 sc1
    buffer_load_dwordx4 v[212:215], v5, s[8:11], s61 offen offset:1024 sc1
    buffer_load_dwordx4 v[216:219], v5, s[8:11], s61 offen offset:2048 sc1
    buffer_load_dwordx4 v[220:223], v5, s[8:11], s61 offen offset:3072 sc1
    s_mov_b32 s75, 2
L_u2_172:
    s_waitcnt vmcnt(0)
    s_cmp_lt_u32 s75, 2
    s_cbranch_scc1 L_c1_173
    v_max3_u32 v96, v160, v161, v162
    v_max3_u32 v96, v96, v163, v164
    v_max3_u32 v96, v96, v165, v166
    v_max3_u32 v96, v96, v167, v168
    v_max3_u32 v96, v96, v169, v170
    v_max3_u32 v96, v96, v171, v172
    v_max3_u32 v96, v96, v173, v174
    v_max3_u32 v96, v96, v175, v176
    v_max3_u32 v96, v96, v177, v178
    v_max3_u32 v96, v96, v179, v180
    v_max3_u32 v96, v96, v181, v182
    v_max3_u32 v96, v96, v183, v184
    v_max3_u32 v96, v96, v185, v186
    v_max3_u32 v96, v96, v187, v188
    v_max3_u32 v96, v96, v189, v190
    v_max3_u32 v96, v96, v191, v192
    v_max3_u32 v96, v96, v193, v194
    v_max3_u32 v96, v96, v195, v196
    v_max3_u32 v96, v96, v197, v198
    v_max3_u32 v96, v96, v199, v200
    v_max3_u32 v96, v96, v201, v202
    v_max3_u32 v96, v96, v203, v204
    v_max3_u32 v96, v96, v205, v206
    v_max3_u32 v96, v96, v207, v208
    v_max3_u32 v96, v96, v209, v210
    v_max3_u32 v96, v96, v211, v212
    v_max3_u32 v96, v96, v213, v214
    v_max3_u32 v96, v96, v215, v216
    v_max3_u32 v96, v96, v217, v218
    v_max3_u32 v96, v96, v219, v220
    v_max3_u32 v96, v96, v221, v222
    v_max_u32 v96, v96, v223
    v_cmp_eq_u32 vcc, -1, v96
    s_branch L_c2_174
L_c1_173:
    v_max3_u32 v96, v160, v161, v162
    v_max3_u32 v96, v96, v163, v164
    v_max3_u32 v96, v96, v165, v166
    v_max3_u32 v96, v96, v167, v168
    v_max3_u32 v96, v96, v169, v170
    v_max3_u32 v96, v96, v171, v172
    v_max3_u32 v96, v96, v173, v174
    v_max3_u32 v96, v96, v175, v176
    v_max3_u32 v96, v96, v177, v178
    v_max3_u32 v96, v96, v179, v180
    v_max3_u32 v96, v96, v181, v182
    v_max3_u32 v96, v96, v183, v184
    v_max3_u32 v96, v96, v185, v186
    v_max3_u32 v96, v96, v187, v188
    v_max3_u32 v96, v96, v189, v190
    v_max_u32 v96, v96, v191
    v_cmp_eq_u32 vcc, -1, v96
L_c2_174:
    s_cbranch_vccz L_xpd_ok_171
    s_add_u32 s59, s59, 1
    s_cmp_lt_u32 s59, s58
    s_cbranch_scc1 L_xpd_170
    s_mov_b32 s58, 0
L_xpd_ok_171:
    s_mov_b32 s62, 0x00030003
    s_mov_b32 s63, 0x00030003
    v_cndmask_b32 v120, 0, v8, s[62:63]
    s_lshl_b64 s[62:63], s[62:63], 2
    v_cndmask_b32 v121, 0, v8, s[62:63]
    s_lshl_b64 s[62:63], s[62:63], 2
    v_cndmask_b32 v122, 0, v8, s[62:63]
    s_lshl_b64 s[62:63], s[62:63], 2
    v_cndmask_b32 v123, 0, v8, s[62:63]
    s_nop 1
    v_mfma_f32_16x16x32_bf16 v[124:127], v[120:123], v[160:163], 0
    v_mfma_f32_16x16x32_bf16 v[124:127], v[120:123], v[164:167], v[124:127]
    v_mfma_f32_16x16x32_bf16 v[124:127], v[120:123], v[168:171], v[124:127]
    v_mfma_f32_16x16x32_bf16 v[124:127], v[120:123], v[172:175], v[124:127]
    v_mfma_f32_16x16x32_bf16 v[124:127], v[120:123], v[176:179], v[124:127]
    v_mfma_f32_16x16x32_bf16 v[124:127], v[120:123], v[180:183], v[124:127]
    v_mfma_f32_16x16x32_bf16 v[124:127], v[120:123], v[184:187], v[124:127]
    v_mfma_f32_16x16x32_bf16 v[124:127], v[120:123], v[188:191], v[124:127]
    s_mul_i32 s61, s78, 73728
    s_lshl_b32 s64, s74, 3
    s_add_u32 s61, s61, s64
    s_nop 4
    v_cvt_pk_bf16_f32 v124, v124, v125
    v_cvt_pk_bf16_f32 v125, v126, v127
    buffer_store_dwordx2 v[124:125], v7, s[28:31], s61 offen
    s_cmp_lt_u32 s75, 2
    s_cbranch_scc1 L_f2_175
    v_mfma_f32_16x16x32_bf16 v[124:127], v[120:123], v[192:195], 0
    v_mfma_f32_16x16x32_bf16 v[124:127], v[120:123], v[196:199], v[124:127]
    v_mfma_f32_16x16x32_bf16 v[124:127], v[120:123], v[200:203], v[124:127]
    v_mfma_f32_16x16x32_bf16 v[124:127], v[120:123], v[204:207], v[124:127]
    v_mfma_f32_16x16x32_bf16 v[124:127], v[120:123], v[208:211], v[124:127]
    v_mfma_f32_16x16x32_bf16 v[124:127], v[120:123], v[212:215], v[124:127]
    v_mfma_f32_16x16x32_bf16 v[124:127], v[120:123], v[216:219], v[124:127]
    v_mfma_f32_16x16x32_bf16 v[124:127], v[120:123], v[220:223], v[124:127]
    s_mul_i32 s61, s78, 73728
    s_lshl_b32 s64, s34, 3
    s_add_u32 s61, s61, s64
    s_nop 4
    v_cvt_pk_bf16_f32 v124, v124, v125
    v_cvt_pk_bf16_f32 v125, v126, v127
    buffer_store_dwordx2 v[124:125], v7, s[28:31], s61 offen
L_f2_175:
    s_waitcnt vmcnt(0)
L_x2end_137:
    s_waitcnt vmcnt(0)
    s_cmp_eq_u32 s5, 1
    s_cbranch_scc1 L_nowx_176
    s_waitcnt vmcnt(0)
    s_barrier
    s_cmp_lg_u32 s4, 0
    s_cbranch_scc1 L_nowb_177
    s_lshl_b32 s60, s5, 5
    s_add_u32 s60, s60, 16
    v_mov_b32 v4, 1
    s_mov_b64 exec, 1
    buffer_atomic_add v4, off, s[12:15], s60 sc0 sc1
    s_waitcnt vmcnt(0)
    v_readfirstlane_b32 s61, v4
    s_mov_b64 exec, -1
    s_cmp_lg_u32 s61, 31
    s_cbranch_scc1 L_nowb_177
    buffer_wbl2 sc1
L_nowb_177:
L_nowx_176:
    s_endpgm
.p2align 8
L_arole:
    v_and_b32 v1, 63, v0
    v_and_b32 v2, 15, v0
    v_lshrrev_b32 v3, 4, v1
    s_sub_u32 s60, s5, 4
    s_lshl_b32 s72, s60, 5
    s_add_u32 s72, s72, s6
    s_lshl_b32 s60, s60, 3
    s_and_b32 s61, s6, 7
    s_add_u32 s70, s60, s61
    s_lshr_b32 s71, s6, 3
    s_lshl_b32 s74, s71, 2
    s_add_u32 s74, s74, s4
    s_lshl_b32 s73, s74, 7
    s_mov_b32 s16, s32
    s_mov_b32 s17, s33
    s_mov_b32 s18, 2359296
    s_mov_b32 s19, 0x00020000
    s_mov_b32 s20, s34
    s_mov_b32 s21, s35
    s_mov_b32 s22, 1990656
    s_mov_b32 s23, 0x00020000
    s_mov_b32 s24, s36
    s_mov_b32 s25, s37
    s_mov_b32 s26, 663552
    s_mov_b32 s27, 0x00020000
    s_mov_b32 s28, s52
    s_mov_b32 s29, s53
    s_mov_b32 s30, 4718592
    s_mov_b32 s31, 0x00020000
    v_and_b32 v16, 31, v0
    v_lshrrev_b32 v17, 5, v0
    v_lshrrev_b32 v18, 3, v16
    v_and_b32 v19, 7, v16
    v_lshlrev_b32 v19, 2, v19
    v_subrev_u32 v20, 24, v16
    v_cmp_gt_u32 vcc, 24, v16
    s_nop 1
    v_cndmask_b32 v18, v20, v18, vcc
    v_mov_b32 v20, 32
    v_cndmask_b32 v19, v20, v19, vcc
    s_movk_i32 s60, 1152
    v_mul_lo_u32 v18, v18, s60
    v_add_u32 v18, v18, v19
    s_movk_i32 s60, 3456
    v_mul_lo_u32 v19, v17, s60
    v_add_u32 v18, v18, v19
    v_mov_b32 v19, 0x80000000
    v_cmp_gt_u32 vcc, 27, v16
    s_nop 1
    v_cndmask_b32 v18, v19, v18, vcc
    v_lshlrev_b32 v19, 2, v0
    s_mul_i32 s77, s70, 36
    v_add_u32 v21, 36864, v19
    buffer_load_dword v64, v18, s[20:23], s77 offen
    s_add_u32 s77, s77, 27648
    buffer_load_dword v65, v18, s[20:23], s77 offen
    s_add_u32 s77, s77, 27648
    buffer_load_dword v66, v18, s[20:23], s77 offen
    s_add_u32 s77, s77, 27648
    buffer_load_dword v67, v18, s[20:23], s77 offen
    s_add_u32 s77, s77, 27648
    buffer_load_dword v68, v18, s[20:23], s77 offen
    s_add_u32 s77, s77, 27648
    buffer_load_dword v69, v18, s[20:23], s77 offen
    s_add_u32 s77, s77, 27648
    buffer_load_dword v70, v18, s[20:23], s77 offen
    s_add_u32 s77, s77, 27648
    buffer_load_dword v71, v18, s[20:23], s77 offen
    s_add_u32 s77, s77, 27648
    buffer_load_dword v72, v18, s[20:23], s77 offen
    s_add_u32 s77, s77, 27648
    buffer_load_dword v73, v18, s[20:23], s77 offen
    s_add_u32 s77, s77, 27648
    buffer_load_dword v74, v18, s[20:23], s77 offen
    s_add_u32 s77, s77, 27648
    buffer_load_dword v75, v18, s[20:23], s77 offen
    s_add_u32 s77, s77, 27648
    buffer_load_dword v76, v18, s[20:23], s77 offen
    s_add_u32 s77, s77, 27648
    buffer_load_dword v77, v18, s[20:23], s77 offen
    s_add_u32 s77, s77, 27648
    buffer_load_dword v78, v18, s[20:23], s77 offen
    s_add_u32 s77, s77, 27648
    buffer_load_dword v79, v18, s[20:23], s77 offen
    s_add_u32 s77, s77, 27648
    buffer_load_dword v80, v18, s[20:23], s77 offen
    s_add_u32 s77, s77, 27648
    buffer_load_dword v81, v18, s[20:23], s77 offen
    s_add_u32 s77, s77, 27648
    buffer_load_dword v82, v18, s[20:23], s77 offen
    s_add_u32 s77, s77, 27648
    buffer_load_dword v83, v18, s[20:23], s77 offen
    s_add_u32 s77, s77, 27648
    buffer_load_dword v84, v18, s[20:23], s77 offen
    s_add_u32 s77, s77, 27648
    buffer_load_dword v85, v18, s[20:23], s77 offen
    s_add_u32 s77, s77, 27648
    buffer_load_dword v86, v18, s[20:23], s77 offen
    s_add_u32 s77, s77, 27648
    buffer_load_dword v87, v18, s[20:23], s77 offen
    s_add_u32 s77, s77, 27648
    buffer_load_dword v88, v18, s[20:23], s77 offen
    s_add_u32 s77, s77, 27648
    buffer_load_dword v89, v18, s[20:23], s77 offen
    s_add_u32 s77, s77, 27648
    buffer_load_dword v90, v18, s[20:23], s77 offen
    s_add_u32 s77, s77, 27648
    buffer_load_dword v91, v18, s[20:23], s77 offen
    s_add_u32 s77, s77, 27648
    buffer_load_dword v92, v18, s[20:23], s77 offen
    s_add_u32 s77, s77, 27648
    buffer_load_dword v93, v18, s[20:23], s77 offen
    s_add_u32 s77, s77, 27648
    buffer_load_dword v94, v18, s[20:23], s77 offen
    s_add_u32 s77, s77, 27648
    buffer_load_dword v95, v18, s[20:23], s77 offen
    s_add_u32 s77, s77, 27648
    buffer_load_dword v96, v18, s[20:23], s77 offen
    s_add_u32 s77, s77, 27648
    buffer_load_dword v97, v18, s[20:23], s77 offen
    s_add_u32 s77, s77, 27648
    buffer_load_dword v98, v18, s[20:23], s77 offen
    s_add_u32 s77, s77, 27648
    buffer_load_dword v99, v18, s[20:23], s77 offen
    s_add_u32 s77, s77, 27648
    buffer_load_dword v100, v18, s[20:23], s77 offen
    s_add_u32 s77, s77, 27648
    buffer_load_dword v101, v18, s[20:23], s77 offen
    s_add_u32 s77, s77, 27648
    buffer_load_dword v102, v18, s[20:23], s77 offen
    s_add_u32 s77, s77, 27648
    buffer_load_dword v103, v18, s[20:23], s77 offen
    s_add_u32 s77, s77, 27648
    buffer_load_dword v104, v18, s[20:23], s77 offen
    s_add_u32 s77, s77, 27648
    buffer_load_dword v105, v18, s[20:23], s77 offen
    s_add_u32 s77, s77, 27648
    buffer_load_dword v106, v18, s[20:23], s77 offen
    s_add_u32 s77, s77, 27648
    buffer_load_dword v107, v18, s[20:23], s77 offen
    s_add_u32 s77, s77, 27648
    buffer_load_dword v108, v18, s[20:23], s77 offen
    s_add_u32 s77, s77, 27648
    buffer_load_dword v109, v18, s[20:23], s77 offen
    s_add_u32 s77, s77, 27648
    buffer_load_dword v110, v18, s[20:23], s77 offen
    s_add_u32 s77, s77, 27648
    buffer_load_dword v111, v18, s[20:23], s77 offen
    s_add_u32 s77, s77, 27648
    buffer_load_dword v112, v18, s[20:23], s77 offen
    s_add_u32 s77, s77, 27648
    buffer_load_dword v113, v18, s[20:23], s77 offen
    s_add_u32 s77, s77, 27648
    buffer_load_dword v114, v18, s[20:23], s77 offen
    s_add_u32 s77, s77, 27648
    buffer_load_dword v115, v18, s[20:23], s77 offen
    s_add_u32 s77, s77, 27648
    buffer_load_dword v116, v18, s[20:23], s77 offen
    s_add_u32 s77, s77, 27648
    buffer_load_dword v117, v18, s[20:23], s77 offen
    s_add_u32 s77, s77, 27648
    buffer_load_dword v118, v18, s[20:23], s77 offen
    s_add_u32 s77, s77, 27648
    buffer_load_dword v119, v18, s[20:23], s77 offen
    s_add_u32 s77, s77, 27648
    buffer_load_dword v120, v18, s[20:23], s77 offen
    s_add_u32 s77, s77, 27648
    buffer_load_dword v121, v18, s[20:23], s77 offen
    s_add_u32 s77, s77, 27648
    buffer_load_dword v122, v18, s[20:23], s77 offen
    s_add_u32 s77, s77, 27648
    buffer_load_dword v123, v18, s[20:23], s77 offen
    s_add_u32 s77, s77, 27648
    buffer_load_dword v124, v18, s[20:23], s77 offen
    s_add_u32 s77, s77, 27648
    buffer_load_dword v125, v18, s[20:23], s77 offen
    s_add_u32 s77, s77, 27648
    buffer_load_dword v126, v18, s[20:23], s77 offen
    s_add_u32 s77, s77, 27648
    buffer_load_dword v127, v18, s[20:23], s77 offen
    s_add_u32 s77, s77, 27648
    buffer_load_dword v128, v18, s[20:23], s77 offen
    s_add_u32 s77, s77, 27648
    buffer_load_dword v129, v18, s[20:23], s77 offen
    s_add_u32 s77, s77, 27648
    buffer_load_dword v130, v18, s[20:23], s77 offen
    s_add_u32 s77, s77, 27648
    buffer_load_dword v131, v18, s[20:23], s77 offen
    s_add_u32 s77, s77, 27648
    buffer_load_dword v132, v18, s[20:23], s77 offen
    s_add_u32 s77, s77, 27648
    buffer_load_dword v133, v18, s[20:23], s77 offen
    s_add_u32 s77, s77, 27648
    buffer_load_dword v134, v18, s[20:23], s77 offen
    s_add_u32 s77, s77, 27648
    buffer_load_dword v135, v18, s[20:23], s77 offen
    s_add_u32 s77, s77, 27648
    s_waitcnt vmcnt(36)
    ds_write_b32 v19, v64 offset:0
    ds_write_b32 v19, v65 offset:1024
    ds_write_b32 v19, v66 offset:2048
    ds_write_b32 v19, v67 offset:3072
    ds_write_b32 v19, v68 offset:4096
    ds_write_b32 v19, v69 offset:5120
    ds_write_b32 v19, v70 offset:6144
    ds_write_b32 v19, v71 offset:7168
    ds_write_b32 v19, v72 offset:8192
    ds_write_b32 v19, v73 offset:9216
    ds_write_b32 v19, v74 offset:10240
    ds_write_b32 v19, v75 offset:11264
    ds_write_b32 v19, v76 offset:12288
    ds_write_b32 v19, v77 offset:13312
    ds_write_b32 v19, v78 offset:14336
    ds_write_b32 v19, v79 offset:15360
    ds_write_b32 v19, v80 offset:16384
    ds_write_b32 v19, v81 offset:17408
    ds_write_b32 v19, v82 offset:18432
    ds_write_b32 v19, v83 offset:19456
    ds_write_b32 v19, v84 offset:20480
    ds_write_b32 v19, v85 offset:21504
    ds_write_b32 v19, v86 offset:22528
    ds_write_b32 v19, v87 offset:23552
    ds_write_b32 v19, v88 offset:24576
    ds_write_b32 v19, v89 offset:25600
    ds_write_b32 v19, v90 offset:26624
    ds_write_b32 v19, v91 offset:27648
    ds_write_b32 v19, v92 offset:28672
    ds_write_b32 v19, v93 offset:29696
    ds_write_b32 v19, v94 offset:30720
    ds_write_b32 v19, v95 offset:31744
    ds_write_b32 v19, v96 offset:32768
    ds_write_b32 v19, v97 offset:33792
    ds_write_b32 v19, v98 offset:34816
    ds_write_b32 v19, v99 offset:35840
    s_waitcnt vmcnt(0)
    ds_write_b32 v21, v100 offset:0
    ds_write_b32 v21, v101 offset:1024
    ds_write_b32 v21, v102 offset:2048
    ds_write_b32 v21, v103 offset:3072
    ds_write_b32 v21, v104 offset:4096
    ds_write_b32 v21, v105 offset:5120
    ds_write_b32 v21, v106 offset:6144
    ds_write_b32 v21, v107 offset:7168
    ds_write_b32 v21, v108 offset:8192
    ds_write_b32 v21, v109 offset:9216
    ds_write_b32 v21, v110 offset:10240
    ds_write_b32 v21, v111 offset:11264
    ds_write_b32 v21, v112 offset:12288
    ds_write_b32 v21, v113 offset:13312
    ds_write_b32 v21, v114 offset:14336
    ds_write_b32 v21, v115 offset:15360
    ds_write_b32 v21, v116 offset:16384
    ds_write_b32 v21, v117 offset:17408
    ds_write_b32 v21, v118 offset:18432
    ds_write_b32 v21, v119 offset:19456
    ds_write_b32 v21, v120 offset:20480
    ds_write_b32 v21, v121 offset:21504
    ds_write_b32 v21, v122 offset:22528
    ds_write_b32 v21, v123 offset:23552
    ds_write_b32 v21, v124 offset:24576
    ds_write_b32 v21, v125 offset:25600
    ds_write_b32 v21, v126 offset:26624
    ds_write_b32 v21, v127 offset:27648
    ds_write_b32 v21, v128 offset:28672
    ds_write_b32 v21, v129 offset:29696
    ds_write_b32 v21, v130 offset:30720
    ds_write_b32 v21, v131 offset:31744
    ds_write_b32 v21, v132 offset:32768
    ds_write_b32 v21, v133 offset:33792
    ds_write_b32 v21, v134 offset:34816
    ds_write_b32 v21, v135 offset:35840
    s_waitcnt lgkmcnt(0)
    s_barrier
    v_lshrrev_b32 v18, 2, v2
    v_lshl_add_u32 v18, v3, 3, v18
    v_and_b32 v19, 3, v2
    v_lshlrev_b32 v20, 3, v19
    v_lshl_add_u32 v16, v18, 7, v20
    v_add_u32 v17, 36864, v16
    ds_read_b64_tr_b16 a[0:1], v16 offset:0
    ds_read_b64_tr_b16 a[2:3], v16 offset:512
    ds_read_b64_tr_b16 a[4:5], v16 offset:4096
    ds_read_b64_tr_b16 a[6:7], v16 offset:4608
    ds_read_b64_tr_b16 a[8:9], v16 offset:8192
    ds_read_b64_tr_b16 a[10:11], v16 offset:8704
    ds_read_b64_tr_b16 a[12:13], v16 offset:12288
    ds_read_b64_tr_b16 a[14:15], v16 offset:12800
    ds_read_b64_tr_b16 a[16:17], v16 offset:16384
    ds_read_b64_tr_b16 a[18:19], v16 offset:16896
    ds_read_b64_tr_b16 a[20:21], v16 offset:20480
    ds_read_b64_tr_b16 a[22:23], v16 offset:20992
    s_waitcnt lgkmcnt(6)
    ds_read_b64_tr_b16 a[24:25], v16 offset:24576
    ds_read_b64_tr_b16 a[26:27], v16 offset:25088
    ds_read_b64_tr_b16 a[28:29], v16 offset:28672
    ds_read_b64_tr_b16 a[30:31], v16 offset:29184
    ds_read_b64_tr_b16 a[32:33], v16 offset:32768
    ds_read_b64_tr_b16 a[34:35], v16 offset:33280
    ds_read_b64_tr_b16 a[36:37], v17 offset:0
    ds_read_b64_tr_b16 a[38:39], v17 offset:512
    ds_read_b64_tr_b16 a[40:41], v17 offset:4096
    ds_read_b64_tr_b16 a[42:43], v17 offset:4608
    ds_read_b64_tr_b16 a[44:45], v17 offset:8192
    ds_read_b64_tr_b16 a[46:47], v17 offset:8704
    s_waitcnt lgkmcnt(6)
    ds_read_b64_tr_b16 a[48:49], v17 offset:12288
    ds_read_b64_tr_b16 a[50:51], v17 offset:12800
    ds_read_b64_tr_b16 a[52:53], v17 offset:16384
    ds_read_b64_tr_b16 a[54:55], v17 offset:16896
    ds_read_b64_tr_b16 a[56:57], v17 offset:20480
    ds_read_b64_tr_b16 a[58:59], v17 offset:20992
    ds_read_b64_tr_b16 a[60:61], v17 offset:24576
    ds_read_b64_tr_b16 a[62:63], v17 offset:25088
    ds_read_b64_tr_b16 a[64:65], v17 offset:28672
    ds_read_b64_tr_b16 a[66:67], v17 offset:29184
    ds_read_b64_tr_b16 a[68:69], v17 offset:32768
    ds_read_b64_tr_b16 a[70:71], v17 offset:33280
    s_waitcnt lgkmcnt(6)
    ds_read_b64_tr_b16 a[72:73], v16 offset:32
    ds_read_b64_tr_b16 a[74:75], v16 offset:544
    ds_read_b64_tr_b16 a[76:77], v16 offset:4128
    ds_read_b64_tr_b16 a[78:79], v16 offset:4640
    ds_read_b64_tr_b16 a[80:81], v16 offset:8224
    ds_read_b64_tr_b16 a[82:83], v16 offset:8736
    ds_read_b64_tr_b16 a[84:85], v16 offset:12320
    ds_read_b64_tr_b16 a[86:87], v16 offset:12832
    ds_read_b64_tr_b16 a[88:89], v16 offset:16416
    ds_read_b64_tr_b16 a[90:91], v16 offset:16928
    ds_read_b64_tr_b16 a[92:93], v16 offset:20512
    ds_read_b64_tr_b16 a[94:95], v16 offset:21024
    s_waitcnt lgkmcnt(6)
    ds_read_b64_tr_b16 a[96:97], v16 offset:24608
    ds_read_b64_tr_b16 a[98:99], v16 offset:25120
    ds_read_b64_tr_b16 a[100:101], v16 offset:28704
    ds_read_b64_tr_b16 a[102:103], v16 offset:29216
    ds_read_b64_tr_b16 a[104:105], v16 offset:32800
    ds_read_b64_tr_b16 a[106:107], v16 offset:33312
    ds_read_b64_tr_b16 a[108:109], v17 offset:32
    ds_read_b64_tr_b16 a[110:111], v17 offset:544
    ds_read_b64_tr_b16 a[112:113], v17 offset:4128
    ds_read_b64_tr_b16 a[114:115], v17 offset:4640
    ds_read_b64_tr_b16 a[116:117], v17 offset:8224
    ds_read_b64_tr_b16 a[118:119], v17 offset:8736
    s_waitcnt lgkmcnt(6)
    ds_read_b64_tr_b16 a[120:121], v17 offset:12320
    ds_read_b64_tr_b16 a[122:123], v17 offset:12832
    ds_read_b64_tr_b16 a[124:125], v17 offset:16416
    ds_read_b64_tr_b16 a[126:127], v17 offset:16928
    ds_read_b64_tr_b16 a[128:129], v17 offset:20512
    ds_read_b64_tr_b16 a[130:131], v17 offset:21024
    ds_read_b64_tr_b16 a[132:133], v17 offset:24608
    ds_read_b64_tr_b16 a[134:135], v17 offset:25120
    ds_read_b64_tr_b16 a[136:137], v17 offset:28704
    ds_read_b64_tr_b16 a[138:139], v17 offset:29216
    ds_read_b64_tr_b16 a[140:141], v17 offset:32800
    ds_read_b64_tr_b16 a[142:143], v17 offset:33312
    s_waitcnt lgkmcnt(6)
    ds_read_b64_tr_b16 a[144:145], v16 offset:64
    ds_read_b64_tr_b16 a[146:147], v16 offset:576
    ds_read_b64_tr_b16 a[148:149], v16 offset:4160
    ds_read_b64_tr_b16 a[150:151], v16 offset:4672
    ds_read_b64_tr_b16 a[152:153], v16 offset:8256
    ds_read_b64_tr_b16 a[154:155], v16 offset:8768
    ds_read_b64_tr_b16 a[156:157], v16 offset:12352
    ds_read_b64_tr_b16 a[158:159], v16 offset:12864
    ds_read_b64_tr_b16 a[160:161], v16 offset:16448
    ds_read_b64_tr_b16 a[162:163], v16 offset:16960
    ds_read_b64_tr_b16 a[164:165], v16 offset:20544
    ds_read_b64_tr_b16 a[166:167], v16 offset:21056
    s_waitcnt lgkmcnt(6)
    ds_read_b64_tr_b16 a[168:169], v16 offset:24640
    ds_read_b64_tr_b16 a[170:171], v16 offset:25152
    ds_read_b64_tr_b16 a[172:173], v16 offset:28736
    ds_read_b64_tr_b16 a[174:175], v16 offset:29248
    ds_read_b64_tr_b16 a[176:177], v16 offset:32832
    ds_read_b64_tr_b16 a[178:179], v16 offset:33344
    ds_read_b64_tr_b16 a[180:181], v17 offset:64
    ds_read_b64_tr_b16 a[182:183], v17 offset:576
    ds_read_b64_tr_b16 a[184:185], v17 offset:4160
    ds_read_b64_tr_b16 a[186:187], v17 offset:4672
    ds_read_b64_tr_b16 a[188:189], v17 offset:8256
    ds_read_b64_tr_b16 a[190:191], v17 offset:8768
    s_waitcnt lgkmcnt(6)
    ds_read_b64_tr_b16 a[192:193], v17 offset:12352
    ds_read_b64_tr_b16 a[194:195], v17 offset:12864
    ds_read_b64_tr_b16 a[196:197], v17 offset:16448
    ds_read_b64_tr_b16 a[198:199], v17 offset:16960
    ds_read_b64_tr_b16 a[200:201], v17 offset:20544
    ds_read_b64_tr_b16 a[202:203], v17 offset:21056
    ds_read_b64_tr_b16 a[204:205], v17 offset:24640
    ds_read_b64_tr_b16 a[206:207], v17 offset:25152
    ds_read_b64_tr_b16 a[208:209], v17 offset:28736
    ds_read_b64_tr_b16 a[210:211], v17 offset:29248
    ds_read_b64_tr_b16 a[212:213], v17 offset:32832
    ds_read_b64_tr_b16 a[214:215], v17 offset:33344
    s_waitcnt lgkmcnt(6)
    ds_read_b64_tr_b16 a[216:217], v16 offset:96
    ds_read_b64_tr_b16 a[218:219], v16 offset:608
    ds_read_b64_tr_b16 a[220:221], v16 offset:4192
    ds_read_b64_tr_b16 a[222:223], v16 offset:4704
    ds_read_b64_tr_b16 a[224:225], v16 offset:8288
    ds_read_b64_tr_b16 a[226:227], v16 offset:8800
    ds_read_b64_tr_b16 a[228:229], v16 offset:12384
    ds_read_b64_tr_b16 a[230:231], v16 offset:12896
    ds_read_b64_tr_b16 a[232:233], v16 offset:16480
    ds_read_b64_tr_b16 a[234:235], v16 offset:16992
    ds_read_b64_tr_b16 a[236:237], v16 offset:20576
    ds_read_b64_tr_b16 a[238:239], v16 offset:21088
    s_waitcnt lgkmcnt(6)
    ds_read_b64_tr_b16 a[240:241], v16 offset:24672
    ds_read_b64_tr_b16 a[242:243], v16 offset:25184
    ds_read_b64_tr_b16 a[244:245], v16 offset:28768
    ds_read_b64_tr_b16 a[246:247], v16 offset:29280
    ds_read_b64_tr_b16 a[248:249], v16 offset:32864
    ds_read_b64_tr_b16 a[250:251], v16 offset:33376
    ds_read_b64_tr_b16 a[252:253], v17 offset:96
    ds_read_b64_tr_b16 a[254:255], v17 offset:608
    ds_read_b64_tr_b16 v[224:225], v17 offset:4192
    ds_read_b64_tr_b16 v[226:227], v17 offset:4704
    ds_read_b64_tr_b16 v[228:229], v17 offset:8288
    ds_read_b64_tr_b16 v[230:231], v17 offset:8800
    s_waitcnt lgkmcnt(6)
    ds_read_b64_tr_b16 v[232:233], v17 offset:12384
    ds_read_b64_tr_b16 v[234:235], v17 offset:12896
    ds_read_b64_tr_b16 v[236:237], v17 offset:16480
    ds_read_b64_tr_b16 v[238:239], v17 offset:16992
    ds_read_b64_tr_b16 v[240:241], v17 offset:20576
    ds_read_b64_tr_b16 v[242:243], v17 offset:21088
    ds_read_b64_tr_b16 v[244:245], v17 offset:24672
    ds_read_b64_tr_b16 v[246:247], v17 offset:25184
    ds_read_b64_tr_b16 v[248:249], v17 offset:28768
    ds_read_b64_tr_b16 v[250:251], v17 offset:29280
    ds_read_b64_tr_b16 v[252:253], v17 offset:32864
    ds_read_b64_tr_b16 v[254:255], v17 offset:33376
    s_waitcnt lgkmcnt(6)
    s_waitcnt lgkmcnt(0)
    s_barrier
    s_mul_i32 s60, s72, 57
    s_lshr_b32 s81, s60, 9
    s_mul_i32 s60, s81, 9
    s_sub_u32 s80, s72, s60
    s_cmp_ge_u32 s72, 72
    s_cbranch_scc1 L_anw_178
    v_lshrrev_b32 v18, 3, v1
    v_and_b32 v19, 7, v1
    s_movk_i32 s60, 1152
    v_mul_lo_u32 v18, v18, s60
    v_lshl_add_u32 v18, v19, 4, v18
    s_lshl_b32 s61, s80, 7
    s_mul_i32 s62, s4, 165888
    s_add_u32 s61, s61, s62
    s_mul_i32 s62, s4, 18432
    s_add_u32 m0, s62, 0
    s_nop 0
    buffer_load_dwordx4 v18, s[24:27], s61 offen lds
    s_add_u32 s61, s61, 9216
    s_add_u32 m0, s62, 1024
    s_nop 0
    buffer_load_dwordx4 v18, s[24:27], s61 offen lds
    s_add_u32 s61, s61, 9216
    s_add_u32 m0, s62, 2048
    s_nop 0
    buffer_load_dwordx4 v18, s[24:27], s61 offen lds
    s_add_u32 s61, s61, 9216
    s_add_u32 m0, s62, 3072
    s_nop 0
    buffer_load_dwordx4 v18, s[24:27], s61 offen lds
    s_add_u32 s61, s61, 9216
    s_add_u32 m0, s62, 4096
    s_nop 0
    buffer_load_dwordx4 v18, s[24:27], s61 offen lds
    s_add_u32 s61, s61, 9216
    s_add_u32 m0, s62, 5120
    s_nop 0
    buffer_load_dwordx4 v18, s[24:27], s61 offen lds
    s_add_u32 s61, s61, 9216
    s_add_u32 m0, s62, 6144
    s_nop 0
    buffer_load_dwordx4 v18, s[24:27], s61 offen lds
    s_add_u32 s61, s61, 9216
    s_add_u32 m0, s62, 7168
    s_nop 0
    buffer_load_dwordx4 v18, s[24:27], s61 offen lds
    s_add_u32 s61, s61, 9216
    s_add_u32 m0, s62, 8192
    s_nop 0
    buffer_load_dwordx4 v18, s[24:27], s61 offen lds
    s_add_u32 s61, s61, 9216
    s_add_u32 m0, s62, 9216
    s_nop 0
    buffer_load_dwordx4 v18, s[24:27], s61 offen lds
    s_add_u32 s61, s61, 9216
    s_add_u32 m0, s62, 10240
    s_nop 0
    buffer_load_dwordx4 v18, s[24:27], s61 offen lds
    s_add_u32 s61, s61, 9216
    s_add_u32 m0, s62, 11264
    s_nop 0
    buffer_load_dwordx4 v18, s[24:27], s61 offen lds
    s_add_u32 s61, s61, 9216
    s_add_u32 m0, s62, 12288
    s_nop 0
    buffer_load_dwordx4 v18, s[24:27], s61 offen lds
    s_add_u32 s61, s61, 9216
    s_add_u32 m0, s62, 13312
    s_nop 0
    buffer_load_dwordx4 v18, s[24:27], s61 offen lds
    s_add_u32 s61, s61, 9216
    s_add_u32 m0, s62, 14336
    s_nop 0
    buffer_load_dwordx4 v18, s[24:27], s61 offen lds
    s_add_u32 s61, s61, 9216
    s_add_u32 m0, s62, 15360
    s_nop 0
    buffer_load_dwordx4 v18, s[24:27], s61 offen lds
    s_add_u32 s61, s61, 9216
    s_add_u32 m0, s62, 16384
    s_nop 0
    buffer_load_dwordx4 v18, s[24:27], s61 offen lds
    s_add_u32 s61, s61, 9216
    s_add_u32 m0, s62, 17408
    s_nop 0
    buffer_load_dwordx4 v18, s[24:27], s61 offen lds
L_anw_178:
    s_movk_i32 s60, 1152
    v_mul_lo_u32 v4, v2, s60
    v_lshl_add_u32 v4, v3, 4, v4
    v_lshlrev_b32 v5, 4, v1
    s_lshl_b32 s60, s4, 13
    s_add_u32 s60, s60, 81920
    v_add_u32 v7, s60, v5
    v_and_b32 v18, 3, v2
    v_mov_b32 v19, 0x3f803f80
    v_cmp_eq_u32 vcc, 2, v18
    s_nop 1
    v_cndmask_b32 v6, 0, v19, vcc
    s_mov_b32 s82, 0x00300030
    s_mov_b32 s83, 0x00300030
    s_mov_b32 s66, 0x0000ffff
    s_mov_b32 s67, 0
    s_mov_b32 s68, 0x3eae1a93
    s_mul_i32 s77, s73, 1152
    s_lshl_b32 s75, s70, 17
    s_add_u32 s75, s75, 134217728
    s_lshl_b32 s76, s70, 17
    s_add_u32 s76, s76, 138412032
    s_lshl_b32 s60, s74, 13
    s_add_u32 s78, s75, s60
    s_add_u32 s69, s76, s60
    s_add_u32 s60, s77, 0
    buffer_load_dwordx4 v[64:67], v4, s[16:19], s60 offen offset:0
    buffer_load_dwordx4 v[68:71], v4, s[16:19], s60 offen offset:64
    buffer_load_dwordx4 v[72:75], v4, s[16:19], s60 offen offset:128
    buffer_load_dwordx4 v[76:79], v4, s[16:19], s60 offen offset:192
    buffer_load_dwordx4 v[80:83], v4, s[16:19], s60 offen offset:256
    buffer_load_dwordx4 v[84:87], v4, s[16:19], s60 offen offset:320
    buffer_load_dwordx4 v[88:91], v4, s[16:19], s60 offen offset:384
    buffer_load_dwordx4 v[92:95], v4, s[16:19], s60 offen offset:448
    buffer_load_dwordx4 v[96:99], v4, s[16:19], s60 offen offset:512
    buffer_load_dwordx4 v[100:103], v4, s[16:19], s60 offen offset:576
    buffer_load_dwordx4 v[104:107], v4, s[16:19], s60 offen offset:640
    buffer_load_dwordx4 v[108:111], v4, s[16:19], s60 offen offset:704
    buffer_load_dwordx4 v[112:115], v4, s[16:19], s60 offen offset:768
    buffer_load_dwordx4 v[116:119], v4, s[16:19], s60 offen offset:832
    buffer_load_dwordx4 v[120:123], v4, s[16:19], s60 offen offset:896
    buffer_load_dwordx4 v[124:127], v4, s[16:19], s60 offen offset:960
    buffer_load_dwordx4 v[128:131], v4, s[16:19], s60 offen offset:1024
    buffer_load_dwordx4 v[132:135], v4, s[16:19], s60 offen offset:1088
    s_add_u32 s60, s77, 18432
    buffer_load_dwordx4 v[136:139], v4, s[16:19], s60 offen offset:0
    buffer_load_dwordx4 v[140:143], v4, s[16:19], s60 offen offset:64
    buffer_load_dwordx4 v[144:147], v4, s[16:19], s60 offen offset:128
    buffer_load_dwordx4 v[148:151], v4, s[16:19], s60 offen offset:192
    buffer_load_dwordx4 v[152:155], v4, s[16:19], s60 offen offset:256
    buffer_load_dwordx4 v[156:159], v4, s[16:19], s60 offen offset:320
    buffer_load_dwordx4 v[160:163], v4, s[16:19], s60 offen offset:384
    buffer_load_dwordx4 v[164:167], v4, s[16:19], s60 offen offset:448
    buffer_load_dwordx4 v[168:171], v4, s[16:19], s60 offen offset:512
    buffer_load_dwordx4 v[172:175], v4, s[16:19], s60 offen offset:576
    buffer_load_dwordx4 v[176:179], v4, s[16:19], s60 offen offset:640
    buffer_load_dwordx4 v[180:183], v4, s[16:19], s60 offen offset:704
    buffer_load_dwordx4 v[184:187], v4, s[16:19], s60 offen offset:768
    buffer_load_dwordx4 v[188:191], v4, s[16:19], s60 offen offset:832
    buffer_load_dwordx4 v[192:195], v4, s[16:19], s60 offen offset:896
    buffer_load_dwordx4 v[196:199], v4, s[16:19], s60 offen offset:960
    buffer_load_dwordx4 v[200:203], v4, s[16:19], s60 offen offset:1024
    buffer_load_dwordx4 v[204:207], v4, s[16:19], s60 offen offset:1088
    s_waitcnt vmcnt(18)
    v_mfma_f32_16x16x32_bf16 v[32:35], a[0:3], v[64:67], 0
    v_mfma_f32_16x16x32_bf16 v[36:39], a[72:75], v[64:67], 0
    v_mfma_f32_16x16x32_bf16 v[40:43], a[216:219], v[64:67], 0
    v_mfma_f32_16x16x32_bf16 v[44:47], v[64:67], a[144:147], 0
    v_mfma_f32_16x16x32_bf16 v[48:51], v[64:67], a[216:219], 0
    v_mfma_f32_16x16x32_bf16 v[32:35], a[4:7], v[68:71], v[32:35]
    v_mfma_f32_16x16x32_bf16 v[36:39], a[76:79], v[68:71], v[36:39]
    v_mfma_f32_16x16x32_bf16 v[40:43], a[220:223], v[68:71], v[40:43]
    v_mfma_f32_16x16x32_bf16 v[44:47], v[68:71], a[148:151], v[44:47]
    v_mfma_f32_16x16x32_bf16 v[48:51], v[68:71], a[220:223], v[48:51]
    v_mfma_f32_16x16x32_bf16 v[32:35], a[8:11], v[72:75], v[32:35]
    v_mfma_f32_16x16x32_bf16 v[36:39], a[80:83], v[72:75], v[36:39]
    v_mfma_f32_16x16x32_bf16 v[40:43], a[224:227], v[72:75], v[40:43]
    v_mfma_f32_16x16x32_bf16 v[44:47], v[72:75], a[152:155], v[44:47]
    v_mfma_f32_16x16x32_bf16 v[48:51], v[72:75], a[224:227], v[48:51]
    v_mfma_f32_16x16x32_bf16 v[32:35], a[12:15], v[76:79], v[32:35]
    v_mfma_f32_16x16x32_bf16 v[36:39], a[84:87], v[76:79], v[36:39]
    v_mfma_f32_16x16x32_bf16 v[40:43], a[228:231], v[76:79], v[40:43]
    v_mfma_f32_16x16x32_bf16 v[44:47], v[76:79], a[156:159], v[44:47]
    v_mfma_f32_16x16x32_bf16 v[48:51], v[76:79], a[228:231], v[48:51]
    v_mfma_f32_16x16x32_bf16 v[32:35], a[16:19], v[80:83], v[32:35]
    v_mfma_f32_16x16x32_bf16 v[36:39], a[88:91], v[80:83], v[36:39]
    v_mfma_f32_16x16x32_bf16 v[40:43], a[232:235], v[80:83], v[40:43]
    v_mfma_f32_16x16x32_bf16 v[44:47], v[80:83], a[160:163], v[44:47]
    v_mfma_f32_16x16x32_bf16 v[48:51], v[80:83], a[232:235], v[48:51]
    v_mfma_f32_16x16x32_bf16 v[32:35], a[20:23], v[84:87], v[32:35]
    v_mfma_f32_16x16x32_bf16 v[36:39], a[92:95], v[84:87], v[36:39]
    v_mfma_f32_16x16x32_bf16 v[40:43], a[236:239], v[84:87], v[40:43]
    v_mfma_f32_16x16x32_bf16 v[44:47], v[84:87], a[164:167], v[44:47]
    v_mfma_f32_16x16x32_bf16 v[48:51], v[84:87], a[236:239], v[48:51]
    v_mfma_f32_16x16x32_bf16 v[32:35], a[24:27], v[88:91], v[32:35]
    v_mfma_f32_16x16x32_bf16 v[36:39], a[96:99], v[88:91], v[36:39]
    v_mfma_f32_16x16x32_bf16 v[40:43], a[240:243], v[88:91], v[40:43]
    v_mfma_f32_16x16x32_bf16 v[44:47], v[88:91], a[168:171], v[44:47]
    v_mfma_f32_16x16x32_bf16 v[48:51], v[88:91], a[240:243], v[48:51]
    v_mfma_f32_16x16x32_bf16 v[32:35], a[28:31], v[92:95], v[32:35]
    v_mfma_f32_16x16x32_bf16 v[36:39], a[100:103], v[92:95], v[36:39]
    v_mfma_f32_16x16x32_bf16 v[40:43], a[244:247], v[92:95], v[40:43]
    v_mfma_f32_16x16x32_bf16 v[44:47], v[92:95], a[172:175], v[44:47]
    v_mfma_f32_16x16x32_bf16 v[48:51], v[92:95], a[244:247], v[48:51]
    v_mfma_f32_16x16x32_bf16 v[32:35], a[32:35], v[96:99], v[32:35]
    v_mfma_f32_16x16x32_bf16 v[36:39], a[104:107], v[96:99], v[36:39]
    v_mfma_f32_16x16x32_bf16 v[40:43], a[248:251], v[96:99], v[40:43]
    v_mfma_f32_16x16x32_bf16 v[44:47], v[96:99], a[176:179], v[44:47]
    v_mfma_f32_16x16x32_bf16 v[48:51], v[96:99], a[248:251], v[48:51]
    v_mfma_f32_16x16x32_bf16 v[32:35], a[36:39], v[100:103], v[32:35]
    v_mfma_f32_16x16x32_bf16 v[36:39], a[108:111], v[100:103], v[36:39]
    v_mfma_f32_16x16x32_bf16 v[40:43], a[252:255], v[100:103], v[40:43]
    v_mfma_f32_16x16x32_bf16 v[44:47], v[100:103], a[180:183], v[44:47]
    v_mfma_f32_16x16x32_bf16 v[48:51], v[100:103], a[252:255], v[48:51]
    v_mfma_f32_16x16x32_bf16 v[32:35], a[40:43], v[104:107], v[32:35]
    v_mfma_f32_16x16x32_bf16 v[36:39], a[112:115], v[104:107], v[36:39]
    v_mfma_f32_16x16x32_bf16 v[40:43], v[224:227], v[104:107], v[40:43]
    v_mfma_f32_16x16x32_bf16 v[44:47], v[104:107], a[184:187], v[44:47]
    v_mfma_f32_16x16x32_bf16 v[48:51], v[104:107], v[224:227], v[48:51]
    v_mfma_f32_16x16x32_bf16 v[32:35], a[44:47], v[108:111], v[32:35]
    v_mfma_f32_16x16x32_bf16 v[36:39], a[116:119], v[108:111], v[36:39]
    v_mfma_f32_16x16x32_bf16 v[40:43], v[228:231], v[108:111], v[40:43]
    v_mfma_f32_16x16x32_bf16 v[44:47], v[108:111], a[188:191], v[44:47]
    v_mfma_f32_16x16x32_bf16 v[48:51], v[108:111], v[228:231], v[48:51]
    v_mfma_f32_16x16x32_bf16 v[32:35], a[48:51], v[112:115], v[32:35]
    v_mfma_f32_16x16x32_bf16 v[36:39], a[120:123], v[112:115], v[36:39]
    v_mfma_f32_16x16x32_bf16 v[40:43], v[232:235], v[112:115], v[40:43]
    v_mfma_f32_16x16x32_bf16 v[44:47], v[112:115], a[192:195], v[44:47]
    v_mfma_f32_16x16x32_bf16 v[48:51], v[112:115], v[232:235], v[48:51]
    v_mfma_f32_16x16x32_bf16 v[32:35], a[52:55], v[116:119], v[32:35]
    v_mfma_f32_16x16x32_bf16 v[36:39], a[124:127], v[116:119], v[36:39]
    v_mfma_f32_16x16x32_bf16 v[40:43], v[236:239], v[116:119], v[40:43]
    v_mfma_f32_16x16x32_bf16 v[44:47], v[116:119], a[196:199], v[44:47]
    v_mfma_f32_16x16x32_bf16 v[48:51], v[116:119], v[236:239], v[48:51]
    v_mfma_f32_16x16x32_bf16 v[32:35], a[56:59], v[120:123], v[32:35]
    v_mfma_f32_16x16x32_bf16 v[36:39], a[128:131], v[120:123], v[36:39]
    v_mfma_f32_16x16x32_bf16 v[40:43], v[240:243], v[120:123], v[40:43]
    v_mfma_f32_16x16x32_bf16 v[44:47], v[120:123], a[200:203], v[44:47]
    v_mfma_f32_16x16x32_bf16 v[48:51], v[120:123], v[240:243], v[48:51]
    v_mfma_f32_16x16x32_bf16 v[32:35], a[60:63], v[124:127], v[32:35]
    v_mfma_f32_16x16x32_bf16 v[36:39], a[132:135], v[124:127], v[36:39]
    v_mfma_f32_16x16x32_bf16 v[40:43], v[244:247], v[124:127], v[40:43]
    v_mfma_f32_16x16x32_bf16 v[44:47], v[124:127], a[204:207], v[44:47]
    v_mfma_f32_16x16x32_bf16 v[48:51], v[124:127], v[244:247], v[48:51]
    v_mfma_f32_16x16x32_bf16 v[32:35], a[64:67], v[128:131], v[32:35]
    v_mfma_f32_16x16x32_bf16 v[36:39], a[136:139], v[128:131], v[36:39]
    v_mfma_f32_16x16x32_bf16 v[40:43], v[248:251], v[128:131], v[40:43]
    v_mfma_f32_16x16x32_bf16 v[44:47], v[128:131], a[208:211], v[44:47]
    v_mfma_f32_16x16x32_bf16 v[48:51], v[128:131], v[248:251], v[48:51]
    v_mfma_f32_16x16x32_bf16 v[32:35], a[68:71], v[132:135], v[32:35]
    v_mfma_f32_16x16x32_bf16 v[36:39], a[140:143], v[132:135], v[36:39]
    v_mfma_f32_16x16x32_bf16 v[40:43], v[252:255], v[132:135], v[40:43]
    v_mfma_f32_16x16x32_bf16 v[44:47], v[132:135], a[212:215], v[44:47]
    v_mfma_f32_16x16x32_bf16 v[48:51], v[132:135], v[252:255], v[48:51]
    s_nop 3
    v_mul_f32 v32, s68, v32
    v_mul_f32 v33, s68, v33
    v_mul_f32 v34, s68, v34
    v_mul_f32 v35, s68, v35
    v_mul_f32 v24, s68, v40
    v_mul_f32 v25, s68, v41
    v_cvt_pk_bf16_f32 v16, v32, v33
    v_cvt_pk_bf16_f32 v17, v34, v35
    v_cvt_pk_bf16_f32 v18, v24, v25
    v_cndmask_b32 v18, 0, v18, s[66:67]
    v_mov_b32 v19, 0
    ds_write_b128 v7, v[16:19] offset:0
    v_cvt_pk_bf16_f32 v20, v36, v37
    v_cvt_pk_bf16_f32 v21, v38, v39
    v_cvt_pk_bf16_f32 v22, v42, v43
    v_cndmask_b32 v22, 0, v22, s[66:67]
    v_mov_b32 v23, 0
    s_add_u32 s60, s78, 0
    buffer_store_dwordx4 v[20:23], v5, s[8:11], s60 offen sc1
    v_cvt_pk_bf16_f32 v52, v44, v45
    v_cvt_pk_bf16_f32 v53, v46, v47
    v_cvt_pk_bf16_f32 v56, v48, v49
    v_cvt_pk_bf16_f32 v57, v50, v51
    v_cndmask_b32 v56, v6, v56, s[82:83]
    v_cndmask_b32 v57, v6, v57, s[82:83]
    s_add_u32 s60, s77, 36864
    buffer_load_dwordx4 v[64:67], v4, s[16:19], s60 offen offset:0
    buffer_load_dwordx4 v[68:71], v4, s[16:19], s60 offen offset:64
    buffer_load_dwordx4 v[72:75], v4, s[16:19], s60 offen offset:128
    buffer_load_dwordx4 v[76:79], v4, s[16:19], s60 offen offset:192
    buffer_load_dwordx4 v[80:83], v4, s[16:19], s60 offen offset:256
    buffer_load_dwordx4 v[84:87], v4, s[16:19], s60 offen offset:320
    buffer_load_dwordx4 v[88:91], v4, s[16:19], s60 offen offset:384
    buffer_load_dwordx4 v[92:95], v4, s[16:19], s60 offen offset:448
    buffer_load_dwordx4 v[96:99], v4, s[16:19], s60 offen offset:512
    buffer_load_dwordx4 v[100:103], v4, s[16:19], s60 offen offset:576
    buffer_load_dwordx4 v[104:107], v4, s[16:19], s60 offen offset:640
    buffer_load_dwordx4 v[108:111], v4, s[16:19], s60 offen offset:704
    buffer_load_dwordx4 v[112:115], v4, s[16:19], s60 offen offset:768
    buffer_load_dwordx4 v[116:119], v4, s[16:19], s60 offen offset:832
    buffer_load_dwordx4 v[120:123], v4, s[16:19], s60 offen offset:896
    buffer_load_dwordx4 v[124:127], v4, s[16:19], s60 offen offset:960
    buffer_load_dwordx4 v[128:131], v4, s[16:19], s60 offen offset:1024
    buffer_load_dwordx4 v[132:135], v4, s[16:19], s60 offen offset:1088
    s_waitcnt vmcnt(19)
    v_mfma_f32_16x16x32_bf16 v[32:35], a[0:3], v[136:139], 0
    v_mfma_f32_16x16x32_bf16 v[36:39], a[72:75], v[136:139], 0
    v_mfma_f32_16x16x32_bf16 v[40:43], a[216:219], v[136:139], 0
    v_mfma_f32_16x16x32_bf16 v[44:47], v[136:139], a[144:147], 0
    v_mfma_f32_16x16x32_bf16 v[48:51], v[136:139], a[216:219], 0
    v_mfma_f32_16x16x32_bf16 v[32:35], a[4:7], v[140:143], v[32:35]
    v_mfma_f32_16x16x32_bf16 v[36:39], a[76:79], v[140:143], v[36:39]
    v_mfma_f32_16x16x32_bf16 v[40:43], a[220:223], v[140:143], v[40:43]
    v_mfma_f32_16x16x32_bf16 v[44:47], v[140:143], a[148:151], v[44:47]
    v_mfma_f32_16x16x32_bf16 v[48:51], v[140:143], a[220:223], v[48:51]
    v_mfma_f32_16x16x32_bf16 v[32:35], a[8:11], v[144:147], v[32:35]
    v_mfma_f32_16x16x32_bf16 v[36:39], a[80:83], v[144:147], v[36:39]
    v_mfma_f32_16x16x32_bf16 v[40:43], a[224:227], v[144:147], v[40:43]
    v_mfma_f32_16x16x32_bf16 v[44:47], v[144:147], a[152:155], v[44:47]
    v_mfma_f32_16x16x32_bf16 v[48:51], v[144:147], a[224:227], v[48:51]
    v_mfma_f32_16x16x32_bf16 v[32:35], a[12:15], v[148:151], v[32:35]
    v_mfma_f32_16x16x32_bf16 v[36:39], a[84:87], v[148:151], v[36:39]
    v_mfma_f32_16x16x32_bf16 v[40:43], a[228:231], v[148:151], v[40:43]
    v_mfma_f32_16x16x32_bf16 v[44:47], v[148:151], a[156:159], v[44:47]
    v_mfma_f32_16x16x32_bf16 v[48:51], v[148:151], a[228:231], v[48:51]
    v_mfma_f32_16x16x32_bf16 v[32:35], a[16:19], v[152:155], v[32:35]
    v_mfma_f32_16x16x32_bf16 v[36:39], a[88:91], v[152:155], v[36:39]
    v_mfma_f32_16x16x32_bf16 v[40:43], a[232:235], v[152:155], v[40:43]
    v_mfma_f32_16x16x32_bf16 v[44:47], v[152:155], a[160:163], v[44:47]
    v_mfma_f32_16x16x32_bf16 v[48:51], v[152:155], a[232:235], v[48:51]
    v_mfma_f32_16x16x32_bf16 v[32:35], a[20:23], v[156:159], v[32:35]
    v_mfma_f32_16x16x32_bf16 v[36:39], a[92:95], v[156:159], v[36:39]
    v_mfma_f32_16x16x32_bf16 v[40:43], a[236:239], v[156:159], v[40:43]
    v_mfma_f32_16x16x32_bf16 v[44:47], v[156:159], a[164:167], v[44:47]
    v_mfma_f32_16x16x32_bf16 v[48:51], v[156:159], a[236:239], v[48:51]
    v_mfma_f32_16x16x32_bf16 v[32:35], a[24:27], v[160:163], v[32:35]
    v_mfma_f32_16x16x32_bf16 v[36:39], a[96:99], v[160:163], v[36:39]
    v_mfma_f32_16x16x32_bf16 v[40:43], a[240:243], v[160:163], v[40:43]
    v_mfma_f32_16x16x32_bf16 v[44:47], v[160:163], a[168:171], v[44:47]
    v_mfma_f32_16x16x32_bf16 v[48:51], v[160:163], a[240:243], v[48:51]
    v_mfma_f32_16x16x32_bf16 v[32:35], a[28:31], v[164:167], v[32:35]
    v_mfma_f32_16x16x32_bf16 v[36:39], a[100:103], v[164:167], v[36:39]
    v_mfma_f32_16x16x32_bf16 v[40:43], a[244:247], v[164:167], v[40:43]
    v_mfma_f32_16x16x32_bf16 v[44:47], v[164:167], a[172:175], v[44:47]
    v_mfma_f32_16x16x32_bf16 v[48:51], v[164:167], a[244:247], v[48:51]
    v_mfma_f32_16x16x32_bf16 v[32:35], a[32:35], v[168:171], v[32:35]
    v_mfma_f32_16x16x32_bf16 v[36:39], a[104:107], v[168:171], v[36:39]
    v_mfma_f32_16x16x32_bf16 v[40:43], a[248:251], v[168:171], v[40:43]
    v_mfma_f32_16x16x32_bf16 v[44:47], v[168:171], a[176:179], v[44:47]
    v_mfma_f32_16x16x32_bf16 v[48:51], v[168:171], a[248:251], v[48:51]
    v_mfma_f32_16x16x32_bf16 v[32:35], a[36:39], v[172:175], v[32:35]
    v_mfma_f32_16x16x32_bf16 v[36:39], a[108:111], v[172:175], v[36:39]
    v_mfma_f32_16x16x32_bf16 v[40:43], a[252:255], v[172:175], v[40:43]
    v_mfma_f32_16x16x32_bf16 v[44:47], v[172:175], a[180:183], v[44:47]
    v_mfma_f32_16x16x32_bf16 v[48:51], v[172:175], a[252:255], v[48:51]
    v_mfma_f32_16x16x32_bf16 v[32:35], a[40:43], v[176:179], v[32:35]
    v_mfma_f32_16x16x32_bf16 v[36:39], a[112:115], v[176:179], v[36:39]
    v_mfma_f32_16x16x32_bf16 v[40:43], v[224:227], v[176:179], v[40:43]
    v_mfma_f32_16x16x32_bf16 v[44:47], v[176:179], a[184:187], v[44:47]
    v_mfma_f32_16x16x32_bf16 v[48:51], v[176:179], v[224:227], v[48:51]
    v_mfma_f32_16x16x32_bf16 v[32:35], a[44:47], v[180:183], v[32:35]
    v_mfma_f32_16x16x32_bf16 v[36:39], a[116:119], v[180:183], v[36:39]
    v_mfma_f32_16x16x32_bf16 v[40:43], v[228:231], v[180:183], v[40:43]
    v_mfma_f32_16x16x32_bf16 v[44:47], v[180:183], a[188:191], v[44:47]
    v_mfma_f32_16x16x32_bf16 v[48:51], v[180:183], v[228:231], v[48:51]
    v_mfma_f32_16x16x32_bf16 v[32:35], a[48:51], v[184:187], v[32:35]
    v_mfma_f32_16x16x32_bf16 v[36:39], a[120:123], v[184:187], v[36:39]
    v_mfma_f32_16x16x32_bf16 v[40:43], v[232:235], v[184:187], v[40:43]
    v_mfma_f32_16x16x32_bf16 v[44:47], v[184:187], a[192:195], v[44:47]
    v_mfma_f32_16x16x32_bf16 v[48:51], v[184:187], v[232:235], v[48:51]
    v_mfma_f32_16x16x32_bf16 v[32:35], a[52:55], v[188:191], v[32:35]
    v_mfma_f32_16x16x32_bf16 v[36:39], a[124:127], v[188:191], v[36:39]
    v_mfma_f32_16x16x32_bf16 v[40:43], v[236:239], v[188:191], v[40:43]
    v_mfma_f32_16x16x32_bf16 v[44:47], v[188:191], a[196:199], v[44:47]
    v_mfma_f32_16x16x32_bf16 v[48:51], v[188:191], v[236:239], v[48:51]
    v_mfma_f32_16x16x32_bf16 v[32:35], a[56:59], v[192:195], v[32:35]
    v_mfma_f32_16x16x32_bf16 v[36:39], a[128:131], v[192:195], v[36:39]
    v_mfma_f32_16x16x32_bf16 v[40:43], v[240:243], v[192:195], v[40:43]
    v_mfma_f32_16x16x32_bf16 v[44:47], v[192:195], a[200:203], v[44:47]
    v_mfma_f32_16x16x32_bf16 v[48:51], v[192:195], v[240:243], v[48:51]
    v_mfma_f32_16x16x32_bf16 v[32:35], a[60:63], v[196:199], v[32:35]
    v_mfma_f32_16x16x32_bf16 v[36:39], a[132:135], v[196:199], v[36:39]
    v_mfma_f32_16x16x32_bf16 v[40:43], v[244:247], v[196:199], v[40:43]
    v_mfma_f32_16x16x32_bf16 v[44:47], v[196:199], a[204:207], v[44:47]
    v_mfma_f32_16x16x32_bf16 v[48:51], v[196:199], v[244:247], v[48:51]
    v_mfma_f32_16x16x32_bf16 v[32:35], a[64:67], v[200:203], v[32:35]
    v_mfma_f32_16x16x32_bf16 v[36:39], a[136:139], v[200:203], v[36:39]
    v_mfma_f32_16x16x32_bf16 v[40:43], v[248:251], v[200:203], v[40:43]
    v_mfma_f32_16x16x32_bf16 v[44:47], v[200:203], a[208:211], v[44:47]
    v_mfma_f32_16x16x32_bf16 v[48:51], v[200:203], v[248:251], v[48:51]
    v_mfma_f32_16x16x32_bf16 v[32:35], a[68:71], v[204:207], v[32:35]
    v_mfma_f32_16x16x32_bf16 v[36:39], a[140:143], v[204:207], v[36:39]
    v_mfma_f32_16x16x32_bf16 v[40:43], v[252:255], v[204:207], v[40:43]
    v_mfma_f32_16x16x32_bf16 v[44:47], v[204:207], a[212:215], v[44:47]
    v_mfma_f32_16x16x32_bf16 v[48:51], v[204:207], v[252:255], v[48:51]
    s_nop 3
    v_mul_f32 v32, s68, v32
    v_mul_f32 v33, s68, v33
    v_mul_f32 v34, s68, v34
    v_mul_f32 v35, s68, v35
    v_mul_f32 v24, s68, v40
    v_mul_f32 v25, s68, v41
    v_cvt_pk_bf16_f32 v16, v32, v33
    v_cvt_pk_bf16_f32 v17, v34, v35
    v_cvt_pk_bf16_f32 v18, v24, v25
    v_cndmask_b32 v18, 0, v18, s[66:67]
    v_mov_b32 v19, 0
    ds_write_b128 v7, v[16:19] offset:1024
    v_cvt_pk_bf16_f32 v20, v36, v37
    v_cvt_pk_bf16_f32 v21, v38, v39
    v_cvt_pk_bf16_f32 v22, v42, v43
    v_cndmask_b32 v22, 0, v22, s[66:67]
    v_mov_b32 v23, 0
    s_add_u32 s60, s78, 1024
    buffer_store_dwordx4 v[20:23], v5, s[8:11], s60 offen sc1
    v_cvt_pk_bf16_f32 v54, v44, v45
    v_cvt_pk_bf16_f32 v55, v46, v47
    v_cvt_pk_bf16_f32 v58, v48, v49
    v_cvt_pk_bf16_f32 v59, v50, v51
    v_cndmask_b32 v58, v6, v58, s[82:83]
    v_cndmask_b32 v59, v6, v59, s[82:83]
    s_add_u32 s60, s69, 0
    buffer_store_dwordx4 v[52:55], v5, s[8:11], s60 offen sc1
    buffer_store_dwordx4 v[56:59], v5, s[8:11], s60 offen offset:1024 sc1
    s_nop 1
    s_add_u32 s60, s77, 55296
    buffer_load_dwordx4 v[136:139], v4, s[16:19], s60 offen offset:0
    buffer_load_dwordx4 v[140:143], v4, s[16:19], s60 offen offset:64
    buffer_load_dwordx4 v[144:147], v4, s[16:19], s60 offen offset:128
    buffer_load_dwordx4 v[148:151], v4, s[16:19], s60 offen offset:192
    buffer_load_dwordx4 v[152:155], v4, s[16:19], s60 offen offset:256
    buffer_load_dwordx4 v[156:159], v4, s[16:19], s60 offen offset:320
    buffer_load_dwordx4 v[160:163], v4, s[16:19], s60 offen offset:384
    buffer_load_dwordx4 v[164:167], v4, s[16:19], s60 offen offset:448
    buffer_load_dwordx4 v[168:171], v4, s[16:19], s60 offen offset:512
    buffer_load_dwordx4 v[172:175], v4, s[16:19], s60 offen offset:576
    buffer_load_dwordx4 v[176:179], v4, s[16:19], s60 offen offset:640
    buffer_load_dwordx4 v[180:183], v4, s[16:19], s60 offen offset:704
    buffer_load_dwordx4 v[184:187], v4, s[16:19], s60 offen offset:768
    buffer_load_dwordx4 v[188:191], v4, s[16:19], s60 offen offset:832
    buffer_load_dwordx4 v[192:195], v4, s[16:19], s60 offen offset:896
    buffer_load_dwordx4 v[196:199], v4, s[16:19], s60 offen offset:960
    buffer_load_dwordx4 v[200:203], v4, s[16:19], s60 offen offset:1024
    buffer_load_dwordx4 v[204:207], v4, s[16:19], s60 offen offset:1088
    s_waitcnt vmcnt(21)
    v_mfma_f32_16x16x32_bf16 v[32:35], a[0:3], v[64:67], 0
    v_mfma_f32_16x16x32_bf16 v[36:39], a[72:75], v[64:67], 0
    v_mfma_f32_16x16x32_bf16 v[40:43], a[216:219], v[64:67], 0
    v_mfma_f32_16x16x32_bf16 v[44:47], v[64:67], a[144:147], 0
    v_mfma_f32_16x16x32_bf16 v[48:51], v[64:67], a[216:219], 0
    v_mfma_f32_16x16x32_bf16 v[32:35], a[4:7], v[68:71], v[32:35]
    v_mfma_f32_16x16x32_bf16 v[36:39], a[76:79], v[68:71], v[36:39]
    v_mfma_f32_16x16x32_bf16 v[40:43], a[220:223], v[68:71], v[40:43]
    v_mfma_f32_16x16x32_bf16 v[44:47], v[68:71], a[148:151], v[44:47]
    v_mfma_f32_16x16x32_bf16 v[48:51], v[68:71], a[220:223], v[48:51]
    v_mfma_f32_16x16x32_bf16 v[32:35], a[8:11], v[72:75], v[32:35]
    v_mfma_f32_16x16x32_bf16 v[36:39], a[80:83], v[72:75], v[36:39]
    v_mfma_f32_16x16x32_bf16 v[40:43], a[224:227], v[72:75], v[40:43]
    v_mfma_f32_16x16x32_bf16 v[44:47], v[72:75], a[152:155], v[44:47]
    v_mfma_f32_16x16x32_bf16 v[48:51], v[72:75], a[224:227], v[48:51]
    v_mfma_f32_16x16x32_bf16 v[32:35], a[12:15], v[76:79], v[32:35]
    v_mfma_f32_16x16x32_bf16 v[36:39], a[84:87], v[76:79], v[36:39]
    v_mfma_f32_16x16x32_bf16 v[40:43], a[228:231], v[76:79], v[40:43]
    v_mfma_f32_16x16x32_bf16 v[44:47], v[76:79], a[156:159], v[44:47]
    v_mfma_f32_16x16x32_bf16 v[48:51], v[76:79], a[228:231], v[48:51]
    v_mfma_f32_16x16x32_bf16 v[32:35], a[16:19], v[80:83], v[32:35]
    v_mfma_f32_16x16x32_bf16 v[36:39], a[88:91], v[80:83], v[36:39]
    v_mfma_f32_16x16x32_bf16 v[40:43], a[232:235], v[80:83], v[40:43]
    v_mfma_f32_16x16x32_bf16 v[44:47], v[80:83], a[160:163], v[44:47]
    v_mfma_f32_16x16x32_bf16 v[48:51], v[80:83], a[232:235], v[48:51]
    v_mfma_f32_16x16x32_bf16 v[32:35], a[20:23], v[84:87], v[32:35]
    v_mfma_f32_16x16x32_bf16 v[36:39], a[92:95], v[84:87], v[36:39]
    v_mfma_f32_16x16x32_bf16 v[40:43], a[236:239], v[84:87], v[40:43]
    v_mfma_f32_16x16x32_bf16 v[44:47], v[84:87], a[164:167], v[44:47]
    v_mfma_f32_16x16x32_bf16 v[48:51], v[84:87], a[236:239], v[48:51]
    v_mfma_f32_16x16x32_bf16 v[32:35], a[24:27], v[88:91], v[32:35]
    v_mfma_f32_16x16x32_bf16 v[36:39], a[96:99], v[88:91], v[36:39]
    v_mfma_f32_16x16x32_bf16 v[40:43], a[240:243], v[88:91], v[40:43]
    v_mfma_f32_16x16x32_bf16 v[44:47], v[88:91], a[168:171], v[44:47]
    v_mfma_f32_16x16x32_bf16 v[48:51], v[88:91], a[240:243], v[48:51]
    v_mfma_f32_16x16x32_bf16 v[32:35], a[28:31], v[92:95], v[32:35]
    v_mfma_f32_16x16x32_bf16 v[36:39], a[100:103], v[92:95], v[36:39]
    v_mfma_f32_16x16x32_bf16 v[40:43], a[244:247], v[92:95], v[40:43]
    v_mfma_f32_16x16x32_bf16 v[44:47], v[92:95], a[172:175], v[44:47]
    v_mfma_f32_16x16x32_bf16 v[48:51], v[92:95], a[244:247], v[48:51]
    v_mfma_f32_16x16x32_bf16 v[32:35], a[32:35], v[96:99], v[32:35]
    v_mfma_f32_16x16x32_bf16 v[36:39], a[104:107], v[96:99], v[36:39]
    v_mfma_f32_16x16x32_bf16 v[40:43], a[248:251], v[96:99], v[40:43]
    v_mfma_f32_16x16x32_bf16 v[44:47], v[96:99], a[176:179], v[44:47]
    v_mfma_f32_16x16x32_bf16 v[48:51], v[96:99], a[248:251], v[48:51]
    v_mfma_f32_16x16x32_bf16 v[32:35], a[36:39], v[100:103], v[32:35]
    v_mfma_f32_16x16x32_bf16 v[36:39], a[108:111], v[100:103], v[36:39]
    v_mfma_f32_16x16x32_bf16 v[40:43], a[252:255], v[100:103], v[40:43]
    v_mfma_f32_16x16x32_bf16 v[44:47], v[100:103], a[180:183], v[44:47]
    v_mfma_f32_16x16x32_bf16 v[48:51], v[100:103], a[252:255], v[48:51]
    v_mfma_f32_16x16x32_bf16 v[32:35], a[40:43], v[104:107], v[32:35]
    v_mfma_f32_16x16x32_bf16 v[36:39], a[112:115], v[104:107], v[36:39]
    v_mfma_f32_16x16x32_bf16 v[40:43], v[224:227], v[104:107], v[40:43]
    v_mfma_f32_16x16x32_bf16 v[44:47], v[104:107], a[184:187], v[44:47]
    v_mfma_f32_16x16x32_bf16 v[48:51], v[104:107], v[224:227], v[48:51]
    v_mfma_f32_16x16x32_bf16 v[32:35], a[44:47], v[108:111], v[32:35]
    v_mfma_f32_16x16x32_bf16 v[36:39], a[116:119], v[108:111], v[36:39]
    v_mfma_f32_16x16x32_bf16 v[40:43], v[228:231], v[108:111], v[40:43]
    v_mfma_f32_16x16x32_bf16 v[44:47], v[108:111], a[188:191], v[44:47]
    v_mfma_f32_16x16x32_bf16 v[48:51], v[108:111], v[228:231], v[48:51]
    v_mfma_f32_16x16x32_bf16 v[32:35], a[48:51], v[112:115], v[32:35]
    v_mfma_f32_16x16x32_bf16 v[36:39], a[120:123], v[112:115], v[36:39]
    v_mfma_f32_16x16x32_bf16 v[40:43], v[232:235], v[112:115], v[40:43]
    v_mfma_f32_16x16x32_bf16 v[44:47], v[112:115], a[192:195], v[44:47]
    v_mfma_f32_16x16x32_bf16 v[48:51], v[112:115], v[232:235], v[48:51]
    v_mfma_f32_16x16x32_bf16 v[32:35], a[52:55], v[116:119], v[32:35]
    v_mfma_f32_16x16x32_bf16 v[36:39], a[124:127], v[116:119], v[36:39]
    v_mfma_f32_16x16x32_bf16 v[40:43], v[236:239], v[116:119], v[40:43]
    v_mfma_f32_16x16x32_bf16 v[44:47], v[116:119], a[196:199], v[44:47]
    v_mfma_f32_16x16x32_bf16 v[48:51], v[116:119], v[236:239], v[48:51]
    v_mfma_f32_16x16x32_bf16 v[32:35], a[56:59], v[120:123], v[32:35]
    v_mfma_f32_16x16x32_bf16 v[36:39], a[128:131], v[120:123], v[36:39]
    v_mfma_f32_16x16x32_bf16 v[40:43], v[240:243], v[120:123], v[40:43]
    v_mfma_f32_16x16x32_bf16 v[44:47], v[120:123], a[200:203], v[44:47]
    v_mfma_f32_16x16x32_bf16 v[48:51], v[120:123], v[240:243], v[48:51]
    v_mfma_f32_16x16x32_bf16 v[32:35], a[60:63], v[124:127], v[32:35]
    v_mfma_f32_16x16x32_bf16 v[36:39], a[132:135], v[124:127], v[36:39]
    v_mfma_f32_16x16x32_bf16 v[40:43], v[244:247], v[124:127], v[40:43]
    v_mfma_f32_16x16x32_bf16 v[44:47], v[124:127], a[204:207], v[44:47]
    v_mfma_f32_16x16x32_bf16 v[48:51], v[124:127], v[244:247], v[48:51]
    v_mfma_f32_16x16x32_bf16 v[32:35], a[64:67], v[128:131], v[32:35]
    v_mfma_f32_16x16x32_bf16 v[36:39], a[136:139], v[128:131], v[36:39]
    v_mfma_f32_16x16x32_bf16 v[40:43], v[248:251], v[128:131], v[40:43]
    v_mfma_f32_16x16x32_bf16 v[44:47], v[128:131], a[208:211], v[44:47]
    v_mfma_f32_16x16x32_bf16 v[48:51], v[128:131], v[248:251], v[48:51]
    v_mfma_f32_16x16x32_bf16 v[32:35], a[68:71], v[132:135], v[32:35]
    v_mfma_f32_16x16x32_bf16 v[36:39], a[140:143], v[132:135], v[36:39]
    v_mfma_f32_16x16x32_bf16 v[40:43], v[252:255], v[132:135], v[40:43]
    v_mfma_f32_16x16x32_bf16 v[44:47], v[132:135], a[212:215], v[44:47]
    v_mfma_f32_16x16x32_bf16 v[48:51], v[132:135], v[252:255], v[48:51]
    s_nop 3
    v_mul_f32 v32, s68, v32
    v_mul_f32 v33, s68, v33
    v_mul_f32 v34, s68, v34
    v_mul_f32 v35, s68, v35
    v_mul_f32 v24, s68, v40
    v_mul_f32 v25, s68, v41
    v_cvt_pk_bf16_f32 v16, v32, v33
    v_cvt_pk_bf16_f32 v17, v34, v35
    v_cvt_pk_bf16_f32 v18, v24, v25
    v_cndmask_b32 v18, 0, v18, s[66:67]
    v_mov_b32 v19, 0
    ds_write_b128 v7, v[16:19] offset:2048
    v_cvt_pk_bf16_f32 v20, v36, v37
    v_cvt_pk_bf16_f32 v21, v38, v39
    v_cvt_pk_bf16_f32 v22, v42, v43
    v_cndmask_b32 v22, 0, v22, s[66:67]
    v_mov_b32 v23, 0
    s_add_u32 s60, s78, 2048
    buffer_store_dwordx4 v[20:23], v5, s[8:11], s60 offen sc1
    v_cvt_pk_bf16_f32 v52, v44, v45
    v_cvt_pk_bf16_f32 v53, v46, v47
    v_cvt_pk_bf16_f32 v56, v48, v49
    v_cvt_pk_bf16_f32 v57, v50, v51
    v_cndmask_b32 v56, v6, v56, s[82:83]
    v_cndmask_b32 v57, v6, v57, s[82:83]
    s_add_u32 s60, s77, 73728
    buffer_load_dwordx4 v[64:67], v4, s[16:19], s60 offen offset:0
    buffer_load_dwordx4 v[68:71], v4, s[16:19], s60 offen offset:64
    buffer_load_dwordx4 v[72:75], v4, s[16:19], s60 offen offset:128
    buffer_load_dwordx4 v[76:79], v4, s[16:19], s60 offen offset:192
    buffer_load_dwordx4 v[80:83], v4, s[16:19], s60 offen offset:256
    buffer_load_dwordx4 v[84:87], v4, s[16:19], s60 offen offset:320
    buffer_load_dwordx4 v[88:91], v4, s[16:19], s60 offen offset:384
    buffer_load_dwordx4 v[92:95], v4, s[16:19], s60 offen offset:448
    buffer_load_dwordx4 v[96:99], v4, s[16:19], s60 offen offset:512
    buffer_load_dwordx4 v[100:103], v4, s[16:19], s60 offen offset:576
    buffer_load_dwordx4 v[104:107], v4, s[16:19], s60 offen offset:640
    buffer_load_dwordx4 v[108:111], v4, s[16:19], s60 offen offset:704
    buffer_load_dwordx4 v[112:115], v4, s[16:19], s60 offen offset:768
    buffer_load_dwordx4 v[116:119], v4, s[16:19], s60 offen offset:832
    buffer_load_dwordx4 v[120:123], v4, s[16:19], s60 offen offset:896
    buffer_load_dwordx4 v[124:127], v4, s[16:19], s60 offen offset:960
    buffer_load_dwordx4 v[128:131], v4, s[16:19], s60 offen offset:1024
    buffer_load_dwordx4 v[132:135], v4, s[16:19], s60 offen offset:1088
    s_waitcnt vmcnt(19)
    v_mfma_f32_16x16x32_bf16 v[32:35], a[0:3], v[136:139], 0
    v_mfma_f32_16x16x32_bf16 v[36:39], a[72:75], v[136:139], 0
    v_mfma_f32_16x16x32_bf16 v[40:43], a[216:219], v[136:139], 0
    v_mfma_f32_16x16x32_bf16 v[44:47], v[136:139], a[144:147], 0
    v_mfma_f32_16x16x32_bf16 v[48:51], v[136:139], a[216:219], 0
    v_mfma_f32_16x16x32_bf16 v[32:35], a[4:7], v[140:143], v[32:35]
    v_mfma_f32_16x16x32_bf16 v[36:39], a[76:79], v[140:143], v[36:39]
    v_mfma_f32_16x16x32_bf16 v[40:43], a[220:223], v[140:143], v[40:43]
    v_mfma_f32_16x16x32_bf16 v[44:47], v[140:143], a[148:151], v[44:47]
    v_mfma_f32_16x16x32_bf16 v[48:51], v[140:143], a[220:223], v[48:51]
    v_mfma_f32_16x16x32_bf16 v[32:35], a[8:11], v[144:147], v[32:35]
    v_mfma_f32_16x16x32_bf16 v[36:39], a[80:83], v[144:147], v[36:39]
    v_mfma_f32_16x16x32_bf16 v[40:43], a[224:227], v[144:147], v[40:43]
    v_mfma_f32_16x16x32_bf16 v[44:47], v[144:147], a[152:155], v[44:47]
    v_mfma_f32_16x16x32_bf16 v[48:51], v[144:147], a[224:227], v[48:51]
    v_mfma_f32_16x16x32_bf16 v[32:35], a[12:15], v[148:151], v[32:35]
    v_mfma_f32_16x16x32_bf16 v[36:39], a[84:87], v[148:151], v[36:39]
    v_mfma_f32_16x16x32_bf16 v[40:43], a[228:231], v[148:151], v[40:43]
    v_mfma_f32_16x16x32_bf16 v[44:47], v[148:151], a[156:159], v[44:47]
    v_mfma_f32_16x16x32_bf16 v[48:51], v[148:151], a[228:231], v[48:51]
    v_mfma_f32_16x16x32_bf16 v[32:35], a[16:19], v[152:155], v[32:35]
    v_mfma_f32_16x16x32_bf16 v[36:39], a[88:91], v[152:155], v[36:39]
    v_mfma_f32_16x16x32_bf16 v[40:43], a[232:235], v[152:155], v[40:43]
    v_mfma_f32_16x16x32_bf16 v[44:47], v[152:155], a[160:163], v[44:47]
    v_mfma_f32_16x16x32_bf16 v[48:51], v[152:155], a[232:235], v[48:51]
    v_mfma_f32_16x16x32_bf16 v[32:35], a[20:23], v[156:159], v[32:35]
    v_mfma_f32_16x16x32_bf16 v[36:39], a[92:95], v[156:159], v[36:39]
    v_mfma_f32_16x16x32_bf16 v[40:43], a[236:239], v[156:159], v[40:43]
    v_mfma_f32_16x16x32_bf16 v[44:47], v[156:159], a[164:167], v[44:47]
    v_mfma_f32_16x16x32_bf16 v[48:51], v[156:159], a[236:239], v[48:51]
    v_mfma_f32_16x16x32_bf16 v[32:35], a[24:27], v[160:163], v[32:35]
    v_mfma_f32_16x16x32_bf16 v[36:39], a[96:99], v[160:163], v[36:39]
    v_mfma_f32_16x16x32_bf16 v[40:43], a[240:243], v[160:163], v[40:43]
    v_mfma_f32_16x16x32_bf16 v[44:47], v[160:163], a[168:171], v[44:47]
    v_mfma_f32_16x16x32_bf16 v[48:51], v[160:163], a[240:243], v[48:51]
    v_mfma_f32_16x16x32_bf16 v[32:35], a[28:31], v[164:167], v[32:35]
    v_mfma_f32_16x16x32_bf16 v[36:39], a[100:103], v[164:167], v[36:39]
    v_mfma_f32_16x16x32_bf16 v[40:43], a[244:247], v[164:167], v[40:43]
    v_mfma_f32_16x16x32_bf16 v[44:47], v[164:167], a[172:175], v[44:47]
    v_mfma_f32_16x16x32_bf16 v[48:51], v[164:167], a[244:247], v[48:51]
    v_mfma_f32_16x16x32_bf16 v[32:35], a[32:35], v[168:171], v[32:35]
    v_mfma_f32_16x16x32_bf16 v[36:39], a[104:107], v[168:171], v[36:39]
    v_mfma_f32_16x16x32_bf16 v[40:43], a[248:251], v[168:171], v[40:43]
    v_mfma_f32_16x16x32_bf16 v[44:47], v[168:171], a[176:179], v[44:47]
    v_mfma_f32_16x16x32_bf16 v[48:51], v[168:171], a[248:251], v[48:51]
    v_mfma_f32_16x16x32_bf16 v[32:35], a[36:39], v[172:175], v[32:35]
    v_mfma_f32_16x16x32_bf16 v[36:39], a[108:111], v[172:175], v[36:39]
    v_mfma_f32_16x16x32_bf16 v[40:43], a[252:255], v[172:175], v[40:43]
    v_mfma_f32_16x16x32_bf16 v[44:47], v[172:175], a[180:183], v[44:47]
    v_mfma_f32_16x16x32_bf16 v[48:51], v[172:175], a[252:255], v[48:51]
    v_mfma_f32_16x16x32_bf16 v[32:35], a[40:43], v[176:179], v[32:35]
    v_mfma_f32_16x16x32_bf16 v[36:39], a[112:115], v[176:179], v[36:39]
    v_mfma_f32_16x16x32_bf16 v[40:43], v[224:227], v[176:179], v[40:43]
    v_mfma_f32_16x16x32_bf16 v[44:47], v[176:179], a[184:187], v[44:47]
    v_mfma_f32_16x16x32_bf16 v[48:51], v[176:179], v[224:227], v[48:51]
    v_mfma_f32_16x16x32_bf16 v[32:35], a[44:47], v[180:183], v[32:35]
    v_mfma_f32_16x16x32_bf16 v[36:39], a[116:119], v[180:183], v[36:39]
    v_mfma_f32_16x16x32_bf16 v[40:43], v[228:231], v[180:183], v[40:43]
    v_mfma_f32_16x16x32_bf16 v[44:47], v[180:183], a[188:191], v[44:47]
    v_mfma_f32_16x16x32_bf16 v[48:51], v[180:183], v[228:231], v[48:51]
    v_mfma_f32_16x16x32_bf16 v[32:35], a[48:51], v[184:187], v[32:35]
    v_mfma_f32_16x16x32_bf16 v[36:39], a[120:123], v[184:187], v[36:39]
    v_mfma_f32_16x16x32_bf16 v[40:43], v[232:235], v[184:187], v[40:43]
    v_mfma_f32_16x16x32_bf16 v[44:47], v[184:187], a[192:195], v[44:47]
    v_mfma_f32_16x16x32_bf16 v[48:51], v[184:187], v[232:235], v[48:51]
    v_mfma_f32_16x16x32_bf16 v[32:35], a[52:55], v[188:191], v[32:35]
    v_mfma_f32_16x16x32_bf16 v[36:39], a[124:127], v[188:191], v[36:39]
    v_mfma_f32_16x16x32_bf16 v[40:43], v[236:239], v[188:191], v[40:43]
    v_mfma_f32_16x16x32_bf16 v[44:47], v[188:191], a[196:199], v[44:47]
    v_mfma_f32_16x16x32_bf16 v[48:51], v[188:191], v[236:239], v[48:51]
    v_mfma_f32_16x16x32_bf16 v[32:35], a[56:59], v[192:195], v[32:35]
    v_mfma_f32_16x16x32_bf16 v[36:39], a[128:131], v[192:195], v[36:39]
    v_mfma_f32_16x16x32_bf16 v[40:43], v[240:243], v[192:195], v[40:43]
    v_mfma_f32_16x16x32_bf16 v[44:47], v[192:195], a[200:203], v[44:47]
    v_mfma_f32_16x16x32_bf16 v[48:51], v[192:195], v[240:243], v[48:51]
    v_mfma_f32_16x16x32_bf16 v[32:35], a[60:63], v[196:199], v[32:35]
    v_mfma_f32_16x16x32_bf16 v[36:39], a[132:135], v[196:199], v[36:39]
    v_mfma_f32_16x16x32_bf16 v[40:43], v[244:247], v[196:199], v[40:43]
    v_mfma_f32_16x16x32_bf16 v[44:47], v[196:199], a[204:207], v[44:47]
    v_mfma_f32_16x16x32_bf16 v[48:51], v[196:199], v[244:247], v[48:51]
    v_mfma_f32_16x16x32_bf16 v[32:35], a[64:67], v[200:203], v[32:35]
    v_mfma_f32_16x16x32_bf16 v[36:39], a[136:139], v[200:203], v[36:39]
    v_mfma_f32_16x16x32_bf16 v[40:43], v[248:251], v[200:203], v[40:43]
    v_mfma_f32_16x16x32_bf16 v[44:47], v[200:203], a[208:211], v[44:47]
    v_mfma_f32_16x16x32_bf16 v[48:51], v[200:203], v[248:251], v[48:51]
    v_mfma_f32_16x16x32_bf16 v[32:35], a[68:71], v[204:207], v[32:35]
    v_mfma_f32_16x16x32_bf16 v[36:39], a[140:143], v[204:207], v[36:39]
    v_mfma_f32_16x16x32_bf16 v[40:43], v[252:255], v[204:207], v[40:43]
    v_mfma_f32_16x16x32_bf16 v[44:47], v[204:207], a[212:215], v[44:47]
    v_mfma_f32_16x16x32_bf16 v[48:51], v[204:207], v[252:255], v[48:51]
    s_nop 3
    v_mul_f32 v32, s68, v32
    v_mul_f32 v33, s68, v33
    v_mul_f32 v34, s68, v34
    v_mul_f32 v35, s68, v35
    v_mul_f32 v24, s68, v40
    v_mul_f32 v25, s68, v41
    v_cvt_pk_bf16_f32 v16, v32, v33
    v_cvt_pk_bf16_f32 v17, v34, v35
    v_cvt_pk_bf16_f32 v18, v24, v25
    v_cndmask_b32 v18, 0, v18, s[66:67]
    v_mov_b32 v19, 0
    ds_write_b128 v7, v[16:19] offset:3072
    v_cvt_pk_bf16_f32 v20, v36, v37
    v_cvt_pk_bf16_f32 v21, v38, v39
    v_cvt_pk_bf16_f32 v22, v42, v43
    v_cndmask_b32 v22, 0, v22, s[66:67]
    v_mov_b32 v23, 0
    s_add_u32 s60, s78, 3072
    buffer_store_dwordx4 v[20:23], v5, s[8:11], s60 offen sc1
    v_cvt_pk_bf16_f32 v54, v44, v45
    v_cvt_pk_bf16_f32 v55, v46, v47
    v_cvt_pk_bf16_f32 v58, v48, v49
    v_cvt_pk_bf16_f32 v59, v50, v51
    v_cndmask_b32 v58, v6, v58, s[82:83]
    v_cndmask_b32 v59, v6, v59, s[82:83]
    s_add_u32 s60, s69, 2048
    buffer_store_dwordx4 v[52:55], v5, s[8:11], s60 offen sc1
    buffer_store_dwordx4 v[56:59], v5, s[8:11], s60 offen offset:1024 sc1
    s_nop 1
    s_add_u32 s60, s77, 92160
    buffer_load_dwordx4 v[136:139], v4, s[16:19], s60 offen offset:0
    buffer_load_dwordx4 v[140:143], v4, s[16:19], s60 offen offset:64
    buffer_load_dwordx4 v[144:147], v4, s[16:19], s60 offen offset:128
    buffer_load_dwordx4 v[148:151], v4, s[16:19], s60 offen offset:192
    buffer_load_dwordx4 v[152:155], v4, s[16:19], s60 offen offset:256
    buffer_load_dwordx4 v[156:159], v4, s[16:19], s60 offen offset:320
    buffer_load_dwordx4 v[160:163], v4, s[16:19], s60 offen offset:384
    buffer_load_dwordx4 v[164:167], v4, s[16:19], s60 offen offset:448
    buffer_load_dwordx4 v[168:171], v4, s[16:19], s60 offen offset:512
    buffer_load_dwordx4 v[172:175], v4, s[16:19], s60 offen offset:576
    buffer_load_dwordx4 v[176:179], v4, s[16:19], s60 offen offset:640
    buffer_load_dwordx4 v[180:183], v4, s[16:19], s60 offen offset:704
    buffer_load_dwordx4 v[184:187], v4, s[16:19], s60 offen offset:768
    buffer_load_dwordx4 v[188:191], v4, s[16:19], s60 offen offset:832
    buffer_load_dwordx4 v[192:195], v4, s[16:19], s60 offen offset:896
    buffer_load_dwordx4 v[196:199], v4, s[16:19], s60 offen offset:960
    buffer_load_dwordx4 v[200:203], v4, s[16:19], s60 offen offset:1024
    buffer_load_dwordx4 v[204:207], v4, s[16:19], s60 offen offset:1088
    s_waitcnt vmcnt(21)
    v_mfma_f32_16x16x32_bf16 v[32:35], a[0:3], v[64:67], 0
    v_mfma_f32_16x16x32_bf16 v[36:39], a[72:75], v[64:67], 0
    v_mfma_f32_16x16x32_bf16 v[40:43], a[216:219], v[64:67], 0
    v_mfma_f32_16x16x32_bf16 v[44:47], v[64:67], a[144:147], 0
    v_mfma_f32_16x16x32_bf16 v[48:51], v[64:67], a[216:219], 0
    v_mfma_f32_16x16x32_bf16 v[32:35], a[4:7], v[68:71], v[32:35]
    v_mfma_f32_16x16x32_bf16 v[36:39], a[76:79], v[68:71], v[36:39]
    v_mfma_f32_16x16x32_bf16 v[40:43], a[220:223], v[68:71], v[40:43]
    v_mfma_f32_16x16x32_bf16 v[44:47], v[68:71], a[148:151], v[44:47]
    v_mfma_f32_16x16x32_bf16 v[48:51], v[68:71], a[220:223], v[48:51]
    v_mfma_f32_16x16x32_bf16 v[32:35], a[8:11], v[72:75], v[32:35]
    v_mfma_f32_16x16x32_bf16 v[36:39], a[80:83], v[72:75], v[36:39]
    v_mfma_f32_16x16x32_bf16 v[40:43], a[224:227], v[72:75], v[40:43]
    v_mfma_f32_16x16x32_bf16 v[44:47], v[72:75], a[152:155], v[44:47]
    v_mfma_f32_16x16x32_bf16 v[48:51], v[72:75], a[224:227], v[48:51]
    v_mfma_f32_16x16x32_bf16 v[32:35], a[12:15], v[76:79], v[32:35]
    v_mfma_f32_16x16x32_bf16 v[36:39], a[84:87], v[76:79], v[36:39]
    v_mfma_f32_16x16x32_bf16 v[40:43], a[228:231], v[76:79], v[40:43]
    v_mfma_f32_16x16x32_bf16 v[44:47], v[76:79], a[156:159], v[44:47]
    v_mfma_f32_16x16x32_bf16 v[48:51], v[76:79], a[228:231], v[48:51]
    v_mfma_f32_16x16x32_bf16 v[32:35], a[16:19], v[80:83], v[32:35]
    v_mfma_f32_16x16x32_bf16 v[36:39], a[88:91], v[80:83], v[36:39]
    v_mfma_f32_16x16x32_bf16 v[40:43], a[232:235], v[80:83], v[40:43]
    v_mfma_f32_16x16x32_bf16 v[44:47], v[80:83], a[160:163], v[44:47]
    v_mfma_f32_16x16x32_bf16 v[48:51], v[80:83], a[232:235], v[48:51]
    v_mfma_f32_16x16x32_bf16 v[32:35], a[20:23], v[84:87], v[32:35]
    v_mfma_f32_16x16x32_bf16 v[36:39], a[92:95], v[84:87], v[36:39]
    v_mfma_f32_16x16x32_bf16 v[40:43], a[236:239], v[84:87], v[40:43]
    v_mfma_f32_16x16x32_bf16 v[44:47], v[84:87], a[164:167], v[44:47]
    v_mfma_f32_16x16x32_bf16 v[48:51], v[84:87], a[236:239], v[48:51]
    v_mfma_f32_16x16x32_bf16 v[32:35], a[24:27], v[88:91], v[32:35]
    v_mfma_f32_16x16x32_bf16 v[36:39], a[96:99], v[88:91], v[36:39]
    v_mfma_f32_16x16x32_bf16 v[40:43], a[240:243], v[88:91], v[40:43]
    v_mfma_f32_16x16x32_bf16 v[44:47], v[88:91], a[168:171], v[44:47]
    v_mfma_f32_16x16x32_bf16 v[48:51], v[88:91], a[240:243], v[48:51]
    v_mfma_f32_16x16x32_bf16 v[32:35], a[28:31], v[92:95], v[32:35]
    v_mfma_f32_16x16x32_bf16 v[36:39], a[100:103], v[92:95], v[36:39]
    v_mfma_f32_16x16x32_bf16 v[40:43], a[244:247], v[92:95], v[40:43]
    v_mfma_f32_16x16x32_bf16 v[44:47], v[92:95], a[172:175], v[44:47]
    v_mfma_f32_16x16x32_bf16 v[48:51], v[92:95], a[244:247], v[48:51]
    v_mfma_f32_16x16x32_bf16 v[32:35], a[32:35], v[96:99], v[32:35]
    v_mfma_f32_16x16x32_bf16 v[36:39], a[104:107], v[96:99], v[36:39]
    v_mfma_f32_16x16x32_bf16 v[40:43], a[248:251], v[96:99], v[40:43]
    v_mfma_f32_16x16x32_bf16 v[44:47], v[96:99], a[176:179], v[44:47]
    v_mfma_f32_16x16x32_bf16 v[48:51], v[96:99], a[248:251], v[48:51]
    v_mfma_f32_16x16x32_bf16 v[32:35], a[36:39], v[100:103], v[32:35]
    v_mfma_f32_16x16x32_bf16 v[36:39], a[108:111], v[100:103], v[36:39]
    v_mfma_f32_16x16x32_bf16 v[40:43], a[252:255], v[100:103], v[40:43]
    v_mfma_f32_16x16x32_bf16 v[44:47], v[100:103], a[180:183], v[44:47]
    v_mfma_f32_16x16x32_bf16 v[48:51], v[100:103], a[252:255], v[48:51]
    v_mfma_f32_16x16x32_bf16 v[32:35], a[40:43], v[104:107], v[32:35]
    v_mfma_f32_16x16x32_bf16 v[36:39], a[112:115], v[104:107], v[36:39]
    v_mfma_f32_16x16x32_bf16 v[40:43], v[224:227], v[104:107], v[40:43]
    v_mfma_f32_16x16x32_bf16 v[44:47], v[104:107], a[184:187], v[44:47]
    v_mfma_f32_16x16x32_bf16 v[48:51], v[104:107], v[224:227], v[48:51]
    v_mfma_f32_16x16x32_bf16 v[32:35], a[44:47], v[108:111], v[32:35]
    v_mfma_f32_16x16x32_bf16 v[36:39], a[116:119], v[108:111], v[36:39]
    v_mfma_f32_16x16x32_bf16 v[40:43], v[228:231], v[108:111], v[40:43]
    v_mfma_f32_16x16x32_bf16 v[44:47], v[108:111], a[188:191], v[44:47]
    v_mfma_f32_16x16x32_bf16 v[48:51], v[108:111], v[228:231], v[48:51]
    v_mfma_f32_16x16x32_bf16 v[32:35], a[48:51], v[112:115], v[32:35]
    v_mfma_f32_16x16x32_bf16 v[36:39], a[120:123], v[112:115], v[36:39]
    v_mfma_f32_16x16x32_bf16 v[40:43], v[232:235], v[112:115], v[40:43]
    v_mfma_f32_16x16x32_bf16 v[44:47], v[112:115], a[192:195], v[44:47]
    v_mfma_f32_16x16x32_bf16 v[48:51], v[112:115], v[232:235], v[48:51]
    v_mfma_f32_16x16x32_bf16 v[32:35], a[52:55], v[116:119], v[32:35]
    v_mfma_f32_16x16x32_bf16 v[36:39], a[124:127], v[116:119], v[36:39]
    v_mfma_f32_16x16x32_bf16 v[40:43], v[236:239], v[116:119], v[40:43]
    v_mfma_f32_16x16x32_bf16 v[44:47], v[116:119], a[196:199], v[44:47]
    v_mfma_f32_16x16x32_bf16 v[48:51], v[116:119], v[236:239], v[48:51]
    v_mfma_f32_16x16x32_bf16 v[32:35], a[56:59], v[120:123], v[32:35]
    v_mfma_f32_16x16x32_bf16 v[36:39], a[128:131], v[120:123], v[36:39]
    v_mfma_f32_16x16x32_bf16 v[40:43], v[240:243], v[120:123], v[40:43]
    v_mfma_f32_16x16x32_bf16 v[44:47], v[120:123], a[200:203], v[44:47]
    v_mfma_f32_16x16x32_bf16 v[48:51], v[120:123], v[240:243], v[48:51]
    v_mfma_f32_16x16x32_bf16 v[32:35], a[60:63], v[124:127], v[32:35]
    v_mfma_f32_16x16x32_bf16 v[36:39], a[132:135], v[124:127], v[36:39]
    v_mfma_f32_16x16x32_bf16 v[40:43], v[244:247], v[124:127], v[40:43]
    v_mfma_f32_16x16x32_bf16 v[44:47], v[124:127], a[204:207], v[44:47]
    v_mfma_f32_16x16x32_bf16 v[48:51], v[124:127], v[244:247], v[48:51]
    v_mfma_f32_16x16x32_bf16 v[32:35], a[64:67], v[128:131], v[32:35]
    v_mfma_f32_16x16x32_bf16 v[36:39], a[136:139], v[128:131], v[36:39]
    v_mfma_f32_16x16x32_bf16 v[40:43], v[248:251], v[128:131], v[40:43]
    v_mfma_f32_16x16x32_bf16 v[44:47], v[128:131], a[208:211], v[44:47]
    v_mfma_f32_16x16x32_bf16 v[48:51], v[128:131], v[248:251], v[48:51]
    v_mfma_f32_16x16x32_bf16 v[32:35], a[68:71], v[132:135], v[32:35]
    v_mfma_f32_16x16x32_bf16 v[36:39], a[140:143], v[132:135], v[36:39]
    v_mfma_f32_16x16x32_bf16 v[40:43], v[252:255], v[132:135], v[40:43]
    v_mfma_f32_16x16x32_bf16 v[44:47], v[132:135], a[212:215], v[44:47]
    v_mfma_f32_16x16x32_bf16 v[48:51], v[132:135], v[252:255], v[48:51]
    s_nop 3
    v_mul_f32 v32, s68, v32
    v_mul_f32 v33, s68, v33
    v_mul_f32 v34, s68, v34
    v_mul_f32 v35, s68, v35
    v_mul_f32 v24, s68, v40
    v_mul_f32 v25, s68, v41
    v_cvt_pk_bf16_f32 v16, v32, v33
    v_cvt_pk_bf16_f32 v17, v34, v35
    v_cvt_pk_bf16_f32 v18, v24, v25
    v_cndmask_b32 v18, 0, v18, s[66:67]
    v_mov_b32 v19, 0
    ds_write_b128 v7, v[16:19] offset:4096
    v_cvt_pk_bf16_f32 v20, v36, v37
    v_cvt_pk_bf16_f32 v21, v38, v39
    v_cvt_pk_bf16_f32 v22, v42, v43
    v_cndmask_b32 v22, 0, v22, s[66:67]
    v_mov_b32 v23, 0
    s_add_u32 s60, s78, 4096
    buffer_store_dwordx4 v[20:23], v5, s[8:11], s60 offen sc1
    v_cvt_pk_bf16_f32 v52, v44, v45
    v_cvt_pk_bf16_f32 v53, v46, v47
    v_cvt_pk_bf16_f32 v56, v48, v49
    v_cvt_pk_bf16_f32 v57, v50, v51
    v_cndmask_b32 v56, v6, v56, s[82:83]
    v_cndmask_b32 v57, v6, v57, s[82:83]
    s_add_u32 s60, s77, 110592
    buffer_load_dwordx4 v[64:67], v4, s[16:19], s60 offen offset:0
    buffer_load_dwordx4 v[68:71], v4, s[16:19], s60 offen offset:64
    buffer_load_dwordx4 v[72:75], v4, s[16:19], s60 offen offset:128
    buffer_load_dwordx4 v[76:79], v4, s[16:19], s60 offen offset:192
    buffer_load_dwordx4 v[80:83], v4, s[16:19], s60 offen offset:256
    buffer_load_dwordx4 v[84:87], v4, s[16:19], s60 offen offset:320
    buffer_load_dwordx4 v[88:91], v4, s[16:19], s60 offen offset:384
    buffer_load_dwordx4 v[92:95], v4, s[16:19], s60 offen offset:448
    buffer_load_dwordx4 v[96:99], v4, s[16:19], s60 offen offset:512
    buffer_load_dwordx4 v[100:103], v4, s[16:19], s60 offen offset:576
    buffer_load_dwordx4 v[104:107], v4, s[16:19], s60 offen offset:640
    buffer_load_dwordx4 v[108:111], v4, s[16:19], s60 offen offset:704
    buffer_load_dwordx4 v[112:115], v4, s[16:19], s60 offen offset:768
    buffer_load_dwordx4 v[116:119], v4, s[16:19], s60 offen offset:832
    buffer_load_dwordx4 v[120:123], v4, s[16:19], s60 offen offset:896
    buffer_load_dwordx4 v[124:127], v4, s[16:19], s60 offen offset:960
    buffer_load_dwordx4 v[128:131], v4, s[16:19], s60 offen offset:1024
    buffer_load_dwordx4 v[132:135], v4, s[16:19], s60 offen offset:1088
    s_waitcnt vmcnt(19)
    v_mfma_f32_16x16x32_bf16 v[32:35], a[0:3], v[136:139], 0
    v_mfma_f32_16x16x32_bf16 v[36:39], a[72:75], v[136:139], 0
    v_mfma_f32_16x16x32_bf16 v[40:43], a[216:219], v[136:139], 0
    v_mfma_f32_16x16x32_bf16 v[44:47], v[136:139], a[144:147], 0
    v_mfma_f32_16x16x32_bf16 v[48:51], v[136:139], a[216:219], 0
    v_mfma_f32_16x16x32_bf16 v[32:35], a[4:7], v[140:143], v[32:35]
    v_mfma_f32_16x16x32_bf16 v[36:39], a[76:79], v[140:143], v[36:39]
    v_mfma_f32_16x16x32_bf16 v[40:43], a[220:223], v[140:143], v[40:43]
    v_mfma_f32_16x16x32_bf16 v[44:47], v[140:143], a[148:151], v[44:47]
    v_mfma_f32_16x16x32_bf16 v[48:51], v[140:143], a[220:223], v[48:51]
    v_mfma_f32_16x16x32_bf16 v[32:35], a[8:11], v[144:147], v[32:35]
    v_mfma_f32_16x16x32_bf16 v[36:39], a[80:83], v[144:147], v[36:39]
    v_mfma_f32_16x16x32_bf16 v[40:43], a[224:227], v[144:147], v[40:43]
    v_mfma_f32_16x16x32_bf16 v[44:47], v[144:147], a[152:155], v[44:47]
    v_mfma_f32_16x16x32_bf16 v[48:51], v[144:147], a[224:227], v[48:51]
    v_mfma_f32_16x16x32_bf16 v[32:35], a[12:15], v[148:151], v[32:35]
    v_mfma_f32_16x16x32_bf16 v[36:39], a[84:87], v[148:151], v[36:39]
    v_mfma_f32_16x16x32_bf16 v[40:43], a[228:231], v[148:151], v[40:43]
    v_mfma_f32_16x16x32_bf16 v[44:47], v[148:151], a[156:159], v[44:47]
    v_mfma_f32_16x16x32_bf16 v[48:51], v[148:151], a[228:231], v[48:51]
    v_mfma_f32_16x16x32_bf16 v[32:35], a[16:19], v[152:155], v[32:35]
    v_mfma_f32_16x16x32_bf16 v[36:39], a[88:91], v[152:155], v[36:39]
    v_mfma_f32_16x16x32_bf16 v[40:43], a[232:235], v[152:155], v[40:43]
    v_mfma_f32_16x16x32_bf16 v[44:47], v[152:155], a[160:163], v[44:47]
    v_mfma_f32_16x16x32_bf16 v[48:51], v[152:155], a[232:235], v[48:51]
    v_mfma_f32_16x16x32_bf16 v[32:35], a[20:23], v[156:159], v[32:35]
    v_mfma_f32_16x16x32_bf16 v[36:39], a[92:95], v[156:159], v[36:39]
    v_mfma_f32_16x16x32_bf16 v[40:43], a[236:239], v[156:159], v[40:43]
    v_mfma_f32_16x16x32_bf16 v[44:47], v[156:159], a[164:167], v[44:47]
    v_mfma_f32_16x16x32_bf16 v[48:51], v[156:159], a[236:239], v[48:51]
    v_mfma_f32_16x16x32_bf16 v[32:35], a[24:27], v[160:163], v[32:35]
    v_mfma_f32_16x16x32_bf16 v[36:39], a[96:99], v[160:163], v[36:39]
    v_mfma_f32_16x16x32_bf16 v[40:43], a[240:243], v[160:163], v[40:43]
    v_mfma_f32_16x16x32_bf16 v[44:47], v[160:163], a[168:171], v[44:47]
    v_mfma_f32_16x16x32_bf16 v[48:51], v[160:163], a[240:243], v[48:51]
    v_mfma_f32_16x16x32_bf16 v[32:35], a[28:31], v[164:167], v[32:35]
    v_mfma_f32_16x16x32_bf16 v[36:39], a[100:103], v[164:167], v[36:39]
    v_mfma_f32_16x16x32_bf16 v[40:43], a[244:247], v[164:167], v[40:43]
    v_mfma_f32_16x16x32_bf16 v[44:47], v[164:167], a[172:175], v[44:47]
    v_mfma_f32_16x16x32_bf16 v[48:51], v[164:167], a[244:247], v[48:51]
    v_mfma_f32_16x16x32_bf16 v[32:35], a[32:35], v[168:171], v[32:35]
    v_mfma_f32_16x16x32_bf16 v[36:39], a[104:107], v[168:171], v[36:39]
    v_mfma_f32_16x16x32_bf16 v[40:43], a[248:251], v[168:171], v[40:43]
    v_mfma_f32_16x16x32_bf16 v[44:47], v[168:171], a[176:179], v[44:47]
    v_mfma_f32_16x16x32_bf16 v[48:51], v[168:171], a[248:251], v[48:51]
    v_mfma_f32_16x16x32_bf16 v[32:35], a[36:39], v[172:175], v[32:35]
    v_mfma_f32_16x16x32_bf16 v[36:39], a[108:111], v[172:175], v[36:39]
    v_mfma_f32_16x16x32_bf16 v[40:43], a[252:255], v[172:175], v[40:43]
    v_mfma_f32_16x16x32_bf16 v[44:47], v[172:175], a[180:183], v[44:47]
    v_mfma_f32_16x16x32_bf16 v[48:51], v[172:175], a[252:255], v[48:51]
    v_mfma_f32_16x16x32_bf16 v[32:35], a[40:43], v[176:179], v[32:35]
    v_mfma_f32_16x16x32_bf16 v[36:39], a[112:115], v[176:179], v[36:39]
    v_mfma_f32_16x16x32_bf16 v[40:43], v[224:227], v[176:179], v[40:43]
    v_mfma_f32_16x16x32_bf16 v[44:47], v[176:179], a[184:187], v[44:47]
    v_mfma_f32_16x16x32_bf16 v[48:51], v[176:179], v[224:227], v[48:51]
    v_mfma_f32_16x16x32_bf16 v[32:35], a[44:47], v[180:183], v[32:35]
    v_mfma_f32_16x16x32_bf16 v[36:39], a[116:119], v[180:183], v[36:39]
    v_mfma_f32_16x16x32_bf16 v[40:43], v[228:231], v[180:183], v[40:43]
    v_mfma_f32_16x16x32_bf16 v[44:47], v[180:183], a[188:191], v[44:47]
    v_mfma_f32_16x16x32_bf16 v[48:51], v[180:183], v[228:231], v[48:51]
    v_mfma_f32_16x16x32_bf16 v[32:35], a[48:51], v[184:187], v[32:35]
    v_mfma_f32_16x16x32_bf16 v[36:39], a[120:123], v[184:187], v[36:39]
    v_mfma_f32_16x16x32_bf16 v[40:43], v[232:235], v[184:187], v[40:43]
    v_mfma_f32_16x16x32_bf16 v[44:47], v[184:187], a[192:195], v[44:47]
    v_mfma_f32_16x16x32_bf16 v[48:51], v[184:187], v[232:235], v[48:51]
    v_mfma_f32_16x16x32_bf16 v[32:35], a[52:55], v[188:191], v[32:35]
    v_mfma_f32_16x16x32_bf16 v[36:39], a[124:127], v[188:191], v[36:39]
    v_mfma_f32_16x16x32_bf16 v[40:43], v[236:239], v[188:191], v[40:43]
    v_mfma_f32_16x16x32_bf16 v[44:47], v[188:191], a[196:199], v[44:47]
    v_mfma_f32_16x16x32_bf16 v[48:51], v[188:191], v[236:239], v[48:51]
    v_mfma_f32_16x16x32_bf16 v[32:35], a[56:59], v[192:195], v[32:35]
    v_mfma_f32_16x16x32_bf16 v[36:39], a[128:131], v[192:195], v[36:39]
    v_mfma_f32_16x16x32_bf16 v[40:43], v[240:243], v[192:195], v[40:43]
    v_mfma_f32_16x16x32_bf16 v[44:47], v[192:195], a[200:203], v[44:47]
    v_mfma_f32_16x16x32_bf16 v[48:51], v[192:195], v[240:243], v[48:51]
    v_mfma_f32_16x16x32_bf16 v[32:35], a[60:63], v[196:199], v[32:35]
    v_mfma_f32_16x16x32_bf16 v[36:39], a[132:135], v[196:199], v[36:39]
    v_mfma_f32_16x16x32_bf16 v[40:43], v[244:247], v[196:199], v[40:43]
    v_mfma_f32_16x16x32_bf16 v[44:47], v[196:199], a[204:207], v[44:47]
    v_mfma_f32_16x16x32_bf16 v[48:51], v[196:199], v[244:247], v[48:51]
    v_mfma_f32_16x16x32_bf16 v[32:35], a[64:67], v[200:203], v[32:35]
    v_mfma_f32_16x16x32_bf16 v[36:39], a[136:139], v[200:203], v[36:39]
    v_mfma_f32_16x16x32_bf16 v[40:43], v[248:251], v[200:203], v[40:43]
    v_mfma_f32_16x16x32_bf16 v[44:47], v[200:203], a[208:211], v[44:47]
    v_mfma_f32_16x16x32_bf16 v[48:51], v[200:203], v[248:251], v[48:51]
    v_mfma_f32_16x16x32_bf16 v[32:35], a[68:71], v[204:207], v[32:35]
    v_mfma_f32_16x16x32_bf16 v[36:39], a[140:143], v[204:207], v[36:39]
    v_mfma_f32_16x16x32_bf16 v[40:43], v[252:255], v[204:207], v[40:43]
    v_mfma_f32_16x16x32_bf16 v[44:47], v[204:207], a[212:215], v[44:47]
    v_mfma_f32_16x16x32_bf16 v[48:51], v[204:207], v[252:255], v[48:51]
    s_nop 3
    v_mul_f32 v32, s68, v32
    v_mul_f32 v33, s68, v33
    v_mul_f32 v34, s68, v34
    v_mul_f32 v35, s68, v35
    v_mul_f32 v24, s68, v40
    v_mul_f32 v25, s68, v41
    v_cvt_pk_bf16_f32 v16, v32, v33
    v_cvt_pk_bf16_f32 v17, v34, v35
    v_cvt_pk_bf16_f32 v18, v24, v25
    v_cndmask_b32 v18, 0, v18, s[66:67]
    v_mov_b32 v19, 0
    ds_write_b128 v7, v[16:19] offset:5120
    v_cvt_pk_bf16_f32 v20, v36, v37
    v_cvt_pk_bf16_f32 v21, v38, v39
    v_cvt_pk_bf16_f32 v22, v42, v43
    v_cndmask_b32 v22, 0, v22, s[66:67]
    v_mov_b32 v23, 0
    s_add_u32 s60, s78, 5120
    buffer_store_dwordx4 v[20:23], v5, s[8:11], s60 offen sc1
    v_cvt_pk_bf16_f32 v54, v44, v45
    v_cvt_pk_bf16_f32 v55, v46, v47
    v_cvt_pk_bf16_f32 v58, v48, v49
    v_cvt_pk_bf16_f32 v59, v50, v51
    v_cndmask_b32 v58, v6, v58, s[82:83]
    v_cndmask_b32 v59, v6, v59, s[82:83]
    s_add_u32 s60, s69, 4096
    buffer_store_dwordx4 v[52:55], v5, s[8:11], s60 offen sc1
    buffer_store_dwordx4 v[56:59], v5, s[8:11], s60 offen offset:1024 sc1
    s_nop 1
    s_add_u32 s60, s77, 129024
    buffer_load_dwordx4 v[136:139], v4, s[16:19], s60 offen offset:0
    buffer_load_dwordx4 v[140:143], v4, s[16:19], s60 offen offset:64
    buffer_load_dwordx4 v[144:147], v4, s[16:19], s60 offen offset:128
    buffer_load_dwordx4 v[148:151], v4, s[16:19], s60 offen offset:192
    buffer_load_dwordx4 v[152:155], v4, s[16:19], s60 offen offset:256
    buffer_load_dwordx4 v[156:159], v4, s[16:19], s60 offen offset:320
    buffer_load_dwordx4 v[160:163], v4, s[16:19], s60 offen offset:384
    buffer_load_dwordx4 v[164:167], v4, s[16:19], s60 offen offset:448
    buffer_load_dwordx4 v[168:171], v4, s[16:19], s60 offen offset:512
    buffer_load_dwordx4 v[172:175], v4, s[16:19], s60 offen offset:576
    buffer_load_dwordx4 v[176:179], v4, s[16:19], s60 offen offset:640
    buffer_load_dwordx4 v[180:183], v4, s[16:19], s60 offen offset:704
    buffer_load_dwordx4 v[184:187], v4, s[16:19], s60 offen offset:768
    buffer_load_dwordx4 v[188:191], v4, s[16:19], s60 offen offset:832
    buffer_load_dwordx4 v[192:195], v4, s[16:19], s60 offen offset:896
    buffer_load_dwordx4 v[196:199], v4, s[16:19], s60 offen offset:960
    buffer_load_dwordx4 v[200:203], v4, s[16:19], s60 offen offset:1024
    buffer_load_dwordx4 v[204:207], v4, s[16:19], s60 offen offset:1088
    s_waitcnt vmcnt(21)
    v_mfma_f32_16x16x32_bf16 v[32:35], a[0:3], v[64:67], 0
    v_mfma_f32_16x16x32_bf16 v[36:39], a[72:75], v[64:67], 0
    v_mfma_f32_16x16x32_bf16 v[40:43], a[216:219], v[64:67], 0
    v_mfma_f32_16x16x32_bf16 v[44:47], v[64:67], a[144:147], 0
    v_mfma_f32_16x16x32_bf16 v[48:51], v[64:67], a[216:219], 0
    v_mfma_f32_16x16x32_bf16 v[32:35], a[4:7], v[68:71], v[32:35]
    v_mfma_f32_16x16x32_bf16 v[36:39], a[76:79], v[68:71], v[36:39]
    v_mfma_f32_16x16x32_bf16 v[40:43], a[220:223], v[68:71], v[40:43]
    v_mfma_f32_16x16x32_bf16 v[44:47], v[68:71], a[148:151], v[44:47]
    v_mfma_f32_16x16x32_bf16 v[48:51], v[68:71], a[220:223], v[48:51]
    v_mfma_f32_16x16x32_bf16 v[32:35], a[8:11], v[72:75], v[32:35]
    v_mfma_f32_16x16x32_bf16 v[36:39], a[80:83], v[72:75], v[36:39]
    v_mfma_f32_16x16x32_bf16 v[40:43], a[224:227], v[72:75], v[40:43]
    v_mfma_f32_16x16x32_bf16 v[44:47], v[72:75], a[152:155], v[44:47]
    v_mfma_f32_16x16x32_bf16 v[48:51], v[72:75], a[224:227], v[48:51]
    v_mfma_f32_16x16x32_bf16 v[32:35], a[12:15], v[76:79], v[32:35]
    v_mfma_f32_16x16x32_bf16 v[36:39], a[84:87], v[76:79], v[36:39]
    v_mfma_f32_16x16x32_bf16 v[40:43], a[228:231], v[76:79], v[40:43]
    v_mfma_f32_16x16x32_bf16 v[44:47], v[76:79], a[156:159], v[44:47]
    v_mfma_f32_16x16x32_bf16 v[48:51], v[76:79], a[228:231], v[48:51]
    v_mfma_f32_16x16x32_bf16 v[32:35], a[16:19], v[80:83], v[32:35]
    v_mfma_f32_16x16x32_bf16 v[36:39], a[88:91], v[80:83], v[36:39]
    v_mfma_f32_16x16x32_bf16 v[40:43], a[232:235], v[80:83], v[40:43]
    v_mfma_f32_16x16x32_bf16 v[44:47], v[80:83], a[160:163], v[44:47]
    v_mfma_f32_16x16x32_bf16 v[48:51], v[80:83], a[232:235], v[48:51]
    v_mfma_f32_16x16x32_bf16 v[32:35], a[20:23], v[84:87], v[32:35]
    v_mfma_f32_16x16x32_bf16 v[36:39], a[92:95], v[84:87], v[36:39]
    v_mfma_f32_16x16x32_bf16 v[40:43], a[236:239], v[84:87], v[40:43]
    v_mfma_f32_16x16x32_bf16 v[44:47], v[84:87], a[164:167], v[44:47]
    v_mfma_f32_16x16x32_bf16 v[48:51], v[84:87], a[236:239], v[48:51]
    v_mfma_f32_16x16x32_bf16 v[32:35], a[24:27], v[88:91], v[32:35]
    v_mfma_f32_16x16x32_bf16 v[36:39], a[96:99], v[88:91], v[36:39]
    v_mfma_f32_16x16x32_bf16 v[40:43], a[240:243], v[88:91], v[40:43]
    v_mfma_f32_16x16x32_bf16 v[44:47], v[88:91], a[168:171], v[44:47]
    v_mfma_f32_16x16x32_bf16 v[48:51], v[88:91], a[240:243], v[48:51]
    v_mfma_f32_16x16x32_bf16 v[32:35], a[28:31], v[92:95], v[32:35]
    v_mfma_f32_16x16x32_bf16 v[36:39], a[100:103], v[92:95], v[36:39]
    v_mfma_f32_16x16x32_bf16 v[40:43], a[244:247], v[92:95], v[40:43]
    v_mfma_f32_16x16x32_bf16 v[44:47], v[92:95], a[172:175], v[44:47]
    v_mfma_f32_16x16x32_bf16 v[48:51], v[92:95], a[244:247], v[48:51]
    v_mfma_f32_16x16x32_bf16 v[32:35], a[32:35], v[96:99], v[32:35]
    v_mfma_f32_16x16x32_bf16 v[36:39], a[104:107], v[96:99], v[36:39]
    v_mfma_f32_16x16x32_bf16 v[40:43], a[248:251], v[96:99], v[40:43]
    v_mfma_f32_16x16x32_bf16 v[44:47], v[96:99], a[176:179], v[44:47]
    v_mfma_f32_16x16x32_bf16 v[48:51], v[96:99], a[248:251], v[48:51]
    v_mfma_f32_16x16x32_bf16 v[32:35], a[36:39], v[100:103], v[32:35]
    v_mfma_f32_16x16x32_bf16 v[36:39], a[108:111], v[100:103], v[36:39]
    v_mfma_f32_16x16x32_bf16 v[40:43], a[252:255], v[100:103], v[40:43]
    v_mfma_f32_16x16x32_bf16 v[44:47], v[100:103], a[180:183], v[44:47]
    v_mfma_f32_16x16x32_bf16 v[48:51], v[100:103], a[252:255], v[48:51]
    v_mfma_f32_16x16x32_bf16 v[32:35], a[40:43], v[104:107], v[32:35]
    v_mfma_f32_16x16x32_bf16 v[36:39], a[112:115], v[104:107], v[36:39]
    v_mfma_f32_16x16x32_bf16 v[40:43], v[224:227], v[104:107], v[40:43]
    v_mfma_f32_16x16x32_bf16 v[44:47], v[104:107], a[184:187], v[44:47]
    v_mfma_f32_16x16x32_bf16 v[48:51], v[104:107], v[224:227], v[48:51]
    v_mfma_f32_16x16x32_bf16 v[32:35], a[44:47], v[108:111], v[32:35]
    v_mfma_f32_16x16x32_bf16 v[36:39], a[116:119], v[108:111], v[36:39]
    v_mfma_f32_16x16x32_bf16 v[40:43], v[228:231], v[108:111], v[40:43]
    v_mfma_f32_16x16x32_bf16 v[44:47], v[108:111], a[188:191], v[44:47]
    v_mfma_f32_16x16x32_bf16 v[48:51], v[108:111], v[228:231], v[48:51]
    v_mfma_f32_16x16x32_bf16 v[32:35], a[48:51], v[112:115], v[32:35]
    v_mfma_f32_16x16x32_bf16 v[36:39], a[120:123], v[112:115], v[36:39]
    v_mfma_f32_16x16x32_bf16 v[40:43], v[232:235], v[112:115], v[40:43]
    v_mfma_f32_16x16x32_bf16 v[44:47], v[112:115], a[192:195], v[44:47]
    v_mfma_f32_16x16x32_bf16 v[48:51], v[112:115], v[232:235], v[48:51]
    v_mfma_f32_16x16x32_bf16 v[32:35], a[52:55], v[116:119], v[32:35]
    v_mfma_f32_16x16x32_bf16 v[36:39], a[124:127], v[116:119], v[36:39]
    v_mfma_f32_16x16x32_bf16 v[40:43], v[236:239], v[116:119], v[40:43]
    v_mfma_f32_16x16x32_bf16 v[44:47], v[116:119], a[196:199], v[44:47]
    v_mfma_f32_16x16x32_bf16 v[48:51], v[116:119], v[236:239], v[48:51]
    v_mfma_f32_16x16x32_bf16 v[32:35], a[56:59], v[120:123], v[32:35]
    v_mfma_f32_16x16x32_bf16 v[36:39], a[128:131], v[120:123], v[36:39]
    v_mfma_f32_16x16x32_bf16 v[40:43], v[240:243], v[120:123], v[40:43]
    v_mfma_f32_16x16x32_bf16 v[44:47], v[120:123], a[200:203], v[44:47]
    v_mfma_f32_16x16x32_bf16 v[48:51], v[120:123], v[240:243], v[48:51]
    v_mfma_f32_16x16x32_bf16 v[32:35], a[60:63], v[124:127], v[32:35]
    v_mfma_f32_16x16x32_bf16 v[36:39], a[132:135], v[124:127], v[36:39]
    v_mfma_f32_16x16x32_bf16 v[40:43], v[244:247], v[124:127], v[40:43]
    v_mfma_f32_16x16x32_bf16 v[44:47], v[124:127], a[204:207], v[44:47]
    v_mfma_f32_16x16x32_bf16 v[48:51], v[124:127], v[244:247], v[48:51]
    v_mfma_f32_16x16x32_bf16 v[32:35], a[64:67], v[128:131], v[32:35]
    v_mfma_f32_16x16x32_bf16 v[36:39], a[136:139], v[128:131], v[36:39]
    v_mfma_f32_16x16x32_bf16 v[40:43], v[248:251], v[128:131], v[40:43]
    v_mfma_f32_16x16x32_bf16 v[44:47], v[128:131], a[208:211], v[44:47]
    v_mfma_f32_16x16x32_bf16 v[48:51], v[128:131], v[248:251], v[48:51]
    v_mfma_f32_16x16x32_bf16 v[32:35], a[68:71], v[132:135], v[32:35]
    v_mfma_f32_16x16x32_bf16 v[36:39], a[140:143], v[132:135], v[36:39]
    v_mfma_f32_16x16x32_bf16 v[40:43], v[252:255], v[132:135], v[40:43]
    v_mfma_f32_16x16x32_bf16 v[44:47], v[132:135], a[212:215], v[44:47]
    v_mfma_f32_16x16x32_bf16 v[48:51], v[132:135], v[252:255], v[48:51]
    s_nop 3
    v_mul_f32 v32, s68, v32
    v_mul_f32 v33, s68, v33
    v_mul_f32 v34, s68, v34
    v_mul_f32 v35, s68, v35
    v_mul_f32 v24, s68, v40
    v_mul_f32 v25, s68, v41
    v_cvt_pk_bf16_f32 v16, v32, v33
    v_cvt_pk_bf16_f32 v17, v34, v35
    v_cvt_pk_bf16_f32 v18, v24, v25
    v_cndmask_b32 v18, 0, v18, s[66:67]
    v_mov_b32 v19, 0
    ds_write_b128 v7, v[16:19] offset:6144
    v_cvt_pk_bf16_f32 v20, v36, v37
    v_cvt_pk_bf16_f32 v21, v38, v39
    v_cvt_pk_bf16_f32 v22, v42, v43
    v_cndmask_b32 v22, 0, v22, s[66:67]
    v_mov_b32 v23, 0
    s_add_u32 s60, s78, 6144
    buffer_store_dwordx4 v[20:23], v5, s[8:11], s60 offen sc1
    v_cvt_pk_bf16_f32 v52, v44, v45
    v_cvt_pk_bf16_f32 v53, v46, v47
    v_cvt_pk_bf16_f32 v56, v48, v49
    v_cvt_pk_bf16_f32 v57, v50, v51
    v_cndmask_b32 v56, v6, v56, s[82:83]
    v_cndmask_b32 v57, v6, v57, s[82:83]
    s_waitcnt vmcnt(1)
    v_mfma_f32_16x16x32_bf16 v[32:35], a[0:3], v[136:139], 0
    v_mfma_f32_16x16x32_bf16 v[36:39], a[72:75], v[136:139], 0
    v_mfma_f32_16x16x32_bf16 v[40:43], a[216:219], v[136:139], 0
    v_mfma_f32_16x16x32_bf16 v[44:47], v[136:139], a[144:147], 0
    v_mfma_f32_16x16x32_bf16 v[48:51], v[136:139], a[216:219], 0
    v_mfma_f32_16x16x32_bf16 v[32:35], a[4:7], v[140:143], v[32:35]
    v_mfma_f32_16x16x32_bf16 v[36:39], a[76:79], v[140:143], v[36:39]
    v_mfma_f32_16x16x32_bf16 v[40:43], a[220:223], v[140:143], v[40:43]
    v_mfma_f32_16x16x32_bf16 v[44:47], v[140:143], a[148:151], v[44:47]
    v_mfma_f32_16x16x32_bf16 v[48:51], v[140:143], a[220:223], v[48:51]
    v_mfma_f32_16x16x32_bf16 v[32:35], a[8:11], v[144:147], v[32:35]
    v_mfma_f32_16x16x32_bf16 v[36:39], a[80:83], v[144:147], v[36:39]
    v_mfma_f32_16x16x32_bf16 v[40:43], a[224:227], v[144:147], v[40:43]
    v_mfma_f32_16x16x32_bf16 v[44:47], v[144:147], a[152:155], v[44:47]
    v_mfma_f32_16x16x32_bf16 v[48:51], v[144:147], a[224:227], v[48:51]
    v_mfma_f32_16x16x32_bf16 v[32:35], a[12:15], v[148:151], v[32:35]
    v_mfma_f32_16x16x32_bf16 v[36:39], a[84:87], v[148:151], v[36:39]
    v_mfma_f32_16x16x32_bf16 v[40:43], a[228:231], v[148:151], v[40:43]
    v_mfma_f32_16x16x32_bf16 v[44:47], v[148:151], a[156:159], v[44:47]
    v_mfma_f32_16x16x32_bf16 v[48:51], v[148:151], a[228:231], v[48:51]
    v_mfma_f32_16x16x32_bf16 v[32:35], a[16:19], v[152:155], v[32:35]
    v_mfma_f32_16x16x32_bf16 v[36:39], a[88:91], v[152:155], v[36:39]
    v_mfma_f32_16x16x32_bf16 v[40:43], a[232:235], v[152:155], v[40:43]
    v_mfma_f32_16x16x32_bf16 v[44:47], v[152:155], a[160:163], v[44:47]
    v_mfma_f32_16x16x32_bf16 v[48:51], v[152:155], a[232:235], v[48:51]
    v_mfma_f32_16x16x32_bf16 v[32:35], a[20:23], v[156:159], v[32:35]
    v_mfma_f32_16x16x32_bf16 v[36:39], a[92:95], v[156:159], v[36:39]
    v_mfma_f32_16x16x32_bf16 v[40:43], a[236:239], v[156:159], v[40:43]
    v_mfma_f32_16x16x32_bf16 v[44:47], v[156:159], a[164:167], v[44:47]
    v_mfma_f32_16x16x32_bf16 v[48:51], v[156:159], a[236:239], v[48:51]
    v_mfma_f32_16x16x32_bf16 v[32:35], a[24:27], v[160:163], v[32:35]
    v_mfma_f32_16x16x32_bf16 v[36:39], a[96:99], v[160:163], v[36:39]
    v_mfma_f32_16x16x32_bf16 v[40:43], a[240:243], v[160:163], v[40:43]
    v_mfma_f32_16x16x32_bf16 v[44:47], v[160:163], a[168:171], v[44:47]
    v_mfma_f32_16x16x32_bf16 v[48:51], v[160:163], a[240:243], v[48:51]
    v_mfma_f32_16x16x32_bf16 v[32:35], a[28:31], v[164:167], v[32:35]
    v_mfma_f32_16x16x32_bf16 v[36:39], a[100:103], v[164:167], v[36:39]
    v_mfma_f32_16x16x32_bf16 v[40:43], a[244:247], v[164:167], v[40:43]
    v_mfma_f32_16x16x32_bf16 v[44:47], v[164:167], a[172:175], v[44:47]
    v_mfma_f32_16x16x32_bf16 v[48:51], v[164:167], a[244:247], v[48:51]
    v_mfma_f32_16x16x32_bf16 v[32:35], a[32:35], v[168:171], v[32:35]
    v_mfma_f32_16x16x32_bf16 v[36:39], a[104:107], v[168:171], v[36:39]
    v_mfma_f32_16x16x32_bf16 v[40:43], a[248:251], v[168:171], v[40:43]
    v_mfma_f32_16x16x32_bf16 v[44:47], v[168:171], a[176:179], v[44:47]
    v_mfma_f32_16x16x32_bf16 v[48:51], v[168:171], a[248:251], v[48:51]
    v_mfma_f32_16x16x32_bf16 v[32:35], a[36:39], v[172:175], v[32:35]
    v_mfma_f32_16x16x32_bf16 v[36:39], a[108:111], v[172:175], v[36:39]
    v_mfma_f32_16x16x32_bf16 v[40:43], a[252:255], v[172:175], v[40:43]
    v_mfma_f32_16x16x32_bf16 v[44:47], v[172:175], a[180:183], v[44:47]
    v_mfma_f32_16x16x32_bf16 v[48:51], v[172:175], a[252:255], v[48:51]
    v_mfma_f32_16x16x32_bf16 v[32:35], a[40:43], v[176:179], v[32:35]
    v_mfma_f32_16x16x32_bf16 v[36:39], a[112:115], v[176:179], v[36:39]
    v_mfma_f32_16x16x32_bf16 v[40:43], v[224:227], v[176:179], v[40:43]
    v_mfma_f32_16x16x32_bf16 v[44:47], v[176:179], a[184:187], v[44:47]
    v_mfma_f32_16x16x32_bf16 v[48:51], v[176:179], v[224:227], v[48:51]
    v_mfma_f32_16x16x32_bf16 v[32:35], a[44:47], v[180:183], v[32:35]
    v_mfma_f32_16x16x32_bf16 v[36:39], a[116:119], v[180:183], v[36:39]
    v_mfma_f32_16x16x32_bf16 v[40:43], v[228:231], v[180:183], v[40:43]
    v_mfma_f32_16x16x32_bf16 v[44:47], v[180:183], a[188:191], v[44:47]
    v_mfma_f32_16x16x32_bf16 v[48:51], v[180:183], v[228:231], v[48:51]
    v_mfma_f32_16x16x32_bf16 v[32:35], a[48:51], v[184:187], v[32:35]
    v_mfma_f32_16x16x32_bf16 v[36:39], a[120:123], v[184:187], v[36:39]
    v_mfma_f32_16x16x32_bf16 v[40:43], v[232:235], v[184:187], v[40:43]
    v_mfma_f32_16x16x32_bf16 v[44:47], v[184:187], a[192:195], v[44:47]
    v_mfma_f32_16x16x32_bf16 v[48:51], v[184:187], v[232:235], v[48:51]
    v_mfma_f32_16x16x32_bf16 v[32:35], a[52:55], v[188:191], v[32:35]
    v_mfma_f32_16x16x32_bf16 v[36:39], a[124:127], v[188:191], v[36:39]
    v_mfma_f32_16x16x32_bf16 v[40:43], v[236:239], v[188:191], v[40:43]
    v_mfma_f32_16x16x32_bf16 v[44:47], v[188:191], a[196:199], v[44:47]
    v_mfma_f32_16x16x32_bf16 v[48:51], v[188:191], v[236:239], v[48:51]
    v_mfma_f32_16x16x32_bf16 v[32:35], a[56:59], v[192:195], v[32:35]
    v_mfma_f32_16x16x32_bf16 v[36:39], a[128:131], v[192:195], v[36:39]
    v_mfma_f32_16x16x32_bf16 v[40:43], v[240:243], v[192:195], v[40:43]
    v_mfma_f32_16x16x32_bf16 v[44:47], v[192:195], a[200:203], v[44:47]
    v_mfma_f32_16x16x32_bf16 v[48:51], v[192:195], v[240:243], v[48:51]
    v_mfma_f32_16x16x32_bf16 v[32:35], a[60:63], v[196:199], v[32:35]
    v_mfma_f32_16x16x32_bf16 v[36:39], a[132:135], v[196:199], v[36:39]
    v_mfma_f32_16x16x32_bf16 v[40:43], v[244:247], v[196:199], v[40:43]
    v_mfma_f32_16x16x32_bf16 v[44:47], v[196:199], a[204:207], v[44:47]
    v_mfma_f32_16x16x32_bf16 v[48:51], v[196:199], v[244:247], v[48:51]
    v_mfma_f32_16x16x32_bf16 v[32:35], a[64:67], v[200:203], v[32:35]
    v_mfma_f32_16x16x32_bf16 v[36:39], a[136:139], v[200:203], v[36:39]
    v_mfma_f32_16x16x32_bf16 v[40:43], v[248:251], v[200:203], v[40:43]
    v_mfma_f32_16x16x32_bf16 v[44:47], v[200:203], a[208:211], v[44:47]
    v_mfma_f32_16x16x32_bf16 v[48:51], v[200:203], v[248:251], v[48:51]
    v_mfma_f32_16x16x32_bf16 v[32:35], a[68:71], v[204:207], v[32:35]
    v_mfma_f32_16x16x32_bf16 v[36:39], a[140:143], v[204:207], v[36:39]
    v_mfma_f32_16x16x32_bf16 v[40:43], v[252:255], v[204:207], v[40:43]
    v_mfma_f32_16x16x32_bf16 v[44:47], v[204:207], a[212:215], v[44:47]
    v_mfma_f32_16x16x32_bf16 v[48:51], v[204:207], v[252:255], v[48:51]
    s_nop 3
    v_mul_f32 v32, s68, v32
    v_mul_f32 v33, s68, v33
    v_mul_f32 v34, s68, v34
    v_mul_f32 v35, s68, v35
    v_mul_f32 v24, s68, v40
    v_mul_f32 v25, s68, v41
    v_cvt_pk_bf16_f32 v16, v32, v33
    v_cvt_pk_bf16_f32 v17, v34, v35
    v_cvt_pk_bf16_f32 v18, v24, v25
    v_cndmask_b32 v18, 0, v18, s[66:67]
    v_mov_b32 v19, 0
    ds_write_b128 v7, v[16:19] offset:7168
    v_cvt_pk_bf16_f32 v20, v36, v37
    v_cvt_pk_bf16_f32 v21, v38, v39
    v_cvt_pk_bf16_f32 v22, v42, v43
    v_cndmask_b32 v22, 0, v22, s[66:67]
    v_mov_b32 v23, 0
    s_add_u32 s60, s78, 7168
    buffer_store_dwordx4 v[20:23], v5, s[8:11], s60 offen sc1
    v_cvt_pk_bf16_f32 v54, v44, v45
    v_cvt_pk_bf16_f32 v55, v46, v47
    v_cvt_pk_bf16_f32 v58, v48, v49
    v_cvt_pk_bf16_f32 v59, v50, v51
    v_cndmask_b32 v58, v6, v58, s[82:83]
    v_cndmask_b32 v59, v6, v59, s[82:83]
    s_add_u32 s60, s69, 6144
    buffer_store_dwordx4 v[52:55], v5, s[8:11], s60 offen sc1
    buffer_store_dwordx4 v[56:59], v5, s[8:11], s60 offen offset:1024 sc1
    s_nop 1
    v_and_b32 v16, 7, v0
    v_lshlrev_b32 v16, 5, v16
    s_mov_b32 s59, 0
L_init_179:
    buffer_load_dwordx2 v[18:19], v16, s[12:15], 0 offen sc1
    s_waitcnt vmcnt(0)
    v_sad_u8 v17, v18, 0, 0
    v_sad_u8 v17, v19, 0, v17
    v_cmp_ne_u32 vcc, 32, v17
    s_cbranch_vccz L_init_ok_180
    s_add_u32 s59, s59, 1
    s_cmp_lt_u32 s59, s58
    s_cbranch_scc1 L_init_179
    s_mov_b32 s58, 0
L_init_ok_180:
    v_or_b32 v17, v18, v19
    v_and_b32 v17, 0x20202020, v17
    s_nop 0
    v_readlane_b32 s7, v17, s5
    s_waitcnt vmcnt(0) lgkmcnt(0)
    s_barrier
    s_lshl_b32 s77, s70, 6
    s_add_u32 s77, s77, 24576
    s_cmp_lg_u32 s4, 0
    s_cbranch_scc1 L_anf_181
    s_lshl_b32 s60, s71, 2
    s_add_u32 s60, s60, s77
    v_mov_b32 v16, 1
    s_mov_b64 exec, 1
    buffer_store_dword v16, off, s[8:11], s60 sc1
    s_mov_b64 exec, -1
L_anf_181:
    ds_read_b128 v[16:19], v7 offset:0
    ds_read_b128 v[20:23], v7 offset:1024
    ds_read_b128 v[24:27], v7 offset:2048
    ds_read_b128 v[28:31], v7 offset:3072
    ds_read_b128 v[32:35], v7 offset:4096
    ds_read_b128 v[36:39], v7 offset:5120
    ds_read_b128 v[40:43], v7 offset:6144
    ds_read_b128 v[44:47], v7 offset:7168
    v_and_b32 v8, 3, v1
    v_lshlrev_b32 v8, 2, v8
    s_mov_b32 s59, 0
L_akv_182:
    buffer_load_dword v9, v8, s[8:11], s77 offen sc1
    s_waitcnt vmcnt(0)
    v_cmp_ne_u32 vcc, 1, v9
    s_cbranch_vccz L_akv_ok_183
    s_add_u32 s59, s59, 1
    s_cmp_lt_u32 s59, s58
    s_cbranch_scc1 L_akv_182
    s_mov_b32 s58, 0
L_akv_ok_183:
    buffer_inv sc1
    s_waitcnt vmcnt(0) lgkmcnt(0)
    v_mov_b32 v144, 0xff7fffff
    v_mov_b32 v145, 0xff7fffff
    v_mov_b32 v146, 0xff7fffff
    v_mov_b32 v147, 0xff7fffff
    v_mov_b32 v148, 0xff7fffff
    v_mov_b32 v149, 0xff7fffff
    v_mov_b32 v150, 0xff7fffff
    v_mov_b32 v151, 0xff7fffff
    s_mov_b32 s77, s75
    buffer_load_dwordx4 v[168:171], v5, s[8:11], s77 offen offset:0
    s_add_u32 s77, s77, 1024
    buffer_load_dwordx4 v[172:175], v5, s[8:11], s77 offen offset:0
    s_add_u32 s77, s77, 1024
    buffer_load_dwordx4 v[176:179], v5, s[8:11], s77 offen offset:0
    s_add_u32 s77, s77, 1024
    buffer_load_dwordx4 v[180:183], v5, s[8:11], s77 offen offset:0
    s_add_u32 s77, s77, 1024
    buffer_load_dwordx4 v[184:187], v5, s[8:11], s77 offen offset:0
    s_add_u32 s77, s77, 1024
    buffer_load_dwordx4 v[188:191], v5, s[8:11], s77 offen offset:0
    s_add_u32 s77, s77, 1024
    buffer_load_dwordx4 v[192:195], v5, s[8:11], s77 offen offset:0
    s_add_u32 s77, s77, 1024
    buffer_load_dwordx4 v[196:199], v5, s[8:11], s77 offen offset:0
    s_add_u32 s77, s77, 1024
    v_mov_b32 v80, 0xff7fffff
    v_mov_b32 v81, 0xff7fffff
    v_mov_b32 v82, 0xff7fffff
    v_mov_b32 v83, 0xff7fffff
    v_mov_b32 v84, 0xff7fffff
    v_mov_b32 v85, 0xff7fffff
    v_mov_b32 v86, 0xff7fffff
    v_mov_b32 v87, 0xff7fffff
    v_mov_b32 v88, 0xff7fffff
    v_mov_b32 v89, 0xff7fffff
    v_mov_b32 v90, 0xff7fffff
    v_mov_b32 v91, 0xff7fffff
    v_mov_b32 v92, 0xff7fffff
    v_mov_b32 v93, 0xff7fffff
    v_mov_b32 v94, 0xff7fffff
    v_mov_b32 v95, 0xff7fffff
    v_mov_b32 v96, 0xff7fffff
    v_mov_b32 v97, 0xff7fffff
    v_mov_b32 v98, 0xff7fffff
    v_mov_b32 v99, 0xff7fffff
    v_mov_b32 v100, 0xff7fffff
    v_mov_b32 v101, 0xff7fffff
    v_mov_b32 v102, 0xff7fffff
    v_mov_b32 v103, 0xff7fffff
    v_mov_b32 v104, 0xff7fffff
    v_mov_b32 v105, 0xff7fffff
    v_mov_b32 v106, 0xff7fffff
    v_mov_b32 v107, 0xff7fffff
    v_mov_b32 v108, 0xff7fffff
    v_mov_b32 v109, 0xff7fffff
    v_mov_b32 v110, 0xff7fffff
    v_mov_b32 v111, 0xff7fffff
    s_mov_b32 s79, 0
L_ap1_184:
    s_waitcnt vmcnt(7)
    v_mfma_f32_16x16x32_bf16 v[80:83], v[168:171], v[16:19], 0
    v_max3_f32 v149, v149, v100, v101
    v_max3_f32 v149, v149, v102, v103
    v_mfma_f32_16x16x32_bf16 v[84:87], v[168:171], v[20:23], 0
    v_max3_f32 v150, v150, v104, v105
    v_max3_f32 v150, v150, v106, v107
    v_mfma_f32_16x16x32_bf16 v[88:91], v[168:171], v[24:27], 0
    v_max3_f32 v151, v151, v108, v109
    v_max3_f32 v151, v151, v110, v111
    v_mfma_f32_16x16x32_bf16 v[92:95], v[168:171], v[28:31], 0
    v_max3_f32 v144, v144, v80, v81
    v_max3_f32 v144, v144, v82, v83
    v_mfma_f32_16x16x32_bf16 v[96:99], v[168:171], v[32:35], 0
    v_max3_f32 v145, v145, v84, v85
    v_max3_f32 v145, v145, v86, v87
    v_mfma_f32_16x16x32_bf16 v[100:103], v[168:171], v[36:39], 0
    v_max3_f32 v146, v146, v88, v89
    v_max3_f32 v146, v146, v90, v91
    v_mfma_f32_16x16x32_bf16 v[104:107], v[168:171], v[40:43], 0
    v_max3_f32 v147, v147, v92, v93
    v_max3_f32 v147, v147, v94, v95
    v_mfma_f32_16x16x32_bf16 v[108:111], v[168:171], v[44:47], 0
    v_max3_f32 v148, v148, v96, v97
    v_max3_f32 v148, v148, v98, v99
    buffer_load_dwordx4 v[168:171], v5, s[8:11], s77 offen
    s_add_u32 s77, s77, 1024
    s_waitcnt vmcnt(7)
    v_mfma_f32_16x16x32_bf16 v[80:83], v[172:175], v[16:19], 0
    v_max3_f32 v149, v149, v100, v101
    v_max3_f32 v149, v149, v102, v103
    v_mfma_f32_16x16x32_bf16 v[84:87], v[172:175], v[20:23], 0
    v_max3_f32 v150, v150, v104, v105
    v_max3_f32 v150, v150, v106, v107
    v_mfma_f32_16x16x32_bf16 v[88:91], v[172:175], v[24:27], 0
    v_max3_f32 v151, v151, v108, v109
    v_max3_f32 v151, v151, v110, v111
    v_mfma_f32_16x16x32_bf16 v[92:95], v[172:175], v[28:31], 0
    v_max3_f32 v144, v144, v80, v81
    v_max3_f32 v144, v144, v82, v83
    v_mfma_f32_16x16x32_bf16 v[96:99], v[172:175], v[32:35], 0
    v_max3_f32 v145, v145, v84, v85
    v_max3_f32 v145, v145, v86, v87
    v_mfma_f32_16x16x32_bf16 v[100:103], v[172:175], v[36:39], 0
    v_max3_f32 v146, v146, v88, v89
    v_max3_f32 v146, v146, v90, v91
    v_mfma_f32_16x16x32_bf16 v[104:107], v[172:175], v[40:43], 0
    v_max3_f32 v147, v147, v92, v93
    v_max3_f32 v147, v147, v94, v95
    v_mfma_f32_16x16x32_bf16 v[108:111], v[172:175], v[44:47], 0
    v_max3_f32 v148, v148, v96, v97
    v_max3_f32 v148, v148, v98, v99
    buffer_load_dwordx4 v[172:175], v5, s[8:11], s77 offen
    s_add_u32 s77, s77, 1024
    s_waitcnt vmcnt(7)
    v_mfma_f32_16x16x32_bf16 v[80:83], v[176:179], v[16:19], 0
    v_max3_f32 v149, v149, v100, v101
    v_max3_f32 v149, v149, v102, v103
    v_mfma_f32_16x16x32_bf16 v[84:87], v[176:179], v[20:23], 0
    v_max3_f32 v150, v150, v104, v105
    v_max3_f32 v150, v150, v106, v107
    v_mfma_f32_16x16x32_bf16 v[88:91], v[176:179], v[24:27], 0
    v_max3_f32 v151, v151, v108, v109
    v_max3_f32 v151, v151, v110, v111
    v_mfma_f32_16x16x32_bf16 v[92:95], v[176:179], v[28:31], 0
    v_max3_f32 v144, v144, v80, v81
    v_max3_f32 v144, v144, v82, v83
    v_mfma_f32_16x16x32_bf16 v[96:99], v[176:179], v[32:35], 0
    v_max3_f32 v145, v145, v84, v85
    v_max3_f32 v145, v145, v86, v87
    v_mfma_f32_16x16x32_bf16 v[100:103], v[176:179], v[36:39], 0
    v_max3_f32 v146, v146, v88, v89
    v_max3_f32 v146, v146, v90, v91
    v_mfma_f32_16x16x32_bf16 v[104:107], v[176:179], v[40:43], 0
    v_max3_f32 v147, v147, v92, v93
    v_max3_f32 v147, v147, v94, v95
    v_mfma_f32_16x16x32_bf16 v[108:111], v[176:179], v[44:47], 0
    v_max3_f32 v148, v148, v96, v97
    v_max3_f32 v148, v148, v98, v99
    buffer_load_dwordx4 v[176:179], v5, s[8:11], s77 offen
    s_add_u32 s77, s77, 1024
    s_waitcnt vmcnt(7)
    v_mfma_f32_16x16x32_bf16 v[80:83], v[180:183], v[16:19], 0
    v_max3_f32 v149, v149, v100, v101
    v_max3_f32 v149, v149, v102, v103
    v_mfma_f32_16x16x32_bf16 v[84:87], v[180:183], v[20:23], 0
    v_max3_f32 v150, v150, v104, v105
    v_max3_f32 v150, v150, v106, v107
    v_mfma_f32_16x16x32_bf16 v[88:91], v[180:183], v[24:27], 0
    v_max3_f32 v151, v151, v108, v109
    v_max3_f32 v151, v151, v110, v111
    v_mfma_f32_16x16x32_bf16 v[92:95], v[180:183], v[28:31], 0
    v_max3_f32 v144, v144, v80, v81
    v_max3_f32 v144, v144, v82, v83
    v_mfma_f32_16x16x32_bf16 v[96:99], v[180:183], v[32:35], 0
    v_max3_f32 v145, v145, v84, v85
    v_max3_f32 v145, v145, v86, v87
    v_mfma_f32_16x16x32_bf16 v[100:103], v[180:183], v[36:39], 0
    v_max3_f32 v146, v146, v88, v89
    v_max3_f32 v146, v146, v90, v91
    v_mfma_f32_16x16x32_bf16 v[104:107], v[180:183], v[40:43], 0
    v_max3_f32 v147, v147, v92, v93
    v_max3_f32 v147, v147, v94, v95
    v_mfma_f32_16x16x32_bf16 v[108:111], v[180:183], v[44:47], 0
    v_max3_f32 v148, v148, v96, v97
    v_max3_f32 v148, v148, v98, v99
    buffer_load_dwordx4 v[180:183], v5, s[8:11], s77 offen
    s_add_u32 s77, s77, 1024
    s_waitcnt vmcnt(7)
    v_mfma_f32_16x16x32_bf16 v[80:83], v[184:187], v[16:19], 0
    v_max3_f32 v149, v149, v100, v101
    v_max3_f32 v149, v149, v102, v103
    v_mfma_f32_16x16x32_bf16 v[84:87], v[184:187], v[20:23], 0
    v_max3_f32 v150, v150, v104, v105
    v_max3_f32 v150, v150, v106, v107
    v_mfma_f32_16x16x32_bf16 v[88:91], v[184:187], v[24:27], 0
    v_max3_f32 v151, v151, v108, v109
    v_max3_f32 v151, v151, v110, v111
    v_mfma_f32_16x16x32_bf16 v[92:95], v[184:187], v[28:31], 0
    v_max3_f32 v144, v144, v80, v81
    v_max3_f32 v144, v144, v82, v83
    v_mfma_f32_16x16x32_bf16 v[96:99], v[184:187], v[32:35], 0
    v_max3_f32 v145, v145, v84, v85
    v_max3_f32 v145, v145, v86, v87
    v_mfma_f32_16x16x32_bf16 v[100:103], v[184:187], v[36:39], 0
    v_max3_f32 v146, v146, v88, v89
    v_max3_f32 v146, v146, v90, v91
    v_mfma_f32_16x16x32_bf16 v[104:107], v[184:187], v[40:43], 0
    v_max3_f32 v147, v147, v92, v93
    v_max3_f32 v147, v147, v94, v95
    v_mfma_f32_16x16x32_bf16 v[108:111], v[184:187], v[44:47], 0
    v_max3_f32 v148, v148, v96, v97
    v_max3_f32 v148, v148, v98, v99
    buffer_load_dwordx4 v[184:187], v5, s[8:11], s77 offen
    s_add_u32 s77, s77, 1024
    s_waitcnt vmcnt(7)
    v_mfma_f32_16x16x32_bf16 v[80:83], v[188:191], v[16:19], 0
    v_max3_f32 v149, v149, v100, v101
    v_max3_f32 v149, v149, v102, v103
    v_mfma_f32_16x16x32_bf16 v[84:87], v[188:191], v[20:23], 0
    v_max3_f32 v150, v150, v104, v105
    v_max3_f32 v150, v150, v106, v107
    v_mfma_f32_16x16x32_bf16 v[88:91], v[188:191], v[24:27], 0
    v_max3_f32 v151, v151, v108, v109
    v_max3_f32 v151, v151, v110, v111
    v_mfma_f32_16x16x32_bf16 v[92:95], v[188:191], v[28:31], 0
    v_max3_f32 v144, v144, v80, v81
    v_max3_f32 v144, v144, v82, v83
    v_mfma_f32_16x16x32_bf16 v[96:99], v[188:191], v[32:35], 0
    v_max3_f32 v145, v145, v84, v85
    v_max3_f32 v145, v145, v86, v87
    v_mfma_f32_16x16x32_bf16 v[100:103], v[188:191], v[36:39], 0
    v_max3_f32 v146, v146, v88, v89
    v_max3_f32 v146, v146, v90, v91
    v_mfma_f32_16x16x32_bf16 v[104:107], v[188:191], v[40:43], 0
    v_max3_f32 v147, v147, v92, v93
    v_max3_f32 v147, v147, v94, v95
    v_mfma_f32_16x16x32_bf16 v[108:111], v[188:191], v[44:47], 0
    v_max3_f32 v148, v148, v96, v97
    v_max3_f32 v148, v148, v98, v99
    buffer_load_dwordx4 v[188:191], v5, s[8:11], s77 offen
    s_add_u32 s77, s77, 1024
    s_waitcnt vmcnt(7)
    v_mfma_f32_16x16x32_bf16 v[80:83], v[192:195], v[16:19], 0
    v_max3_f32 v149, v149, v100, v101
    v_max3_f32 v149, v149, v102, v103
    v_mfma_f32_16x16x32_bf16 v[84:87], v[192:195], v[20:23], 0
    v_max3_f32 v150, v150, v104, v105
    v_max3_f32 v150, v150, v106, v107
    v_mfma_f32_16x16x32_bf16 v[88:91], v[192:195], v[24:27], 0
    v_max3_f32 v151, v151, v108, v109
    v_max3_f32 v151, v151, v110, v111
    v_mfma_f32_16x16x32_bf16 v[92:95], v[192:195], v[28:31], 0
    v_max3_f32 v144, v144, v80, v81
    v_max3_f32 v144, v144, v82, v83
    v_mfma_f32_16x16x32_bf16 v[96:99], v[192:195], v[32:35], 0
    v_max3_f32 v145, v145, v84, v85
    v_max3_f32 v145, v145, v86, v87
    v_mfma_f32_16x16x32_bf16 v[100:103], v[192:195], v[36:39], 0
    v_max3_f32 v146, v146, v88, v89
    v_max3_f32 v146, v146, v90, v91
    v_mfma_f32_16x16x32_bf16 v[104:107], v[192:195], v[40:43], 0
    v_max3_f32 v147, v147, v92, v93
    v_max3_f32 v147, v147, v94, v95
    v_mfma_f32_16x16x32_bf16 v[108:111], v[192:195], v[44:47], 0
    v_max3_f32 v148, v148, v96, v97
    v_max3_f32 v148, v148, v98, v99
    buffer_load_dwordx4 v[192:195], v5, s[8:11], s77 offen
    s_add_u32 s77, s77, 1024
    s_waitcnt vmcnt(7)
    v_mfma_f32_16x16x32_bf16 v[80:83], v[196:199], v[16:19], 0
    v_max3_f32 v149, v149, v100, v101
    v_max3_f32 v149, v149, v102, v103
    v_mfma_f32_16x16x32_bf16 v[84:87], v[196:199], v[20:23], 0
    v_max3_f32 v150, v150, v104, v105
    v_max3_f32 v150, v150, v106, v107
    v_mfma_f32_16x16x32_bf16 v[88:91], v[196:199], v[24:27], 0
    v_max3_f32 v151, v151, v108, v109
    v_max3_f32 v151, v151, v110, v111
    v_mfma_f32_16x16x32_bf16 v[92:95], v[196:199], v[28:31], 0
    v_max3_f32 v144, v144, v80, v81
    v_max3_f32 v144, v144, v82, v83
    v_mfma_f32_16x16x32_bf16 v[96:99], v[196:199], v[32:35], 0
    v_max3_f32 v145, v145, v84, v85
    v_max3_f32 v145, v145, v86, v87
    v_mfma_f32_16x16x32_bf16 v[100:103], v[196:199], v[36:39], 0
    v_max3_f32 v146, v146, v88, v89
    v_max3_f32 v146, v146, v90, v91
    v_mfma_f32_16x16x32_bf16 v[104:107], v[196:199], v[40:43], 0
    v_max3_f32 v147, v147, v92, v93
    v_max3_f32 v147, v147, v94, v95
    v_mfma_f32_16x16x32_bf16 v[108:111], v[196:199], v[44:47], 0
    v_max3_f32 v148, v148, v96, v97
    v_max3_f32 v148, v148, v98, v99
    buffer_load_dwordx4 v[196:199], v5, s[8:11], s77 offen
    s_add_u32 s77, s77, 1024
    s_add_u32 s79, s79, 1
    s_cmp_lt_u32 s79, 16
    s_cbranch_scc1 L_ap1_184
    s_nop 0
    v_max3_f32 v149, v149, v100, v101
    v_max3_f32 v149, v149, v102, v103
    v_max3_f32 v150, v150, v104, v105
    v_max3_f32 v150, v150, v106, v107
    v_max3_f32 v151, v151, v108, v109
    v_max3_f32 v151, v151, v110, v111
    v_mov_b32 v152, v144
    s_nop 1
    v_permlane16_swap_b32 v144, v152
    v_max_f32 v144, v144, v152
    v_mov_b32 v152, v144
    s_nop 1
    v_permlane32_swap_b32 v144, v152
    v_max_f32 v144, v144, v152
    v_sub_f32 v48, 0, v144
    v_sub_f32 v49, 0, v144
    v_sub_f32 v50, 0, v144
    v_sub_f32 v51, 0, v144
    v_mov_b32 v152, v145
    s_nop 1
    v_permlane16_swap_b32 v145, v152
    v_max_f32 v145, v145, v152
    v_mov_b32 v152, v145
    s_nop 1
    v_permlane32_swap_b32 v145, v152
    v_max_f32 v145, v145, v152
    v_sub_f32 v52, 0, v145
    v_sub_f32 v53, 0, v145
    v_sub_f32 v54, 0, v145
    v_sub_f32 v55, 0, v145
    v_mov_b32 v152, v146
    s_nop 1
    v_permlane16_swap_b32 v146, v152
    v_max_f32 v146, v146, v152
    v_mov_b32 v152, v146
    s_nop 1
    v_permlane32_swap_b32 v146, v152
    v_max_f32 v146, v146, v152
    v_sub_f32 v56, 0, v146
    v_sub_f32 v57, 0, v146
    v_sub_f32 v58, 0, v146
    v_sub_f32 v59, 0, v146
    v_mov_b32 v152, v147
    s_nop 1
    v_permlane16_swap_b32 v147, v152
    v_max_f32 v147, v147, v152
    v_mov_b32 v152, v147
    s_nop 1
    v_permlane32_swap_b32 v147, v152
    v_max_f32 v147, v147, v152
    v_sub_f32 v60, 0, v147
    v_sub_f32 v61, 0, v147
    v_sub_f32 v62, 0, v147
    v_sub_f32 v63, 0, v147
    v_mov_b32 v152, v148
    s_nop 1
    v_permlane16_swap_b32 v148, v152
    v_max_f32 v148, v148, v152
    v_mov_b32 v152, v148
    s_nop 1
    v_permlane32_swap_b32 v148, v152
    v_max_f32 v148, v148, v152
    v_sub_f32 v64, 0, v148
    v_sub_f32 v65, 0, v148
    v_sub_f32 v66, 0, v148
    v_sub_f32 v67, 0, v148
    v_mov_b32 v152, v149
    s_nop 1
    v_permlane16_swap_b32 v149, v152
    v_max_f32 v149, v149, v152
    v_mov_b32 v152, v149
    s_nop 1
    v_permlane32_swap_b32 v149, v152
    v_max_f32 v149, v149, v152
    v_sub_f32 v68, 0, v149
    v_sub_f32 v69, 0, v149
    v_sub_f32 v70, 0, v149
    v_sub_f32 v71, 0, v149
    v_mov_b32 v152, v150
    s_nop 1
    v_permlane16_swap_b32 v150, v152
    v_max_f32 v150, v150, v152
    v_mov_b32 v152, v150
    s_nop 1
    v_permlane32_swap_b32 v150, v152
    v_max_f32 v150, v150, v152
    v_sub_f32 v72, 0, v150
    v_sub_f32 v73, 0, v150
    v_sub_f32 v74, 0, v150
    v_sub_f32 v75, 0, v150
    v_mov_b32 v152, v151
    s_nop 1
    v_permlane16_swap_b32 v151, v152
    v_max_f32 v151, v151, v152
    v_mov_b32 v152, v151
    s_nop 1
    v_permlane32_swap_b32 v151, v152
    v_max_f32 v151, v151, v152
    v_sub_f32 v76, 0, v151
    v_sub_f32 v77, 0, v151
    v_sub_f32 v78, 0, v151
    v_sub_f32 v79, 0, v151
    s_waitcnt vmcnt(0)
    s_mov_b32 s77, s75
    s_mov_b32 s78, s76
    buffer_load_dwordx4 v[168:171], v5, s[8:11], s77 offen
    buffer_load_dwordx4 v[172:175], v5, s[8:11], s77 offen offset:1024
    buffer_load_dwordx4 v[176:179], v5, s[8:11], s78 offen
    buffer_load_dwordx4 v[180:183], v5, s[8:11], s78 offen offset:1024
    s_add_u32 s77, s77, 2048
    s_add_u32 s78, s78, 2048
    buffer_load_dwordx4 v[184:187], v5, s[8:11], s77 offen
    buffer_load_dwordx4 v[188:191], v5, s[8:11], s77 offen offset:1024
    buffer_load_dwordx4 v[192:195], v5, s[8:11], s78 offen
    buffer_load_dwordx4 v[196:199], v5, s[8:11], s78 offen offset:1024
    s_add_u32 s77, s77, 2048
    s_add_u32 s78, s78, 2048
    buffer_load_dwordx4 v[200:203], v5, s[8:11], s77 offen
    buffer_load_dwordx4 v[204:207], v5, s[8:11], s77 offen offset:1024
    buffer_load_dwordx4 v[208:211], v5, s[8:11], s78 offen
    buffer_load_dwordx4 v[212:215], v5, s[8:11], s78 offen offset:1024
    s_add_u32 s77, s77, 2048
    s_add_u32 s78, s78, 2048
    v_mov_b32 v80, 0
    v_mov_b32 v81, 0
    v_mov_b32 v82, 0
    v_mov_b32 v83, 0
    v_mov_b32 v84, 0
    v_mov_b32 v85, 0
    v_mov_b32 v86, 0
    v_mov_b32 v87, 0
    v_mov_b32 v88, 0
    v_mov_b32 v89, 0
    v_mov_b32 v90, 0
    v_mov_b32 v91, 0
    v_mov_b32 v92, 0
    v_mov_b32 v93, 0
    v_mov_b32 v94, 0
    v_mov_b32 v95, 0
    v_mov_b32 v96, 0
    v_mov_b32 v97, 0
    v_mov_b32 v98, 0
    v_mov_b32 v99, 0
    v_mov_b32 v100, 0
    v_mov_b32 v101, 0
    v_mov_b32 v102, 0
    v_mov_b32 v103, 0
    v_mov_b32 v104, 0
    v_mov_b32 v105, 0
    v_mov_b32 v106, 0
    v_mov_b32 v107, 0
    v_mov_b32 v108, 0
    v_mov_b32 v109, 0
    v_mov_b32 v110, 0
    v_mov_b32 v111, 0
    v_mov_b32 v112, 0
    v_mov_b32 v113, 0
    v_mov_b32 v114, 0
    v_mov_b32 v115, 0
    v_mov_b32 v116, 0
    v_mov_b32 v117, 0
    v_mov_b32 v118, 0
    v_mov_b32 v119, 0
    v_mov_b32 v120, 0
    v_mov_b32 v121, 0
    v_mov_b32 v122, 0
    v_mov_b32 v123, 0
    v_mov_b32 v124, 0
    v_mov_b32 v125, 0
    v_mov_b32 v126, 0
    v_mov_b32 v127, 0
    v_mov_b32 v128, 0
    v_mov_b32 v129, 0
    v_mov_b32 v130, 0
    v_mov_b32 v131, 0
    v_mov_b32 v132, 0
    v_mov_b32 v133, 0
    v_mov_b32 v134, 0
    v_mov_b32 v135, 0
    v_mov_b32 v136, 0
    v_mov_b32 v137, 0
    v_mov_b32 v138, 0
    v_mov_b32 v139, 0
    v_mov_b32 v140, 0
    v_mov_b32 v141, 0
    v_mov_b32 v142, 0
    v_mov_b32 v143, 0
    v_mov_b32 v144, 0
    v_mov_b32 v145, 0
    v_mov_b32 v146, 0
    v_mov_b32 v147, 0
    v_mov_b32 v148, 0
    v_mov_b32 v149, 0
    v_mov_b32 v150, 0
    v_mov_b32 v151, 0
    v_mov_b32 v152, 0
    v_mov_b32 v153, 0
    v_mov_b32 v154, 0
    v_mov_b32 v155, 0
    v_mov_b32 v156, 0
    v_mov_b32 v157, 0
    v_mov_b32 v158, 0
    v_mov_b32 v159, 0
    v_mov_b32 v160, 0
    v_mov_b32 v161, 0
    v_mov_b32 v162, 0
    v_mov_b32 v163, 0
    v_mov_b32 v164, 0
    v_mov_b32 v165, 0
    v_mov_b32 v166, 0
    v_mov_b32 v167, 0
    v_mov_b32 v224, 0
    v_mov_b32 v225, 0
    v_mov_b32 v226, 0
    v_mov_b32 v227, 0
    v_mov_b32 v228, 0
    v_mov_b32 v229, 0
    v_mov_b32 v230, 0
    v_mov_b32 v231, 0
    s_waitcnt vmcnt(8)
    v_mfma_f32_16x16x32_bf16 v[144:147], v[168:171], v[16:19], v[48:51]
    v_mfma_f32_16x16x32_bf16 v[148:151], v[172:175], v[16:19], v[48:51]
    s_nop 7
    s_mov_b32 s79, 0
L_ap2_185:
    v_mfma_f32_16x16x32_bf16 v[152:155], v[168:171], v[20:23], v[52:55]
    v_exp_f32 v144, v144
    v_exp_f32 v145, v145
    v_cvt_pk_bf16_f32 v167, v158, v159
    v_mfma_f32_16x16x32_bf16 v[156:159], v[172:175], v[20:23], v[52:55]
    v_exp_f32 v146, v146
    v_exp_f32 v147, v147
    v_cvt_pk_bf16_f32 v160, v144, v145
    v_mfma_f32_16x16x32_bf16 v[108:111], v[224:227], v[164:167], v[108:111]
    v_exp_f32 v148, v148
    v_exp_f32 v149, v149
    v_cvt_pk_bf16_f32 v161, v146, v147
    v_mfma_f32_16x16x32_bf16 v[140:143], v[228:231], v[164:167], v[140:143]
    v_exp_f32 v150, v150
    v_exp_f32 v151, v151
    v_cvt_pk_bf16_f32 v162, v148, v149
    buffer_load_dwordx4 v[216:219], v5, s[8:11], s77 offen
    buffer_load_dwordx4 v[220:223], v5, s[8:11], s77 offen offset:1024
    buffer_load_dwordx4 v[224:227], v5, s[8:11], s78 offen
    buffer_load_dwordx4 v[228:231], v5, s[8:11], s78 offen offset:1024
    s_add_u32 s77, s77, 2048
    s_add_u32 s78, s78, 2048
    v_mfma_f32_16x16x32_bf16 v[144:147], v[168:171], v[24:27], v[56:59]
    v_exp_f32 v152, v152
    v_exp_f32 v153, v153
    v_cvt_pk_bf16_f32 v163, v150, v151
    v_mfma_f32_16x16x32_bf16 v[148:151], v[172:175], v[24:27], v[56:59]
    v_exp_f32 v154, v154
    v_exp_f32 v155, v155
    v_cvt_pk_bf16_f32 v164, v152, v153
    v_mfma_f32_16x16x32_bf16 v[80:83], v[176:179], v[160:163], v[80:83]
    v_exp_f32 v156, v156
    v_exp_f32 v157, v157
    v_cvt_pk_bf16_f32 v165, v154, v155
    v_mfma_f32_16x16x32_bf16 v[112:115], v[180:183], v[160:163], v[112:115]
    v_exp_f32 v158, v158
    v_exp_f32 v159, v159
    v_cvt_pk_bf16_f32 v166, v156, v157
    v_mfma_f32_16x16x32_bf16 v[152:155], v[168:171], v[28:31], v[60:63]
    v_exp_f32 v144, v144
    v_exp_f32 v145, v145
    v_cvt_pk_bf16_f32 v167, v158, v159
    v_mfma_f32_16x16x32_bf16 v[156:159], v[172:175], v[28:31], v[60:63]
    v_exp_f32 v146, v146
    v_exp_f32 v147, v147
    v_cvt_pk_bf16_f32 v160, v144, v145
    v_mfma_f32_16x16x32_bf16 v[84:87], v[176:179], v[164:167], v[84:87]
    v_exp_f32 v148, v148
    v_exp_f32 v149, v149
    v_cvt_pk_bf16_f32 v161, v146, v147
    v_mfma_f32_16x16x32_bf16 v[116:119], v[180:183], v[164:167], v[116:119]
    v_exp_f32 v150, v150
    v_exp_f32 v151, v151
    v_cvt_pk_bf16_f32 v162, v148, v149
    v_mfma_f32_16x16x32_bf16 v[144:147], v[168:171], v[32:35], v[64:67]
    v_exp_f32 v152, v152
    v_exp_f32 v153, v153
    v_cvt_pk_bf16_f32 v163, v150, v151
    v_mfma_f32_16x16x32_bf16 v[148:151], v[172:175], v[32:35], v[64:67]
    v_exp_f32 v154, v154
    v_exp_f32 v155, v155
    v_cvt_pk_bf16_f32 v164, v152, v153
    v_mfma_f32_16x16x32_bf16 v[88:91], v[176:179], v[160:163], v[88:91]
    v_exp_f32 v156, v156
    v_exp_f32 v157, v157
    v_cvt_pk_bf16_f32 v165, v154, v155
    v_mfma_f32_16x16x32_bf16 v[120:123], v[180:183], v[160:163], v[120:123]
    v_exp_f32 v158, v158
    v_exp_f32 v159, v159
    v_cvt_pk_bf16_f32 v166, v156, v157
    v_mfma_f32_16x16x32_bf16 v[152:155], v[168:171], v[36:39], v[68:71]
    v_exp_f32 v144, v144
    v_exp_f32 v145, v145
    v_cvt_pk_bf16_f32 v167, v158, v159
    v_mfma_f32_16x16x32_bf16 v[156:159], v[172:175], v[36:39], v[68:71]
    v_exp_f32 v146, v146
    v_exp_f32 v147, v147
    v_cvt_pk_bf16_f32 v160, v144, v145
    v_mfma_f32_16x16x32_bf16 v[92:95], v[176:179], v[164:167], v[92:95]
    v_exp_f32 v148, v148
    v_exp_f32 v149, v149
    v_cvt_pk_bf16_f32 v161, v146, v147
    v_mfma_f32_16x16x32_bf16 v[124:127], v[180:183], v[164:167], v[124:127]
    v_exp_f32 v150, v150
    v_exp_f32 v151, v151
    v_cvt_pk_bf16_f32 v162, v148, v149
    v_mfma_f32_16x16x32_bf16 v[144:147], v[168:171], v[40:43], v[72:75]
    v_exp_f32 v152, v152
    v_exp_f32 v153, v153
    v_cvt_pk_bf16_f32 v163, v150, v151
    v_mfma_f32_16x16x32_bf16 v[148:151], v[172:175], v[40:43], v[72:75]
    v_exp_f32 v154, v154
    v_exp_f32 v155, v155
    v_cvt_pk_bf16_f32 v164, v152, v153
    v_mfma_f32_16x16x32_bf16 v[96:99], v[176:179], v[160:163], v[96:99]
    v_exp_f32 v156, v156
    v_exp_f32 v157, v157
    v_cvt_pk_bf16_f32 v165, v154, v155
    v_mfma_f32_16x16x32_bf16 v[128:131], v[180:183], v[160:163], v[128:131]
    v_exp_f32 v158, v158
    v_exp_f32 v159, v159
    v_cvt_pk_bf16_f32 v166, v156, v157
    v_mfma_f32_16x16x32_bf16 v[152:155], v[168:171], v[44:47], v[76:79]
    v_exp_f32 v144, v144
    v_exp_f32 v145, v145
    v_cvt_pk_bf16_f32 v167, v158, v159
    v_mfma_f32_16x16x32_bf16 v[156:159], v[172:175], v[44:47], v[76:79]
    v_exp_f32 v146, v146
    v_exp_f32 v147, v147
    v_cvt_pk_bf16_f32 v160, v144, v145
    v_mfma_f32_16x16x32_bf16 v[100:103], v[176:179], v[164:167], v[100:103]
    v_exp_f32 v148, v148
    v_exp_f32 v149, v149
    v_cvt_pk_bf16_f32 v161, v146, v147
    v_mfma_f32_16x16x32_bf16 v[132:135], v[180:183], v[164:167], v[132:135]
    v_exp_f32 v150, v150
    v_exp_f32 v151, v151
    v_cvt_pk_bf16_f32 v162, v148, v149
    s_waitcnt vmcnt(8)
    v_mfma_f32_16x16x32_bf16 v[144:147], v[184:187], v[16:19], v[48:51]
    v_exp_f32 v152, v152
    v_exp_f32 v153, v153
    v_cvt_pk_bf16_f32 v163, v150, v151
    v_mfma_f32_16x16x32_bf16 v[148:151], v[188:191], v[16:19], v[48:51]
    v_exp_f32 v154, v154
    v_exp_f32 v155, v155
    v_cvt_pk_bf16_f32 v164, v152, v153
    v_mfma_f32_16x16x32_bf16 v[104:107], v[176:179], v[160:163], v[104:107]
    v_exp_f32 v156, v156
    v_exp_f32 v157, v157
    v_cvt_pk_bf16_f32 v165, v154, v155
    v_mfma_f32_16x16x32_bf16 v[136:139], v[180:183], v[160:163], v[136:139]
    v_exp_f32 v158, v158
    v_exp_f32 v159, v159
    v_cvt_pk_bf16_f32 v166, v156, v157
    v_mfma_f32_16x16x32_bf16 v[152:155], v[184:187], v[20:23], v[52:55]
    v_exp_f32 v144, v144
    v_exp_f32 v145, v145
    v_cvt_pk_bf16_f32 v167, v158, v159
    v_mfma_f32_16x16x32_bf16 v[156:159], v[188:191], v[20:23], v[52:55]
    v_exp_f32 v146, v146
    v_exp_f32 v147, v147
    v_cvt_pk_bf16_f32 v160, v144, v145
    v_mfma_f32_16x16x32_bf16 v[108:111], v[176:179], v[164:167], v[108:111]
    v_exp_f32 v148, v148
    v_exp_f32 v149, v149
    v_cvt_pk_bf16_f32 v161, v146, v147
    v_mfma_f32_16x16x32_bf16 v[140:143], v[180:183], v[164:167], v[140:143]
    v_exp_f32 v150, v150
    v_exp_f32 v151, v151
    v_cvt_pk_bf16_f32 v162, v148, v149
    buffer_load_dwordx4 v[168:171], v5, s[8:11], s77 offen
    buffer_load_dwordx4 v[172:175], v5, s[8:11], s77 offen offset:1024
    buffer_load_dwordx4 v[176:179], v5, s[8:11], s78 offen
    buffer_load_dwordx4 v[180:183], v5, s[8:11], s78 offen offset:1024
    s_add_u32 s77, s77, 2048
    s_add_u32 s78, s78, 2048
    v_mfma_f32_16x16x32_bf16 v[144:147], v[184:187], v[24:27], v[56:59]
    v_exp_f32 v152, v152
    v_exp_f32 v153, v153
    v_cvt_pk_bf16_f32 v163, v150, v151
    v_mfma_f32_16x16x32_bf16 v[148:151], v[188:191], v[24:27], v[56:59]
    v_exp_f32 v154, v154
    v_exp_f32 v155, v155
    v_cvt_pk_bf16_f32 v164, v152, v153
    v_mfma_f32_16x16x32_bf16 v[80:83], v[192:195], v[160:163], v[80:83]
    v_exp_f32 v156, v156
    v_exp_f32 v157, v157
    v_cvt_pk_bf16_f32 v165, v154, v155
    v_mfma_f32_16x16x32_bf16 v[112:115], v[196:199], v[160:163], v[112:115]
    v_exp_f32 v158, v158
    v_exp_f32 v159, v159
    v_cvt_pk_bf16_f32 v166, v156, v157
    v_mfma_f32_16x16x32_bf16 v[152:155], v[184:187], v[28:31], v[60:63]
    v_exp_f32 v144, v144
    v_exp_f32 v145, v145
    v_cvt_pk_bf16_f32 v167, v158, v159
    v_mfma_f32_16x16x32_bf16 v[156:159], v[188:191], v[28:31], v[60:63]
    v_exp_f32 v146, v146
    v_exp_f32 v147, v147
    v_cvt_pk_bf16_f32 v160, v144, v145
    v_mfma_f32_16x16x32_bf16 v[84:87], v[192:195], v[164:167], v[84:87]
    v_exp_f32 v148, v148
    v_exp_f32 v149, v149
    v_cvt_pk_bf16_f32 v161, v146, v147
    v_mfma_f32_16x16x32_bf16 v[116:119], v[196:199], v[164:167], v[116:119]
    v_exp_f32 v150, v150
    v_exp_f32 v151, v151
    v_cvt_pk_bf16_f32 v162, v148, v149
    v_mfma_f32_16x16x32_bf16 v[144:147], v[184:187], v[32:35], v[64:67]
    v_exp_f32 v152, v152
    v_exp_f32 v153, v153
    v_cvt_pk_bf16_f32 v163, v150, v151
    v_mfma_f32_16x16x32_bf16 v[148:151], v[188:191], v[32:35], v[64:67]
    v_exp_f32 v154, v154
    v_exp_f32 v155, v155
    v_cvt_pk_bf16_f32 v164, v152, v153
    v_mfma_f32_16x16x32_bf16 v[88:91], v[192:195], v[160:163], v[88:91]
    v_exp_f32 v156, v156
    v_exp_f32 v157, v157
    v_cvt_pk_bf16_f32 v165, v154, v155
    v_mfma_f32_16x16x32_bf16 v[120:123], v[196:199], v[160:163], v[120:123]
    v_exp_f32 v158, v158
    v_exp_f32 v159, v159
    v_cvt_pk_bf16_f32 v166, v156, v157
    v_mfma_f32_16x16x32_bf16 v[152:155], v[184:187], v[36:39], v[68:71]
    v_exp_f32 v144, v144
    v_exp_f32 v145, v145
    v_cvt_pk_bf16_f32 v167, v158, v159
    v_mfma_f32_16x16x32_bf16 v[156:159], v[188:191], v[36:39], v[68:71]
    v_exp_f32 v146, v146
    v_exp_f32 v147, v147
    v_cvt_pk_bf16_f32 v160, v144, v145
    v_mfma_f32_16x16x32_bf16 v[92:95], v[192:195], v[164:167], v[92:95]
    v_exp_f32 v148, v148
    v_exp_f32 v149, v149
    v_cvt_pk_bf16_f32 v161, v146, v147
    v_mfma_f32_16x16x32_bf16 v[124:127], v[196:199], v[164:167], v[124:127]
    v_exp_f32 v150, v150
    v_exp_f32 v151, v151
    v_cvt_pk_bf16_f32 v162, v148, v149
    v_mfma_f32_16x16x32_bf16 v[144:147], v[184:187], v[40:43], v[72:75]
    v_exp_f32 v152, v152
    v_exp_f32 v153, v153
    v_cvt_pk_bf16_f32 v163, v150, v151
    v_mfma_f32_16x16x32_bf16 v[148:151], v[188:191], v[40:43], v[72:75]
    v_exp_f32 v154, v154
    v_exp_f32 v155, v155
    v_cvt_pk_bf16_f32 v164, v152, v153
    v_mfma_f32_16x16x32_bf16 v[96:99], v[192:195], v[160:163], v[96:99]
    v_exp_f32 v156, v156
    v_exp_f32 v157, v157
    v_cvt_pk_bf16_f32 v165, v154, v155
    v_mfma_f32_16x16x32_bf16 v[128:131], v[196:199], v[160:163], v[128:131]
    v_exp_f32 v158, v158
    v_exp_f32 v159, v159
    v_cvt_pk_bf16_f32 v166, v156, v157
    v_mfma_f32_16x16x32_bf16 v[152:155], v[184:187], v[44:47], v[76:79]
    v_exp_f32 v144, v144
    v_exp_f32 v145, v145
    v_cvt_pk_bf16_f32 v167, v158, v159
    v_mfma_f32_16x16x32_bf16 v[156:159], v[188:191], v[44:47], v[76:79]
    v_exp_f32 v146, v146
    v_exp_f32 v147, v147
    v_cvt_pk_bf16_f32 v160, v144, v145
    v_mfma_f32_16x16x32_bf16 v[100:103], v[192:195], v[164:167], v[100:103]
    v_exp_f32 v148, v148
    v_exp_f32 v149, v149
    v_cvt_pk_bf16_f32 v161, v146, v147
    v_mfma_f32_16x16x32_bf16 v[132:135], v[196:199], v[164:167], v[132:135]
    v_exp_f32 v150, v150
    v_exp_f32 v151, v151
    v_cvt_pk_bf16_f32 v162, v148, v149
    s_waitcnt vmcnt(8)
    v_mfma_f32_16x16x32_bf16 v[144:147], v[200:203], v[16:19], v[48:51]
    v_exp_f32 v152, v152
    v_exp_f32 v153, v153
    v_cvt_pk_bf16_f32 v163, v150, v151
    v_mfma_f32_16x16x32_bf16 v[148:151], v[204:207], v[16:19], v[48:51]
    v_exp_f32 v154, v154
    v_exp_f32 v155, v155
    v_cvt_pk_bf16_f32 v164, v152, v153
    v_mfma_f32_16x16x32_bf16 v[104:107], v[192:195], v[160:163], v[104:107]
    v_exp_f32 v156, v156
    v_exp_f32 v157, v157
    v_cvt_pk_bf16_f32 v165, v154, v155
    v_mfma_f32_16x16x32_bf16 v[136:139], v[196:199], v[160:163], v[136:139]
    v_exp_f32 v158, v158
    v_exp_f32 v159, v159
    v_cvt_pk_bf16_f32 v166, v156, v157
    v_mfma_f32_16x16x32_bf16 v[152:155], v[200:203], v[20:23], v[52:55]
    v_exp_f32 v144, v144
    v_exp_f32 v145, v145
    v_cvt_pk_bf16_f32 v167, v158, v159
    v_mfma_f32_16x16x32_bf16 v[156:159], v[204:207], v[20:23], v[52:55]
    v_exp_f32 v146, v146
    v_exp_f32 v147, v147
    v_cvt_pk_bf16_f32 v160, v144, v145
    v_mfma_f32_16x16x32_bf16 v[108:111], v[192:195], v[164:167], v[108:111]
    v_exp_f32 v148, v148
    v_exp_f32 v149, v149
    v_cvt_pk_bf16_f32 v161, v146, v147
    v_mfma_f32_16x16x32_bf16 v[140:143], v[196:199], v[164:167], v[140:143]
    v_exp_f32 v150, v150
    v_exp_f32 v151, v151
    v_cvt_pk_bf16_f32 v162, v148, v149
    buffer_load_dwordx4 v[184:187], v5, s[8:11], s77 offen
    buffer_load_dwordx4 v[188:191], v5, s[8:11], s77 offen offset:1024
    buffer_load_dwordx4 v[192:195], v5, s[8:11], s78 offen
    buffer_load_dwordx4 v[196:199], v5, s[8:11], s78 offen offset:1024
    s_add_u32 s77, s77, 2048
    s_add_u32 s78, s78, 2048
    v_mfma_f32_16x16x32_bf16 v[144:147], v[200:203], v[24:27], v[56:59]
    v_exp_f32 v152, v152
    v_exp_f32 v153, v153
    v_cvt_pk_bf16_f32 v163, v150, v151
    v_mfma_f32_16x16x32_bf16 v[148:151], v[204:207], v[24:27], v[56:59]
    v_exp_f32 v154, v154
    v_exp_f32 v155, v155
    v_cvt_pk_bf16_f32 v164, v152, v153
    v_mfma_f32_16x16x32_bf16 v[80:83], v[208:211], v[160:163], v[80:83]
    v_exp_f32 v156, v156
    v_exp_f32 v157, v157
    v_cvt_pk_bf16_f32 v165, v154, v155
    v_mfma_f32_16x16x32_bf16 v[112:115], v[212:215], v[160:163], v[112:115]
    v_exp_f32 v158, v158
    v_exp_f32 v159, v159
    v_cvt_pk_bf16_f32 v166, v156, v157
    v_mfma_f32_16x16x32_bf16 v[152:155], v[200:203], v[28:31], v[60:63]
    v_exp_f32 v144, v144
    v_exp_f32 v145, v145
    v_cvt_pk_bf16_f32 v167, v158, v159
    v_mfma_f32_16x16x32_bf16 v[156:159], v[204:207], v[28:31], v[60:63]
    v_exp_f32 v146, v146
    v_exp_f32 v147, v147
    v_cvt_pk_bf16_f32 v160, v144, v145
    v_mfma_f32_16x16x32_bf16 v[84:87], v[208:211], v[164:167], v[84:87]
    v_exp_f32 v148, v148
    v_exp_f32 v149, v149
    v_cvt_pk_bf16_f32 v161, v146, v147
    v_mfma_f32_16x16x32_bf16 v[116:119], v[212:215], v[164:167], v[116:119]
    v_exp_f32 v150, v150
    v_exp_f32 v151, v151
    v_cvt_pk_bf16_f32 v162, v148, v149
    v_mfma_f32_16x16x32_bf16 v[144:147], v[200:203], v[32:35], v[64:67]
    v_exp_f32 v152, v152
    v_exp_f32 v153, v153
    v_cvt_pk_bf16_f32 v163, v150, v151
    v_mfma_f32_16x16x32_bf16 v[148:151], v[204:207], v[32:35], v[64:67]
    v_exp_f32 v154, v154
    v_exp_f32 v155, v155
    v_cvt_pk_bf16_f32 v164, v152, v153
    v_mfma_f32_16x16x32_bf16 v[88:91], v[208:211], v[160:163], v[88:91]
    v_exp_f32 v156, v156
    v_exp_f32 v157, v157
    v_cvt_pk_bf16_f32 v165, v154, v155
    v_mfma_f32_16x16x32_bf16 v[120:123], v[212:215], v[160:163], v[120:123]
    v_exp_f32 v158, v158
    v_exp_f32 v159, v159
    v_cvt_pk_bf16_f32 v166, v156, v157
    v_mfma_f32_16x16x32_bf16 v[152:155], v[200:203], v[36:39], v[68:71]
    v_exp_f32 v144, v144
    v_exp_f32 v145, v145
    v_cvt_pk_bf16_f32 v167, v158, v159
    v_mfma_f32_16x16x32_bf16 v[156:159], v[204:207], v[36:39], v[68:71]
    v_exp_f32 v146, v146
    v_exp_f32 v147, v147
    v_cvt_pk_bf16_f32 v160, v144, v145
    v_mfma_f32_16x16x32_bf16 v[92:95], v[208:211], v[164:167], v[92:95]
    v_exp_f32 v148, v148
    v_exp_f32 v149, v149
    v_cvt_pk_bf16_f32 v161, v146, v147
    v_mfma_f32_16x16x32_bf16 v[124:127], v[212:215], v[164:167], v[124:127]
    v_exp_f32 v150, v150
    v_exp_f32 v151, v151
    v_cvt_pk_bf16_f32 v162, v148, v149
    v_mfma_f32_16x16x32_bf16 v[144:147], v[200:203], v[40:43], v[72:75]
    v_exp_f32 v152, v152
    v_exp_f32 v153, v153
    v_cvt_pk_bf16_f32 v163, v150, v151
    v_mfma_f32_16x16x32_bf16 v[148:151], v[204:207], v[40:43], v[72:75]
    v_exp_f32 v154, v154
    v_exp_f32 v155, v155
    v_cvt_pk_bf16_f32 v164, v152, v153
    v_mfma_f32_16x16x32_bf16 v[96:99], v[208:211], v[160:163], v[96:99]
    v_exp_f32 v156, v156
    v_exp_f32 v157, v157
    v_cvt_pk_bf16_f32 v165, v154, v155
    v_mfma_f32_16x16x32_bf16 v[128:131], v[212:215], v[160:163], v[128:131]
    v_exp_f32 v158, v158
    v_exp_f32 v159, v159
    v_cvt_pk_bf16_f32 v166, v156, v157
    v_mfma_f32_16x16x32_bf16 v[152:155], v[200:203], v[44:47], v[76:79]
    v_exp_f32 v144, v144
    v_exp_f32 v145, v145
    v_cvt_pk_bf16_f32 v167, v158, v159
    v_mfma_f32_16x16x32_bf16 v[156:159], v[204:207], v[44:47], v[76:79]
    v_exp_f32 v146, v146
    v_exp_f32 v147, v147
    v_cvt_pk_bf16_f32 v160, v144, v145
    v_mfma_f32_16x16x32_bf16 v[100:103], v[208:211], v[164:167], v[100:103]
    v_exp_f32 v148, v148
    v_exp_f32 v149, v149
    v_cvt_pk_bf16_f32 v161, v146, v147
    v_mfma_f32_16x16x32_bf16 v[132:135], v[212:215], v[164:167], v[132:135]
    v_exp_f32 v150, v150
    v_exp_f32 v151, v151
    v_cvt_pk_bf16_f32 v162, v148, v149
    s_waitcnt vmcnt(8)
    v_mfma_f32_16x16x32_bf16 v[144:147], v[216:219], v[16:19], v[48:51]
    v_exp_f32 v152, v152
    v_exp_f32 v153, v153
    v_cvt_pk_bf16_f32 v163, v150, v151
    v_mfma_f32_16x16x32_bf16 v[148:151], v[220:223], v[16:19], v[48:51]
    v_exp_f32 v154, v154
    v_exp_f32 v155, v155
    v_cvt_pk_bf16_f32 v164, v152, v153
    v_mfma_f32_16x16x32_bf16 v[104:107], v[208:211], v[160:163], v[104:107]
    v_exp_f32 v156, v156
    v_exp_f32 v157, v157
    v_cvt_pk_bf16_f32 v165, v154, v155
    v_mfma_f32_16x16x32_bf16 v[136:139], v[212:215], v[160:163], v[136:139]
    v_exp_f32 v158, v158
    v_exp_f32 v159, v159
    v_cvt_pk_bf16_f32 v166, v156, v157
    v_mfma_f32_16x16x32_bf16 v[152:155], v[216:219], v[20:23], v[52:55]
    v_exp_f32 v144, v144
    v_exp_f32 v145, v145
    v_cvt_pk_bf16_f32 v167, v158, v159
    v_mfma_f32_16x16x32_bf16 v[156:159], v[220:223], v[20:23], v[52:55]
    v_exp_f32 v146, v146
    v_exp_f32 v147, v147
    v_cvt_pk_bf16_f32 v160, v144, v145
    v_mfma_f32_16x16x32_bf16 v[108:111], v[208:211], v[164:167], v[108:111]
    v_exp_f32 v148, v148
    v_exp_f32 v149, v149
    v_cvt_pk_bf16_f32 v161, v146, v147
    v_mfma_f32_16x16x32_bf16 v[140:143], v[212:215], v[164:167], v[140:143]
    v_exp_f32 v150, v150
    v_exp_f32 v151, v151
    v_cvt_pk_bf16_f32 v162, v148, v149
    buffer_load_dwordx4 v[200:203], v5, s[8:11], s77 offen
    buffer_load_dwordx4 v[204:207], v5, s[8:11], s77 offen offset:1024
    buffer_load_dwordx4 v[208:211], v5, s[8:11], s78 offen
    buffer_load_dwordx4 v[212:215], v5, s[8:11], s78 offen offset:1024
    s_add_u32 s77, s77, 2048
    s_add_u32 s78, s78, 2048
    v_mfma_f32_16x16x32_bf16 v[144:147], v[216:219], v[24:27], v[56:59]
    v_exp_f32 v152, v152
    v_exp_f32 v153, v153
    v_cvt_pk_bf16_f32 v163, v150, v151
    v_mfma_f32_16x16x32_bf16 v[148:151], v[220:223], v[24:27], v[56:59]
    v_exp_f32 v154, v154
    v_exp_f32 v155, v155
    v_cvt_pk_bf16_f32 v164, v152, v153
    v_mfma_f32_16x16x32_bf16 v[80:83], v[224:227], v[160:163], v[80:83]
    v_exp_f32 v156, v156
    v_exp_f32 v157, v157
    v_cvt_pk_bf16_f32 v165, v154, v155
    v_mfma_f32_16x16x32_bf16 v[112:115], v[228:231], v[160:163], v[112:115]
    v_exp_f32 v158, v158
    v_exp_f32 v159, v159
    v_cvt_pk_bf16_f32 v166, v156, v157
    v_mfma_f32_16x16x32_bf16 v[152:155], v[216:219], v[28:31], v[60:63]
    v_exp_f32 v144, v144
    v_exp_f32 v145, v145
    v_cvt_pk_bf16_f32 v167, v158, v159
    v_mfma_f32_16x16x32_bf16 v[156:159], v[220:223], v[28:31], v[60:63]
    v_exp_f32 v146, v146
    v_exp_f32 v147, v147
    v_cvt_pk_bf16_f32 v160, v144, v145
    v_mfma_f32_16x16x32_bf16 v[84:87], v[224:227], v[164:167], v[84:87]
    v_exp_f32 v148, v148
    v_exp_f32 v149, v149
    v_cvt_pk_bf16_f32 v161, v146, v147
    v_mfma_f32_16x16x32_bf16 v[116:119], v[228:231], v[164:167], v[116:119]
    v_exp_f32 v150, v150
    v_exp_f32 v151, v151
    v_cvt_pk_bf16_f32 v162, v148, v149
    v_mfma_f32_16x16x32_bf16 v[144:147], v[216:219], v[32:35], v[64:67]
    v_exp_f32 v152, v152
    v_exp_f32 v153, v153
    v_cvt_pk_bf16_f32 v163, v150, v151
    v_mfma_f32_16x16x32_bf16 v[148:151], v[220:223], v[32:35], v[64:67]
    v_exp_f32 v154, v154
    v_exp_f32 v155, v155
    v_cvt_pk_bf16_f32 v164, v152, v153
    v_mfma_f32_16x16x32_bf16 v[88:91], v[224:227], v[160:163], v[88:91]
    v_exp_f32 v156, v156
    v_exp_f32 v157, v157
    v_cvt_pk_bf16_f32 v165, v154, v155
    v_mfma_f32_16x16x32_bf16 v[120:123], v[228:231], v[160:163], v[120:123]
    v_exp_f32 v158, v158
    v_exp_f32 v159, v159
    v_cvt_pk_bf16_f32 v166, v156, v157
    v_mfma_f32_16x16x32_bf16 v[152:155], v[216:219], v[36:39], v[68:71]
    v_exp_f32 v144, v144
    v_exp_f32 v145, v145
    v_cvt_pk_bf16_f32 v167, v158, v159
    v_mfma_f32_16x16x32_bf16 v[156:159], v[220:223], v[36:39], v[68:71]
    v_exp_f32 v146, v146
    v_exp_f32 v147, v147
    v_cvt_pk_bf16_f32 v160, v144, v145
    v_mfma_f32_16x16x32_bf16 v[92:95], v[224:227], v[164:167], v[92:95]
    v_exp_f32 v148, v148
    v_exp_f32 v149, v149
    v_cvt_pk_bf16_f32 v161, v146, v147
    v_mfma_f32_16x16x32_bf16 v[124:127], v[228:231], v[164:167], v[124:127]
    v_exp_f32 v150, v150
    v_exp_f32 v151, v151
    v_cvt_pk_bf16_f32 v162, v148, v149
    v_mfma_f32_16x16x32_bf16 v[144:147], v[216:219], v[40:43], v[72:75]
    v_exp_f32 v152, v152
    v_exp_f32 v153, v153
    v_cvt_pk_bf16_f32 v163, v150, v151
    v_mfma_f32_16x16x32_bf16 v[148:151], v[220:223], v[40:43], v[72:75]
    v_exp_f32 v154, v154
    v_exp_f32 v155, v155
    v_cvt_pk_bf16_f32 v164, v152, v153
    v_mfma_f32_16x16x32_bf16 v[96:99], v[224:227], v[160:163], v[96:99]
    v_exp_f32 v156, v156
    v_exp_f32 v157, v157
    v_cvt_pk_bf16_f32 v165, v154, v155
    v_mfma_f32_16x16x32_bf16 v[128:131], v[228:231], v[160:163], v[128:131]
    v_exp_f32 v158, v158
    v_exp_f32 v159, v159
    v_cvt_pk_bf16_f32 v166, v156, v157
    v_mfma_f32_16x16x32_bf16 v[152:155], v[216:219], v[44:47], v[76:79]
    v_exp_f32 v144, v144
    v_exp_f32 v145, v145
    v_cvt_pk_bf16_f32 v167, v158, v159
    v_mfma_f32_16x16x32_bf16 v[156:159], v[220:223], v[44:47], v[76:79]
    v_exp_f32 v146, v146
    v_exp_f32 v147, v147
    v_cvt_pk_bf16_f32 v160, v144, v145
    v_mfma_f32_16x16x32_bf16 v[100:103], v[224:227], v[164:167], v[100:103]
    v_exp_f32 v148, v148
    v_exp_f32 v149, v149
    v_cvt_pk_bf16_f32 v161, v146, v147
    v_mfma_f32_16x16x32_bf16 v[132:135], v[228:231], v[164:167], v[132:135]
    v_exp_f32 v150, v150
    v_exp_f32 v151, v151
    v_cvt_pk_bf16_f32 v162, v148, v149
    s_waitcnt vmcnt(8)
    v_mfma_f32_16x16x32_bf16 v[144:147], v[168:171], v[16:19], v[48:51]
    v_exp_f32 v152, v152
    v_exp_f32 v153, v153
    v_cvt_pk_bf16_f32 v163, v150, v151
    v_mfma_f32_16x16x32_bf16 v[148:151], v[172:175], v[16:19], v[48:51]
    v_exp_f32 v154, v154
    v_exp_f32 v155, v155
    v_cvt_pk_bf16_f32 v164, v152, v153
    v_mfma_f32_16x16x32_bf16 v[104:107], v[224:227], v[160:163], v[104:107]
    v_exp_f32 v156, v156
    v_exp_f32 v157, v157
    v_cvt_pk_bf16_f32 v165, v154, v155
    v_mfma_f32_16x16x32_bf16 v[136:139], v[228:231], v[160:163], v[136:139]
    v_exp_f32 v158, v158
    v_exp_f32 v159, v159
    v_cvt_pk_bf16_f32 v166, v156, v157
    s_add_u32 s79, s79, 1
    s_cmp_lt_u32 s79, 16
    s_cbranch_scc1 L_ap2_185
    s_nop 1
    v_cvt_pk_bf16_f32 v167, v158, v159
    s_nop 1
    v_mfma_f32_16x16x32_bf16 v[108:111], v[224:227], v[164:167], v[108:111]
    v_mfma_f32_16x16x32_bf16 v[140:143], v[228:231], v[164:167], v[140:143]
    s_waitcnt vmcnt(0)
    s_movk_i32 s60, 1152
    v_mul_lo_u32 v8, v2, s60
    v_add_u32 v9, 32, v8
    v_lshl_add_u32 v8, v3, 3, v8
    v_mov_b32 v10, 0x80000000
    v_cmp_eq_u32 vcc, 1, v3
    s_nop 1
    v_cndmask_b32 v9, v10, v9, vcc
    s_mul_i32 s77, s73, 1152
    s_mul_i32 s60, s70, 36
    s_add_u32 s77, s77, s60
    s_add_u32 s77, s77, 142606336
    v_rcp_f32 v147, v114
    s_nop 0
    v_mul_f32 v80, v80, v147
    v_mul_f32 v81, v81, v147
    v_mul_f32 v82, v82, v147
    v_mul_f32 v83, v83, v147
    v_mul_f32 v112, v112, v147
    v_mul_f32 v113, v113, v147
    v_cvt_pk_bf16_f32 v144, v80, v81
    v_cvt_pk_bf16_f32 v145, v82, v83
    v_cvt_pk_bf16_f32 v146, v112, v113
    buffer_store_dwordx2 v[144:145], v8, s[8:11], s77 offen sc1
    buffer_store_dword v146, v9, s[8:11], s77 offen sc1
    s_add_u32 s77, s77, 18432
    v_rcp_f32 v151, v118
    s_nop 0
    v_mul_f32 v84, v84, v151
    v_mul_f32 v85, v85, v151
    v_mul_f32 v86, v86, v151
    v_mul_f32 v87, v87, v151
    v_mul_f32 v116, v116, v151
    v_mul_f32 v117, v117, v151
    v_cvt_pk_bf16_f32 v148, v84, v85
    v_cvt_pk_bf16_f32 v149, v86, v87
    v_cvt_pk_bf16_f32 v150, v116, v117
    buffer_store_dwordx2 v[148:149], v8, s[8:11], s77 offen sc1
    buffer_store_dword v150, v9, s[8:11], s77 offen sc1
    s_add_u32 s77, s77, 18432
    v_rcp_f32 v147, v122
    s_nop 0
    v_mul_f32 v88, v88, v147
    v_mul_f32 v89, v89, v147
    v_mul_f32 v90, v90, v147
    v_mul_f32 v91, v91, v147
    v_mul_f32 v120, v120, v147
    v_mul_f32 v121, v121, v147
    v_cvt_pk_bf16_f32 v144, v88, v89
    v_cvt_pk_bf16_f32 v145, v90, v91
    v_cvt_pk_bf16_f32 v146, v120, v121
    buffer_store_dwordx2 v[144:145], v8, s[8:11], s77 offen sc1
    buffer_store_dword v146, v9, s[8:11], s77 offen sc1
    s_add_u32 s77, s77, 18432
    v_rcp_f32 v151, v126
    s_nop 0
    v_mul_f32 v92, v92, v151
    v_mul_f32 v93, v93, v151
    v_mul_f32 v94, v94, v151
    v_mul_f32 v95, v95, v151
    v_mul_f32 v124, v124, v151
    v_mul_f32 v125, v125, v151
    v_cvt_pk_bf16_f32 v148, v92, v93
    v_cvt_pk_bf16_f32 v149, v94, v95
    v_cvt_pk_bf16_f32 v150, v124, v125
    buffer_store_dwordx2 v[148:149], v8, s[8:11], s77 offen sc1
    buffer_store_dword v150, v9, s[8:11], s77 offen sc1
    s_add_u32 s77, s77, 18432
    v_rcp_f32 v147, v130
    s_nop 0
    v_mul_f32 v96, v96, v147
    v_mul_f32 v97, v97, v147
    v_mul_f32 v98, v98, v147
    v_mul_f32 v99, v99, v147
    v_mul_f32 v128, v128, v147
    v_mul_f32 v129, v129, v147
    v_cvt_pk_bf16_f32 v144, v96, v97
    v_cvt_pk_bf16_f32 v145, v98, v99
    v_cvt_pk_bf16_f32 v146, v128, v129
    buffer_store_dwordx2 v[144:145], v8, s[8:11], s77 offen sc1
    buffer_store_dword v146, v9, s[8:11], s77 offen sc1
    s_add_u32 s77, s77, 18432
    v_rcp_f32 v151, v134
    s_nop 0
    v_mul_f32 v100, v100, v151
    v_mul_f32 v101, v101, v151
    v_mul_f32 v102, v102, v151
    v_mul_f32 v103, v103, v151
    v_mul_f32 v132, v132, v151
    v_mul_f32 v133, v133, v151
    v_cvt_pk_bf16_f32 v148, v100, v101
    v_cvt_pk_bf16_f32 v149, v102, v103
    v_cvt_pk_bf16_f32 v150, v132, v133
    buffer_store_dwordx2 v[148:149], v8, s[8:11], s77 offen sc1
    buffer_store_dword v150, v9, s[8:11], s77 offen sc1
    s_add_u32 s77, s77, 18432
    v_rcp_f32 v147, v138
    s_nop 0
    v_mul_f32 v104, v104, v147
    v_mul_f32 v105, v105, v147
    v_mul_f32 v106, v106, v147
    v_mul_f32 v107, v107, v147
    v_mul_f32 v136, v136, v147
    v_mul_f32 v137, v137, v147
    v_cvt_pk_bf16_f32 v144, v104, v105
    v_cvt_pk_bf16_f32 v145, v106, v107
    v_cvt_pk_bf16_f32 v146, v136, v137
    buffer_store_dwordx2 v[144:145], v8, s[8:11], s77 offen sc1
    buffer_store_dword v146, v9, s[8:11], s77 offen sc1
    s_add_u32 s77, s77, 18432
    v_rcp_f32 v151, v142
    s_nop 0
    v_mul_f32 v108, v108, v151
    v_mul_f32 v109, v109, v151
    v_mul_f32 v110, v110, v151
    v_mul_f32 v111, v111, v151
    v_mul_f32 v140, v140, v151
    v_mul_f32 v141, v141, v151
    v_cvt_pk_bf16_f32 v148, v108, v109
    v_cvt_pk_bf16_f32 v149, v110, v111
    v_cvt_pk_bf16_f32 v150, v140, v141
    buffer_store_dwordx2 v[148:149], v8, s[8:11], s77 offen sc1
    buffer_store_dword v150, v9, s[8:11], s77 offen sc1
    s_add_u32 s77, s77, 18432
    s_waitcnt vmcnt(0)
    s_lshl_b32 s60, s74, 7
    s_lshl_b32 s61, s70, 2
    s_add_u32 s60, s60, s61
    s_add_u32 s60, s60, 26624
    v_mov_b32 v16, 1
    s_mov_b64 exec, 1
    buffer_store_dword v16, off, s[8:11], s60 sc1
    s_mov_b64 exec, -1
    s_cmp_ge_u32 s72, 72
    s_cbranch_scc1 L_aend_186
    v_lshrrev_b32 v18, 2, v2
    v_lshl_add_u32 v18, v3, 3, v18
    v_and_b32 v19, 3, v2
    v_lshlrev_b32 v19, 5, v19
    v_lshl_add_u32 v16, v18, 7, v19
    v_add_u32 v17, 36864, v16
    ds_read_b64_tr_b16 a[0:1], v16 offset:0
    ds_read_b64_tr_b16 a[2:3], v16 offset:512
    ds_read_b64_tr_b16 a[4:5], v16 offset:4096
    ds_read_b64_tr_b16 a[6:7], v16 offset:4608
    ds_read_b64_tr_b16 a[8:9], v16 offset:8192
    ds_read_b64_tr_b16 a[10:11], v16 offset:8704
    ds_read_b64_tr_b16 a[12:13], v16 offset:12288
    ds_read_b64_tr_b16 a[14:15], v16 offset:12800
    ds_read_b64_tr_b16 a[16:17], v16 offset:16384
    ds_read_b64_tr_b16 a[18:19], v16 offset:16896
    ds_read_b64_tr_b16 a[20:21], v16 offset:20480
    ds_read_b64_tr_b16 a[22:23], v16 offset:20992
    s_waitcnt lgkmcnt(6)
    ds_read_b64_tr_b16 a[24:25], v16 offset:24576
    ds_read_b64_tr_b16 a[26:27], v16 offset:25088
    ds_read_b64_tr_b16 a[28:29], v16 offset:28672
    ds_read_b64_tr_b16 a[30:31], v16 offset:29184
    ds_read_b64_tr_b16 a[32:33], v16 offset:32768
    ds_read_b64_tr_b16 a[34:35], v16 offset:33280
    ds_read_b64_tr_b16 a[36:37], v17 offset:0
    ds_read_b64_tr_b16 a[38:39], v17 offset:512
    ds_read_b64_tr_b16 a[40:41], v17 offset:4096
    ds_read_b64_tr_b16 a[42:43], v17 offset:4608
    ds_read_b64_tr_b16 a[44:45], v17 offset:8192
    ds_read_b64_tr_b16 a[46:47], v17 offset:8704
    s_waitcnt lgkmcnt(6)
    ds_read_b64_tr_b16 a[48:49], v17 offset:12288
    ds_read_b64_tr_b16 a[50:51], v17 offset:12800
    ds_read_b64_tr_b16 a[52:53], v17 offset:16384
    ds_read_b64_tr_b16 a[54:55], v17 offset:16896
    ds_read_b64_tr_b16 a[56:57], v17 offset:20480
    ds_read_b64_tr_b16 a[58:59], v17 offset:20992
    ds_read_b64_tr_b16 a[60:61], v17 offset:24576
    ds_read_b64_tr_b16 a[62:63], v17 offset:25088
    ds_read_b64_tr_b16 a[64:65], v17 offset:28672
    ds_read_b64_tr_b16 a[66:67], v17 offset:29184
    ds_read_b64_tr_b16 a[68:69], v17 offset:32768
    ds_read_b64_tr_b16 a[70:71], v17 offset:33280
    s_waitcnt lgkmcnt(6)
    ds_read_b64_tr_b16 a[72:73], v16 offset:8
    ds_read_b64_tr_b16 a[74:75], v16 offset:520
    ds_read_b64_tr_b16 a[76:77], v16 offset:4104
    ds_read_b64_tr_b16 a[78:79], v16 offset:4616
    ds_read_b64_tr_b16 a[80:81], v16 offset:8200
    ds_read_b64_tr_b16 a[82:83], v16 offset:8712
    ds_read_b64_tr_b16 a[84:85], v16 offset:12296
    ds_read_b64_tr_b16 a[86:87], v16 offset:12808
    ds_read_b64_tr_b16 a[88:89], v16 offset:16392
    ds_read_b64_tr_b16 a[90:91], v16 offset:16904
    ds_read_b64_tr_b16 a[92:93], v16 offset:20488
    ds_read_b64_tr_b16 a[94:95], v16 offset:21000
    s_waitcnt lgkmcnt(6)
    ds_read_b64_tr_b16 a[96:97], v16 offset:24584
    ds_read_b64_tr_b16 a[98:99], v16 offset:25096
    ds_read_b64_tr_b16 a[100:101], v16 offset:28680
    ds_read_b64_tr_b16 a[102:103], v16 offset:29192
    ds_read_b64_tr_b16 a[104:105], v16 offset:32776
    ds_read_b64_tr_b16 a[106:107], v16 offset:33288
    ds_read_b64_tr_b16 a[108:109], v17 offset:8
    ds_read_b64_tr_b16 a[110:111], v17 offset:520
    ds_read_b64_tr_b16 a[112:113], v17 offset:4104
    ds_read_b64_tr_b16 a[114:115], v17 offset:4616
    ds_read_b64_tr_b16 a[116:117], v17 offset:8200
    ds_read_b64_tr_b16 a[118:119], v17 offset:8712
    s_waitcnt lgkmcnt(6)
    ds_read_b64_tr_b16 a[120:121], v17 offset:12296
    ds_read_b64_tr_b16 a[122:123], v17 offset:12808
    ds_read_b64_tr_b16 a[124:125], v17 offset:16392
    ds_read_b64_tr_b16 a[126:127], v17 offset:16904
    ds_read_b64_tr_b16 a[128:129], v17 offset:20488
    ds_read_b64_tr_b16 a[130:131], v17 offset:21000
    ds_read_b64_tr_b16 a[132:133], v17 offset:24584
    ds_read_b64_tr_b16 a[134:135], v17 offset:25096
    ds_read_b64_tr_b16 a[136:137], v17 offset:28680
    ds_read_b64_tr_b16 a[138:139], v17 offset:29192
    ds_read_b64_tr_b16 a[140:141], v17 offset:32776
    ds_read_b64_tr_b16 a[142:143], v17 offset:33288
    s_waitcnt lgkmcnt(6)
    ds_read_b64_tr_b16 a[144:145], v16 offset:16
    ds_read_b64_tr_b16 a[146:147], v16 offset:528
    ds_read_b64_tr_b16 a[148:149], v16 offset:4112
    ds_read_b64_tr_b16 a[150:151], v16 offset:4624
    ds_read_b64_tr_b16 a[152:153], v16 offset:8208
    ds_read_b64_tr_b16 a[154:155], v16 offset:8720
    ds_read_b64_tr_b16 a[156:157], v16 offset:12304
    ds_read_b64_tr_b16 a[158:159], v16 offset:12816
    ds_read_b64_tr_b16 a[160:161], v16 offset:16400
    ds_read_b64_tr_b16 a[162:163], v16 offset:16912
    ds_read_b64_tr_b16 a[164:165], v16 offset:20496
    ds_read_b64_tr_b16 a[166:167], v16 offset:21008
    s_waitcnt lgkmcnt(6)
    ds_read_b64_tr_b16 a[168:169], v16 offset:24592
    ds_read_b64_tr_b16 a[170:171], v16 offset:25104
    ds_read_b64_tr_b16 a[172:173], v16 offset:28688
    ds_read_b64_tr_b16 a[174:175], v16 offset:29200
    ds_read_b64_tr_b16 a[176:177], v16 offset:32784
    ds_read_b64_tr_b16 a[178:179], v16 offset:33296
    ds_read_b64_tr_b16 a[180:181], v17 offset:16
    ds_read_b64_tr_b16 a[182:183], v17 offset:528
    ds_read_b64_tr_b16 a[184:185], v17 offset:4112
    ds_read_b64_tr_b16 a[186:187], v17 offset:4624
    ds_read_b64_tr_b16 a[188:189], v17 offset:8208
    ds_read_b64_tr_b16 a[190:191], v17 offset:8720
    s_waitcnt lgkmcnt(6)
    ds_read_b64_tr_b16 a[192:193], v17 offset:12304
    ds_read_b64_tr_b16 a[194:195], v17 offset:12816
    ds_read_b64_tr_b16 a[196:197], v17 offset:16400
    ds_read_b64_tr_b16 a[198:199], v17 offset:16912
    ds_read_b64_tr_b16 a[200:201], v17 offset:20496
    ds_read_b64_tr_b16 a[202:203], v17 offset:21008
    ds_read_b64_tr_b16 a[204:205], v17 offset:24592
    ds_read_b64_tr_b16 a[206:207], v17 offset:25104
    ds_read_b64_tr_b16 a[208:209], v17 offset:28688
    ds_read_b64_tr_b16 a[210:211], v17 offset:29200
    ds_read_b64_tr_b16 a[212:213], v17 offset:32784
    ds_read_b64_tr_b16 a[214:215], v17 offset:33296
    s_waitcnt lgkmcnt(6)
    ds_read_b64_tr_b16 a[216:217], v16 offset:24
    ds_read_b64_tr_b16 a[218:219], v16 offset:536
    ds_read_b64_tr_b16 a[220:221], v16 offset:4120
    ds_read_b64_tr_b16 a[222:223], v16 offset:4632
    ds_read_b64_tr_b16 a[224:225], v16 offset:8216
    ds_read_b64_tr_b16 a[226:227], v16 offset:8728
    ds_read_b64_tr_b16 a[228:229], v16 offset:12312
    ds_read_b64_tr_b16 a[230:231], v16 offset:12824
    ds_read_b64_tr_b16 a[232:233], v16 offset:16408
    ds_read_b64_tr_b16 a[234:235], v16 offset:16920
    ds_read_b64_tr_b16 a[236:237], v16 offset:20504
    ds_read_b64_tr_b16 a[238:239], v16 offset:21016
    s_waitcnt lgkmcnt(6)
    ds_read_b64_tr_b16 a[240:241], v16 offset:24600
    ds_read_b64_tr_b16 a[242:243], v16 offset:25112
    ds_read_b64_tr_b16 a[244:245], v16 offset:28696
    ds_read_b64_tr_b16 a[246:247], v16 offset:29208
    ds_read_b64_tr_b16 a[248:249], v16 offset:32792
    ds_read_b64_tr_b16 a[250:251], v16 offset:33304
    ds_read_b64_tr_b16 a[252:253], v17 offset:24
    ds_read_b64_tr_b16 a[254:255], v17 offset:536
    ds_read_b64_tr_b16 v[224:225], v17 offset:4120
    ds_read_b64_tr_b16 v[226:227], v17 offset:4632
    ds_read_b64_tr_b16 v[228:229], v17 offset:8216
    ds_read_b64_tr_b16 v[230:231], v17 offset:8728
    s_waitcnt lgkmcnt(6)
    ds_read_b64_tr_b16 v[232:233], v17 offset:12312
    ds_read_b64_tr_b16 v[234:235], v17 offset:12824
    ds_read_b64_tr_b16 v[236:237], v17 offset:16408
    ds_read_b64_tr_b16 v[238:239], v17 offset:16920
    ds_read_b64_tr_b16 v[240:241], v17 offset:20504
    ds_read_b64_tr_b16 v[242:243], v17 offset:21016
    ds_read_b64_tr_b16 v[244:245], v17 offset:24600
    ds_read_b64_tr_b16 v[246:247], v17 offset:25112
    ds_read_b64_tr_b16 v[248:249], v17 offset:28696
    ds_read_b64_tr_b16 v[250:251], v17 offset:29208
    ds_read_b64_tr_b16 v[252:253], v17 offset:32792
    ds_read_b64_tr_b16 v[254:255], v17 offset:33304
    s_waitcnt lgkmcnt(6)
    s_waitcnt lgkmcnt(0)
    s_lshl_b32 s60, s81, 1
    s_lshr_b32 s61, s4, 1
    s_add_u32 s60, s60, s61
    s_lshl_b32 s60, s60, 7
    s_add_u32 s78, s60, 26624
    v_and_b32 v8, 31, v1
    v_lshlrev_b32 v8, 2, v8
    s_mov_b32 s59, 0
L_aoc_187:
    buffer_load_dword v9, v8, s[8:11], s78 offen sc1
    s_waitcnt vmcnt(0)
    v_cmp_ne_u32 vcc, 1, v9
    s_cbranch_vccz L_aoc_ok_188
    s_add_u32 s59, s59, 1
    s_cmp_lt_u32 s59, s58
    s_cbranch_scc1 L_aoc_187
    s_mov_b32 s58, 0
L_aoc_ok_188:
    s_lshl_b32 s60, s81, 8
    s_lshl_b32 s61, s4, 6
    s_add_u32 s73, s60, s61
    s_mul_i32 s77, s73, 1152
    s_add_u32 s77, s77, 142606336
    s_mul_i32 s78, s73, 2304
    s_lshl_b32 s60, s80, 7
    s_add_u32 s78, s78, s60
    s_movk_i32 s60, 2304
    v_mul_lo_u32 v8, v2, s60
    v_lshl_add_u32 v8, v3, 5, v8
    s_add_u32 s60, s77, 0
    buffer_load_dwordx4 v[64:67], v4, s[8:11], s60 offen offset:0 sc1
    buffer_load_dwordx4 v[68:71], v4, s[8:11], s60 offen offset:64 sc1
    buffer_load_dwordx4 v[72:75], v4, s[8:11], s60 offen offset:128 sc1
    buffer_load_dwordx4 v[76:79], v4, s[8:11], s60 offen offset:192 sc1
    buffer_load_dwordx4 v[80:83], v4, s[8:11], s60 offen offset:256 sc1
    buffer_load_dwordx4 v[84:87], v4, s[8:11], s60 offen offset:320 sc1
    buffer_load_dwordx4 v[88:91], v4, s[8:11], s60 offen offset:384 sc1
    buffer_load_dwordx4 v[92:95], v4, s[8:11], s60 offen offset:448 sc1
    buffer_load_dwordx4 v[96:99], v4, s[8:11], s60 offen offset:512 sc1
    buffer_load_dwordx4 v[100:103], v4, s[8:11], s60 offen offset:576 sc1
    buffer_load_dwordx4 v[104:107], v4, s[8:11], s60 offen offset:640 sc1
    buffer_load_dwordx4 v[108:111], v4, s[8:11], s60 offen offset:704 sc1
    buffer_load_dwordx4 v[112:115], v4, s[8:11], s60 offen offset:768 sc1
    buffer_load_dwordx4 v[116:119], v4, s[8:11], s60 offen offset:832 sc1
    buffer_load_dwordx4 v[120:123], v4, s[8:11], s60 offen offset:896 sc1
    buffer_load_dwordx4 v[124:127], v4, s[8:11], s60 offen offset:960 sc1
    buffer_load_dwordx4 v[128:131], v4, s[8:11], s60 offen offset:1024 sc1
    buffer_load_dwordx4 v[132:135], v4, s[8:11], s60 offen offset:1088 sc1
    s_add_u32 s60, s77, 18432
    buffer_load_dwordx4 v[136:139], v4, s[8:11], s60 offen offset:0 sc1
    buffer_load_dwordx4 v[140:143], v4, s[8:11], s60 offen offset:64 sc1
    buffer_load_dwordx4 v[144:147], v4, s[8:11], s60 offen offset:128 sc1
    buffer_load_dwordx4 v[148:151], v4, s[8:11], s60 offen offset:192 sc1
    buffer_load_dwordx4 v[152:155], v4, s[8:11], s60 offen offset:256 sc1
    buffer_load_dwordx4 v[156:159], v4, s[8:11], s60 offen offset:320 sc1
    buffer_load_dwordx4 v[160:163], v4, s[8:11], s60 offen offset:384 sc1
    buffer_load_dwordx4 v[164:167], v4, s[8:11], s60 offen offset:448 sc1
    buffer_load_dwordx4 v[168:171], v4, s[8:11], s60 offen offset:512 sc1
    buffer_load_dwordx4 v[172:175], v4, s[8:11], s60 offen offset:576 sc1
    buffer_load_dwordx4 v[176:179], v4, s[8:11], s60 offen offset:640 sc1
    buffer_load_dwordx4 v[180:183], v4, s[8:11], s60 offen offset:704 sc1
    buffer_load_dwordx4 v[184:187], v4, s[8:11], s60 offen offset:768 sc1
    buffer_load_dwordx4 v[188:191], v4, s[8:11], s60 offen offset:832 sc1
    buffer_load_dwordx4 v[192:195], v4, s[8:11], s60 offen offset:896 sc1
    buffer_load_dwordx4 v[196:199], v4, s[8:11], s60 offen offset:960 sc1
    buffer_load_dwordx4 v[200:203], v4, s[8:11], s60 offen offset:1024 sc1
    buffer_load_dwordx4 v[204:207], v4, s[8:11], s60 offen offset:1088 sc1
    s_waitcnt vmcnt(18)
    v_mfma_f32_16x16x32_bf16 v[32:35], a[0:3], v[64:67], 0
    v_mfma_f32_16x16x32_bf16 v[36:39], a[72:75], v[64:67], 0
    v_mfma_f32_16x16x32_bf16 v[40:43], a[144:147], v[64:67], 0
    v_mfma_f32_16x16x32_bf16 v[44:47], a[216:219], v[64:67], 0
    v_mfma_f32_16x16x32_bf16 v[32:35], a[4:7], v[68:71], v[32:35]
    v_mfma_f32_16x16x32_bf16 v[36:39], a[76:79], v[68:71], v[36:39]
    v_mfma_f32_16x16x32_bf16 v[40:43], a[148:151], v[68:71], v[40:43]
    v_mfma_f32_16x16x32_bf16 v[44:47], a[220:223], v[68:71], v[44:47]
    v_mfma_f32_16x16x32_bf16 v[32:35], a[8:11], v[72:75], v[32:35]
    v_mfma_f32_16x16x32_bf16 v[36:39], a[80:83], v[72:75], v[36:39]
    v_mfma_f32_16x16x32_bf16 v[40:43], a[152:155], v[72:75], v[40:43]
    v_mfma_f32_16x16x32_bf16 v[44:47], a[224:227], v[72:75], v[44:47]
    v_mfma_f32_16x16x32_bf16 v[32:35], a[12:15], v[76:79], v[32:35]
    v_mfma_f32_16x16x32_bf16 v[36:39], a[84:87], v[76:79], v[36:39]
    v_mfma_f32_16x16x32_bf16 v[40:43], a[156:159], v[76:79], v[40:43]
    v_mfma_f32_16x16x32_bf16 v[44:47], a[228:231], v[76:79], v[44:47]
    v_mfma_f32_16x16x32_bf16 v[32:35], a[16:19], v[80:83], v[32:35]
    v_mfma_f32_16x16x32_bf16 v[36:39], a[88:91], v[80:83], v[36:39]
    v_mfma_f32_16x16x32_bf16 v[40:43], a[160:163], v[80:83], v[40:43]
    v_mfma_f32_16x16x32_bf16 v[44:47], a[232:235], v[80:83], v[44:47]
    v_mfma_f32_16x16x32_bf16 v[32:35], a[20:23], v[84:87], v[32:35]
    v_mfma_f32_16x16x32_bf16 v[36:39], a[92:95], v[84:87], v[36:39]
    v_mfma_f32_16x16x32_bf16 v[40:43], a[164:167], v[84:87], v[40:43]
    v_mfma_f32_16x16x32_bf16 v[44:47], a[236:239], v[84:87], v[44:47]
    v_mfma_f32_16x16x32_bf16 v[32:35], a[24:27], v[88:91], v[32:35]
    v_mfma_f32_16x16x32_bf16 v[36:39], a[96:99], v[88:91], v[36:39]
    v_mfma_f32_16x16x32_bf16 v[40:43], a[168:171], v[88:91], v[40:43]
    v_mfma_f32_16x16x32_bf16 v[44:47], a[240:243], v[88:91], v[44:47]
    v_mfma_f32_16x16x32_bf16 v[32:35], a[28:31], v[92:95], v[32:35]
    v_mfma_f32_16x16x32_bf16 v[36:39], a[100:103], v[92:95], v[36:39]
    v_mfma_f32_16x16x32_bf16 v[40:43], a[172:175], v[92:95], v[40:43]
    v_mfma_f32_16x16x32_bf16 v[44:47], a[244:247], v[92:95], v[44:47]
    v_mfma_f32_16x16x32_bf16 v[32:35], a[32:35], v[96:99], v[32:35]
    v_mfma_f32_16x16x32_bf16 v[36:39], a[104:107], v[96:99], v[36:39]
    v_mfma_f32_16x16x32_bf16 v[40:43], a[176:179], v[96:99], v[40:43]
    v_mfma_f32_16x16x32_bf16 v[44:47], a[248:251], v[96:99], v[44:47]
    v_mfma_f32_16x16x32_bf16 v[32:35], a[36:39], v[100:103], v[32:35]
    v_mfma_f32_16x16x32_bf16 v[36:39], a[108:111], v[100:103], v[36:39]
    v_mfma_f32_16x16x32_bf16 v[40:43], a[180:183], v[100:103], v[40:43]
    v_mfma_f32_16x16x32_bf16 v[44:47], a[252:255], v[100:103], v[44:47]
    v_mfma_f32_16x16x32_bf16 v[32:35], a[40:43], v[104:107], v[32:35]
    v_mfma_f32_16x16x32_bf16 v[36:39], a[112:115], v[104:107], v[36:39]
    v_mfma_f32_16x16x32_bf16 v[40:43], a[184:187], v[104:107], v[40:43]
    v_mfma_f32_16x16x32_bf16 v[44:47], v[224:227], v[104:107], v[44:47]
    v_mfma_f32_16x16x32_bf16 v[32:35], a[44:47], v[108:111], v[32:35]
    v_mfma_f32_16x16x32_bf16 v[36:39], a[116:119], v[108:111], v[36:39]
    v_mfma_f32_16x16x32_bf16 v[40:43], a[188:191], v[108:111], v[40:43]
    v_mfma_f32_16x16x32_bf16 v[44:47], v[228:231], v[108:111], v[44:47]
    v_mfma_f32_16x16x32_bf16 v[32:35], a[48:51], v[112:115], v[32:35]
    v_mfma_f32_16x16x32_bf16 v[36:39], a[120:123], v[112:115], v[36:39]
    v_mfma_f32_16x16x32_bf16 v[40:43], a[192:195], v[112:115], v[40:43]
    v_mfma_f32_16x16x32_bf16 v[44:47], v[232:235], v[112:115], v[44:47]
    v_mfma_f32_16x16x32_bf16 v[32:35], a[52:55], v[116:119], v[32:35]
    v_mfma_f32_16x16x32_bf16 v[36:39], a[124:127], v[116:119], v[36:39]
    v_mfma_f32_16x16x32_bf16 v[40:43], a[196:199], v[116:119], v[40:43]
    v_mfma_f32_16x16x32_bf16 v[44:47], v[236:239], v[116:119], v[44:47]
    v_mfma_f32_16x16x32_bf16 v[32:35], a[56:59], v[120:123], v[32:35]
    v_mfma_f32_16x16x32_bf16 v[36:39], a[128:131], v[120:123], v[36:39]
    v_mfma_f32_16x16x32_bf16 v[40:43], a[200:203], v[120:123], v[40:43]
    v_mfma_f32_16x16x32_bf16 v[44:47], v[240:243], v[120:123], v[44:47]
    v_mfma_f32_16x16x32_bf16 v[32:35], a[60:63], v[124:127], v[32:35]
    v_mfma_f32_16x16x32_bf16 v[36:39], a[132:135], v[124:127], v[36:39]
    v_mfma_f32_16x16x32_bf16 v[40:43], a[204:207], v[124:127], v[40:43]
    v_mfma_f32_16x16x32_bf16 v[44:47], v[244:247], v[124:127], v[44:47]
    v_mfma_f32_16x16x32_bf16 v[32:35], a[64:67], v[128:131], v[32:35]
    v_mfma_f32_16x16x32_bf16 v[36:39], a[136:139], v[128:131], v[36:39]
    v_mfma_f32_16x16x32_bf16 v[40:43], a[208:211], v[128:131], v[40:43]
    v_mfma_f32_16x16x32_bf16 v[44:47], v[248:251], v[128:131], v[44:47]
    v_mfma_f32_16x16x32_bf16 v[32:35], a[68:71], v[132:135], v[32:35]
    v_mfma_f32_16x16x32_bf16 v[36:39], a[140:143], v[132:135], v[36:39]
    v_mfma_f32_16x16x32_bf16 v[40:43], a[212:215], v[132:135], v[40:43]
    v_mfma_f32_16x16x32_bf16 v[44:47], v[252:255], v[132:135], v[44:47]
    s_nop 4
    v_cvt_pk_bf16_f32 v16, v32, v33
    v_cvt_pk_bf16_f32 v17, v34, v35
    v_cvt_pk_bf16_f32 v18, v36, v37
    v_cvt_pk_bf16_f32 v19, v38, v39
    v_cvt_pk_bf16_f32 v20, v40, v41
    v_cvt_pk_bf16_f32 v21, v42, v43
    v_cvt_pk_bf16_f32 v22, v44, v45
    v_cvt_pk_bf16_f32 v23, v46, v47
    s_add_u32 s60, s78, 0
    buffer_store_dwordx4 v[16:19], v8, s[28:31], s60 offen
    buffer_store_dwordx4 v[20:23], v8, s[28:31], s60 offen offset:16
    s_nop 1
    s_add_u32 s60, s77, 36864
    buffer_load_dwordx4 v[64:67], v4, s[8:11], s60 offen offset:0 sc1
    buffer_load_dwordx4 v[68:71], v4, s[8:11], s60 offen offset:64 sc1
    buffer_load_dwordx4 v[72:75], v4, s[8:11], s60 offen offset:128 sc1
    buffer_load_dwordx4 v[76:79], v4, s[8:11], s60 offen offset:192 sc1
    buffer_load_dwordx4 v[80:83], v4, s[8:11], s60 offen offset:256 sc1
    buffer_load_dwordx4 v[84:87], v4, s[8:11], s60 offen offset:320 sc1
    buffer_load_dwordx4 v[88:91], v4, s[8:11], s60 offen offset:384 sc1
    buffer_load_dwordx4 v[92:95], v4, s[8:11], s60 offen offset:448 sc1
    buffer_load_dwordx4 v[96:99], v4, s[8:11], s60 offen offset:512 sc1
    buffer_load_dwordx4 v[100:103], v4, s[8:11], s60 offen offset:576 sc1
    buffer_load_dwordx4 v[104:107], v4, s[8:11], s60 offen offset:640 sc1
    buffer_load_dwordx4 v[108:111], v4, s[8:11], s60 offen offset:704 sc1
    buffer_load_dwordx4 v[112:115], v4, s[8:11], s60 offen offset:768 sc1
    buffer_load_dwordx4 v[116:119], v4, s[8:11], s60 offen offset:832 sc1
    buffer_load_dwordx4 v[120:123], v4, s[8:11], s60 offen offset:896 sc1
    buffer_load_dwordx4 v[124:127], v4, s[8:11], s60 offen offset:960 sc1
    buffer_load_dwordx4 v[128:131], v4, s[8:11], s60 offen offset:1024 sc1
    buffer_load_dwordx4 v[132:135], v4, s[8:11], s60 offen offset:1088 sc1
    s_waitcnt vmcnt(20)
    v_mfma_f32_16x16x32_bf16 v[32:35], a[0:3], v[136:139], 0
    v_mfma_f32_16x16x32_bf16 v[36:39], a[72:75], v[136:139], 0
    v_mfma_f32_16x16x32_bf16 v[40:43], a[144:147], v[136:139], 0
    v_mfma_f32_16x16x32_bf16 v[44:47], a[216:219], v[136:139], 0
    v_mfma_f32_16x16x32_bf16 v[32:35], a[4:7], v[140:143], v[32:35]
    v_mfma_f32_16x16x32_bf16 v[36:39], a[76:79], v[140:143], v[36:39]
    v_mfma_f32_16x16x32_bf16 v[40:43], a[148:151], v[140:143], v[40:43]
    v_mfma_f32_16x16x32_bf16 v[44:47], a[220:223], v[140:143], v[44:47]
    v_mfma_f32_16x16x32_bf16 v[32:35], a[8:11], v[144:147], v[32:35]
    v_mfma_f32_16x16x32_bf16 v[36:39], a[80:83], v[144:147], v[36:39]
    v_mfma_f32_16x16x32_bf16 v[40:43], a[152:155], v[144:147], v[40:43]
    v_mfma_f32_16x16x32_bf16 v[44:47], a[224:227], v[144:147], v[44:47]
    v_mfma_f32_16x16x32_bf16 v[32:35], a[12:15], v[148:151], v[32:35]
    v_mfma_f32_16x16x32_bf16 v[36:39], a[84:87], v[148:151], v[36:39]
    v_mfma_f32_16x16x32_bf16 v[40:43], a[156:159], v[148:151], v[40:43]
    v_mfma_f32_16x16x32_bf16 v[44:47], a[228:231], v[148:151], v[44:47]
    v_mfma_f32_16x16x32_bf16 v[32:35], a[16:19], v[152:155], v[32:35]
    v_mfma_f32_16x16x32_bf16 v[36:39], a[88:91], v[152:155], v[36:39]
    v_mfma_f32_16x16x32_bf16 v[40:43], a[160:163], v[152:155], v[40:43]
    v_mfma_f32_16x16x32_bf16 v[44:47], a[232:235], v[152:155], v[44:47]
    v_mfma_f32_16x16x32_bf16 v[32:35], a[20:23], v[156:159], v[32:35]
    v_mfma_f32_16x16x32_bf16 v[36:39], a[92:95], v[156:159], v[36:39]
    v_mfma_f32_16x16x32_bf16 v[40:43], a[164:167], v[156:159], v[40:43]
    v_mfma_f32_16x16x32_bf16 v[44:47], a[236:239], v[156:159], v[44:47]
    v_mfma_f32_16x16x32_bf16 v[32:35], a[24:27], v[160:163], v[32:35]
    v_mfma_f32_16x16x32_bf16 v[36:39], a[96:99], v[160:163], v[36:39]
    v_mfma_f32_16x16x32_bf16 v[40:43], a[168:171], v[160:163], v[40:43]
    v_mfma_f32_16x16x32_bf16 v[44:47], a[240:243], v[160:163], v[44:47]
    v_mfma_f32_16x16x32_bf16 v[32:35], a[28:31], v[164:167], v[32:35]
    v_mfma_f32_16x16x32_bf16 v[36:39], a[100:103], v[164:167], v[36:39]
    v_mfma_f32_16x16x32_bf16 v[40:43], a[172:175], v[164:167], v[40:43]
    v_mfma_f32_16x16x32_bf16 v[44:47], a[244:247], v[164:167], v[44:47]
    v_mfma_f32_16x16x32_bf16 v[32:35], a[32:35], v[168:171], v[32:35]
    v_mfma_f32_16x16x32_bf16 v[36:39], a[104:107], v[168:171], v[36:39]
    v_mfma_f32_16x16x32_bf16 v[40:43], a[176:179], v[168:171], v[40:43]
    v_mfma_f32_16x16x32_bf16 v[44:47], a[248:251], v[168:171], v[44:47]
    v_mfma_f32_16x16x32_bf16 v[32:35], a[36:39], v[172:175], v[32:35]
    v_mfma_f32_16x16x32_bf16 v[36:39], a[108:111], v[172:175], v[36:39]
    v_mfma_f32_16x16x32_bf16 v[40:43], a[180:183], v[172:175], v[40:43]
    v_mfma_f32_16x16x32_bf16 v[44:47], a[252:255], v[172:175], v[44:47]
    v_mfma_f32_16x16x32_bf16 v[32:35], a[40:43], v[176:179], v[32:35]
    v_mfma_f32_16x16x32_bf16 v[36:39], a[112:115], v[176:179], v[36:39]
    v_mfma_f32_16x16x32_bf16 v[40:43], a[184:187], v[176:179], v[40:43]
    v_mfma_f32_16x16x32_bf16 v[44:47], v[224:227], v[176:179], v[44:47]
    v_mfma_f32_16x16x32_bf16 v[32:35], a[44:47], v[180:183], v[32:35]
    v_mfma_f32_16x16x32_bf16 v[36:39], a[116:119], v[180:183], v[36:39]
    v_mfma_f32_16x16x32_bf16 v[40:43], a[188:191], v[180:183], v[40:43]
    v_mfma_f32_16x16x32_bf16 v[44:47], v[228:231], v[180:183], v[44:47]
    v_mfma_f32_16x16x32_bf16 v[32:35], a[48:51], v[184:187], v[32:35]
    v_mfma_f32_16x16x32_bf16 v[36:39], a[120:123], v[184:187], v[36:39]
    v_mfma_f32_16x16x32_bf16 v[40:43], a[192:195], v[184:187], v[40:43]
    v_mfma_f32_16x16x32_bf16 v[44:47], v[232:235], v[184:187], v[44:47]
    v_mfma_f32_16x16x32_bf16 v[32:35], a[52:55], v[188:191], v[32:35]
    v_mfma_f32_16x16x32_bf16 v[36:39], a[124:127], v[188:191], v[36:39]
    v_mfma_f32_16x16x32_bf16 v[40:43], a[196:199], v[188:191], v[40:43]
    v_mfma_f32_16x16x32_bf16 v[44:47], v[236:239], v[188:191], v[44:47]
    v_mfma_f32_16x16x32_bf16 v[32:35], a[56:59], v[192:195], v[32:35]
    v_mfma_f32_16x16x32_bf16 v[36:39], a[128:131], v[192:195], v[36:39]
    v_mfma_f32_16x16x32_bf16 v[40:43], a[200:203], v[192:195], v[40:43]
    v_mfma_f32_16x16x32_bf16 v[44:47], v[240:243], v[192:195], v[44:47]
    v_mfma_f32_16x16x32_bf16 v[32:35], a[60:63], v[196:199], v[32:35]
    v_mfma_f32_16x16x32_bf16 v[36:39], a[132:135], v[196:199], v[36:39]
    v_mfma_f32_16x16x32_bf16 v[40:43], a[204:207], v[196:199], v[40:43]
    v_mfma_f32_16x16x32_bf16 v[44:47], v[244:247], v[196:199], v[44:47]
    v_mfma_f32_16x16x32_bf16 v[32:35], a[64:67], v[200:203], v[32:35]
    v_mfma_f32_16x16x32_bf16 v[36:39], a[136:139], v[200:203], v[36:39]
    v_mfma_f32_16x16x32_bf16 v[40:43], a[208:211], v[200:203], v[40:43]
    v_mfma_f32_16x16x32_bf16 v[44:47], v[248:251], v[200:203], v[44:47]
    v_mfma_f32_16x16x32_bf16 v[32:35], a[68:71], v[204:207], v[32:35]
    v_mfma_f32_16x16x32_bf16 v[36:39], a[140:143], v[204:207], v[36:39]
    v_mfma_f32_16x16x32_bf16 v[40:43], a[212:215], v[204:207], v[40:43]
    v_mfma_f32_16x16x32_bf16 v[44:47], v[252:255], v[204:207], v[44:47]
    s_nop 4
    v_cvt_pk_bf16_f32 v16, v32, v33
    v_cvt_pk_bf16_f32 v17, v34, v35
    v_cvt_pk_bf16_f32 v18, v36, v37
    v_cvt_pk_bf16_f32 v19, v38, v39
    v_cvt_pk_bf16_f32 v20, v40, v41
    v_cvt_pk_bf16_f32 v21, v42, v43
    v_cvt_pk_bf16_f32 v22, v44, v45
    v_cvt_pk_bf16_f32 v23, v46, v47
    s_add_u32 s60, s78, 36864
    buffer_store_dwordx4 v[16:19], v8, s[28:31], s60 offen
    buffer_store_dwordx4 v[20:23], v8, s[28:31], s60 offen offset:16
    s_nop 1
    s_add_u32 s60, s77, 55296
    buffer_load_dwordx4 v[136:139], v4, s[8:11], s60 offen offset:0 sc1
    buffer_load_dwordx4 v[140:143], v4, s[8:11], s60 offen offset:64 sc1
    buffer_load_dwordx4 v[144:147], v4, s[8:11], s60 offen offset:128 sc1
    buffer_load_dwordx4 v[148:151], v4, s[8:11], s60 offen offset:192 sc1
    buffer_load_dwordx4 v[152:155], v4, s[8:11], s60 offen offset:256 sc1
    buffer_load_dwordx4 v[156:159], v4, s[8:11], s60 offen offset:320 sc1
    buffer_load_dwordx4 v[160:163], v4, s[8:11], s60 offen offset:384 sc1
    buffer_load_dwordx4 v[164:167], v4, s[8:11], s60 offen offset:448 sc1
    buffer_load_dwordx4 v[168:171], v4, s[8:11], s60 offen offset:512 sc1
    buffer_load_dwordx4 v[172:175], v4, s[8:11], s60 offen offset:576 sc1
    buffer_load_dwordx4 v[176:179], v4, s[8:11], s60 offen offset:640 sc1
    buffer_load_dwordx4 v[180:183], v4, s[8:11], s60 offen offset:704 sc1
    buffer_load_dwordx4 v[184:187], v4, s[8:11], s60 offen offset:768 sc1
    buffer_load_dwordx4 v[188:191], v4, s[8:11], s60 offen offset:832 sc1
    buffer_load_dwordx4 v[192:195], v4, s[8:11], s60 offen offset:896 sc1
    buffer_load_dwordx4 v[196:199], v4, s[8:11], s60 offen offset:960 sc1
    buffer_load_dwordx4 v[200:203], v4, s[8:11], s60 offen offset:1024 sc1
    buffer_load_dwordx4 v[204:207], v4, s[8:11], s60 offen offset:1088 sc1
    s_waitcnt vmcnt(20)
    v_mfma_f32_16x16x32_bf16 v[32:35], a[0:3], v[64:67], 0
    v_mfma_f32_16x16x32_bf16 v[36:39], a[72:75], v[64:67], 0
    v_mfma_f32_16x16x32_bf16 v[40:43], a[144:147], v[64:67], 0
    v_mfma_f32_16x16x32_bf16 v[44:47], a[216:219], v[64:67], 0
    v_mfma_f32_16x16x32_bf16 v[32:35], a[4:7], v[68:71], v[32:35]
    v_mfma_f32_16x16x32_bf16 v[36:39], a[76:79], v[68:71], v[36:39]
    v_mfma_f32_16x16x32_bf16 v[40:43], a[148:151], v[68:71], v[40:43]
    v_mfma_f32_16x16x32_bf16 v[44:47], a[220:223], v[68:71], v[44:47]
    v_mfma_f32_16x16x32_bf16 v[32:35], a[8:11], v[72:75], v[32:35]
    v_mfma_f32_16x16x32_bf16 v[36:39], a[80:83], v[72:75], v[36:39]
    v_mfma_f32_16x16x32_bf16 v[40:43], a[152:155], v[72:75], v[40:43]
    v_mfma_f32_16x16x32_bf16 v[44:47], a[224:227], v[72:75], v[44:47]
    v_mfma_f32_16x16x32_bf16 v[32:35], a[12:15], v[76:79], v[32:35]
    v_mfma_f32_16x16x32_bf16 v[36:39], a[84:87], v[76:79], v[36:39]
    v_mfma_f32_16x16x32_bf16 v[40:43], a[156:159], v[76:79], v[40:43]
    v_mfma_f32_16x16x32_bf16 v[44:47], a[228:231], v[76:79], v[44:47]
    v_mfma_f32_16x16x32_bf16 v[32:35], a[16:19], v[80:83], v[32:35]
    v_mfma_f32_16x16x32_bf16 v[36:39], a[88:91], v[80:83], v[36:39]
    v_mfma_f32_16x16x32_bf16 v[40:43], a[160:163], v[80:83], v[40:43]
    v_mfma_f32_16x16x32_bf16 v[44:47], a[232:235], v[80:83], v[44:47]
    v_mfma_f32_16x16x32_bf16 v[32:35], a[20:23], v[84:87], v[32:35]
    v_mfma_f32_16x16x32_bf16 v[36:39], a[92:95], v[84:87], v[36:39]
    v_mfma_f32_16x16x32_bf16 v[40:43], a[164:167], v[84:87], v[40:43]
    v_mfma_f32_16x16x32_bf16 v[44:47], a[236:239], v[84:87], v[44:47]
    v_mfma_f32_16x16x32_bf16 v[32:35], a[24:27], v[88:91], v[32:35]
    v_mfma_f32_16x16x32_bf16 v[36:39], a[96:99], v[88:91], v[36:39]
    v_mfma_f32_16x16x32_bf16 v[40:43], a[168:171], v[88:91], v[40:43]
    v_mfma_f32_16x16x32_bf16 v[44:47], a[240:243], v[88:91], v[44:47]
    v_mfma_f32_16x16x32_bf16 v[32:35], a[28:31], v[92:95], v[32:35]
    v_mfma_f32_16x16x32_bf16 v[36:39], a[100:103], v[92:95], v[36:39]
    v_mfma_f32_16x16x32_bf16 v[40:43], a[172:175], v[92:95], v[40:43]
    v_mfma_f32_16x16x32_bf16 v[44:47], a[244:247], v[92:95], v[44:47]
    v_mfma_f32_16x16x32_bf16 v[32:35], a[32:35], v[96:99], v[32:35]
    v_mfma_f32_16x16x32_bf16 v[36:39], a[104:107], v[96:99], v[36:39]
    v_mfma_f32_16x16x32_bf16 v[40:43], a[176:179], v[96:99], v[40:43]
    v_mfma_f32_16x16x32_bf16 v[44:47], a[248:251], v[96:99], v[44:47]
    v_mfma_f32_16x16x32_bf16 v[32:35], a[36:39], v[100:103], v[32:35]
    v_mfma_f32_16x16x32_bf16 v[36:39], a[108:111], v[100:103], v[36:39]
    v_mfma_f32_16x16x32_bf16 v[40:43], a[180:183], v[100:103], v[40:43]
    v_mfma_f32_16x16x32_bf16 v[44:47], a[252:255], v[100:103], v[44:47]
    v_mfma_f32_16x16x32_bf16 v[32:35], a[40:43], v[104:107], v[32:35]
    v_mfma_f32_16x16x32_bf16 v[36:39], a[112:115], v[104:107], v[36:39]
    v_mfma_f32_16x16x32_bf16 v[40:43], a[184:187], v[104:107], v[40:43]
    v_mfma_f32_16x16x32_bf16 v[44:47], v[224:227], v[104:107], v[44:47]
    v_mfma_f32_16x16x32_bf16 v[32:35], a[44:47], v[108:111], v[32:35]
    v_mfma_f32_16x16x32_bf16 v[36:39], a[116:119], v[108:111], v[36:39]
    v_mfma_f32_16x16x32_bf16 v[40:43], a[188:191], v[108:111], v[40:43]
    v_mfma_f32_16x16x32_bf16 v[44:47], v[228:231], v[108:111], v[44:47]
    v_mfma_f32_16x16x32_bf16 v[32:35], a[48:51], v[112:115], v[32:35]
    v_mfma_f32_16x16x32_bf16 v[36:39], a[120:123], v[112:115], v[36:39]
    v_mfma_f32_16x16x32_bf16 v[40:43], a[192:195], v[112:115], v[40:43]
    v_mfma_f32_16x16x32_bf16 v[44:47], v[232:235], v[112:115], v[44:47]
    v_mfma_f32_16x16x32_bf16 v[32:35], a[52:55], v[116:119], v[32:35]
    v_mfma_f32_16x16x32_bf16 v[36:39], a[124:127], v[116:119], v[36:39]
    v_mfma_f32_16x16x32_bf16 v[40:43], a[196:199], v[116:119], v[40:43]
    v_mfma_f32_16x16x32_bf16 v[44:47], v[236:239], v[116:119], v[44:47]
    v_mfma_f32_16x16x32_bf16 v[32:35], a[56:59], v[120:123], v[32:35]
    v_mfma_f32_16x16x32_bf16 v[36:39], a[128:131], v[120:123], v[36:39]
    v_mfma_f32_16x16x32_bf16 v[40:43], a[200:203], v[120:123], v[40:43]
    v_mfma_f32_16x16x32_bf16 v[44:47], v[240:243], v[120:123], v[44:47]
    v_mfma_f32_16x16x32_bf16 v[32:35], a[60:63], v[124:127], v[32:35]
    v_mfma_f32_16x16x32_bf16 v[36:39], a[132:135], v[124:127], v[36:39]
    v_mfma_f32_16x16x32_bf16 v[40:43], a[204:207], v[124:127], v[40:43]
    v_mfma_f32_16x16x32_bf16 v[44:47], v[244:247], v[124:127], v[44:47]
    v_mfma_f32_16x16x32_bf16 v[32:35], a[64:67], v[128:131], v[32:35]
    v_mfma_f32_16x16x32_bf16 v[36:39], a[136:139], v[128:131], v[36:39]
    v_mfma_f32_16x16x32_bf16 v[40:43], a[208:211], v[128:131], v[40:43]
    v_mfma_f32_16x16x32_bf16 v[44:47], v[248:251], v[128:131], v[44:47]
    v_mfma_f32_16x16x32_bf16 v[32:35], a[68:71], v[132:135], v[32:35]
    v_mfma_f32_16x16x32_bf16 v[36:39], a[140:143], v[132:135], v[36:39]
    v_mfma_f32_16x16x32_bf16 v[40:43], a[212:215], v[132:135], v[40:43]
    v_mfma_f32_16x16x32_bf16 v[44:47], v[252:255], v[132:135], v[44:47]
    s_nop 4
    v_cvt_pk_bf16_f32 v16, v32, v33
    v_cvt_pk_bf16_f32 v17, v34, v35
    v_cvt_pk_bf16_f32 v18, v36, v37
    v_cvt_pk_bf16_f32 v19, v38, v39
    v_cvt_pk_bf16_f32 v20, v40, v41
    v_cvt_pk_bf16_f32 v21, v42, v43
    v_cvt_pk_bf16_f32 v22, v44, v45
    v_cvt_pk_bf16_f32 v23, v46, v47
    s_add_u32 s60, s78, 73728
    buffer_store_dwordx4 v[16:19], v8, s[28:31], s60 offen
    buffer_store_dwordx4 v[20:23], v8, s[28:31], s60 offen offset:16
    s_nop 1
    s_waitcnt vmcnt(2)
    v_mfma_f32_16x16x32_bf16 v[32:35], a[0:3], v[136:139], 0
    v_mfma_f32_16x16x32_bf16 v[36:39], a[72:75], v[136:139], 0
    v_mfma_f32_16x16x32_bf16 v[40:43], a[144:147], v[136:139], 0
    v_mfma_f32_16x16x32_bf16 v[44:47], a[216:219], v[136:139], 0
    v_mfma_f32_16x16x32_bf16 v[32:35], a[4:7], v[140:143], v[32:35]
    v_mfma_f32_16x16x32_bf16 v[36:39], a[76:79], v[140:143], v[36:39]
    v_mfma_f32_16x16x32_bf16 v[40:43], a[148:151], v[140:143], v[40:43]
    v_mfma_f32_16x16x32_bf16 v[44:47], a[220:223], v[140:143], v[44:47]
    v_mfma_f32_16x16x32_bf16 v[32:35], a[8:11], v[144:147], v[32:35]
    v_mfma_f32_16x16x32_bf16 v[36:39], a[80:83], v[144:147], v[36:39]
    v_mfma_f32_16x16x32_bf16 v[40:43], a[152:155], v[144:147], v[40:43]
    v_mfma_f32_16x16x32_bf16 v[44:47], a[224:227], v[144:147], v[44:47]
    v_mfma_f32_16x16x32_bf16 v[32:35], a[12:15], v[148:151], v[32:35]
    v_mfma_f32_16x16x32_bf16 v[36:39], a[84:87], v[148:151], v[36:39]
    v_mfma_f32_16x16x32_bf16 v[40:43], a[156:159], v[148:151], v[40:43]
    v_mfma_f32_16x16x32_bf16 v[44:47], a[228:231], v[148:151], v[44:47]
    v_mfma_f32_16x16x32_bf16 v[32:35], a[16:19], v[152:155], v[32:35]
    v_mfma_f32_16x16x32_bf16 v[36:39], a[88:91], v[152:155], v[36:39]
    v_mfma_f32_16x16x32_bf16 v[40:43], a[160:163], v[152:155], v[40:43]
    v_mfma_f32_16x16x32_bf16 v[44:47], a[232:235], v[152:155], v[44:47]
    v_mfma_f32_16x16x32_bf16 v[32:35], a[20:23], v[156:159], v[32:35]
    v_mfma_f32_16x16x32_bf16 v[36:39], a[92:95], v[156:159], v[36:39]
    v_mfma_f32_16x16x32_bf16 v[40:43], a[164:167], v[156:159], v[40:43]
    v_mfma_f32_16x16x32_bf16 v[44:47], a[236:239], v[156:159], v[44:47]
    v_mfma_f32_16x16x32_bf16 v[32:35], a[24:27], v[160:163], v[32:35]
    v_mfma_f32_16x16x32_bf16 v[36:39], a[96:99], v[160:163], v[36:39]
    v_mfma_f32_16x16x32_bf16 v[40:43], a[168:171], v[160:163], v[40:43]
    v_mfma_f32_16x16x32_bf16 v[44:47], a[240:243], v[160:163], v[44:47]
    v_mfma_f32_16x16x32_bf16 v[32:35], a[28:31], v[164:167], v[32:35]
    v_mfma_f32_16x16x32_bf16 v[36:39], a[100:103], v[164:167], v[36:39]
    v_mfma_f32_16x16x32_bf16 v[40:43], a[172:175], v[164:167], v[40:43]
    v_mfma_f32_16x16x32_bf16 v[44:47], a[244:247], v[164:167], v[44:47]
    v_mfma_f32_16x16x32_bf16 v[32:35], a[32:35], v[168:171], v[32:35]
    v_mfma_f32_16x16x32_bf16 v[36:39], a[104:107], v[168:171], v[36:39]
    v_mfma_f32_16x16x32_bf16 v[40:43], a[176:179], v[168:171], v[40:43]
    v_mfma_f32_16x16x32_bf16 v[44:47], a[248:251], v[168:171], v[44:47]
    v_mfma_f32_16x16x32_bf16 v[32:35], a[36:39], v[172:175], v[32:35]
    v_mfma_f32_16x16x32_bf16 v[36:39], a[108:111], v[172:175], v[36:39]
    v_mfma_f32_16x16x32_bf16 v[40:43], a[180:183], v[172:175], v[40:43]
    v_mfma_f32_16x16x32_bf16 v[44:47], a[252:255], v[172:175], v[44:47]
    v_mfma_f32_16x16x32_bf16 v[32:35], a[40:43], v[176:179], v[32:35]
    v_mfma_f32_16x16x32_bf16 v[36:39], a[112:115], v[176:179], v[36:39]
    v_mfma_f32_16x16x32_bf16 v[40:43], a[184:187], v[176:179], v[40:43]
    v_mfma_f32_16x16x32_bf16 v[44:47], v[224:227], v[176:179], v[44:47]
    v_mfma_f32_16x16x32_bf16 v[32:35], a[44:47], v[180:183], v[32:35]
    v_mfma_f32_16x16x32_bf16 v[36:39], a[116:119], v[180:183], v[36:39]
    v_mfma_f32_16x16x32_bf16 v[40:43], a[188:191], v[180:183], v[40:43]
    v_mfma_f32_16x16x32_bf16 v[44:47], v[228:231], v[180:183], v[44:47]
    v_mfma_f32_16x16x32_bf16 v[32:35], a[48:51], v[184:187], v[32:35]
    v_mfma_f32_16x16x32_bf16 v[36:39], a[120:123], v[184:187], v[36:39]
    v_mfma_f32_16x16x32_bf16 v[40:43], a[192:195], v[184:187], v[40:43]
    v_mfma_f32_16x16x32_bf16 v[44:47], v[232:235], v[184:187], v[44:47]
    v_mfma_f32_16x16x32_bf16 v[32:35], a[52:55], v[188:191], v[32:35]
    v_mfma_f32_16x16x32_bf16 v[36:39], a[124:127], v[188:191], v[36:39]
    v_mfma_f32_16x16x32_bf16 v[40:43], a[196:199], v[188:191], v[40:43]
    v_mfma_f32_16x16x32_bf16 v[44:47], v[236:239], v[188:191], v[44:47]
    v_mfma_f32_16x16x32_bf16 v[32:35], a[56:59], v[192:195], v[32:35]
    v_mfma_f32_16x16x32_bf16 v[36:39], a[128:131], v[192:195], v[36:39]
    v_mfma_f32_16x16x32_bf16 v[40:43], a[200:203], v[192:195], v[40:43]
    v_mfma_f32_16x16x32_bf16 v[44:47], v[240:243], v[192:195], v[44:47]
    v_mfma_f32_16x16x32_bf16 v[32:35], a[60:63], v[196:199], v[32:35]
    v_mfma_f32_16x16x32_bf16 v[36:39], a[132:135], v[196:199], v[36:39]
    v_mfma_f32_16x16x32_bf16 v[40:43], a[204:207], v[196:199], v[40:43]
    v_mfma_f32_16x16x32_bf16 v[44:47], v[244:247], v[196:199], v[44:47]
    v_mfma_f32_16x16x32_bf16 v[32:35], a[64:67], v[200:203], v[32:35]
    v_mfma_f32_16x16x32_bf16 v[36:39], a[136:139], v[200:203], v[36:39]
    v_mfma_f32_16x16x32_bf16 v[40:43], a[208:211], v[200:203], v[40:43]
    v_mfma_f32_16x16x32_bf16 v[44:47], v[248:251], v[200:203], v[44:47]
    v_mfma_f32_16x16x32_bf16 v[32:35], a[68:71], v[204:207], v[32:35]
    v_mfma_f32_16x16x32_bf16 v[36:39], a[140:143], v[204:207], v[36:39]
    v_mfma_f32_16x16x32_bf16 v[40:43], a[212:215], v[204:207], v[40:43]
    v_mfma_f32_16x16x32_bf16 v[44:47], v[252:255], v[204:207], v[44:47]
    s_nop 4
    v_cvt_pk_bf16_f32 v16, v32, v33
    v_cvt_pk_bf16_f32 v17, v34, v35
    v_cvt_pk_bf16_f32 v18, v36, v37
    v_cvt_pk_bf16_f32 v19, v38, v39
    v_cvt_pk_bf16_f32 v20, v40, v41
    v_cvt_pk_bf16_f32 v21, v42, v43
    v_cvt_pk_bf16_f32 v22, v44, v45
    v_cvt_pk_bf16_f32 v23, v46, v47
    s_add_u32 s60, s78, 110592
    buffer_store_dwordx4 v[16:19], v8, s[28:31], s60 offen
    buffer_store_dwordx4 v[20:23], v8, s[28:31], s60 offen offset:16
    s_nop 1
L_aend_186:
    s_waitcnt vmcnt(0)
    s_waitcnt vmcnt(0)
    s_barrier
    s_cmp_lg_u32 s4, 0
    s_cbranch_scc1 L_nowb_189
    s_lshl_b32 s60, s5, 5
    s_add_u32 s60, s60, 16
    v_mov_b32 v4, 1
    s_mov_b64 exec, 1
    buffer_atomic_add v4, off, s[12:15], s60 sc0 sc1
    s_waitcnt vmcnt(0)
    v_readfirstlane_b32 s61, v4
    s_mov_b64 exec, -1
    s_cmp_lg_u32 s61, 31
    s_cbranch_scc1 L_nowb_189
    buffer_wbl2 sc1
L_nowb_189:
L_exit:
    s_endpgm
.section .rodata,"a"
.p2align 6
.amdhsa_kernel concat_heads__mha_block__memory_aug_recurrent_mem_tr__prompt_kernel
  .amdhsa_next_free_vgpr 512
  .amdhsa_next_free_sgpr 102
  .amdhsa_accum_offset 256
  .amdhsa_group_segment_fixed_size 0
  .amdhsa_kernarg_size 104
  .amdhsa_user_sgpr_count 2
  .amdhsa_user_sgpr_kernarg_segment_ptr 1
  .amdhsa_system_sgpr_workgroup_id_x 1
.end_amdhsa_kernel
```
